```python
import torch

def _softmax(x, axis=-1):
    return torch.softmax(x, dim=axis)
def _gelu(x):
    return torch.nn.functional.gelu(x, approximate="tanh")
def _silu(x):
    return torch.nn.functional.silu(x)
def _sigmoid(x):
    return torch.sigmoid(x)
def _layernorm(x, axis=-1, eps=1e-5):
    m = x.mean(dim=axis, keepdim=True)
    v = x.var(dim=axis, keepdim=True, unbiased=False)
    return (x - m) / torch.sqrt(v + eps)
def _scatter_add(tgt, idx, src, axis=0):
    return tgt.clone().index_add_(axis, idx, src)
def _segment_sum(src, seg, n):
    out = torch.zeros((n,) + src.shape[1:], dtype=src.dtype)
    return out.index_add_(0, seg, src)
def _pad(x, pw):
    flat = tuple(v for pair in reversed(pw) for v in pair)
    return torch.nn.functional.pad(x, flat)

kernel_name = 'standalone__mha_block_cached__near_ridge'

def setup_inputs():

    _w = (lambda a: (lambda t: t.to(torch.bfloat16) if t.is_floating_point() else t)(torch.as_tensor(a)))
    B, Sq, D = 16, 112, 448
    H, Sk, Dh = 16, 512, 256
    return {
        "x": _w((lambda *s: torch.randn(*s, dtype=torch.bfloat16) * 0.8)(B, Sq, D)),
        "k_cache": _w((lambda *s: torch.randn(*s, dtype=torch.bfloat16) * 0.8)(B, H, Sk, Dh)),
        "v_cache": _w((lambda *s: torch.randn(*s, dtype=torch.bfloat16) * 0.05)(B, H, Sk, Dh)),
        "wq": _w((lambda *s: torch.randn(*s, dtype=torch.bfloat16) * 0.8)(D, H * Dh) * (D ** -0.5)),
        "wo": _w((lambda *s: torch.randn(*s, dtype=torch.bfloat16) * 0.05)(H * Dh, D) * ((H * Dh) ** -0.5)),
    }

def reference(x, k_cache, v_cache, wq, wo):
    B, Sq, D = x.shape
    H, Dh = 16, 256
    q = (lambda x, *d: x.permute(*d))((x @ wq).reshape(B, Sq, H, Dh), 0, 2, 1, 3)
    scores = torch.einsum("bhqd,bhkd->bhqk", q, k_cache) * (Dh ** -0.5)
    p = _softmax(scores, axis=-1)
    o = torch.einsum("bhqk,bhkd->bhqd", p, v_cache)
    return (lambda x, *d: x.permute(*d))(o, 0, 2, 1, 3).reshape(B, Sq, H * Dh) @ wo
```

```asm
; @launch kernel=standalone__mha_block_cached__near_ridge_kernel grid=(256,1,1) block=(256,1,1) lds=163840
; @launch kernel=mha_reduce_kernel grid=(224,1,1) block=(448,1,1) lds=0
.amdgcn_target "amdgcn-amd-amdhsa--gfx950"
.macro mf a0,a1,a2,a3
v_mfma_f32_16x16x32_bf16 \a0,\a1,\a2,\a3
.endm
.macro cvp a0,a1,a2
v_cvt_pk_bf16_f32 \a0,\a1,\a2
.endm
.macro ard a0,a1
v_accvgpr_read_b32 \a0,\a1
.endm
.macro awr a0,a1
v_accvgpr_write_b32 \a0,\a1
.endm
.macro trr d,a,o
ds_read_b64_tr_b16 \d,\a offset:\o
.endm
.text
.set CODE_SLICES,(L_pf_end-standalone__mha_block_cached__near_ridge_kernel)/1024
.globl standalone__mha_block_cached__near_ridge_kernel
.p2align 8
.type standalone__mha_block_cached__near_ridge_kernel,@function
standalone__mha_block_cached__near_ridge_kernel:
s_cmp_lt_u32 s2,256
s_cbranch_scc1 L_go
s_endpgm
L_go:
s_load_dwordx16 s[4:19],s[0:1],0
v_and_b32 v192,63,v0
v_lshrrev_b32 v176,6,v0
s_nop 0
v_readfirstlane_b32 s44,v176
s_getpc_b64 s[58:59]
L_pc:
s_sub_u32 s58,s58,L_pc-standalone__mha_block_cached__near_ridge_kernel
s_subb_u32 s59,s59,0
s_lshr_b32 s56,s2,3
s_lshl_b32 s56,s56,2
s_add_u32 s56,s56,s44
s_min_u32 s56,s56,CODE_SLICES-1
s_lshl_b32 s56,s56,10
v_and_b32 v178,15,v192
v_lshlrev_b32 v178,6,v178
v_add_u32 v178,s56,v178
global_load_dword v147,v178,s[58:59]
s_and_b32 s54,s2,3
s_lshl_b32 s54,s54,2
s_bfe_u32 s56,s2,0x20003
s_add_u32 s54,s54,s56
s_bfe_u32 s55,s2,0x10002
s_lshl_b32 s55,s55,3
s_lshr_b32 s56,s2,5
s_add_u32 s55,s55,s56
s_and_b32 s59,s54,3
s_lshl_b32 s59,s59,1
s_add_u32 s59,s59,s55
s_mul_i32 s56,s59,9363
s_lshr_b32 s56,s56,16
s_mul_i32 s56,s56,7
s_sub_u32 s56,s59,s56
s_lshl_b32 s92,s56,7
s_lshl_b32 s49,s44,12
s_mul_i32 s45,s44,28672
v_lshrrev_b32 v178,3,v192
v_mul_u32_u24 v178,896,v178
v_lshrrev_b32 v179,4,v192
v_and_b32 v180,7,v192
v_xor_b32 v180,v180,v179
v_lshl_add_u32 v212,v180,4,v178
v_xor_b32 v180,4,v180
v_lshl_add_u32 v213,v180,4,v178
v_add_u32 v214,12288,v212
v_add_u32 v213,6144,v213
v_add_u32 v215,12288,v213
s_mul_i32 s58,s55,100352
s_mov_b32 s22,100352
s_mov_b32 s23,0x20000
s_waitcnt lgkmcnt(0)
s_add_u32 s20,s4,s58
s_addc_u32 s21,s5,0
s_add_u32 m0,s49,0
s_add_u32 s48,s45,s92
buffer_load_dwordx4 v212,s[20:23],s48 offen lds
buffer_load_dwordx4 v213,s[20:23],s48 offen offset:1024 lds
buffer_load_dwordx4 v214,s[20:23],s48 offen offset:2048 lds
buffer_load_dwordx4 v215,s[20:23],s48 offen offset:3072 lds
s_lshl_b32 s52,s44,16
v_and_b32 v176,31,v192
v_lshrrev_b32 v177,5,v192
s_and_b32 s58,s44,1
s_lshl_b32 s58,s58,2
v_or_b32 v181,s58,v177
v_or_b32 v178,0,v181
v_lshlrev_b32 v178,1,v178
v_xor_b32 v178,v178,v176
v_lshlrev_b32 v178,4,v178
v_lshl_add_u32 v178,v177,13,v178
v_mov_b32 v216,v178
v_or_b32 v178,2,v181
v_lshlrev_b32 v178,1,v178
v_xor_b32 v178,v178,v176
v_lshlrev_b32 v178,4,v178
v_lshl_add_u32 v178,v177,13,v178
v_add_u32 v217,15360,v178
v_add_u32 v218,30720,v216
v_add_u32 v219,30720,v217
s_lshl_b32 s59,s54,9
s_sub_u32 s34,3670016,s59
s_mov_b32 s35,0x20000
s_add_u32 s32,s10,s59
s_addc_u32 s33,s11,0
s_add_u32 m0,s49,16384
s_lshl_b32 s48,s92,12
s_add_u32 s48,s48,s52
buffer_load_dwordx4 v216,s[32:35],s48 offen lds
buffer_load_dwordx4 v217,s[32:35],s48 offen offset:1024 lds
buffer_load_dwordx4 v218,s[32:35],s48 offen offset:2048 lds
buffer_load_dwordx4 v219,s[32:35],s48 offen offset:3072 lds
s_add_u32 m0,s49,32768
s_lshl_b32 s48,s92,12
s_add_u32 s48,s48,s52
s_add_u32 s48,s48,262144
buffer_load_dwordx4 v216,s[32:35],s48 offen lds
buffer_load_dwordx4 v217,s[32:35],s48 offen offset:1024 lds
buffer_load_dwordx4 v218,s[32:35],s48 offen offset:2048 lds
buffer_load_dwordx4 v219,s[32:35],s48 offen offset:3072 lds
s_add_u32 s56,s56,1
s_cmp_eq_u32 s56,7
s_cselect_b32 s56,0,s56
s_lshl_b32 s93,s56,7
s_add_u32 s56,s56,1
s_cmp_eq_u32 s56,7
s_cselect_b32 s56,0,s56
s_lshl_b32 s94,s56,7
s_add_u32 s56,s56,1
s_cmp_eq_u32 s56,7
s_cselect_b32 s56,0,s56
s_lshl_b32 s95,s56,7
s_add_u32 s56,s56,1
s_cmp_eq_u32 s56,7
s_cselect_b32 s56,0,s56
s_lshl_b32 s96,s56,7
s_add_u32 s56,s56,1
s_cmp_eq_u32 s56,7
s_cselect_b32 s56,0,s56
s_lshl_b32 s97,s56,7
s_add_u32 s56,s56,1
s_cmp_eq_u32 s56,7
s_cselect_b32 s56,0,s56
s_lshl_b32 s98,s56,7
s_lshl_b32 s57,s55,4
s_add_u32 s57,s57,s54
s_lshl_b32 s58,s57,18
s_add_u32 s24,s6,s58
s_addc_u32 s25,s7,0
s_mov_b32 s26,0x40000
s_mov_b32 s27,0x20000
s_mov_b32 s50,s49
s_and_b32 s56,s44,1
s_lshl_b32 s56,s56,3
v_add_u32 v179,s56,v177
v_add_u32 v178,0,v179
v_xor_b32 v178,v178,v176
v_lshlrev_b32 v178,4,v178
v_lshl_add_u32 v208,v177,9,v178
v_add_u32 v178,2,v179
v_xor_b32 v178,v178,v176
v_lshlrev_b32 v178,4,v178
v_lshl_add_u32 v209,v177,9,v178
v_add_u32 v178,4,v179
v_xor_b32 v178,v178,v176
v_lshlrev_b32 v178,4,v178
v_lshl_add_u32 v210,v177,9,v178
v_add_u32 v178,6,v179
v_xor_b32 v178,v178,v176
v_lshlrev_b32 v178,4,v178
v_lshl_add_u32 v211,v177,9,v178
s_add_u32 m0,s49,49152
s_add_u32 s48,s50,0
buffer_load_dwordx4 v208,s[24:27],s48 offen nt lds
buffer_load_dwordx4 v209,s[24:27],s48 offen offset:1024 nt lds
buffer_load_dwordx4 v210,s[24:27],s48 offen offset:2048 nt lds
buffer_load_dwordx4 v211,s[24:27],s48 offen offset:3072 nt lds
s_add_u32 s28,s8,s58
s_addc_u32 s29,s9,0
s_mov_b32 s30,0x40000
s_mov_b32 s31,0x20000
s_lshl_b32 s51,s44,13
s_mul_i32 s58,s54,229376
s_add_u32 s36,s12,s58
s_addc_u32 s37,s13,0
s_mov_b32 s38,229376
s_mov_b32 s39,0x20000
s_mul_i32 s53,s44,28672
s_mul_i32 s58,s57,114688
s_add_u32 s40,s18,s58
s_addc_u32 s41,s19,0
s_mov_b32 s42,114688
s_mov_b32 s43,0x20000
s_mov_b32 s46,0x3db8aa3b
s_mov_b32 s47,0x3db8aa3b
v_lshlrev_b32 v144,4,v192
v_add_u32 v207,s49,v144
v_bfe_u32 v178,v192,2,2
v_and_b32 v179,3,v192
v_lshrrev_b32 v180,4,v192
v_and_b32 v181,1,v180
v_lshl_or_b32 v181,v181,2,v178
v_lshl_add_u32 v182,v180,3,v178
v_lshlrev_b32 v182,9,v182
v_lshl_add_u32 v182,v179,3,v182
v_lshl_add_u32 v182,v181,5,v182
v_xor_b32 v193,0,v182
v_xor_b32 v194,32,v182
v_xor_b32 v195,64,v182
v_xor_b32 v196,96,v182
v_xor_b32 v197,128,v182
v_xor_b32 v198,160,v182
v_xor_b32 v199,192,v182
v_xor_b32 v200,224,v182
v_and_b32 v181,1,v180
v_lshrrev_b32 v183,1,v178
v_lshl_or_b32 v181,v181,1,v183
v_lshl_add_u32 v182,v180,2,v178
v_lshlrev_b32 v182,7,v182
v_lshl_add_u32 v182,v179,3,v182
v_lshl_add_u32 v182,v181,5,v182
v_xor_b32 v201,0,v182
v_xor_b32 v202,32,v182
v_xor_b32 v203,64,v182
v_xor_b32 v204,96,v182
v_bfe_u32 v181,v192,1,3
v_xor_b32 v181,v181,v180
v_lshlrev_b32 v181,4,v181
v_and_b32 v182,15,v192
v_lshl_add_u32 v181,v182,7,v181
v_add_u32 v205,s49,v181
v_xor_b32 v206,64,v205
s_mul_i32 s58,s44,28672
v_add_u32 v220,s58,v144
s_cmp_eq_u32 s44,3
s_mov_b32 s58,1024
s_cselect_b32 s58,0x7ff00000,s58
v_add_u32 v221,s58,v220
v_mov_b32 v222,0xff800000
s_mov_b32 s58,0xff800000
s_cselect_b32 s58,0x45800000,s58
v_mov_b32 v223,s58
s_waitcnt vmcnt(12)
s_waitcnt vmcnt(8)
s_barrier
ds_read_b128 a[64:67],v205
ds_read_b128 a[68:71],v205 offset:2048
ds_read_b128 a[72:75],v206
ds_read_b128 a[76:79],v206 offset:2048
trr a[224:225],v193,16384
trr a[226:227],v193,18432
trr a[228:229],v194,16384
trr a[230:231],v194,18432
trr a[232:233],v195,16384
trr a[234:235],v195,18432
trr a[236:237],v196,16384
trr a[238:239],v196,18432
trr a[240:241],v197,16384
trr a[242:243],v197,18432
trr a[244:245],v198,16384
s_waitcnt lgkmcnt(14)
trr a[246:247],v198,18432
s_cmp_eq_u32 s44,3
s_cbranch_scc1 L_wave3
s_waitcnt lgkmcnt(8)
trr a[248:249],v199,16384
mf v[0:3],a[224:227],a[64:67],0
trr a[250:251],v199,18432
mf v[4:7],a[224:227],a[68:71],0
trr a[252:253],v200,16384
trr a[254:255],v200,18432
s_add_u32 m0,s49,65536
mf v[12:15],a[228:231],a[68:71],0
s_add_u32 s48,s45,s93
buffer_load_dwordx4 v212,s[20:23],s48 offen lds
mf v[8:11],a[228:231],a[64:67],0
s_waitcnt lgkmcnt(8)
trr a[224:225],v193,16640
mf v[16:19],a[232:235],a[64:67],0
trr a[226:227],v193,18688
buffer_load_dwordx4 v213,s[20:23],s48 offen offset:1024 lds
mf v[20:23],a[232:235],a[68:71],0
trr a[228:229],v194,16640
trr a[230:231],v194,18688
mf v[28:31],a[236:239],a[68:71],0
buffer_load_dwordx4 v214,s[20:23],s48 offen offset:2048 lds
mf v[24:27],a[236:239],a[64:67],0
s_waitcnt lgkmcnt(8)
trr a[232:233],v195,16640
mf v[32:35],a[240:243],a[64:67],0
trr a[234:235],v195,18688
buffer_load_dwordx4 v215,s[20:23],s48 offen offset:3072 lds
mf v[36:39],a[240:243],a[68:71],0
trr a[236:237],v196,16640
trr a[238:239],v196,18688
s_add_u32 m0,s49,81920
mf v[44:47],a[244:247],a[68:71],0
s_lshl_b32 s48,s93,12
s_add_u32 s48,s48,s52
buffer_load_dwordx4 v216,s[32:35],s48 offen lds
mf v[40:43],a[244:247],a[64:67],0
s_waitcnt lgkmcnt(8)
trr a[240:241],v197,16640
mf v[48:51],a[248:251],a[64:67],0
trr a[242:243],v197,18688
buffer_load_dwordx4 v217,s[32:35],s48 offen offset:1024 lds
mf v[52:55],a[248:251],a[68:71],0
trr a[244:245],v198,16640
trr a[246:247],v198,18688
mf v[60:63],a[252:255],a[68:71],0
buffer_load_dwordx4 v218,s[32:35],s48 offen offset:2048 lds
mf v[56:59],a[252:255],a[64:67],0
s_waitcnt lgkmcnt(8)
trr a[248:249],v199,16640
mf v[64:67],a[224:227],a[64:67],0
trr a[250:251],v199,18688
buffer_load_dwordx4 v219,s[32:35],s48 offen offset:3072 lds
mf v[68:71],a[224:227],a[68:71],0
trr a[252:253],v200,16640
mf v[76:79],a[228:231],a[68:71],0
trr a[254:255],v200,18688
mf v[72:75],a[228:231],a[64:67],0
s_waitcnt lgkmcnt(8)
s_waitcnt vmcnt(12)
s_barrier
mf v[80:83],a[232:235],a[64:67],0
trr a[224:225],v193,32768
trr a[226:227],v193,34816
mf v[84:87],a[232:235],a[68:71],0
trr a[228:229],v194,32768
trr a[230:231],v194,34816
s_add_u32 m0,s49,0
s_lshl_b32 s48,s93,12
mf v[92:95],a[236:239],a[68:71],0
s_add_u32 s48,s48,s52
s_add_u32 s48,s48,262144
buffer_load_dwordx4 v216,s[32:35],s48 offen lds
mf v[88:91],a[236:239],a[64:67],0
s_waitcnt lgkmcnt(8)
trr a[232:233],v195,32768
mf v[96:99],a[240:243],a[64:67],0
trr a[234:235],v195,34816
mf v[100:103],a[240:243],a[68:71],0
trr a[236:237],v196,32768
mf v[108:111],a[244:247],a[68:71],0
trr a[238:239],v196,34816
mf v[104:107],a[244:247],a[64:67],0
s_waitcnt lgkmcnt(8)
trr a[240:241],v197,32768
mf v[112:115],a[248:251],a[64:67],0
trr a[242:243],v197,34816
buffer_load_dwordx4 v217,s[32:35],s48 offen offset:1024 lds
mf v[116:119],a[248:251],a[68:71],0
trr a[244:245],v198,32768
mf v[124:127],a[252:255],a[68:71],0
trr a[246:247],v198,34816
mf v[120:123],a[252:255],a[64:67],0
s_waitcnt lgkmcnt(8)
trr a[248:249],v199,32768
mf v[0:3],a[224:227],a[72:75],v[0:3]
trr a[250:251],v199,34816
mf v[4:7],a[224:227],a[76:79],v[4:7]
trr a[252:253],v200,32768
trr a[254:255],v200,34816
mf v[12:15],a[228:231],a[76:79],v[12:15]
buffer_load_dwordx4 v218,s[32:35],s48 offen offset:2048 lds
mf v[8:11],a[228:231],a[72:75],v[8:11]
s_waitcnt lgkmcnt(8)
trr a[224:225],v193,33024
mf v[16:19],a[232:235],a[72:75],v[16:19]
trr a[226:227],v193,35072
mf v[20:23],a[232:235],a[76:79],v[20:23]
trr a[228:229],v194,33024
mf v[28:31],a[236:239],a[76:79],v[28:31]
trr a[230:231],v194,35072
mf v[24:27],a[236:239],a[72:75],v[24:27]
s_waitcnt lgkmcnt(8)
trr a[232:233],v195,33024
mf v[32:35],a[240:243],a[72:75],v[32:35]
trr a[234:235],v195,35072
buffer_load_dwordx4 v219,s[32:35],s48 offen offset:3072 lds
mf v[36:39],a[240:243],a[76:79],v[36:39]
trr a[236:237],v196,33024
mf v[44:47],a[244:247],a[76:79],v[44:47]
trr a[238:239],v196,35072
mf v[40:43],a[244:247],a[72:75],v[40:43]
s_waitcnt lgkmcnt(8)
trr a[240:241],v197,33024
mf v[48:51],a[248:251],a[72:75],v[48:51]
trr a[242:243],v197,35072
mf v[52:55],a[248:251],a[76:79],v[52:55]
trr a[244:245],v198,33024
mf v[60:63],a[252:255],a[76:79],v[60:63]
trr a[246:247],v198,35072
mf v[56:59],a[252:255],a[72:75],v[56:59]
s_waitcnt lgkmcnt(8)
trr a[248:249],v199,33024
mf v[64:67],a[224:227],a[72:75],v[64:67]
trr a[250:251],v199,35072
mf v[68:71],a[224:227],a[76:79],v[68:71]
v_add_u32 v193,0x10000,v193
trr a[252:253],v200,33024
mf v[76:79],a[228:231],a[76:79],v[76:79]
trr a[254:255],v200,35072
mf v[72:75],a[228:231],a[72:75],v[72:75]
s_waitcnt lgkmcnt(8)
s_waitcnt vmcnt(4)
s_barrier
mf v[80:83],a[232:235],a[72:75],v[80:83]
v_add_u32 v194,0x10000,v194
trr a[224:225],v193,16384
trr a[226:227],v193,18432
mf v[84:87],a[232:235],a[76:79],v[84:87]
v_add_u32 v205,0x10000,v205
v_add_u32 v206,0x10000,v206
v_add_u32 v195,0x10000,v195
trr a[228:229],v194,16384
mf v[92:95],a[236:239],a[76:79],v[92:95]
trr a[230:231],v194,18432
s_add_u32 m0,s49,16384
s_add_u32 s48,s45,s94
buffer_load_dwordx4 v212,s[20:23],s48 offen lds
mf v[88:91],a[236:239],a[72:75],v[88:91]
s_waitcnt lgkmcnt(8)
ds_read_b128 a[80:83],v205
v_add_u32 v196,0x10000,v196
mf v[96:99],a[240:243],a[72:75],v[96:99]
trr a[232:233],v195,16384
trr a[234:235],v195,18432
buffer_load_dwordx4 v213,s[20:23],s48 offen offset:1024 lds
mf v[100:103],a[240:243],a[76:79],v[100:103]
ds_read_b128 a[84:87],v205 offset:2048
v_add_u32 v197,0x10000,v197
trr a[236:237],v196,16384
mf v[108:111],a[244:247],a[76:79],v[108:111]
trr a[238:239],v196,18432
buffer_load_dwordx4 v214,s[20:23],s48 offen offset:2048 lds
mf v[104:107],a[244:247],a[72:75],v[104:107]
s_waitcnt lgkmcnt(10)
ds_read_b128 a[88:91],v206
v_add_u32 v198,0x10000,v198
mf v[112:115],a[248:251],a[72:75],v[112:115]
trr a[240:241],v197,16384
trr a[242:243],v197,18432
buffer_load_dwordx4 v215,s[20:23],s48 offen offset:3072 lds
mf v[116:119],a[248:251],a[76:79],v[116:119]
ds_read_b128 a[92:95],v206 offset:2048
v_add_u32 v199,0x10000,v199
trr a[244:245],v198,16384
s_waitcnt lgkmcnt(14)
trr a[246:247],v198,18432
mf v[124:127],a[252:255],a[76:79],v[124:127]
s_add_u32 m0,s49,98304
s_lshl_b32 s48,s94,12
s_add_u32 s48,s48,s52
buffer_load_dwordx4 v216,s[32:35],s48 offen lds
mf v[120:123],a[252:255],a[72:75],v[120:123]
s_waitcnt lgkmcnt(12)
v_add_u32 v200,0x10000,v200
trr a[248:249],v199,16384
s_waitcnt lgkmcnt(12)
mf v[0:3],a[224:227],a[80:83],v[0:3]
trr a[250:251],v199,18432
buffer_load_dwordx4 v217,s[32:35],s48 offen offset:1024 lds
s_waitcnt lgkmcnt(10)
mf v[4:7],a[224:227],a[84:87],v[4:7]
trr a[252:253],v200,16384
trr a[254:255],v200,18432
mf v[12:15],a[228:231],a[84:87],v[12:15]
buffer_load_dwordx4 v218,s[32:35],s48 offen offset:2048 lds
mf v[8:11],a[228:231],a[80:83],v[8:11]
s_waitcnt lgkmcnt(10)
trr a[224:225],v193,16640
mf v[16:19],a[232:235],a[80:83],v[16:19]
trr a[226:227],v193,18688
buffer_load_dwordx4 v219,s[32:35],s48 offen offset:3072 lds
mf v[20:23],a[232:235],a[84:87],v[20:23]
trr a[228:229],v194,16640
trr a[230:231],v194,18688
mf v[28:31],a[236:239],a[84:87],v[28:31]
s_add_u32 s48,s50,16384
buffer_load_dwordx4 a[96:99],v208,s[24:27],s48 offen nt
mf v[24:27],a[236:239],a[80:83],v[24:27]
s_waitcnt lgkmcnt(8)
trr a[232:233],v195,16640
mf v[32:35],a[240:243],a[80:83],v[32:35]
trr a[234:235],v195,18688
buffer_load_dwordx4 a[100:103],v209,s[24:27],s48 offen offset:1024 nt
mf v[36:39],a[240:243],a[84:87],v[36:39]
trr a[236:237],v196,16640
trr a[238:239],v196,18688
mf v[44:47],a[244:247],a[84:87],v[44:47]
buffer_load_dwordx4 a[104:107],v210,s[24:27],s48 offen offset:2048 nt
mf v[40:43],a[244:247],a[80:83],v[40:43]
s_waitcnt lgkmcnt(8)
trr a[240:241],v197,16640
mf v[48:51],a[248:251],a[80:83],v[48:51]
trr a[242:243],v197,18688
buffer_load_dwordx4 a[108:111],v211,s[24:27],s48 offen offset:3072 nt
mf v[52:55],a[248:251],a[84:87],v[52:55]
trr a[244:245],v198,16640
mf v[60:63],a[252:255],a[84:87],v[60:63]
trr a[246:247],v198,18688
mf v[56:59],a[252:255],a[80:83],v[56:59]
s_waitcnt lgkmcnt(8)
trr a[248:249],v199,16640
mf v[64:67],a[224:227],a[80:83],v[64:67]
trr a[250:251],v199,18688
mf v[68:71],a[224:227],a[84:87],v[68:71]
v_add_u32 v193,0xffff0000,v193
trr a[252:253],v200,16640
mf v[76:79],a[228:231],a[84:87],v[76:79]
trr a[254:255],v200,18688
mf v[72:75],a[228:231],a[80:83],v[72:75]
s_waitcnt lgkmcnt(8)
s_waitcnt vmcnt(12)
s_barrier
mf v[80:83],a[232:235],a[80:83],v[80:83]
v_add_u32 v194,0xffff0000,v194
trr a[224:225],v193,0
trr a[226:227],v193,2048
mf v[84:87],a[232:235],a[84:87],v[84:87]
v_add_u32 v195,0xffff0000,v195
trr a[228:229],v194,0
trr a[230:231],v194,2048
s_add_u32 m0,s49,32768
mf v[92:95],a[236:239],a[84:87],v[92:95]
s_lshl_b32 s48,s94,12
s_add_u32 s48,s48,s52
s_add_u32 s48,s48,262144
buffer_load_dwordx4 v216,s[32:35],s48 offen lds
mf v[88:91],a[236:239],a[80:83],v[88:91]
s_waitcnt lgkmcnt(8)
v_add_u32 v196,0xffff0000,v196
mf v[96:99],a[240:243],a[80:83],v[96:99]
trr a[232:233],v195,0
trr a[234:235],v195,2048
mf v[100:103],a[240:243],a[84:87],v[100:103]
v_add_u32 v197,0xffff0000,v197
trr a[236:237],v196,0
mf v[108:111],a[244:247],a[84:87],v[108:111]
trr a[238:239],v196,2048
mf v[104:107],a[244:247],a[80:83],v[104:107]
s_waitcnt lgkmcnt(8)
v_add_u32 v198,0xffff0000,v198
trr a[240:241],v197,0
mf v[112:115],a[248:251],a[80:83],v[112:115]
trr a[242:243],v197,2048
buffer_load_dwordx4 v217,s[32:35],s48 offen offset:1024 lds
mf v[116:119],a[248:251],a[84:87],v[116:119]
v_add_u32 v199,0xffff0000,v199
trr a[244:245],v198,0
mf v[124:127],a[252:255],a[84:87],v[124:127]
trr a[246:247],v198,2048
mf v[120:123],a[252:255],a[80:83],v[120:123]
s_waitcnt lgkmcnt(8)
v_add_u32 v200,0xffff0000,v200
mf v[0:3],a[224:227],a[88:91],v[0:3]
trr a[248:249],v199,0
trr a[250:251],v199,2048
mf v[4:7],a[224:227],a[92:95],v[4:7]
trr a[252:253],v200,0
trr a[254:255],v200,2048
mf v[12:15],a[228:231],a[92:95],v[12:15]
buffer_load_dwordx4 v218,s[32:35],s48 offen offset:2048 lds
mf v[8:11],a[228:231],a[88:91],v[8:11]
s_waitcnt lgkmcnt(8)
trr a[224:225],v193,256
mf v[16:19],a[232:235],a[88:91],v[16:19]
trr a[226:227],v193,2304
mf v[20:23],a[232:235],a[92:95],v[20:23]
trr a[228:229],v194,256
mf v[28:31],a[236:239],a[92:95],v[28:31]
trr a[230:231],v194,2304
mf v[24:27],a[236:239],a[88:91],v[24:27]
s_waitcnt lgkmcnt(8)
trr a[232:233],v195,256
mf v[32:35],a[240:243],a[88:91],v[32:35]
trr a[234:235],v195,2304
buffer_load_dwordx4 v219,s[32:35],s48 offen offset:3072 lds
mf v[36:39],a[240:243],a[92:95],v[36:39]
trr a[236:237],v196,256
mf v[44:47],a[244:247],a[92:95],v[44:47]
trr a[238:239],v196,2304
mf v[40:43],a[244:247],a[88:91],v[40:43]
s_waitcnt lgkmcnt(8)
trr a[240:241],v197,256
mf v[48:51],a[248:251],a[88:91],v[48:51]
trr a[242:243],v197,2304
mf v[52:55],a[248:251],a[92:95],v[52:55]
trr a[244:245],v198,256
mf v[60:63],a[252:255],a[92:95],v[60:63]
trr a[246:247],v198,2304
mf v[56:59],a[252:255],a[88:91],v[56:59]
s_waitcnt lgkmcnt(8)
trr a[248:249],v199,256
mf v[64:67],a[224:227],a[88:91],v[64:67]
trr a[250:251],v199,2304
mf v[68:71],a[224:227],a[92:95],v[68:71]
v_add_u32 v193,0x10000,v193
trr a[252:253],v200,256
mf v[76:79],a[228:231],a[92:95],v[76:79]
trr a[254:255],v200,2304
mf v[72:75],a[228:231],a[88:91],v[72:75]
s_waitcnt lgkmcnt(8)
s_waitcnt vmcnt(8)
s_barrier
mf v[80:83],a[232:235],a[88:91],v[80:83]
v_add_u32 v194,0x10000,v194
trr a[224:225],v193,32768
trr a[226:227],v193,34816
mf v[84:87],a[232:235],a[92:95],v[84:87]
v_add_u32 v205,0xffff0000,v205
v_add_u32 v206,0xffff0000,v206
v_add_u32 v195,0x10000,v195
trr a[228:229],v194,32768
mf v[92:95],a[236:239],a[92:95],v[92:95]
trr a[230:231],v194,34816
s_add_u32 m0,s49,65536
s_add_u32 s48,s45,s95
buffer_load_dwordx4 v212,s[20:23],s48 offen lds
mf v[88:91],a[236:239],a[88:91],v[88:91]
s_waitcnt lgkmcnt(8)
ds_read_b128 a[64:67],v205 offset:16384
v_add_u32 v196,0x10000,v196
mf v[96:99],a[240:243],a[88:91],v[96:99]
trr a[232:233],v195,32768
trr a[234:235],v195,34816
buffer_load_dwordx4 v213,s[20:23],s48 offen offset:1024 lds
mf v[100:103],a[240:243],a[92:95],v[100:103]
ds_read_b128 a[68:71],v205 offset:18432
v_add_u32 v197,0x10000,v197
trr a[236:237],v196,32768
mf v[108:111],a[244:247],a[92:95],v[108:111]
trr a[238:239],v196,34816
buffer_load_dwordx4 v214,s[20:23],s48 offen offset:2048 lds
mf v[104:107],a[244:247],a[88:91],v[104:107]
s_waitcnt lgkmcnt(10)
ds_read_b128 a[72:75],v206 offset:16384
v_add_u32 v198,0x10000,v198
mf v[112:115],a[248:251],a[88:91],v[112:115]
trr a[240:241],v197,32768
trr a[242:243],v197,34816
buffer_load_dwordx4 v215,s[20:23],s48 offen offset:3072 lds
mf v[116:119],a[248:251],a[92:95],v[116:119]
ds_read_b128 a[76:79],v206 offset:18432
v_add_u32 v199,0x10000,v199
trr a[244:245],v198,32768
s_waitcnt lgkmcnt(14)
trr a[246:247],v198,34816
mf v[124:127],a[252:255],a[92:95],v[124:127]
s_add_u32 m0,s49,81920
s_lshl_b32 s48,s95,12
s_add_u32 s48,s48,s52
buffer_load_dwordx4 v216,s[32:35],s48 offen lds
mf v[120:123],a[252:255],a[88:91],v[120:123]
s_waitcnt lgkmcnt(12)
v_add_u32 v200,0x10000,v200
trr a[248:249],v199,32768
s_waitcnt lgkmcnt(12)
mf v[0:3],a[224:227],a[64:67],v[0:3]
trr a[250:251],v199,34816
buffer_load_dwordx4 v217,s[32:35],s48 offen offset:1024 lds
s_waitcnt lgkmcnt(10)
mf v[4:7],a[224:227],a[68:71],v[4:7]
trr a[252:253],v200,32768
trr a[254:255],v200,34816
mf v[12:15],a[228:231],a[68:71],v[12:15]
buffer_load_dwordx4 v218,s[32:35],s48 offen offset:2048 lds
mf v[8:11],a[228:231],a[64:67],v[8:11]
s_waitcnt lgkmcnt(10)
trr a[224:225],v193,33024
mf v[16:19],a[232:235],a[64:67],v[16:19]
trr a[226:227],v193,35072
buffer_load_dwordx4 v219,s[32:35],s48 offen offset:3072 lds
mf v[20:23],a[232:235],a[68:71],v[20:23]
trr a[228:229],v194,33024
trr a[230:231],v194,35072
s_add_u32 m0,s49,114688
mf v[28:31],a[236:239],a[68:71],v[28:31]
s_add_u32 s48,s50,32768
buffer_load_dwordx4 v208,s[24:27],s48 offen nt lds
mf v[24:27],a[236:239],a[64:67],v[24:27]
s_waitcnt lgkmcnt(8)
trr a[232:233],v195,33024
mf v[32:35],a[240:243],a[64:67],v[32:35]
trr a[234:235],v195,35072
buffer_load_dwordx4 v209,s[24:27],s48 offen offset:1024 nt lds
mf v[36:39],a[240:243],a[68:71],v[36:39]
trr a[236:237],v196,33024
trr a[238:239],v196,35072
mf v[44:47],a[244:247],a[68:71],v[44:47]
buffer_load_dwordx4 v210,s[24:27],s48 offen offset:2048 nt lds
mf v[40:43],a[244:247],a[64:67],v[40:43]
s_waitcnt lgkmcnt(8)
trr a[240:241],v197,33024
mf v[48:51],a[248:251],a[64:67],v[48:51]
trr a[242:243],v197,35072
buffer_load_dwordx4 v211,s[24:27],s48 offen offset:3072 nt lds
mf v[52:55],a[248:251],a[68:71],v[52:55]
trr a[244:245],v198,33024
mf v[60:63],a[252:255],a[68:71],v[60:63]
trr a[246:247],v198,35072
mf v[56:59],a[252:255],a[64:67],v[56:59]
s_waitcnt lgkmcnt(8)
trr a[248:249],v199,33024
mf v[64:67],a[224:227],a[64:67],v[64:67]
trr a[250:251],v199,35072
mf v[68:71],a[224:227],a[68:71],v[68:71]
v_add_u32 v193,0xffff0000,v193
trr a[252:253],v200,33024
mf v[76:79],a[228:231],a[68:71],v[76:79]
trr a[254:255],v200,35072
mf v[72:75],a[228:231],a[64:67],v[72:75]
s_waitcnt lgkmcnt(8)
s_waitcnt vmcnt(12)
s_barrier
mf v[80:83],a[232:235],a[64:67],v[80:83]
v_add_u32 v194,0xffff0000,v194
trr a[224:225],v193,32768
trr a[226:227],v193,34816
mf v[84:87],a[232:235],a[68:71],v[84:87]
v_add_u32 v195,0xffff0000,v195
trr a[228:229],v194,32768
trr a[230:231],v194,34816
s_add_u32 m0,s49,0
mf v[92:95],a[236:239],a[68:71],v[92:95]
s_lshl_b32 s48,s95,12
s_add_u32 s48,s48,s52
s_add_u32 s48,s48,262144
buffer_load_dwordx4 v216,s[32:35],s48 offen lds
mf v[88:91],a[236:239],a[64:67],v[88:91]
s_waitcnt lgkmcnt(8)
v_add_u32 v196,0xffff0000,v196
mf v[96:99],a[240:243],a[64:67],v[96:99]
trr a[232:233],v195,32768
trr a[234:235],v195,34816
mf v[100:103],a[240:243],a[68:71],v[100:103]
v_add_u32 v197,0xffff0000,v197
trr a[236:237],v196,32768
mf v[108:111],a[244:247],a[68:71],v[108:111]
trr a[238:239],v196,34816
mf v[104:107],a[244:247],a[64:67],v[104:107]
s_waitcnt lgkmcnt(8)
v_add_u32 v198,0xffff0000,v198
trr a[240:241],v197,32768
mf v[112:115],a[248:251],a[64:67],v[112:115]
trr a[242:243],v197,34816
buffer_load_dwordx4 v217,s[32:35],s48 offen offset:1024 lds
mf v[116:119],a[248:251],a[68:71],v[116:119]
v_add_u32 v199,0xffff0000,v199
trr a[244:245],v198,32768
mf v[124:127],a[252:255],a[68:71],v[124:127]
trr a[246:247],v198,34816
mf v[120:123],a[252:255],a[64:67],v[120:123]
s_waitcnt lgkmcnt(8)
v_add_u32 v200,0xffff0000,v200
mf v[0:3],a[224:227],a[72:75],v[0:3]
trr a[248:249],v199,32768
trr a[250:251],v199,34816
mf v[4:7],a[224:227],a[76:79],v[4:7]
trr a[252:253],v200,32768
trr a[254:255],v200,34816
mf v[12:15],a[228:231],a[76:79],v[12:15]
buffer_load_dwordx4 v218,s[32:35],s48 offen offset:2048 lds
mf v[8:11],a[228:231],a[72:75],v[8:11]
s_waitcnt lgkmcnt(8)
trr a[224:225],v193,33024
mf v[16:19],a[232:235],a[72:75],v[16:19]
trr a[226:227],v193,35072
mf v[20:23],a[232:235],a[76:79],v[20:23]
trr a[228:229],v194,33024
mf v[28:31],a[236:239],a[76:79],v[28:31]
trr a[230:231],v194,35072
mf v[24:27],a[236:239],a[72:75],v[24:27]
s_waitcnt lgkmcnt(8)
trr a[232:233],v195,33024
mf v[32:35],a[240:243],a[72:75],v[32:35]
trr a[234:235],v195,35072
buffer_load_dwordx4 v219,s[32:35],s48 offen offset:3072 lds
mf v[36:39],a[240:243],a[76:79],v[36:39]
trr a[236:237],v196,33024
mf v[44:47],a[244:247],a[76:79],v[44:47]
trr a[238:239],v196,35072
mf v[40:43],a[244:247],a[72:75],v[40:43]
s_waitcnt lgkmcnt(8)
trr a[240:241],v197,33024
mf v[48:51],a[248:251],a[72:75],v[48:51]
trr a[242:243],v197,35072
mf v[52:55],a[248:251],a[76:79],v[52:55]
trr a[244:245],v198,33024
mf v[60:63],a[252:255],a[76:79],v[60:63]
trr a[246:247],v198,35072
mf v[56:59],a[252:255],a[72:75],v[56:59]
s_waitcnt lgkmcnt(8)
trr a[248:249],v199,33024
mf v[64:67],a[224:227],a[72:75],v[64:67]
trr a[250:251],v199,35072
mf v[68:71],a[224:227],a[76:79],v[68:71]
v_add_u32 v193,0x10000,v193
trr a[252:253],v200,33024
mf v[76:79],a[228:231],a[76:79],v[76:79]
trr a[254:255],v200,35072
mf v[72:75],a[228:231],a[72:75],v[72:75]
s_waitcnt lgkmcnt(8)
s_waitcnt vmcnt(8)
s_barrier
mf v[80:83],a[232:235],a[72:75],v[80:83]
v_add_u32 v194,0x10000,v194
trr a[224:225],v193,16384
trr a[226:227],v193,18432
mf v[84:87],a[232:235],a[76:79],v[84:87]
v_add_u32 v205,0x10000,v205
v_add_u32 v206,0x10000,v206
v_add_u32 v195,0x10000,v195
trr a[228:229],v194,16384
mf v[92:95],a[236:239],a[76:79],v[92:95]
trr a[230:231],v194,18432
s_add_u32 m0,s49,16384
s_add_u32 s48,s45,s96
buffer_load_dwordx4 v212,s[20:23],s48 offen lds
mf v[88:91],a[236:239],a[72:75],v[88:91]
s_waitcnt lgkmcnt(8)
ds_read_b128 a[80:83],v205
v_add_u32 v196,0x10000,v196
mf v[96:99],a[240:243],a[72:75],v[96:99]
trr a[232:233],v195,16384
trr a[234:235],v195,18432
buffer_load_dwordx4 v213,s[20:23],s48 offen offset:1024 lds
mf v[100:103],a[240:243],a[76:79],v[100:103]
ds_read_b128 a[84:87],v205 offset:2048
v_add_u32 v197,0x10000,v197
trr a[236:237],v196,16384
mf v[108:111],a[244:247],a[76:79],v[108:111]
trr a[238:239],v196,18432
buffer_load_dwordx4 v214,s[20:23],s48 offen offset:2048 lds
mf v[104:107],a[244:247],a[72:75],v[104:107]
s_waitcnt lgkmcnt(10)
ds_read_b128 a[88:91],v206
v_add_u32 v198,0x10000,v198
mf v[112:115],a[248:251],a[72:75],v[112:115]
trr a[240:241],v197,16384
trr a[242:243],v197,18432
buffer_load_dwordx4 v215,s[20:23],s48 offen offset:3072 lds
mf v[116:119],a[248:251],a[76:79],v[116:119]
ds_read_b128 a[92:95],v206 offset:2048
v_add_u32 v199,0x10000,v199
trr a[244:245],v198,16384
s_waitcnt lgkmcnt(14)
trr a[246:247],v198,18432
mf v[124:127],a[252:255],a[76:79],v[124:127]
s_add_u32 m0,s49,98304
s_lshl_b32 s48,s96,12
s_add_u32 s48,s48,s52
buffer_load_dwordx4 v216,s[32:35],s48 offen lds
mf v[120:123],a[252:255],a[72:75],v[120:123]
s_waitcnt lgkmcnt(12)
v_add_u32 v200,0x10000,v200
trr a[248:249],v199,16384
s_waitcnt lgkmcnt(12)
mf v[0:3],a[224:227],a[80:83],v[0:3]
trr a[250:251],v199,18432
buffer_load_dwordx4 v217,s[32:35],s48 offen offset:1024 lds
s_waitcnt lgkmcnt(10)
mf v[4:7],a[224:227],a[84:87],v[4:7]
trr a[252:253],v200,16384
trr a[254:255],v200,18432
mf v[12:15],a[228:231],a[84:87],v[12:15]
buffer_load_dwordx4 v218,s[32:35],s48 offen offset:2048 lds
mf v[8:11],a[228:231],a[80:83],v[8:11]
s_waitcnt lgkmcnt(10)
trr a[224:225],v193,16640
mf v[16:19],a[232:235],a[80:83],v[16:19]
trr a[226:227],v193,18688
buffer_load_dwordx4 v219,s[32:35],s48 offen offset:3072 lds
mf v[20:23],a[232:235],a[84:87],v[20:23]
trr a[228:229],v194,16640
trr a[230:231],v194,18688
mf v[28:31],a[236:239],a[84:87],v[28:31]
s_add_u32 s48,s50,49152
buffer_load_dwordx4 a[112:115],v208,s[24:27],s48 offen nt
mf v[24:27],a[236:239],a[80:83],v[24:27]
s_waitcnt lgkmcnt(8)
trr a[232:233],v195,16640
mf v[32:35],a[240:243],a[80:83],v[32:35]
trr a[234:235],v195,18688
buffer_load_dwordx4 a[116:119],v209,s[24:27],s48 offen offset:1024 nt
mf v[36:39],a[240:243],a[84:87],v[36:39]
trr a[236:237],v196,16640
trr a[238:239],v196,18688
mf v[44:47],a[244:247],a[84:87],v[44:47]
buffer_load_dwordx4 a[120:123],v210,s[24:27],s48 offen offset:2048 nt
mf v[40:43],a[244:247],a[80:83],v[40:43]
s_waitcnt lgkmcnt(8)
trr a[240:241],v197,16640
mf v[48:51],a[248:251],a[80:83],v[48:51]
trr a[242:243],v197,18688
buffer_load_dwordx4 a[124:127],v211,s[24:27],s48 offen offset:3072 nt
mf v[52:55],a[248:251],a[84:87],v[52:55]
trr a[244:245],v198,16640
mf v[60:63],a[252:255],a[84:87],v[60:63]
trr a[246:247],v198,18688
mf v[56:59],a[252:255],a[80:83],v[56:59]
s_waitcnt lgkmcnt(8)
trr a[248:249],v199,16640
mf v[64:67],a[224:227],a[80:83],v[64:67]
trr a[250:251],v199,18688
mf v[68:71],a[224:227],a[84:87],v[68:71]
v_add_u32 v193,0xffff0000,v193
trr a[252:253],v200,16640
mf v[76:79],a[228:231],a[84:87],v[76:79]
trr a[254:255],v200,18688
mf v[72:75],a[228:231],a[80:83],v[72:75]
s_waitcnt lgkmcnt(8)
s_waitcnt vmcnt(12)
s_barrier
mf v[80:83],a[232:235],a[80:83],v[80:83]
v_add_u32 v194,0xffff0000,v194
trr a[224:225],v193,0
trr a[226:227],v193,2048
mf v[84:87],a[232:235],a[84:87],v[84:87]
v_add_u32 v195,0xffff0000,v195
trr a[228:229],v194,0
trr a[230:231],v194,2048
s_add_u32 m0,s49,32768
mf v[92:95],a[236:239],a[84:87],v[92:95]
s_lshl_b32 s48,s96,12
s_add_u32 s48,s48,s52
s_add_u32 s48,s48,262144
buffer_load_dwordx4 v216,s[32:35],s48 offen lds
mf v[88:91],a[236:239],a[80:83],v[88:91]
s_waitcnt lgkmcnt(8)
v_add_u32 v196,0xffff0000,v196
mf v[96:99],a[240:243],a[80:83],v[96:99]
trr a[232:233],v195,0
trr a[234:235],v195,2048
mf v[100:103],a[240:243],a[84:87],v[100:103]
v_add_u32 v197,0xffff0000,v197
trr a[236:237],v196,0
mf v[108:111],a[244:247],a[84:87],v[108:111]
trr a[238:239],v196,2048
mf v[104:107],a[244:247],a[80:83],v[104:107]
s_waitcnt lgkmcnt(8)
v_add_u32 v198,0xffff0000,v198
trr a[240:241],v197,0
mf v[112:115],a[248:251],a[80:83],v[112:115]
trr a[242:243],v197,2048
buffer_load_dwordx4 v217,s[32:35],s48 offen offset:1024 lds
mf v[116:119],a[248:251],a[84:87],v[116:119]
v_add_u32 v199,0xffff0000,v199
trr a[244:245],v198,0
mf v[124:127],a[252:255],a[84:87],v[124:127]
trr a[246:247],v198,2048
mf v[120:123],a[252:255],a[80:83],v[120:123]
s_waitcnt lgkmcnt(8)
v_add_u32 v200,0xffff0000,v200
mf v[0:3],a[224:227],a[88:91],v[0:3]
trr a[248:249],v199,0
trr a[250:251],v199,2048
mf v[4:7],a[224:227],a[92:95],v[4:7]
trr a[252:253],v200,0
trr a[254:255],v200,2048
mf v[12:15],a[228:231],a[92:95],v[12:15]
buffer_load_dwordx4 v218,s[32:35],s48 offen offset:2048 lds
mf v[8:11],a[228:231],a[88:91],v[8:11]
s_waitcnt lgkmcnt(8)
trr a[224:225],v193,256
mf v[16:19],a[232:235],a[88:91],v[16:19]
trr a[226:227],v193,2304
mf v[20:23],a[232:235],a[92:95],v[20:23]
trr a[228:229],v194,256
mf v[28:31],a[236:239],a[92:95],v[28:31]
trr a[230:231],v194,2304
mf v[24:27],a[236:239],a[88:91],v[24:27]
s_waitcnt lgkmcnt(8)
trr a[232:233],v195,256
mf v[32:35],a[240:243],a[88:91],v[32:35]
trr a[234:235],v195,2304
buffer_load_dwordx4 v219,s[32:35],s48 offen offset:3072 lds
mf v[36:39],a[240:243],a[92:95],v[36:39]
trr a[236:237],v196,256
mf v[44:47],a[244:247],a[92:95],v[44:47]
trr a[238:239],v196,2304
mf v[40:43],a[244:247],a[88:91],v[40:43]
s_waitcnt lgkmcnt(8)
trr a[240:241],v197,256
mf v[48:51],a[248:251],a[88:91],v[48:51]
trr a[242:243],v197,2304
mf v[52:55],a[248:251],a[92:95],v[52:55]
trr a[244:245],v198,256
mf v[60:63],a[252:255],a[92:95],v[60:63]
trr a[246:247],v198,2304
mf v[56:59],a[252:255],a[88:91],v[56:59]
s_waitcnt lgkmcnt(8)
trr a[248:249],v199,256
mf v[64:67],a[224:227],a[88:91],v[64:67]
trr a[250:251],v199,2304
mf v[68:71],a[224:227],a[92:95],v[68:71]
v_add_u32 v193,0x10000,v193
trr a[252:253],v200,256
mf v[76:79],a[228:231],a[92:95],v[76:79]
trr a[254:255],v200,2304
mf v[72:75],a[228:231],a[88:91],v[72:75]
s_waitcnt lgkmcnt(8)
s_waitcnt vmcnt(8)
s_barrier
mf v[80:83],a[232:235],a[88:91],v[80:83]
v_add_u32 v194,0x10000,v194
trr a[224:225],v193,32768
trr a[226:227],v193,34816
mf v[84:87],a[232:235],a[92:95],v[84:87]
v_add_u32 v205,0xffff0000,v205
v_add_u32 v206,0xffff0000,v206
v_add_u32 v195,0x10000,v195
trr a[228:229],v194,32768
mf v[92:95],a[236:239],a[92:95],v[92:95]
trr a[230:231],v194,34816
s_add_u32 m0,s49,65536
s_add_u32 s48,s45,s97
buffer_load_dwordx4 v212,s[20:23],s48 offen lds
mf v[88:91],a[236:239],a[88:91],v[88:91]
s_waitcnt lgkmcnt(8)
ds_read_b128 a[64:67],v205 offset:16384
v_add_u32 v196,0x10000,v196
mf v[96:99],a[240:243],a[88:91],v[96:99]
trr a[232:233],v195,32768
trr a[234:235],v195,34816
buffer_load_dwordx4 v213,s[20:23],s48 offen offset:1024 lds
mf v[100:103],a[240:243],a[92:95],v[100:103]
ds_read_b128 a[68:71],v205 offset:18432
v_add_u32 v197,0x10000,v197
trr a[236:237],v196,32768
mf v[108:111],a[244:247],a[92:95],v[108:111]
trr a[238:239],v196,34816
buffer_load_dwordx4 v214,s[20:23],s48 offen offset:2048 lds
mf v[104:107],a[244:247],a[88:91],v[104:107]
s_waitcnt lgkmcnt(10)
ds_read_b128 a[72:75],v206 offset:16384
v_add_u32 v198,0x10000,v198
mf v[112:115],a[248:251],a[88:91],v[112:115]
trr a[240:241],v197,32768
trr a[242:243],v197,34816
buffer_load_dwordx4 v215,s[20:23],s48 offen offset:3072 lds
mf v[116:119],a[248:251],a[92:95],v[116:119]
ds_read_b128 a[76:79],v206 offset:18432
v_add_u32 v199,0x10000,v199
trr a[244:245],v198,32768
s_waitcnt lgkmcnt(14)
trr a[246:247],v198,34816
mf v[124:127],a[252:255],a[92:95],v[124:127]
s_add_u32 m0,s49,81920
s_lshl_b32 s48,s97,12
s_add_u32 s48,s48,s52
buffer_load_dwordx4 v216,s[32:35],s48 offen lds
mf v[120:123],a[252:255],a[88:91],v[120:123]
s_waitcnt lgkmcnt(12)
v_add_u32 v200,0x10000,v200
trr a[248:249],v199,32768
s_waitcnt lgkmcnt(12)
mf v[0:3],a[224:227],a[64:67],v[0:3]
trr a[250:251],v199,34816
buffer_load_dwordx4 v217,s[32:35],s48 offen offset:1024 lds
s_waitcnt lgkmcnt(10)
mf v[4:7],a[224:227],a[68:71],v[4:7]
trr a[252:253],v200,32768
trr a[254:255],v200,34816
mf v[12:15],a[228:231],a[68:71],v[12:15]
buffer_load_dwordx4 v218,s[32:35],s48 offen offset:2048 lds
mf v[8:11],a[228:231],a[64:67],v[8:11]
s_waitcnt lgkmcnt(10)
trr a[224:225],v193,33024
mf v[16:19],a[232:235],a[64:67],v[16:19]
trr a[226:227],v193,35072
buffer_load_dwordx4 v219,s[32:35],s48 offen offset:3072 lds
mf v[20:23],a[232:235],a[68:71],v[20:23]
trr a[228:229],v194,33024
trr a[230:231],v194,35072
s_add_u32 m0,s49,131072
mf v[28:31],a[236:239],a[68:71],v[28:31]
s_add_u32 s48,s50,65536
buffer_load_dwordx4 v208,s[24:27],s48 offen nt lds
mf v[24:27],a[236:239],a[64:67],v[24:27]
s_waitcnt lgkmcnt(8)
trr a[232:233],v195,33024
mf v[32:35],a[240:243],a[64:67],v[32:35]
trr a[234:235],v195,35072
buffer_load_dwordx4 v209,s[24:27],s48 offen offset:1024 nt lds
mf v[36:39],a[240:243],a[68:71],v[36:39]
trr a[236:237],v196,33024
trr a[238:239],v196,35072
mf v[44:47],a[244:247],a[68:71],v[44:47]
buffer_load_dwordx4 v210,s[24:27],s48 offen offset:2048 nt lds
mf v[40:43],a[244:247],a[64:67],v[40:43]
s_waitcnt lgkmcnt(8)
trr a[240:241],v197,33024
mf v[48:51],a[248:251],a[64:67],v[48:51]
trr a[242:243],v197,35072
buffer_load_dwordx4 v211,s[24:27],s48 offen offset:3072 nt lds
mf v[52:55],a[248:251],a[68:71],v[52:55]
trr a[244:245],v198,33024
mf v[60:63],a[252:255],a[68:71],v[60:63]
trr a[246:247],v198,35072
mf v[56:59],a[252:255],a[64:67],v[56:59]
s_waitcnt lgkmcnt(8)
trr a[248:249],v199,33024
mf v[64:67],a[224:227],a[64:67],v[64:67]
trr a[250:251],v199,35072
mf v[68:71],a[224:227],a[68:71],v[68:71]
v_add_u32 v193,0xffff0000,v193
trr a[252:253],v200,33024
mf v[76:79],a[228:231],a[68:71],v[76:79]
trr a[254:255],v200,35072
mf v[72:75],a[228:231],a[64:67],v[72:75]
s_waitcnt lgkmcnt(8)
s_waitcnt vmcnt(12)
s_barrier
mf v[80:83],a[232:235],a[64:67],v[80:83]
v_add_u32 v194,0xffff0000,v194
trr a[224:225],v193,32768
trr a[226:227],v193,34816
mf v[84:87],a[232:235],a[68:71],v[84:87]
v_add_u32 v195,0xffff0000,v195
trr a[228:229],v194,32768
trr a[230:231],v194,34816
ds_write_b128 v207,a[112:115]
mf v[92:95],a[236:239],a[68:71],v[92:95]
s_add_u32 m0,s49,16384
s_lshl_b32 s48,s97,12
s_add_u32 s48,s48,s52
s_add_u32 s48,s48,262144
buffer_load_dwordx4 v216,s[32:35],s48 offen lds
mf v[88:91],a[236:239],a[64:67],v[88:91]
s_waitcnt lgkmcnt(9)
v_add_u32 v196,0xffff0000,v196
mf v[96:99],a[240:243],a[64:67],v[96:99]
trr a[232:233],v195,32768
trr a[234:235],v195,34816
mf v[100:103],a[240:243],a[68:71],v[100:103]
v_add_u32 v197,0xffff0000,v197
trr a[236:237],v196,32768
trr a[238:239],v196,34816
mf v[108:111],a[244:247],a[68:71],v[108:111]
ds_write_b128 v207,a[116:119] offset:1024
buffer_load_dwordx4 v217,s[32:35],s48 offen offset:1024 lds
mf v[104:107],a[244:247],a[64:67],v[104:107]
s_waitcnt lgkmcnt(10)
v_add_u32 v198,0xffff0000,v198
mf v[112:115],a[248:251],a[64:67],v[112:115]
trr a[240:241],v197,32768
trr a[242:243],v197,34816
mf v[116:119],a[248:251],a[68:71],v[116:119]
v_add_u32 v199,0xffff0000,v199
trr a[244:245],v198,32768
trr a[246:247],v198,34816
mf v[124:127],a[252:255],a[68:71],v[124:127]
ds_write_b128 v207,a[120:123] offset:2048
buffer_load_dwordx4 v218,s[32:35],s48 offen offset:2048 lds
mf v[120:123],a[252:255],a[64:67],v[120:123]
s_waitcnt lgkmcnt(11)
v_add_u32 v200,0xffff0000,v200
mf v[0:3],a[224:227],a[72:75],v[0:3]
trr a[248:249],v199,32768
trr a[250:251],v199,34816
mf v[4:7],a[224:227],a[76:79],v[4:7]
trr a[252:253],v200,32768
trr a[254:255],v200,34816
mf v[12:15],a[228:231],a[76:79],v[12:15]
s_waitcnt lgkmcnt(14)
ds_write_b128 v207,a[124:127] offset:3072
buffer_load_dwordx4 v219,s[32:35],s48 offen offset:3072 lds
mf v[8:11],a[228:231],a[72:75],v[8:11]
s_waitcnt lgkmcnt(11)
trr a[224:225],v193,33024
mf v[16:19],a[232:235],a[72:75],v[16:19]
trr a[226:227],v193,35072
mf v[20:23],a[232:235],a[76:79],v[20:23]
trr a[228:229],v194,33024
trr a[230:231],v194,35072
mf v[28:31],a[236:239],a[76:79],v[28:31]
s_add_u32 s48,s50,81920
buffer_load_dwordx4 a[128:131],v208,s[24:27],s48 offen nt
mf v[24:27],a[236:239],a[72:75],v[24:27]
s_waitcnt lgkmcnt(10)
trr a[232:233],v195,33024
mf v[32:35],a[240:243],a[72:75],v[32:35]
trr a[234:235],v195,35072
mf v[36:39],a[240:243],a[76:79],v[36:39]
trr a[236:237],v196,33024
trr a[238:239],v196,35072
mf v[44:47],a[244:247],a[76:79],v[44:47]
buffer_load_dwordx4 a[132:135],v209,s[24:27],s48 offen offset:1024 nt
mf v[40:43],a[244:247],a[72:75],v[40:43]
s_waitcnt lgkmcnt(9)
trr a[240:241],v197,33024
mf v[48:51],a[248:251],a[72:75],v[48:51]
trr a[242:243],v197,35072
mf v[52:55],a[248:251],a[76:79],v[52:55]
trr a[244:245],v198,33024
trr a[246:247],v198,35072
mf v[60:63],a[252:255],a[76:79],v[60:63]
buffer_load_dwordx4 a[136:139],v210,s[24:27],s48 offen offset:2048 nt
mf v[56:59],a[252:255],a[72:75],v[56:59]
s_waitcnt lgkmcnt(8)
trr a[248:249],v199,33024
mf v[64:67],a[224:227],a[72:75],v[64:67]
trr a[250:251],v199,35072
mf v[68:71],a[224:227],a[76:79],v[68:71]
v_add_u32 v193,0x10000,v193
trr a[252:253],v200,33024
mf v[76:79],a[228:231],a[76:79],v[76:79]
trr a[254:255],v200,35072
buffer_load_dwordx4 a[140:143],v211,s[24:27],s48 offen offset:3072 nt
mf v[72:75],a[228:231],a[72:75],v[72:75]
s_waitcnt lgkmcnt(8)
s_waitcnt vmcnt(12)
s_barrier
mf v[80:83],a[232:235],a[72:75],v[80:83]
v_add_u32 v194,0x10000,v194
trr a[224:225],v193,16384
trr a[226:227],v193,18432
mf v[84:87],a[232:235],a[76:79],v[84:87]
v_add_u32 v205,0x10000,v205
v_add_u32 v206,0x10000,v206
v_add_u32 v195,0x10000,v195
trr a[228:229],v194,16384
mf v[92:95],a[236:239],a[76:79],v[92:95]
trr a[230:231],v194,18432
s_add_u32 m0,s49,98304
s_add_u32 s48,s45,s98
buffer_load_dwordx4 v212,s[20:23],s48 offen lds
mf v[88:91],a[236:239],a[72:75],v[88:91]
s_waitcnt lgkmcnt(8)
ds_read_b128 a[80:83],v205
v_add_u32 v196,0x10000,v196
mf v[96:99],a[240:243],a[72:75],v[96:99]
trr a[232:233],v195,16384
trr a[234:235],v195,18432
buffer_load_dwordx4 v213,s[20:23],s48 offen offset:1024 lds
mf v[100:103],a[240:243],a[76:79],v[100:103]
ds_read_b128 a[84:87],v205 offset:2048
v_add_u32 v197,0x10000,v197
trr a[236:237],v196,16384
mf v[108:111],a[244:247],a[76:79],v[108:111]
trr a[238:239],v196,18432
buffer_load_dwordx4 v214,s[20:23],s48 offen offset:2048 lds
mf v[104:107],a[244:247],a[72:75],v[104:107]
s_waitcnt lgkmcnt(10)
ds_read_b128 a[88:91],v206
v_add_u32 v198,0x10000,v198
mf v[112:115],a[248:251],a[72:75],v[112:115]
trr a[240:241],v197,16384
trr a[242:243],v197,18432
buffer_load_dwordx4 v215,s[20:23],s48 offen offset:3072 lds
mf v[116:119],a[248:251],a[76:79],v[116:119]
ds_read_b128 a[92:95],v206 offset:2048
v_add_u32 v199,0x10000,v199
trr a[244:245],v198,16384
s_waitcnt lgkmcnt(14)
trr a[246:247],v198,18432
mf v[124:127],a[252:255],a[76:79],v[124:127]
s_add_u32 m0,s49,147456
s_lshl_b32 s48,s98,12
s_add_u32 s48,s48,s52
buffer_load_dwordx4 v216,s[32:35],s48 offen lds
mf v[120:123],a[252:255],a[72:75],v[120:123]
s_waitcnt lgkmcnt(12)
v_add_u32 v200,0x10000,v200
trr a[248:249],v199,16384
s_waitcnt lgkmcnt(12)
mf v[0:3],a[224:227],a[80:83],v[0:3]
trr a[250:251],v199,18432
buffer_load_dwordx4 v217,s[32:35],s48 offen offset:1024 lds
s_waitcnt lgkmcnt(10)
mf v[4:7],a[224:227],a[84:87],v[4:7]
trr a[252:253],v200,16384
trr a[254:255],v200,18432
mf v[12:15],a[228:231],a[84:87],v[12:15]
buffer_load_dwordx4 v218,s[32:35],s48 offen offset:2048 lds
mf v[8:11],a[228:231],a[80:83],v[8:11]
s_waitcnt lgkmcnt(10)
trr a[224:225],v193,16640
mf v[16:19],a[232:235],a[80:83],v[16:19]
trr a[226:227],v193,18688
buffer_load_dwordx4 v219,s[32:35],s48 offen offset:3072 lds
mf v[20:23],a[232:235],a[84:87],v[20:23]
trr a[228:229],v194,16640
trr a[230:231],v194,18688
mf v[28:31],a[236:239],a[84:87],v[28:31]
s_add_u32 s48,s50,98304
buffer_load_dwordx4 a[144:147],v208,s[24:27],s48 offen nt
mf v[24:27],a[236:239],a[80:83],v[24:27]
s_waitcnt lgkmcnt(8)
trr a[232:233],v195,16640
mf v[32:35],a[240:243],a[80:83],v[32:35]
trr a[234:235],v195,18688
buffer_load_dwordx4 a[148:151],v209,s[24:27],s48 offen offset:1024 nt
mf v[36:39],a[240:243],a[84:87],v[36:39]
trr a[236:237],v196,16640
trr a[238:239],v196,18688
mf v[44:47],a[244:247],a[84:87],v[44:47]
buffer_load_dwordx4 a[152:155],v210,s[24:27],s48 offen offset:2048 nt
mf v[40:43],a[244:247],a[80:83],v[40:43]
s_waitcnt lgkmcnt(8)
trr a[240:241],v197,16640
mf v[48:51],a[248:251],a[80:83],v[48:51]
trr a[242:243],v197,18688
buffer_load_dwordx4 a[156:159],v211,s[24:27],s48 offen offset:3072 nt
mf v[52:55],a[248:251],a[84:87],v[52:55]
trr a[244:245],v198,16640
mf v[60:63],a[252:255],a[84:87],v[60:63]
trr a[246:247],v198,18688
mf v[56:59],a[252:255],a[80:83],v[56:59]
s_waitcnt lgkmcnt(8)
trr a[248:249],v199,16640
mf v[64:67],a[224:227],a[80:83],v[64:67]
trr a[250:251],v199,18688
mf v[68:71],a[224:227],a[84:87],v[68:71]
v_add_u32 v193,0xffff0000,v193
trr a[252:253],v200,16640
mf v[76:79],a[228:231],a[84:87],v[76:79]
trr a[254:255],v200,18688
mf v[72:75],a[228:231],a[80:83],v[72:75]
s_waitcnt lgkmcnt(8)
s_waitcnt vmcnt(16)
s_barrier
mf v[80:83],a[232:235],a[80:83],v[80:83]
v_add_u32 v194,0xffff0000,v194
trr a[224:225],v193,16384
trr a[226:227],v193,18432
mf v[84:87],a[232:235],a[84:87],v[84:87]
v_add_u32 v195,0xffff0000,v195
trr a[228:229],v194,16384
trr a[230:231],v194,18432
s_add_u32 m0,s49,32768
mf v[92:95],a[236:239],a[84:87],v[92:95]
s_lshl_b32 s48,s98,12
s_add_u32 s48,s48,s52
s_add_u32 s48,s48,262144
buffer_load_dwordx4 v216,s[32:35],s48 offen lds
mf v[88:91],a[236:239],a[80:83],v[88:91]
s_waitcnt lgkmcnt(8)
v_add_u32 v196,0xffff0000,v196
mf v[96:99],a[240:243],a[80:83],v[96:99]
trr a[232:233],v195,16384
trr a[234:235],v195,18432
mf v[100:103],a[240:243],a[84:87],v[100:103]
v_add_u32 v197,0xffff0000,v197
trr a[236:237],v196,16384
mf v[108:111],a[244:247],a[84:87],v[108:111]
trr a[238:239],v196,18432
buffer_load_dwordx4 v217,s[32:35],s48 offen offset:1024 lds
mf v[104:107],a[244:247],a[80:83],v[104:107]
s_waitcnt lgkmcnt(8)
v_add_u32 v198,0xffff0000,v198
mf v[112:115],a[248:251],a[80:83],v[112:115]
trr a[240:241],v197,16384
trr a[242:243],v197,18432
mf v[116:119],a[248:251],a[84:87],v[116:119]
v_add_u32 v199,0xffff0000,v199
trr a[244:245],v198,16384
mf v[124:127],a[252:255],a[84:87],v[124:127]
trr a[246:247],v198,18432
buffer_load_dwordx4 v218,s[32:35],s48 offen offset:2048 lds
mf v[120:123],a[252:255],a[80:83],v[120:123]
s_waitcnt lgkmcnt(8)
v_add_u32 v200,0xffff0000,v200
mf v[0:3],a[224:227],a[88:91],v[0:3]
trr a[248:249],v199,16384
trr a[250:251],v199,18432
mf v[4:7],a[224:227],a[92:95],v[4:7]
trr a[252:253],v200,16384
trr a[254:255],v200,18432
mf v[12:15],a[228:231],a[92:95],v[12:15]
buffer_load_dwordx4 v219,s[32:35],s48 offen offset:3072 lds
mf v[8:11],a[228:231],a[88:91],v[8:11]
s_waitcnt lgkmcnt(8)
trr a[224:225],v193,16640
mf v[16:19],a[232:235],a[88:91],v[16:19]
trr a[226:227],v193,18688
mf v[20:23],a[232:235],a[92:95],v[20:23]
trr a[228:229],v194,16640
trr a[230:231],v194,18688
mf v[28:31],a[236:239],a[92:95],v[28:31]
s_add_u32 s48,s50,114688
buffer_load_dwordx4 a[160:163],v208,s[24:27],s48 offen nt
mf v[24:27],a[236:239],a[88:91],v[24:27]
s_waitcnt lgkmcnt(8)
trr a[232:233],v195,16640
mf v[32:35],a[240:243],a[88:91],v[32:35]
trr a[234:235],v195,18688
mf v[36:39],a[240:243],a[92:95],v[36:39]
trr a[236:237],v196,16640
trr a[238:239],v196,18688
mf v[44:47],a[244:247],a[92:95],v[44:47]
buffer_load_dwordx4 a[164:167],v209,s[24:27],s48 offen offset:1024 nt
mf v[40:43],a[244:247],a[88:91],v[40:43]
s_waitcnt lgkmcnt(8)
trr a[240:241],v197,16640
mf v[48:51],a[248:251],a[88:91],v[48:51]
trr a[242:243],v197,18688
mf v[52:55],a[248:251],a[92:95],v[52:55]
trr a[244:245],v198,16640
trr a[246:247],v198,18688
mf v[60:63],a[252:255],a[92:95],v[60:63]
buffer_load_dwordx4 a[168:171],v210,s[24:27],s48 offen offset:2048 nt
mf v[56:59],a[252:255],a[88:91],v[56:59]
s_waitcnt lgkmcnt(8)
trr a[248:249],v199,16640
mf v[64:67],a[224:227],a[88:91],v[64:67]
trr a[250:251],v199,18688
mf v[68:71],a[224:227],a[92:95],v[68:71]
v_add_u32 v193,0x20000,v193
trr a[252:253],v200,16640
mf v[76:79],a[228:231],a[92:95],v[76:79]
trr a[254:255],v200,18688
buffer_load_dwordx4 a[172:175],v211,s[24:27],s48 offen offset:3072 nt
mf v[72:75],a[228:231],a[88:91],v[72:75]
s_waitcnt lgkmcnt(8)
s_waitcnt vmcnt(12)
s_barrier
mf v[80:83],a[232:235],a[88:91],v[80:83]
v_add_u32 v194,0x20000,v194
trr a[224:225],v193,16384
trr a[226:227],v193,18432
mf v[84:87],a[232:235],a[92:95],v[84:87]
v_add_u32 v195,0x20000,v195
trr a[228:229],v194,16384
trr a[230:231],v194,18432
mf v[92:95],a[236:239],a[92:95],v[92:95]
v_add_u32 v191,0x10000,v207
ds_write_b128 v191,a[96:99]
mf v[88:91],a[236:239],a[88:91],v[88:91]
s_waitcnt lgkmcnt(9)
ds_read_b128 a[64:67],v205 offset:32768
v_add_u32 v196,0x20000,v196
mf v[96:99],a[240:243],a[88:91],v[96:99]
trr a[232:233],v195,16384
trr a[234:235],v195,18432
mf v[100:103],a[240:243],a[92:95],v[100:103]
ds_read_b128 a[68:71],v205 offset:34816
v_add_u32 v197,0x20000,v197
trr a[236:237],v196,16384
mf v[108:111],a[244:247],a[92:95],v[108:111]
trr a[238:239],v196,18432
s_waitcnt lgkmcnt(14)
ds_write_b128 v191,a[100:103] offset:1024
mf v[104:107],a[244:247],a[88:91],v[104:107]
s_waitcnt lgkmcnt(12)
ds_read_b128 a[72:75],v206 offset:32768
v_add_u32 v198,0x20000,v198
mf v[112:115],a[248:251],a[88:91],v[112:115]
trr a[240:241],v197,16384
trr a[242:243],v197,18432
mf v[116:119],a[248:251],a[92:95],v[116:119]
s_waitcnt lgkmcnt(14)
ds_read_b128 a[76:79],v206 offset:34816
v_add_u32 v199,0x20000,v199
s_waitcnt lgkmcnt(14)
trr a[244:245],v198,16384
mf v[124:127],a[252:255],a[92:95],v[124:127]
s_waitcnt lgkmcnt(14)
trr a[246:247],v198,18432
s_waitcnt lgkmcnt(14)
ds_write_b128 v191,a[104:107] offset:2048
mf v[120:123],a[252:255],a[88:91],v[120:123]
v_add_u32 v200,0x20000,v200
s_waitcnt lgkmcnt(14)
trr a[248:249],v199,16384
s_waitcnt lgkmcnt(14)
mf v[0:3],a[224:227],a[64:67],v[0:3]
trr a[250:251],v199,18432
v_lshrrev_b32 v186,3,v192
s_waitcnt lgkmcnt(12)
mf v[4:7],a[224:227],a[68:71],v[4:7]
trr a[252:253],v200,16384
trr a[254:255],v200,18432
mf v[12:15],a[228:231],a[68:71],v[12:15]
ds_write_b128 v191,a[108:111] offset:3072
v_lshlrev_b32 v186,9,v186
mf v[8:11],a[228:231],a[64:67],v[8:11]
s_waitcnt lgkmcnt(13)
trr a[224:225],v193,16640
mf v[16:19],a[232:235],a[64:67],v[16:19]
trr a[226:227],v193,18688
v_lshrrev_b32 v187,4,v192
mf v[20:23],a[232:235],a[68:71],v[20:23]
s_waitcnt lgkmcnt(14)
trr a[228:229],v194,16640
s_waitcnt lgkmcnt(14)
trr a[230:231],v194,18688
mf v[28:31],a[236:239],a[68:71],v[28:31]
v_lshlrev_b32 v187,1,v187
mf v[24:27],a[236:239],a[64:67],v[24:27]
s_waitcnt lgkmcnt(10)
trr a[232:233],v195,16640
mf v[32:35],a[240:243],a[64:67],v[32:35]
trr a[234:235],v195,18688
v_and_b32 v188,7,v192
mf v[36:39],a[240:243],a[68:71],v[36:39]
trr a[236:237],v196,16640
trr a[238:239],v196,18688
mf v[44:47],a[244:247],a[68:71],v[44:47]
v_xor_b32 v187,v187,v188
mf v[40:43],a[244:247],a[64:67],v[40:43]
s_waitcnt lgkmcnt(9)
trr a[240:241],v197,16640
mf v[48:51],a[248:251],a[64:67],v[48:51]
trr a[242:243],v197,18688
v_lshl_add_u32 v212,v187,4,v186
mf v[52:55],a[248:251],a[68:71],v[52:55]
trr a[244:245],v198,16640
trr a[246:247],v198,18688
mf v[60:63],a[252:255],a[68:71],v[60:63]
v_add_u32 v213,3072,v212
mf v[56:59],a[252:255],a[64:67],v[56:59]
s_waitcnt lgkmcnt(8)
trr a[248:249],v199,16640
mf v[64:67],a[224:227],a[64:67],v[64:67]
trr a[250:251],v199,18688
v_add_u32 v214,6144,v212
mf v[68:71],a[224:227],a[68:71],v[68:71]
v_add_u32 v193,0xfffe0000,v193
trr a[252:253],v200,16640
mf v[76:79],a[228:231],a[68:71],v[76:79]
trr a[254:255],v200,18688
v_add_u32 v215,9216,v212
mf v[72:75],a[228:231],a[64:67],v[72:75]
s_waitcnt lgkmcnt(8)
s_waitcnt vmcnt(4)
s_barrier
v_add_u32 v194,0xfffe0000,v194
mf v[80:83],a[232:235],a[64:67],v[80:83]
trr a[224:225],v193,32768
trr a[226:227],v193,34816
s_lshl_b32 s51,s44,14
mf v[84:87],a[232:235],a[68:71],v[84:87]
v_add_u32 v195,0xfffe0000,v195
trr a[228:229],v194,32768
trr a[230:231],v194,34816
s_add_u32 m0,s49,16384
mf v[92:95],a[236:239],a[68:71],v[92:95]
s_add_u32 s48,s50,131072
buffer_load_dwordx4 v208,s[24:27],s48 offen nt lds
v_lshrrev_b32 v186,3,v192
v_mul_u32_u24 v186,896,v186
mf v[88:91],a[236:239],a[64:67],v[88:91]
s_waitcnt lgkmcnt(8)
v_add_u32 v196,0xfffe0000,v196
trr a[232:233],v195,32768
mf v[96:99],a[240:243],a[64:67],v[96:99]
trr a[234:235],v195,34816
v_lshrrev_b32 v187,4,v192
v_lshlrev_b32 v187,1,v187
mf v[100:103],a[240:243],a[68:71],v[100:103]
v_add_u32 v197,0xfffe0000,v197
trr a[236:237],v196,32768
trr a[238:239],v196,34816
mf v[108:111],a[244:247],a[68:71],v[108:111]
v_and_b32 v188,7,v192
v_xor_b32 v187,v187,v188
mf v[104:107],a[244:247],a[64:67],v[104:107]
s_waitcnt lgkmcnt(8)
v_add_u32 v198,0xfffe0000,v198
trr a[240:241],v197,32768
trr a[242:243],v197,34816
mf v[112:115],a[248:251],a[64:67],v[112:115]
buffer_load_dwordx4 v209,s[24:27],s48 offen offset:1024 nt lds
v_lshl_add_u32 v216,v187,4,v186
v_add_u32 v217,6144,v216
mf v[116:119],a[248:251],a[68:71],v[116:119]
v_add_u32 v199,0xfffe0000,v199
trr a[244:245],v198,32768
trr a[246:247],v198,34816
mf v[124:127],a[252:255],a[68:71],v[124:127]
s_mul_i32 s53,s44,14336
s_lshl_b32 s61,s44,11
mf v[120:123],a[252:255],a[64:67],v[120:123]
s_waitcnt lgkmcnt(8)
v_add_u32 v200,0xfffe0000,v200
mf v[0:3],a[224:227],a[72:75],v[0:3]
trr a[248:249],v199,32768
trr a[250:251],v199,34816
mf v[4:7],a[224:227],a[76:79],v[4:7]
trr a[252:253],v200,32768
trr a[254:255],v200,34816
mf v[12:15],a[228:231],a[76:79],v[12:15]
buffer_load_dwordx4 v210,s[24:27],s48 offen offset:2048 nt lds
mf v[8:11],a[228:231],a[72:75],v[8:11]
s_waitcnt lgkmcnt(8)
trr a[224:225],v193,33024
mf v[16:19],a[232:235],a[72:75],v[16:19]
trr a[226:227],v193,35072
mf v[20:23],a[232:235],a[76:79],v[20:23]
trr a[228:229],v194,33024
mf v[28:31],a[236:239],a[76:79],v[28:31]
trr a[230:231],v194,35072
mf v[24:27],a[236:239],a[72:75],v[24:27]
s_waitcnt lgkmcnt(8)
trr a[232:233],v195,33024
trr a[234:235],v195,35072
buffer_load_dwordx4 v211,s[24:27],s48 offen offset:3072 nt lds
v_mul_f32 v0,s46,v0
v_mul_f32 v1,s46,v1
v_mul_f32 v2,s46,v2
v_mul_f32 v3,s46,v3
v_mul_f32 v8,s46,v8
v_mul_f32 v9,s46,v9
v_mul_f32 v10,s46,v10
v_mul_f32 v11,s46,v11
cvp v180,v0,v1
cvp v181,v2,v3
cvp v182,v8,v9
cvp v183,v10,v11
s_nop 0
v_permlane32_swap_b32 v180,v182
v_permlane32_swap_b32 v181,v183
s_nop 0
v_permlane16_swap_b32 v180,v182
v_permlane16_swap_b32 v181,v183
awr a0,v180
awr a1,v181
mf v[32:35],a[240:243],a[72:75],v[32:35]
awr a2,v182
awr a3,v183
v_mul_f32 v4,s46,v4
v_mul_f32 v5,s46,v5
v_mul_f32 v6,s46,v6
v_mul_f32 v7,s46,v7
v_mul_f32 v12,s46,v12
v_mul_f32 v13,s46,v13
v_mul_f32 v14,s46,v14
v_mul_f32 v15,s46,v15
cvp v184,v4,v5
cvp v185,v6,v7
cvp v186,v12,v13
cvp v187,v14,v15
s_nop 0
v_permlane32_swap_b32 v184,v186
v_permlane32_swap_b32 v185,v187
s_nop 0
v_permlane16_swap_b32 v184,v186
v_permlane16_swap_b32 v185,v187
awr a4,v184
awr a5,v185
awr a6,v186
awr a7,v187
mf v[36:39],a[240:243],a[76:79],v[36:39]
trr a[236:237],v196,33024
mf v[44:47],a[244:247],a[76:79],v[44:47]
trr a[238:239],v196,35072
mf v[40:43],a[244:247],a[72:75],v[40:43]
s_waitcnt lgkmcnt(8)
trr a[240:241],v197,33024
trr a[242:243],v197,35072
v_mul_f32 v16,s46,v16
v_mul_f32 v17,s46,v17
v_mul_f32 v18,s46,v18
v_mul_f32 v19,s46,v19
v_mul_f32 v24,s46,v24
v_mul_f32 v25,s46,v25
v_mul_f32 v26,s46,v26
v_mul_f32 v27,s46,v27
cvp v180,v16,v17
cvp v181,v18,v19
cvp v182,v24,v25
cvp v183,v26,v27
s_nop 0
v_permlane32_swap_b32 v180,v182
v_permlane32_swap_b32 v181,v183
s_nop 0
v_permlane16_swap_b32 v180,v182
v_permlane16_swap_b32 v181,v183
awr a8,v180
awr a9,v181
awr a10,v182
mf v[48:51],a[248:251],a[72:75],v[48:51]
awr a11,v183
v_mul_f32 v20,s46,v20
v_mul_f32 v21,s46,v21
v_mul_f32 v22,s46,v22
v_mul_f32 v23,s46,v23
v_mul_f32 v28,s46,v28
v_mul_f32 v29,s46,v29
v_mul_f32 v30,s46,v30
v_mul_f32 v31,s46,v31
cvp v184,v20,v21
cvp v185,v22,v23
cvp v186,v28,v29
cvp v187,v30,v31
s_nop 0
v_permlane32_swap_b32 v184,v186
v_permlane32_swap_b32 v185,v187
s_nop 0
v_permlane16_swap_b32 v184,v186
v_permlane16_swap_b32 v185,v187
awr a12,v184
awr a13,v185
awr a14,v186
awr a15,v187
mf v[52:55],a[248:251],a[76:79],v[52:55]
trr a[244:245],v198,33024
mf v[60:63],a[252:255],a[76:79],v[60:63]
trr a[246:247],v198,35072
mf v[56:59],a[252:255],a[72:75],v[56:59]
s_waitcnt lgkmcnt(8)
trr a[248:249],v199,33024
trr a[250:251],v199,35072
v_mul_f32 v32,s46,v32
v_mul_f32 v33,s46,v33
v_mul_f32 v34,s46,v34
v_mul_f32 v35,s46,v35
v_mul_f32 v40,s46,v40
v_mul_f32 v41,s46,v41
v_mul_f32 v42,s46,v42
v_mul_f32 v43,s46,v43
cvp v180,v32,v33
cvp v181,v34,v35
cvp v182,v40,v41
cvp v183,v42,v43
s_nop 0
v_permlane32_swap_b32 v180,v182
v_permlane32_swap_b32 v181,v183
s_nop 0
v_permlane16_swap_b32 v180,v182
v_permlane16_swap_b32 v181,v183
awr a16,v180
awr a17,v181
awr a18,v182
mf v[64:67],a[224:227],a[72:75],v[64:67]
awr a19,v183
v_mul_f32 v36,s46,v36
v_mul_f32 v37,s46,v37
v_mul_f32 v38,s46,v38
v_mul_f32 v39,s46,v39
v_mul_f32 v44,s46,v44
v_mul_f32 v45,s46,v45
v_mul_f32 v46,s46,v46
v_mul_f32 v47,s46,v47
cvp v184,v36,v37
cvp v185,v38,v39
cvp v186,v44,v45
cvp v187,v46,v47
s_nop 0
v_permlane32_swap_b32 v184,v186
v_permlane32_swap_b32 v185,v187
s_nop 0
v_permlane16_swap_b32 v184,v186
v_permlane16_swap_b32 v185,v187
awr a20,v184
awr a21,v185
awr a22,v186
awr a23,v187
mf v[68:71],a[224:227],a[76:79],v[68:71]
trr a[252:253],v200,33024
mf v[76:79],a[228:231],a[76:79],v[76:79]
trr a[254:255],v200,35072
mf v[72:75],a[228:231],a[72:75],v[72:75]
s_waitcnt lgkmcnt(8)
s_barrier
v_and_b32 v176,15,v192
v_lshrrev_b32 v177,4,v192
v_xor_b32 v177,v177,v176
v_lshlrev_b32 v177,4,v177
v_lshl_add_u32 v177,v176,9,v177
v_xor_b32 v193,0,v177
v_xor_b32 v194,64,v177
v_xor_b32 v195,128,v177
v_xor_b32 v196,192,v177
ds_read_b128 a[224:227],v193 offset:49152
v_mul_f32 v48,s46,v48
v_mul_f32 v49,s46,v49
v_mul_f32 v50,s46,v50
v_mul_f32 v51,s46,v51
v_mul_f32 v56,s46,v56
v_mul_f32 v57,s46,v57
v_mul_f32 v58,s46,v58
v_mul_f32 v59,s46,v59
cvp v180,v48,v49
cvp v181,v50,v51
cvp v182,v56,v57
cvp v183,v58,v59
s_nop 0
v_permlane32_swap_b32 v180,v182
v_permlane32_swap_b32 v181,v183
mf v[80:83],a[232:235],a[72:75],v[80:83]
v_permlane16_swap_b32 v180,v182
v_permlane16_swap_b32 v181,v183
awr a24,v180
awr a25,v181
awr a26,v182
awr a27,v183
v_mul_f32 v52,s46,v52
v_mul_f32 v53,s46,v53
v_mul_f32 v54,s46,v54
v_mul_f32 v55,s46,v55
v_mul_f32 v60,s46,v60
v_mul_f32 v61,s46,v61
v_mul_f32 v62,s46,v62
v_mul_f32 v63,s46,v63
cvp v184,v52,v53
cvp v185,v54,v55
cvp v186,v60,v61
cvp v187,v62,v63
s_nop 0
v_permlane32_swap_b32 v184,v186
v_permlane32_swap_b32 v185,v187
s_nop 0
v_permlane16_swap_b32 v184,v186
v_permlane16_swap_b32 v185,v187
awr a28,v184
awr a29,v185
awr a30,v186
awr a31,v187
mf v[84:87],a[232:235],a[76:79],v[84:87]
ds_read_b128 a[228:231],v193 offset:57344
s_waitcnt vmcnt(4)
v_add_u32 v191,0x10000,v207
ds_write_b128 v191,a[160:163] offset:16384
mf v[92:95],a[236:239],a[76:79],v[92:95]
s_add_u32 m0,s49,98304
s_add_u32 s48,s50,147456
buffer_load_dwordx4 v208,s[24:27],s48 offen nt lds
mf v[88:91],a[236:239],a[72:75],v[88:91]
s_waitcnt lgkmcnt(7)
ds_read_b128 a[232:235],v194 offset:49152
v_mul_f32 v64,s46,v64
v_mul_f32 v65,s46,v65
v_mul_f32 v66,s46,v66
v_mul_f32 v67,s46,v67
v_mul_f32 v72,s46,v72
v_mul_f32 v73,s46,v73
v_mul_f32 v74,s46,v74
v_mul_f32 v75,s46,v75
cvp v180,v64,v65
cvp v181,v66,v67
cvp v182,v72,v73
cvp v183,v74,v75
s_nop 0
v_permlane32_swap_b32 v180,v182
v_permlane32_swap_b32 v181,v183
s_nop 0
v_permlane16_swap_b32 v180,v182
v_permlane16_swap_b32 v181,v183
awr a32,v180
awr a33,v181
awr a34,v182
mf v[96:99],a[240:243],a[72:75],v[96:99]
awr a35,v183
v_mul_f32 v68,s46,v68
v_mul_f32 v69,s46,v69
v_mul_f32 v70,s46,v70
v_mul_f32 v71,s46,v71
v_mul_f32 v76,s46,v76
v_mul_f32 v77,s46,v77
v_mul_f32 v78,s46,v78
v_mul_f32 v79,s46,v79
cvp v184,v68,v69
cvp v185,v70,v71
cvp v186,v76,v77
cvp v187,v78,v79
s_nop 0
v_permlane32_swap_b32 v184,v186
v_permlane32_swap_b32 v185,v187
s_nop 0
v_permlane16_swap_b32 v184,v186
v_permlane16_swap_b32 v185,v187
awr a36,v184
awr a37,v185
awr a38,v186
awr a39,v187
mf v[100:103],a[240:243],a[76:79],v[100:103]
ds_read_b128 a[236:239],v194 offset:57344
mf v[108:111],a[244:247],a[76:79],v[108:111]
ds_write_b128 v191,a[164:167] offset:17408
mf v[104:107],a[244:247],a[72:75],v[104:107]
s_waitcnt lgkmcnt(6)
ds_read_b128 a[240:243],v195 offset:49152
buffer_load_dwordx4 v209,s[24:27],s48 offen offset:1024 nt lds
v_mul_f32 v80,s46,v80
v_mul_f32 v81,s46,v81
v_mul_f32 v82,s46,v82
v_mul_f32 v83,s46,v83
v_mul_f32 v88,s46,v88
v_mul_f32 v89,s46,v89
v_mul_f32 v90,s46,v90
v_mul_f32 v91,s46,v91
cvp v180,v80,v81
cvp v181,v82,v83
cvp v182,v88,v89
cvp v183,v90,v91
s_nop 0
v_permlane32_swap_b32 v180,v182
v_permlane32_swap_b32 v181,v183
s_nop 0
v_permlane16_swap_b32 v180,v182
v_permlane16_swap_b32 v181,v183
awr a40,v180
awr a41,v181
awr a42,v182
mf v[112:115],a[248:251],a[72:75],v[112:115]
awr a43,v183
v_mul_f32 v84,s46,v84
v_mul_f32 v85,s46,v85
v_mul_f32 v86,s46,v86
v_mul_f32 v87,s46,v87
v_mul_f32 v92,s46,v92
v_mul_f32 v93,s46,v93
v_mul_f32 v94,s46,v94
v_mul_f32 v95,s46,v95
cvp v184,v84,v85
cvp v185,v86,v87
cvp v186,v92,v93
cvp v187,v94,v95
s_nop 0
v_permlane32_swap_b32 v184,v186
v_permlane32_swap_b32 v185,v187
s_nop 0
v_permlane16_swap_b32 v184,v186
v_permlane16_swap_b32 v185,v187
awr a44,v184
awr a45,v185
awr a46,v186
awr a47,v187
mf v[116:119],a[248:251],a[76:79],v[116:119]
ds_read_b128 a[244:247],v195 offset:57344
mf v[124:127],a[252:255],a[76:79],v[124:127]
ds_write_b128 v191,a[168:171] offset:18432
mf v[120:123],a[252:255],a[72:75],v[120:123]
s_waitcnt lgkmcnt(7)
ds_read_b128 a[248:251],v196 offset:49152
v_mul_f32 v96,s46,v96
v_mul_f32 v97,s46,v97
v_mul_f32 v98,s46,v98
v_mul_f32 v99,s46,v99
v_mul_f32 v104,s46,v104
v_mul_f32 v105,s46,v105
v_mul_f32 v106,s46,v106
v_mul_f32 v107,s46,v107
cvp v180,v96,v97
cvp v181,v98,v99
cvp v182,v104,v105
cvp v183,v106,v107
s_nop 0
v_permlane32_swap_b32 v180,v182
v_permlane32_swap_b32 v181,v183
s_nop 0
v_permlane16_swap_b32 v180,v182
v_permlane16_swap_b32 v181,v183
awr a48,v180
awr a49,v181
awr a50,v182
mf v[128:131],a[224:227],a[0:3],0
awr a51,v183
v_mul_f32 v100,s46,v100
v_mul_f32 v101,s46,v101
v_mul_f32 v102,s46,v102
v_mul_f32 v103,s46,v103
v_mul_f32 v108,s46,v108
v_mul_f32 v109,s46,v109
v_mul_f32 v110,s46,v110
v_mul_f32 v111,s46,v111
cvp v184,v100,v101
cvp v185,v102,v103
cvp v186,v108,v109
cvp v187,v110,v111
s_nop 0
v_permlane32_swap_b32 v184,v186
v_permlane32_swap_b32 v185,v187
s_nop 0
v_permlane16_swap_b32 v184,v186
v_permlane16_swap_b32 v185,v187
awr a52,v184
awr a53,v185
awr a54,v186
awr a55,v187
mf v[132:135],a[224:227],a[4:7],0
ds_read_b128 a[252:255],v196 offset:57344
ds_write_b128 v191,a[172:175] offset:19456
mf v[140:143],a[228:231],a[4:7],0
buffer_load_dwordx4 v210,s[24:27],s48 offen offset:2048 nt lds
mf v[136:139],a[228:231],a[0:3],0
s_waitcnt lgkmcnt(7)
ds_read_b128 a[224:227],v193 offset:49408
v_mul_f32 v112,s46,v112
v_mul_f32 v113,s46,v113
v_mul_f32 v114,s46,v114
v_mul_f32 v115,s46,v115
v_mul_f32 v120,s46,v120
v_mul_f32 v121,s46,v121
v_mul_f32 v122,s46,v122
v_mul_f32 v123,s46,v123
cvp v180,v112,v113
cvp v181,v114,v115
cvp v182,v120,v121
cvp v183,v122,v123
s_nop 0
v_permlane32_swap_b32 v180,v182
v_permlane32_swap_b32 v181,v183
s_nop 0
v_permlane16_swap_b32 v180,v182
v_permlane16_swap_b32 v181,v183
awr a56,v180
awr a57,v181
awr a58,v182
mf v[128:131],a[232:235],a[8:11],v[128:131]
awr a59,v183
v_mul_f32 v116,s46,v116
v_mul_f32 v117,s46,v117
v_mul_f32 v118,s46,v118
v_mul_f32 v119,s46,v119
v_mul_f32 v124,s46,v124
v_mul_f32 v125,s46,v125
v_mul_f32 v126,s46,v126
v_mul_f32 v127,s46,v127
cvp v184,v116,v117
cvp v185,v118,v119
cvp v186,v124,v125
cvp v187,v126,v127
s_nop 0
v_permlane32_swap_b32 v184,v186
v_permlane32_swap_b32 v185,v187
s_nop 0
v_permlane16_swap_b32 v184,v186
v_permlane16_swap_b32 v185,v187
awr a60,v184
awr a61,v185
awr a62,v186
awr a63,v187
mf v[132:135],a[232:235],a[12:15],v[132:135]
ds_read_b128 a[228:231],v193 offset:57600
mf v[140:143],a[236:239],a[12:15],v[140:143]
mf v[136:139],a[236:239],a[8:11],v[136:139]
s_waitcnt lgkmcnt(6)
ds_read_b128 a[232:235],v194 offset:49408
mf v[128:131],a[240:243],a[16:19],v[128:131]
buffer_load_dwordx4 v211,s[24:27],s48 offen offset:3072 nt lds
mf v[132:135],a[240:243],a[20:23],v[132:135]
ds_read_b128 a[236:239],v194 offset:57600
mf v[140:143],a[244:247],a[20:23],v[140:143]
mf v[136:139],a[244:247],a[16:19],v[136:139]
s_waitcnt lgkmcnt(5)
mf v[128:131],a[248:251],a[24:27],v[128:131]
ds_read_b128 a[240:243],v195 offset:49408
mf v[132:135],a[248:251],a[28:31],v[132:135]
ds_read_b128 a[244:247],v195 offset:57600
mf v[140:143],a[252:255],a[28:31],v[140:143]
mf v[136:139],a[252:255],a[24:27],v[136:139]
s_waitcnt lgkmcnt(4)
mf v[128:131],a[224:227],a[32:35],v[128:131]
ds_read_b128 a[248:251],v196 offset:49408
mf v[132:135],a[224:227],a[36:39],v[132:135]
v_add_u32 v193,0x10000,v193
mf v[140:143],a[228:231],a[36:39],v[140:143]
ds_read_b128 a[252:255],v196 offset:57600
mf v[136:139],a[228:231],a[32:35],v[136:139]
s_waitcnt lgkmcnt(4)
s_barrier
mf v[128:131],a[232:235],a[40:43],v[128:131]
ds_read_b128 a[224:227],v193
mf v[132:135],a[232:235],a[44:47],v[132:135]
v_add_u32 v194,0x10000,v194
ds_read_b128 a[228:231],v193 offset:8192
mf v[140:143],a[236:239],a[44:47],v[140:143]
ds_write_b128 v207,a[128:131] offset:32768
s_add_u32 s48,s50,163840
buffer_load_dwordx4 a[176:179],v208,s[24:27],s48 offen nt
mf v[136:139],a[236:239],a[40:43],v[136:139]
s_waitcnt lgkmcnt(5)
mf v[128:131],a[240:243],a[48:51],v[128:131]
ds_read_b128 a[232:235],v194
mf v[132:135],a[240:243],a[52:55],v[132:135]
v_add_u32 v195,0x10000,v195
ds_read_b128 a[236:239],v194 offset:8192
mf v[140:143],a[244:247],a[52:55],v[140:143]
ds_write_b128 v207,a[132:135] offset:33792
mf v[136:139],a[244:247],a[48:51],v[136:139]
s_waitcnt lgkmcnt(6)
ds_read_b128 a[240:243],v195
mf v[128:131],a[248:251],a[56:59],v[128:131]
buffer_load_dwordx4 a[180:183],v209,s[24:27],s48 offen offset:1024 nt
mf v[132:135],a[248:251],a[60:63],v[132:135]
v_add_u32 v196,0x10000,v196
ds_read_b128 a[244:247],v195 offset:8192
mf v[140:143],a[252:255],a[60:63],v[140:143]
ds_write_b128 v207,a[136:139] offset:34816
mf v[136:139],a[252:255],a[56:59],v[136:139]
s_waitcnt lgkmcnt(7)
mf v[144:147],a[224:227],a[0:3],0
ds_read_b128 a[248:251],v196
mf v[148:151],a[224:227],a[4:7],0
ds_read_b128 a[252:255],v196 offset:8192
ds_write_b128 v207,a[140:143] offset:35840
mf v[156:159],a[228:231],a[4:7],0
buffer_load_dwordx4 a[184:187],v210,s[24:27],s48 offen offset:2048 nt
mf v[152:155],a[228:231],a[0:3],0
s_waitcnt lgkmcnt(7)
mf v[144:147],a[232:235],a[8:11],v[144:147]
ds_read_b128 a[224:227],v193 offset:256
mf v[148:151],a[232:235],a[12:15],v[148:151]
ds_read_b128 a[228:231],v193 offset:8448
v_add_u32 v191,0x20000,v207
ds_write_b128 v191,a[144:147] offset:16384
v_max3_f32 v222,v128,v129,v130
mf v[156:159],a[236:239],a[12:15],v[156:159]
v_max3_f32 v223,v132,v133,v134
v_max3_f32 v222,v222,v131,v136
v_max3_f32 v223,v223,v135,v140
v_max3_f32 v222,v222,v137,v138
v_max3_f32 v223,v223,v141,v142
mf v[152:155],a[236:239],a[8:11],v[152:155]
s_waitcnt lgkmcnt(7)
ds_read_b128 a[232:235],v194 offset:256
buffer_load_dwordx4 a[188:191],v211,s[24:27],s48 offen offset:3072 nt
v_max_f32 v222,v222,v139
mf v[144:147],a[240:243],a[16:19],v[144:147]
v_max_f32 v223,v223,v143
v_mov_b32 v176,v222
v_mov_b32 v180,v223
s_nop 0
v_permlane32_swap_b32 v176,v222
mf v[148:151],a[240:243],a[20:23],v[148:151]
ds_read_b128 a[236:239],v194 offset:8448
ds_write_b128 v191,a[148:151] offset:17408
v_permlane32_swap_b32 v180,v223
v_max_f32 v222,v222,v176
mf v[156:159],a[244:247],a[20:23],v[156:159]
v_max_f32 v223,v223,v180
v_mov_b32 v176,v222
v_mov_b32 v180,v223
s_nop 0
v_permlane16_swap_b32 v176,v222
mf v[152:155],a[244:247],a[16:19],v[152:155]
s_waitcnt lgkmcnt(7)
ds_read_b128 a[240:243],v195 offset:256
v_permlane16_swap_b32 v180,v223
v_max_f32 v222,v222,v176
mf v[144:147],a[248:251],a[24:27],v[144:147]
v_max_f32 v223,v223,v180
v_ceil_f32 v222,v222
v_ceil_f32 v223,v223
mf v[148:151],a[248:251],a[28:31],v[148:151]
ds_read_b128 a[244:247],v195 offset:8448
ds_write_b128 v191,a[152:155] offset:18432
v_sub_f32 v226,0,v222
v_sub_f32 v230,0,v223
mf v[156:159],a[252:255],a[28:31],v[156:159]
v_sub_f32 v227,0,v222
v_sub_f32 v231,0,v223
v_sub_f32 v228,0,v222
mf v[152:155],a[252:255],a[24:27],v[152:155]
s_waitcnt lgkmcnt(7)
ds_read_b128 a[248:251],v196 offset:256
v_sub_f32 v232,0,v223
v_sub_f32 v229,0,v222
mf v[144:147],a[224:227],a[32:35],v[144:147]
v_sub_f32 v233,0,v223
v_sub_f32 v128,v128,v222
v_sub_f32 v132,v132,v223
v_sub_f32 v129,v129,v222
mf v[148:151],a[224:227],a[36:39],v[148:151]
ds_read_b128 a[252:255],v196 offset:8448
ds_write_b128 v191,a[156:159] offset:19456
v_sub_f32 v133,v133,v223
v_sub_f32 v130,v130,v222
mf v[156:159],a[228:231],a[36:39],v[156:159]
v_sub_f32 v134,v134,v223
v_exp_f32 v128,v128
v_exp_f32 v132,v132
mf v[152:155],a[228:231],a[32:35],v[152:155]
s_waitcnt lgkmcnt(7)
s_barrier
ds_read_b128 a[224:227],v193 offset:49152
v_sub_f32 v131,v131,v222
mf v[144:147],a[232:235],a[40:43],v[144:147]
v_sub_f32 v135,v135,v223
v_exp_f32 v129,v129
v_exp_f32 v133,v133
v_sub_f32 v136,v136,v222
v_sub_f32 v140,v140,v223
mf v[148:151],a[232:235],a[44:47],v[148:151]
ds_read_b128 a[228:231],v193 offset:57344
s_add_u32 m0,s49,49152
s_add_u32 s48,s50,180224
buffer_load_dwordx4 v208,s[24:27],s48 offen nt lds
v_exp_f32 v130,v130
mf v[156:159],a[236:239],a[44:47],v[156:159]
v_exp_f32 v134,v134
v_sub_f32 v137,v137,v222
v_sub_f32 v141,v141,v223
v_exp_f32 v131,v131
mf v[152:155],a[236:239],a[40:43],v[152:155]
s_waitcnt lgkmcnt(6)
ds_read_b128 a[232:235],v194 offset:49152
v_exp_f32 v135,v135
cvp v0,v128,v129
mf v[144:147],a[240:243],a[48:51],v[144:147]
cvp v4,v132,v133
v_sub_f32 v138,v138,v222
v_sub_f32 v142,v142,v223
mf v[148:151],a[240:243],a[52:55],v[148:151]
ds_read_b128 a[236:239],v194 offset:57344
buffer_load_dwordx4 v209,s[24:27],s48 offen offset:1024 nt lds
v_exp_f32 v136,v136
v_exp_f32 v140,v140
mf v[156:159],a[244:247],a[52:55],v[156:159]
v_sub_f32 v139,v139,v222
v_sub_f32 v143,v143,v223
v_exp_f32 v137,v137
v_exp_f32 v141,v141
mf v[152:155],a[244:247],a[48:51],v[152:155]
s_waitcnt lgkmcnt(5)
ds_read_b128 a[240:243],v195 offset:49152
cvp v1,v130,v131
cvp v5,v134,v135
mf v[144:147],a[248:251],a[56:59],v[144:147]
v_exp_f32 v138,v138
v_exp_f32 v142,v142
v_exp_f32 v139,v139
mf v[148:151],a[248:251],a[60:63],v[148:151]
ds_read_b128 a[244:247],v195 offset:57344
buffer_load_dwordx4 v210,s[24:27],s48 offen offset:2048 nt lds
v_exp_f32 v143,v143
cvp v2,v136,v137
mf v[156:159],a[252:255],a[60:63],v[156:159]
cvp v6,v140,v141
cvp v3,v138,v139
cvp v7,v142,v143
mf v[152:155],a[252:255],a[56:59],v[152:155]
s_waitcnt lgkmcnt(4)
mf v[160:163],a[224:227],a[0:3],v[226:229]
ds_read_b128 a[248:251],v196 offset:49152
mf v[164:167],a[224:227],a[4:7],v[230:233]
ds_read_b128 a[252:255],v196 offset:57344
mf v[172:175],a[228:231],a[4:7],v[230:233]
buffer_load_dwordx4 v211,s[24:27],s48 offen offset:3072 nt lds
mf v[168:171],a[228:231],a[0:3],v[226:229]
s_waitcnt lgkmcnt(4)
mf v[160:163],a[232:235],a[8:11],v[160:163]
ds_read_b128 a[224:227],v193 offset:49408
mf v[164:167],a[232:235],a[12:15],v[164:167]
ds_read_b128 a[228:231],v193 offset:57600
s_add_u32 s48,s50,196608
buffer_load_dwordx4 a[192:195],v208,s[24:27],s48 offen nt
mf v[172:175],a[236:239],a[12:15],v[172:175]
v_sub_f32 v144,v144,v222
v_sub_f32 v148,v148,v223
v_sub_f32 v145,v145,v222
mf v[168:171],a[236:239],a[8:11],v[168:171]
s_waitcnt lgkmcnt(4)
ds_read_b128 a[232:235],v194 offset:49408
mf v[160:163],a[240:243],a[16:19],v[160:163]
v_sub_f32 v149,v149,v223
v_sub_f32 v146,v146,v222
mf v[164:167],a[240:243],a[20:23],v[164:167]
ds_read_b128 a[236:239],v194 offset:57600
buffer_load_dwordx4 a[196:199],v209,s[24:27],s48 offen offset:1024 nt
v_sub_f32 v150,v150,v223
mf v[172:175],a[244:247],a[20:23],v[172:175]
v_exp_f32 v144,v144
v_exp_f32 v148,v148
mf v[168:171],a[244:247],a[16:19],v[168:171]
s_waitcnt lgkmcnt(4)
ds_read_b128 a[240:243],v195 offset:49408
mf v[160:163],a[248:251],a[24:27],v[160:163]
v_sub_f32 v147,v147,v222
v_sub_f32 v151,v151,v223
mf v[164:167],a[248:251],a[28:31],v[164:167]
ds_read_b128 a[244:247],v195 offset:57600
buffer_load_dwordx4 a[200:203],v210,s[24:27],s48 offen offset:2048 nt
v_exp_f32 v145,v145
mf v[172:175],a[252:255],a[28:31],v[172:175]
v_exp_f32 v149,v149
v_sub_f32 v152,v152,v222
mf v[168:171],a[252:255],a[24:27],v[168:171]
s_waitcnt lgkmcnt(4)
ds_read_b128 a[248:251],v196 offset:49408
mf v[160:163],a[224:227],a[32:35],v[160:163]
v_sub_f32 v156,v156,v223
v_exp_f32 v146,v146
mf v[164:167],a[224:227],a[36:39],v[164:167]
v_add_u32 v193,0xffff0000,v193
ds_read_b128 a[252:255],v196 offset:57600
buffer_load_dwordx4 a[204:207],v211,s[24:27],s48 offen offset:3072 nt
mf v[172:175],a[228:231],a[36:39],v[172:175]
v_exp_f32 v150,v150
v_sub_f32 v153,v153,v222
v_sub_f32 v157,v157,v223
mf v[168:171],a[228:231],a[32:35],v[168:171]
s_waitcnt lgkmcnt(4)
s_barrier
mf v[160:163],a[232:235],a[40:43],v[160:163]
ds_read_b128 a[224:227],v193
v_exp_f32 v147,v147
v_exp_f32 v151,v151
mf v[164:167],a[232:235],a[44:47],v[164:167]
v_add_u32 v194,0xffff0000,v194
ds_read_b128 a[228:231],v193 offset:8192
cvp v8,v144,v145
mf v[172:175],a[236:239],a[44:47],v[172:175]
cvp v12,v148,v149
v_sub_f32 v154,v154,v222
mf v[168:171],a[236:239],a[40:43],v[168:171]
s_waitcnt lgkmcnt(4)
ds_read_b128 a[232:235],v194
mf v[160:163],a[240:243],a[48:51],v[160:163]
v_sub_f32 v158,v158,v223
v_exp_f32 v152,v152
mf v[164:167],a[240:243],a[52:55],v[164:167]
v_add_u32 v195,0xffff0000,v195
ds_read_b128 a[236:239],v194 offset:8192
v_exp_f32 v156,v156
mf v[172:175],a[244:247],a[52:55],v[172:175]
v_sub_f32 v155,v155,v222
v_sub_f32 v159,v159,v223
mf v[168:171],a[244:247],a[48:51],v[168:171]
s_waitcnt lgkmcnt(4)
ds_read_b128 a[240:243],v195
mf v[160:163],a[248:251],a[56:59],v[160:163]
v_exp_f32 v153,v153
v_exp_f32 v157,v157
mf v[164:167],a[248:251],a[60:63],v[164:167]
v_add_u32 v196,0xffff0000,v196
ds_read_b128 a[244:247],v195 offset:8192
cvp v9,v146,v147
mf v[172:175],a[252:255],a[60:63],v[172:175]
cvp v13,v150,v151
v_exp_f32 v154,v154
mf v[168:171],a[252:255],a[56:59],v[168:171]
s_waitcnt lgkmcnt(4)
ds_read_b128 a[248:251],v196
mf v[128:131],a[224:227],a[0:3],v[226:229]
v_exp_f32 v158,v158
v_exp_f32 v155,v155
mf v[132:135],a[224:227],a[4:7],v[230:233]
ds_read_b128 a[252:255],v196 offset:8192
v_exp_f32 v159,v159
mf v[140:143],a[228:231],a[4:7],v[230:233]
cvp v10,v152,v153
cvp v14,v156,v157
mf v[136:139],a[228:231],a[0:3],v[226:229]
s_waitcnt lgkmcnt(4)
ds_read_b128 a[224:227],v193 offset:256
mf v[128:131],a[232:235],a[8:11],v[128:131]
cvp v11,v154,v155
cvp v15,v158,v159
mf v[132:135],a[232:235],a[12:15],v[132:135]
ds_read_b128 a[228:231],v193 offset:8448
v_exp_f32 v160,v160
mf v[140:143],a[236:239],a[12:15],v[140:143]
v_exp_f32 v164,v164
mf v[136:139],a[236:239],a[8:11],v[136:139]
s_waitcnt lgkmcnt(4)
ds_read_b128 a[232:235],v194 offset:256
mf v[128:131],a[240:243],a[16:19],v[128:131]
v_exp_f32 v161,v161
mf v[132:135],a[240:243],a[20:23],v[132:135]
ds_read_b128 a[236:239],v194 offset:8448
v_exp_f32 v165,v165
mf v[140:143],a[244:247],a[20:23],v[140:143]
v_exp_f32 v162,v162
mf v[136:139],a[244:247],a[16:19],v[136:139]
s_waitcnt lgkmcnt(4)
ds_read_b128 a[240:243],v195 offset:256
mf v[128:131],a[248:251],a[24:27],v[128:131]
v_exp_f32 v166,v166
mf v[132:135],a[248:251],a[28:31],v[132:135]
ds_read_b128 a[244:247],v195 offset:8448
v_exp_f32 v163,v163
mf v[140:143],a[252:255],a[28:31],v[140:143]
v_exp_f32 v167,v167
mf v[136:139],a[252:255],a[24:27],v[136:139]
s_waitcnt lgkmcnt(4)
ds_read_b128 a[248:251],v196 offset:256
mf v[128:131],a[224:227],a[32:35],v[128:131]
cvp v16,v160,v161
mf v[132:135],a[224:227],a[36:39],v[132:135]
v_add_u32 v193,0x20000,v193
ds_read_b128 a[252:255],v196 offset:8448
mf v[140:143],a[228:231],a[36:39],v[140:143]
cvp v20,v164,v165
v_exp_f32 v168,v168
mf v[136:139],a[228:231],a[32:35],v[136:139]
s_waitcnt lgkmcnt(4)
s_barrier
mf v[128:131],a[232:235],a[40:43],v[128:131]
ds_read_b128 a[224:227],v193
v_exp_f32 v172,v172
mf v[132:135],a[232:235],a[44:47],v[132:135]
v_add_u32 v194,0x20000,v194
ds_read_b128 a[228:231],v193 offset:8192
mf v[140:143],a[236:239],a[44:47],v[140:143]
v_exp_f32 v169,v169
v_exp_f32 v173,v173
mf v[136:139],a[236:239],a[40:43],v[136:139]
s_waitcnt lgkmcnt(4)
ds_read_b128 a[232:235],v194
mf v[128:131],a[240:243],a[48:51],v[128:131]
cvp v17,v162,v163
mf v[132:135],a[240:243],a[52:55],v[132:135]
v_add_u32 v195,0x20000,v195
ds_read_b128 a[236:239],v194 offset:8192
mf v[140:143],a[244:247],a[52:55],v[140:143]
cvp v21,v166,v167
v_exp_f32 v170,v170
mf v[136:139],a[244:247],a[48:51],v[136:139]
s_waitcnt lgkmcnt(4)
ds_read_b128 a[240:243],v195
mf v[128:131],a[248:251],a[56:59],v[128:131]
v_exp_f32 v174,v174
mf v[132:135],a[248:251],a[60:63],v[132:135]
v_add_u32 v196,0x20000,v196
ds_read_b128 a[244:247],v195 offset:8192
mf v[140:143],a[252:255],a[60:63],v[140:143]
v_exp_f32 v171,v171
v_exp_f32 v175,v175
mf v[136:139],a[252:255],a[56:59],v[136:139]
s_waitcnt lgkmcnt(4)
ds_read_b128 a[248:251],v196
mf v[144:147],a[224:227],a[0:3],v[226:229]
cvp v18,v168,v169
mf v[148:151],a[224:227],a[4:7],v[230:233]
ds_read_b128 a[252:255],v196 offset:8192
cvp v22,v172,v173
mf v[156:159],a[228:231],a[4:7],v[230:233]
cvp v19,v170,v171
mf v[152:155],a[228:231],a[0:3],v[226:229]
s_waitcnt lgkmcnt(4)
ds_read_b128 a[224:227],v193 offset:256
mf v[144:147],a[232:235],a[8:11],v[144:147]
cvp v23,v174,v175
mf v[148:151],a[232:235],a[12:15],v[148:151]
ds_read_b128 a[228:231],v193 offset:8448
v_exp_f32 v128,v128
mf v[156:159],a[236:239],a[12:15],v[156:159]
v_exp_f32 v132,v132
mf v[152:155],a[236:239],a[8:11],v[152:155]
s_waitcnt lgkmcnt(4)
ds_read_b128 a[232:235],v194 offset:256
mf v[144:147],a[240:243],a[16:19],v[144:147]
v_exp_f32 v129,v129
mf v[148:151],a[240:243],a[20:23],v[148:151]
ds_read_b128 a[236:239],v194 offset:8448
v_exp_f32 v133,v133
mf v[156:159],a[244:247],a[20:23],v[156:159]
v_exp_f32 v130,v130
mf v[152:155],a[244:247],a[16:19],v[152:155]
s_waitcnt lgkmcnt(4)
ds_read_b128 a[240:243],v195 offset:256
mf v[144:147],a[248:251],a[24:27],v[144:147]
v_exp_f32 v134,v134
mf v[148:151],a[248:251],a[28:31],v[148:151]
ds_read_b128 a[244:247],v195 offset:8448
v_exp_f32 v131,v131
mf v[156:159],a[252:255],a[28:31],v[156:159]
v_exp_f32 v135,v135
mf v[152:155],a[252:255],a[24:27],v[152:155]
s_waitcnt lgkmcnt(4)
ds_read_b128 a[248:251],v196 offset:256
mf v[144:147],a[224:227],a[32:35],v[144:147]
cvp v24,v128,v129
mf v[148:151],a[224:227],a[36:39],v[148:151]
v_add_u32 v193,0xfffe0000,v193
ds_read_b128 a[252:255],v196 offset:8448
mf v[156:159],a[228:231],a[36:39],v[156:159]
cvp v28,v132,v133
v_exp_f32 v136,v136
mf v[152:155],a[228:231],a[32:35],v[152:155]
s_waitcnt lgkmcnt(4)
s_barrier
mf v[144:147],a[232:235],a[40:43],v[144:147]
ds_read_b128 a[224:227],v193 offset:32768
v_exp_f32 v140,v140
mf v[148:151],a[232:235],a[44:47],v[148:151]
v_add_u32 v194,0xfffe0000,v194
ds_read_b128 a[228:231],v193 offset:40960
s_waitcnt vmcnt(8)
ds_write_b128 v207,a[176:179]
mf v[156:159],a[236:239],a[44:47],v[156:159]
s_add_u32 s48,s50,212992
buffer_load_dwordx4 a[208:211],v208,s[24:27],s48 offen nt
v_exp_f32 v137,v137
v_exp_f32 v141,v141
mf v[152:155],a[236:239],a[40:43],v[152:155]
s_waitcnt lgkmcnt(5)
ds_read_b128 a[232:235],v194 offset:32768
mf v[144:147],a[240:243],a[48:51],v[144:147]
cvp v25,v130,v131
mf v[148:151],a[240:243],a[52:55],v[148:151]
v_add_u32 v195,0xfffe0000,v195
ds_read_b128 a[236:239],v194 offset:40960
ds_write_b128 v207,a[180:183] offset:1024
mf v[156:159],a[244:247],a[52:55],v[156:159]
cvp v29,v134,v135
v_exp_f32 v138,v138
mf v[152:155],a[244:247],a[48:51],v[152:155]
s_waitcnt lgkmcnt(6)
ds_read_b128 a[240:243],v195 offset:32768
mf v[144:147],a[248:251],a[56:59],v[144:147]
buffer_load_dwordx4 a[212:215],v209,s[24:27],s48 offen offset:1024 nt
v_exp_f32 v142,v142
mf v[148:151],a[248:251],a[60:63],v[148:151]
v_add_u32 v196,0xfffe0000,v196
ds_read_b128 a[244:247],v195 offset:40960
ds_write_b128 v207,a[184:187] offset:2048
mf v[156:159],a[252:255],a[60:63],v[156:159]
v_exp_f32 v139,v139
v_exp_f32 v143,v143
mf v[152:155],a[252:255],a[56:59],v[152:155]
s_waitcnt lgkmcnt(7)
ds_read_b128 a[248:251],v196 offset:32768
mf v[160:163],a[224:227],a[0:3],v[226:229]
cvp v26,v136,v137
mf v[164:167],a[224:227],a[4:7],v[230:233]
ds_read_b128 a[252:255],v196 offset:40960
ds_write_b128 v207,a[188:191] offset:3072
buffer_load_dwordx4 a[216:219],v210,s[24:27],s48 offen offset:2048 nt
mf v[172:175],a[228:231],a[4:7],v[230:233]
cvp v30,v140,v141
cvp v27,v138,v139
mf v[168:171],a[228:231],a[0:3],v[226:229]
s_waitcnt lgkmcnt(7)
ds_read_b128 a[224:227],v193 offset:33024
mf v[160:163],a[232:235],a[8:11],v[160:163]
cvp v31,v142,v143
mf v[164:167],a[232:235],a[12:15],v[164:167]
ds_read_b128 a[228:231],v193 offset:41216
v_exp_f32 v144,v144
mf v[172:175],a[236:239],a[12:15],v[172:175]
v_exp_f32 v148,v148
mf v[168:171],a[236:239],a[8:11],v[168:171]
s_waitcnt lgkmcnt(6)
ds_read_b128 a[232:235],v194 offset:33024
mf v[160:163],a[240:243],a[16:19],v[160:163]
buffer_load_dwordx4 a[220:223],v211,s[24:27],s48 offen offset:3072 nt
v_exp_f32 v145,v145
mf v[164:167],a[240:243],a[20:23],v[164:167]
ds_read_b128 a[236:239],v194 offset:41216
v_exp_f32 v149,v149
mf v[172:175],a[244:247],a[20:23],v[172:175]
v_exp_f32 v146,v146
mf v[168:171],a[244:247],a[16:19],v[168:171]
s_waitcnt lgkmcnt(5)
ds_read_b128 a[240:243],v195 offset:33024
mf v[160:163],a[248:251],a[24:27],v[160:163]
v_exp_f32 v150,v150
mf v[164:167],a[248:251],a[28:31],v[164:167]
ds_read_b128 a[244:247],v195 offset:41216
v_exp_f32 v147,v147
mf v[172:175],a[252:255],a[28:31],v[172:175]
v_exp_f32 v151,v151
mf v[168:171],a[252:255],a[24:27],v[168:171]
s_waitcnt lgkmcnt(4)
ds_read_b128 a[248:251],v196 offset:33024
mf v[160:163],a[224:227],a[32:35],v[160:163]
cvp v32,v144,v145
mf v[164:167],a[224:227],a[36:39],v[164:167]
v_add_u32 v193,0x20000,v193
ds_read_b128 a[252:255],v196 offset:41216
mf v[172:175],a[228:231],a[36:39],v[172:175]
cvp v36,v148,v149
v_exp_f32 v152,v152
mf v[168:171],a[228:231],a[32:35],v[168:171]
s_waitcnt lgkmcnt(4)
s_barrier
mf v[160:163],a[232:235],a[40:43],v[160:163]
ds_read_b128 a[224:227],v193 offset:16384
v_exp_f32 v156,v156
mf v[164:167],a[232:235],a[44:47],v[164:167]
v_add_u32 v194,0x20000,v194
ds_read_b128 a[228:231],v193 offset:24576
s_add_u32 m0,s49,65536
s_add_u32 s48,s50,229376
mf v[172:175],a[236:239],a[44:47],v[172:175]
buffer_load_dwordx4 v208,s[24:27],s48 offen nt lds
v_exp_f32 v153,v153
v_exp_f32 v157,v157
mf v[168:171],a[236:239],a[40:43],v[168:171]
s_waitcnt lgkmcnt(4)
ds_read_b128 a[232:235],v194 offset:16384
mf v[160:163],a[240:243],a[48:51],v[160:163]
cvp v33,v146,v147
mf v[164:167],a[240:243],a[52:55],v[164:167]
v_add_u32 v195,0x20000,v195
ds_read_b128 a[236:239],v194 offset:24576
mf v[172:175],a[244:247],a[52:55],v[172:175]
cvp v37,v150,v151
v_exp_f32 v154,v154
mf v[168:171],a[244:247],a[48:51],v[168:171]
s_waitcnt lgkmcnt(4)
ds_read_b128 a[240:243],v195 offset:16384
mf v[160:163],a[248:251],a[56:59],v[160:163]
buffer_load_dwordx4 v209,s[24:27],s48 offen offset:1024 nt lds
v_exp_f32 v158,v158
mf v[164:167],a[248:251],a[60:63],v[164:167]
v_add_u32 v196,0x20000,v196
ds_read_b128 a[244:247],v195 offset:24576
mf v[172:175],a[252:255],a[60:63],v[172:175]
v_exp_f32 v155,v155
v_exp_f32 v159,v159
mf v[168:171],a[252:255],a[56:59],v[168:171]
s_waitcnt lgkmcnt(4)
ds_read_b128 a[248:251],v196 offset:16384
mf v[128:131],a[224:227],a[0:3],v[226:229]
cvp v34,v152,v153
mf v[132:135],a[224:227],a[4:7],v[230:233]
ds_read_b128 a[252:255],v196 offset:24576
buffer_load_dwordx4 v210,s[24:27],s48 offen offset:2048 nt lds
mf v[140:143],a[228:231],a[4:7],v[230:233]
cvp v38,v156,v157
cvp v35,v154,v155
mf v[136:139],a[228:231],a[0:3],v[226:229]
s_waitcnt lgkmcnt(4)
ds_read_b128 a[224:227],v193 offset:16640
mf v[128:131],a[232:235],a[8:11],v[128:131]
cvp v39,v158,v159
mf v[132:135],a[232:235],a[12:15],v[132:135]
ds_read_b128 a[228:231],v193 offset:24832
v_exp_f32 v160,v160
mf v[140:143],a[236:239],a[12:15],v[140:143]
v_exp_f32 v164,v164
mf v[136:139],a[236:239],a[8:11],v[136:139]
s_waitcnt lgkmcnt(4)
ds_read_b128 a[232:235],v194 offset:16640
mf v[128:131],a[240:243],a[16:19],v[128:131]
buffer_load_dwordx4 v211,s[24:27],s48 offen offset:3072 nt lds
v_exp_f32 v161,v161
mf v[132:135],a[240:243],a[20:23],v[132:135]
ds_read_b128 a[236:239],v194 offset:24832
v_exp_f32 v165,v165
mf v[140:143],a[244:247],a[20:23],v[140:143]
v_exp_f32 v162,v162
mf v[136:139],a[244:247],a[16:19],v[136:139]
s_waitcnt lgkmcnt(4)
ds_read_b128 a[240:243],v195 offset:16640
mf v[128:131],a[248:251],a[24:27],v[128:131]
v_exp_f32 v166,v166
mf v[132:135],a[248:251],a[28:31],v[132:135]
ds_read_b128 a[244:247],v195 offset:24832
v_exp_f32 v163,v163
mf v[140:143],a[252:255],a[28:31],v[140:143]
v_exp_f32 v167,v167
mf v[136:139],a[252:255],a[24:27],v[136:139]
s_waitcnt lgkmcnt(4)
ds_read_b128 a[248:251],v196 offset:16640
mf v[128:131],a[224:227],a[32:35],v[128:131]
cvp v40,v160,v161
mf v[132:135],a[224:227],a[36:39],v[132:135]
v_add_u32 v193,0xffff0000,v193
ds_read_b128 a[252:255],v196 offset:24832
mf v[140:143],a[228:231],a[36:39],v[140:143]
cvp v44,v164,v165
v_exp_f32 v168,v168
mf v[136:139],a[228:231],a[32:35],v[136:139]
s_waitcnt lgkmcnt(4)
s_barrier
mf v[128:131],a[232:235],a[40:43],v[128:131]
ds_read_b128 a[224:227],v193 offset:16384
v_exp_f32 v172,v172
mf v[132:135],a[232:235],a[44:47],v[132:135]
v_add_u32 v194,0xffff0000,v194
ds_read_b128 a[228:231],v193 offset:24576
s_waitcnt vmcnt(8)
mf v[140:143],a[236:239],a[44:47],v[140:143]
ds_write_b128 v207,a[192:195] offset:32768
v_exp_f32 v169,v169
v_exp_f32 v173,v173
mf v[136:139],a[236:239],a[40:43],v[136:139]
s_waitcnt lgkmcnt(5)
ds_read_b128 a[232:235],v194 offset:16384
mf v[128:131],a[240:243],a[48:51],v[128:131]
cvp v41,v162,v163
mf v[132:135],a[240:243],a[52:55],v[132:135]
v_add_u32 v195,0xffff0000,v195
ds_read_b128 a[236:239],v194 offset:24576
ds_write_b128 v207,a[196:199] offset:33792
mf v[140:143],a[244:247],a[52:55],v[140:143]
cvp v45,v166,v167
v_exp_f32 v170,v170
mf v[136:139],a[244:247],a[48:51],v[136:139]
s_waitcnt lgkmcnt(6)
ds_read_b128 a[240:243],v195 offset:16384
mf v[128:131],a[248:251],a[56:59],v[128:131]
v_exp_f32 v174,v174
mf v[132:135],a[248:251],a[60:63],v[132:135]
v_add_u32 v196,0xffff0000,v196
ds_read_b128 a[244:247],v195 offset:24576
ds_write_b128 v207,a[200:203] offset:34816
mf v[140:143],a[252:255],a[60:63],v[140:143]
v_exp_f32 v171,v171
v_exp_f32 v175,v175
mf v[136:139],a[252:255],a[56:59],v[136:139]
s_waitcnt lgkmcnt(7)
ds_read_b128 a[248:251],v196 offset:16384
mf v[144:147],a[224:227],a[0:3],v[226:229]
cvp v42,v168,v169
mf v[148:151],a[224:227],a[4:7],v[230:233]
ds_read_b128 a[252:255],v196 offset:24576
ds_write_b128 v207,a[204:207] offset:35840
mf v[156:159],a[228:231],a[4:7],v[230:233]
cvp v46,v172,v173
cvp v43,v170,v171
mf v[152:155],a[228:231],a[0:3],v[226:229]
s_waitcnt lgkmcnt(7)
ds_read_b128 a[224:227],v193 offset:16640
mf v[144:147],a[232:235],a[8:11],v[144:147]
cvp v47,v174,v175
mf v[148:151],a[232:235],a[12:15],v[148:151]
ds_read_b128 a[228:231],v193 offset:24832
v_exp_f32 v128,v128
mf v[156:159],a[236:239],a[12:15],v[156:159]
v_exp_f32 v132,v132
mf v[152:155],a[236:239],a[8:11],v[152:155]
s_waitcnt lgkmcnt(6)
ds_read_b128 a[232:235],v194 offset:16640
mf v[144:147],a[240:243],a[16:19],v[144:147]
v_exp_f32 v129,v129
mf v[148:151],a[240:243],a[20:23],v[148:151]
ds_read_b128 a[236:239],v194 offset:24832
v_exp_f32 v133,v133
mf v[156:159],a[244:247],a[20:23],v[156:159]
v_exp_f32 v130,v130
mf v[152:155],a[244:247],a[16:19],v[152:155]
s_waitcnt lgkmcnt(5)
ds_read_b128 a[240:243],v195 offset:16640
mf v[144:147],a[248:251],a[24:27],v[144:147]
v_exp_f32 v134,v134
mf v[148:151],a[248:251],a[28:31],v[148:151]
ds_read_b128 a[244:247],v195 offset:24832
v_exp_f32 v131,v131
mf v[156:159],a[252:255],a[28:31],v[156:159]
v_exp_f32 v135,v135
mf v[152:155],a[252:255],a[24:27],v[152:155]
s_waitcnt lgkmcnt(4)
ds_read_b128 a[248:251],v196 offset:16640
mf v[144:147],a[224:227],a[32:35],v[144:147]
cvp v48,v128,v129
mf v[148:151],a[224:227],a[36:39],v[148:151]
v_add_u32 v193,0xffff0000,v193
ds_read_b128 a[252:255],v196 offset:24832
mf v[156:159],a[228:231],a[36:39],v[156:159]
cvp v52,v132,v133
v_exp_f32 v136,v136
mf v[152:155],a[228:231],a[32:35],v[152:155]
s_waitcnt lgkmcnt(4)
s_barrier
mf v[144:147],a[232:235],a[40:43],v[144:147]
ds_read_b128 a[224:227],v193 offset:16384
v_exp_f32 v140,v140
mf v[148:151],a[232:235],a[44:47],v[148:151]
v_add_u32 v194,0xffff0000,v194
ds_read_b128 a[228:231],v193 offset:24576
s_add_u32 m0,s49,114688
s_add_u32 s48,s50,245760
mf v[156:159],a[236:239],a[44:47],v[156:159]
buffer_load_dwordx4 v208,s[24:27],s48 offen nt lds
v_exp_f32 v137,v137
v_exp_f32 v141,v141
mf v[152:155],a[236:239],a[40:43],v[152:155]
s_waitcnt lgkmcnt(4)
ds_read_b128 a[232:235],v194 offset:16384
mf v[144:147],a[240:243],a[48:51],v[144:147]
cvp v49,v130,v131
mf v[148:151],a[240:243],a[52:55],v[148:151]
v_add_u32 v195,0xffff0000,v195
ds_read_b128 a[236:239],v194 offset:24576
mf v[156:159],a[244:247],a[52:55],v[156:159]
cvp v53,v134,v135
v_exp_f32 v138,v138
mf v[152:155],a[244:247],a[48:51],v[152:155]
s_waitcnt lgkmcnt(4)
ds_read_b128 a[240:243],v195 offset:16384
mf v[144:147],a[248:251],a[56:59],v[144:147]
buffer_load_dwordx4 v209,s[24:27],s48 offen offset:1024 nt lds
v_exp_f32 v142,v142
mf v[148:151],a[248:251],a[60:63],v[148:151]
v_add_u32 v196,0xffff0000,v196
ds_read_b128 a[244:247],v195 offset:24576
mf v[156:159],a[252:255],a[60:63],v[156:159]
v_exp_f32 v139,v139
v_exp_f32 v143,v143
mf v[152:155],a[252:255],a[56:59],v[152:155]
s_waitcnt lgkmcnt(4)
ds_read_b128 a[248:251],v196 offset:16384
mf v[160:163],a[224:227],a[0:3],v[226:229]
cvp v50,v136,v137
mf v[164:167],a[224:227],a[4:7],v[230:233]
ds_read_b128 a[252:255],v196 offset:24576
buffer_load_dwordx4 v210,s[24:27],s48 offen offset:2048 nt lds
mf v[172:175],a[228:231],a[4:7],v[230:233]
cvp v54,v140,v141
cvp v51,v138,v139
mf v[168:171],a[228:231],a[0:3],v[226:229]
s_waitcnt lgkmcnt(4)
ds_read_b128 a[224:227],v193 offset:16640
mf v[160:163],a[232:235],a[8:11],v[160:163]
cvp v55,v142,v143
mf v[164:167],a[232:235],a[12:15],v[164:167]
ds_read_b128 a[228:231],v193 offset:24832
v_exp_f32 v144,v144
mf v[172:175],a[236:239],a[12:15],v[172:175]
v_exp_f32 v148,v148
mf v[168:171],a[236:239],a[8:11],v[168:171]
s_waitcnt lgkmcnt(4)
ds_read_b128 a[232:235],v194 offset:16640
mf v[160:163],a[240:243],a[16:19],v[160:163]
buffer_load_dwordx4 v211,s[24:27],s48 offen offset:3072 nt lds
v_exp_f32 v145,v145
mf v[164:167],a[240:243],a[20:23],v[164:167]
ds_read_b128 a[236:239],v194 offset:24832
v_exp_f32 v149,v149
mf v[172:175],a[244:247],a[20:23],v[172:175]
v_exp_f32 v146,v146
mf v[168:171],a[244:247],a[16:19],v[168:171]
s_waitcnt lgkmcnt(4)
ds_read_b128 a[240:243],v195 offset:16640
mf v[160:163],a[248:251],a[24:27],v[160:163]
v_exp_f32 v150,v150
mf v[164:167],a[248:251],a[28:31],v[164:167]
ds_read_b128 a[244:247],v195 offset:24832
v_exp_f32 v147,v147
mf v[172:175],a[252:255],a[28:31],v[172:175]
v_exp_f32 v151,v151
mf v[168:171],a[252:255],a[24:27],v[168:171]
s_waitcnt lgkmcnt(4)
ds_read_b128 a[248:251],v196 offset:16640
mf v[160:163],a[224:227],a[32:35],v[160:163]
cvp v56,v144,v145
mf v[164:167],a[224:227],a[36:39],v[164:167]
v_add_u32 v193,0x10000,v193
ds_read_b128 a[252:255],v196 offset:24832
mf v[172:175],a[228:231],a[36:39],v[172:175]
cvp v60,v148,v149
v_exp_f32 v152,v152
mf v[168:171],a[228:231],a[32:35],v[168:171]
s_waitcnt lgkmcnt(4)
s_barrier
mf v[160:163],a[232:235],a[40:43],v[160:163]
ds_read_b128 a[224:227],v193 offset:32768
v_exp_f32 v156,v156
mf v[164:167],a[232:235],a[44:47],v[164:167]
v_add_u32 v194,0x10000,v194
ds_read_b128 a[228:231],v193 offset:40960
s_waitcnt vmcnt(8)
v_add_u32 v191,0x10000,v207
mf v[172:175],a[236:239],a[44:47],v[172:175]
ds_write_b128 v191,a[208:211] offset:16384
v_exp_f32 v153,v153
v_exp_f32 v157,v157
mf v[168:171],a[236:239],a[40:43],v[168:171]
s_waitcnt lgkmcnt(5)
ds_read_b128 a[232:235],v194 offset:32768
mf v[160:163],a[240:243],a[48:51],v[160:163]
cvp v57,v146,v147
mf v[164:167],a[240:243],a[52:55],v[164:167]
v_add_u32 v195,0x10000,v195
ds_read_b128 a[236:239],v194 offset:40960
ds_write_b128 v191,a[212:215] offset:17408
mf v[172:175],a[244:247],a[52:55],v[172:175]
cvp v61,v150,v151
v_exp_f32 v154,v154
mf v[168:171],a[244:247],a[48:51],v[168:171]
s_waitcnt lgkmcnt(6)
ds_read_b128 a[240:243],v195 offset:32768
mf v[160:163],a[248:251],a[56:59],v[160:163]
v_exp_f32 v158,v158
mf v[164:167],a[248:251],a[60:63],v[164:167]
v_add_u32 v196,0x10000,v196
ds_read_b128 a[244:247],v195 offset:40960
ds_write_b128 v191,a[216:219] offset:18432
mf v[172:175],a[252:255],a[60:63],v[172:175]
v_exp_f32 v155,v155
v_exp_f32 v159,v159
mf v[168:171],a[252:255],a[56:59],v[168:171]
s_waitcnt lgkmcnt(7)
ds_read_b128 a[248:251],v196 offset:32768
mf v[128:131],a[224:227],a[0:3],v[226:229]
cvp v58,v152,v153
mf v[132:135],a[224:227],a[4:7],v[230:233]
ds_read_b128 a[252:255],v196 offset:40960
ds_write_b128 v191,a[220:223] offset:19456
mf v[140:143],a[228:231],a[4:7],v[230:233]
cvp v62,v156,v157
cvp v59,v154,v155
mf v[136:139],a[228:231],a[0:3],v[226:229]
s_waitcnt lgkmcnt(7)
ds_read_b128 a[224:227],v193 offset:33024
mf v[128:131],a[232:235],a[8:11],v[128:131]
cvp v63,v158,v159
mf v[132:135],a[232:235],a[12:15],v[132:135]
ds_read_b128 a[228:231],v193 offset:41216
v_exp_f32 v160,v160
mf v[140:143],a[236:239],a[12:15],v[140:143]
v_exp_f32 v164,v164
mf v[136:139],a[236:239],a[8:11],v[136:139]
s_waitcnt lgkmcnt(6)
ds_read_b128 a[232:235],v194 offset:33024
mf v[128:131],a[240:243],a[16:19],v[128:131]
v_exp_f32 v161,v161
mf v[132:135],a[240:243],a[20:23],v[132:135]
ds_read_b128 a[236:239],v194 offset:41216
v_exp_f32 v165,v165
mf v[140:143],a[244:247],a[20:23],v[140:143]
v_exp_f32 v162,v162
mf v[136:139],a[244:247],a[16:19],v[136:139]
s_waitcnt lgkmcnt(5)
ds_read_b128 a[240:243],v195 offset:33024
mf v[128:131],a[248:251],a[24:27],v[128:131]
v_exp_f32 v166,v166
mf v[132:135],a[248:251],a[28:31],v[132:135]
ds_read_b128 a[244:247],v195 offset:41216
v_exp_f32 v163,v163
mf v[140:143],a[252:255],a[28:31],v[140:143]
v_exp_f32 v167,v167
mf v[136:139],a[252:255],a[24:27],v[136:139]
s_waitcnt lgkmcnt(4)
ds_read_b128 a[248:251],v196 offset:33024
mf v[128:131],a[224:227],a[32:35],v[128:131]
cvp v64,v160,v161
mf v[132:135],a[224:227],a[36:39],v[132:135]
v_add_u32 v193,0xffff0000,v193
ds_read_b128 a[252:255],v196 offset:41216
mf v[140:143],a[228:231],a[36:39],v[140:143]
cvp v68,v164,v165
v_exp_f32 v168,v168
mf v[136:139],a[228:231],a[32:35],v[136:139]
s_waitcnt lgkmcnt(4)
s_barrier
mf v[128:131],a[232:235],a[40:43],v[128:131]
ds_read_b128 a[224:227],v193
v_exp_f32 v172,v172
mf v[132:135],a[232:235],a[44:47],v[132:135]
v_add_u32 v194,0xffff0000,v194
ds_read_b128 a[228:231],v193 offset:8192
s_add_u32 m0,s49,16384
s_add_u32 s48,s51,0
mf v[140:143],a[236:239],a[44:47],v[140:143]
buffer_load_dwordx4 v212,s[28:31],s48 offen nt lds
v_exp_f32 v169,v169
v_exp_f32 v173,v173
mf v[136:139],a[236:239],a[40:43],v[136:139]
s_waitcnt lgkmcnt(4)
ds_read_b128 a[232:235],v194
mf v[128:131],a[240:243],a[48:51],v[128:131]
cvp v65,v162,v163
mf v[132:135],a[240:243],a[52:55],v[132:135]
v_add_u32 v195,0xffff0000,v195
ds_read_b128 a[236:239],v194 offset:8192
mf v[140:143],a[244:247],a[52:55],v[140:143]
cvp v69,v166,v167
v_exp_f32 v170,v170
mf v[136:139],a[244:247],a[48:51],v[136:139]
s_waitcnt lgkmcnt(4)
ds_read_b128 a[240:243],v195
mf v[128:131],a[248:251],a[56:59],v[128:131]
buffer_load_dwordx4 v213,s[28:31],s48 offen offset:1024 nt lds
v_exp_f32 v174,v174
mf v[132:135],a[248:251],a[60:63],v[132:135]
v_add_u32 v196,0xffff0000,v196
ds_read_b128 a[244:247],v195 offset:8192
mf v[140:143],a[252:255],a[60:63],v[140:143]
v_exp_f32 v171,v171
v_exp_f32 v175,v175
mf v[136:139],a[252:255],a[56:59],v[136:139]
s_waitcnt lgkmcnt(4)
ds_read_b128 a[248:251],v196
mf v[144:147],a[224:227],a[0:3],v[226:229]
cvp v66,v168,v169
mf v[148:151],a[224:227],a[4:7],v[230:233]
ds_read_b128 a[252:255],v196 offset:8192
buffer_load_dwordx4 v214,s[28:31],s48 offen offset:2048 nt lds
mf v[156:159],a[228:231],a[4:7],v[230:233]
cvp v70,v172,v173
cvp v67,v170,v171
mf v[152:155],a[228:231],a[0:3],v[226:229]
s_waitcnt lgkmcnt(4)
ds_read_b128 a[224:227],v193 offset:256
mf v[144:147],a[232:235],a[8:11],v[144:147]
cvp v71,v174,v175
mf v[148:151],a[232:235],a[12:15],v[148:151]
ds_read_b128 a[228:231],v193 offset:8448
v_exp_f32 v128,v128
mf v[156:159],a[236:239],a[12:15],v[156:159]
v_exp_f32 v132,v132
mf v[152:155],a[236:239],a[8:11],v[152:155]
s_waitcnt lgkmcnt(4)
ds_read_b128 a[232:235],v194 offset:256
mf v[144:147],a[240:243],a[16:19],v[144:147]
buffer_load_dwordx4 v215,s[28:31],s48 offen offset:3072 nt lds
v_exp_f32 v129,v129
mf v[148:151],a[240:243],a[20:23],v[148:151]
ds_read_b128 a[236:239],v194 offset:8448
v_exp_f32 v133,v133
mf v[156:159],a[244:247],a[20:23],v[156:159]
v_exp_f32 v130,v130
mf v[152:155],a[244:247],a[16:19],v[152:155]
s_waitcnt lgkmcnt(4)
ds_read_b128 a[240:243],v195 offset:256
mf v[144:147],a[248:251],a[24:27],v[144:147]
v_exp_f32 v134,v134
mf v[148:151],a[248:251],a[28:31],v[148:151]
ds_read_b128 a[244:247],v195 offset:8448
v_exp_f32 v131,v131
mf v[156:159],a[252:255],a[28:31],v[156:159]
v_exp_f32 v135,v135
mf v[152:155],a[252:255],a[24:27],v[152:155]
s_waitcnt lgkmcnt(4)
ds_read_b128 a[248:251],v196 offset:256
mf v[144:147],a[224:227],a[32:35],v[144:147]
cvp v72,v128,v129
mf v[148:151],a[224:227],a[36:39],v[148:151]
ds_read_b128 a[252:255],v196 offset:8448
cvp v76,v132,v133
mf v[156:159],a[228:231],a[36:39],v[156:159]
v_exp_f32 v136,v136
mf v[152:155],a[228:231],a[32:35],v[152:155]
s_waitcnt lgkmcnt(4)
s_barrier
mf v[144:147],a[232:235],a[40:43],v[144:147]
ds_read_b128 a[224:227],v193 offset:49152
v_exp_f32 v140,v140
mf v[148:151],a[232:235],a[44:47],v[148:151]
ds_read_b128 a[228:231],v193 offset:57344
s_add_u32 m0,s61,98304
s_add_u32 s48,s53,s92
mf v[156:159],a[236:239],a[44:47],v[156:159]
buffer_load_dwordx4 v216,s[36:39],s48 offen lds
v_exp_f32 v137,v137
v_exp_f32 v141,v141
mf v[152:155],a[236:239],a[40:43],v[152:155]
s_waitcnt lgkmcnt(4)
ds_read_b128 a[232:235],v194 offset:49152
mf v[144:147],a[240:243],a[48:51],v[144:147]
cvp v73,v130,v131
mf v[148:151],a[240:243],a[52:55],v[148:151]
ds_read_b128 a[236:239],v194 offset:57344
buffer_load_dwordx4 v217,s[36:39],s48 offen offset:1024 lds
mf v[156:159],a[244:247],a[52:55],v[156:159]
cvp v77,v134,v135
v_exp_f32 v138,v138
mf v[152:155],a[244:247],a[48:51],v[152:155]
s_waitcnt lgkmcnt(4)
ds_read_b128 a[240:243],v195 offset:49152
mf v[144:147],a[248:251],a[56:59],v[144:147]
v_exp_f32 v142,v142
mf v[148:151],a[248:251],a[60:63],v[148:151]
ds_read_b128 a[244:247],v195 offset:57344
s_add_u32 m0,s61,106496
s_add_u32 s48,s53,s93
mf v[156:159],a[252:255],a[60:63],v[156:159]
buffer_load_dwordx4 v216,s[36:39],s48 offen lds
v_exp_f32 v139,v139
v_exp_f32 v143,v143
mf v[152:155],a[252:255],a[56:59],v[152:155]
s_waitcnt lgkmcnt(4)
ds_read_b128 a[248:251],v196 offset:49152
mf v[160:163],a[224:227],a[0:3],v[226:229]
cvp v74,v136,v137
mf v[164:167],a[224:227],a[4:7],v[230:233]
ds_read_b128 a[252:255],v196 offset:57344
buffer_load_dwordx4 v217,s[36:39],s48 offen offset:1024 lds
mf v[172:175],a[228:231],a[4:7],v[230:233]
cvp v78,v140,v141
cvp v75,v138,v139
mf v[168:171],a[228:231],a[0:3],v[226:229]
s_waitcnt lgkmcnt(4)
ds_read_b128 a[224:227],v193 offset:49408
mf v[160:163],a[232:235],a[8:11],v[160:163]
cvp v79,v142,v143
mf v[164:167],a[232:235],a[12:15],v[164:167]
ds_read_b128 a[228:231],v193 offset:57600
s_add_u32 m0,s49,131072
s_add_u32 s48,s51,65536
mf v[172:175],a[236:239],a[12:15],v[172:175]
buffer_load_dwordx4 v212,s[28:31],s48 offen nt lds
v_exp_f32 v144,v144
v_exp_f32 v148,v148
mf v[168:171],a[236:239],a[8:11],v[168:171]
s_waitcnt lgkmcnt(4)
ds_read_b128 a[232:235],v194 offset:49408
mf v[160:163],a[240:243],a[16:19],v[160:163]
v_exp_f32 v145,v145
mf v[164:167],a[240:243],a[20:23],v[164:167]
ds_read_b128 a[236:239],v194 offset:57600
buffer_load_dwordx4 v213,s[28:31],s48 offen offset:1024 nt lds
mf v[172:175],a[244:247],a[20:23],v[172:175]
v_exp_f32 v149,v149
v_exp_f32 v146,v146
mf v[168:171],a[244:247],a[16:19],v[168:171]
s_waitcnt lgkmcnt(4)
ds_read_b128 a[240:243],v195 offset:49408
mf v[160:163],a[248:251],a[24:27],v[160:163]
v_exp_f32 v150,v150
mf v[164:167],a[248:251],a[28:31],v[164:167]
ds_read_b128 a[244:247],v195 offset:57600
buffer_load_dwordx4 v214,s[28:31],s48 offen offset:2048 nt lds
mf v[172:175],a[252:255],a[28:31],v[172:175]
v_exp_f32 v147,v147
v_exp_f32 v151,v151
mf v[168:171],a[252:255],a[24:27],v[168:171]
s_waitcnt lgkmcnt(4)
ds_read_b128 a[248:251],v196 offset:49408
mf v[160:163],a[224:227],a[32:35],v[160:163]
cvp v80,v144,v145
mf v[164:167],a[224:227],a[36:39],v[164:167]
ds_read_b128 a[252:255],v196 offset:57600
buffer_load_dwordx4 v215,s[28:31],s48 offen offset:3072 nt lds
mf v[172:175],a[228:231],a[36:39],v[172:175]
cvp v84,v148,v149
v_exp_f32 v152,v152
mf v[168:171],a[228:231],a[32:35],v[168:171]
s_waitcnt lgkmcnt(4)
s_barrier
mf v[160:163],a[232:235],a[40:43],v[160:163]
ds_read_b128 a[224:227],v193 offset:32768
v_exp_f32 v156,v156
mf v[164:167],a[232:235],a[44:47],v[164:167]
ds_read_b128 a[228:231],v193 offset:40960
v_exp_f32 v153,v153
mf v[172:175],a[236:239],a[44:47],v[172:175]
v_exp_f32 v157,v157
mf v[168:171],a[236:239],a[40:43],v[168:171]
s_waitcnt lgkmcnt(4)
ds_read_b128 a[232:235],v194 offset:32768
mf v[160:163],a[240:243],a[48:51],v[160:163]
cvp v81,v146,v147
mf v[164:167],a[240:243],a[52:55],v[164:167]
ds_read_b128 a[236:239],v194 offset:40960
cvp v85,v150,v151
mf v[172:175],a[244:247],a[52:55],v[172:175]
v_exp_f32 v154,v154
mf v[168:171],a[244:247],a[48:51],v[168:171]
s_waitcnt lgkmcnt(4)
ds_read_b128 a[240:243],v195 offset:32768
mf v[160:163],a[248:251],a[56:59],v[160:163]
v_exp_f32 v158,v158
mf v[164:167],a[248:251],a[60:63],v[164:167]
ds_read_b128 a[244:247],v195 offset:40960
v_exp_f32 v155,v155
mf v[172:175],a[252:255],a[60:63],v[172:175]
v_exp_f32 v159,v159
mf v[168:171],a[252:255],a[56:59],v[168:171]
s_waitcnt lgkmcnt(4)
ds_read_b128 a[248:251],v196 offset:32768
mf v[128:131],a[224:227],a[0:3],v[226:229]
cvp v82,v152,v153
mf v[132:135],a[224:227],a[4:7],v[230:233]
ds_read_b128 a[252:255],v196 offset:40960
cvp v86,v156,v157
mf v[140:143],a[228:231],a[4:7],v[230:233]
cvp v83,v154,v155
mf v[136:139],a[228:231],a[0:3],v[226:229]
s_waitcnt lgkmcnt(4)
ds_read_b128 a[224:227],v193 offset:33024
mf v[128:131],a[232:235],a[8:11],v[128:131]
cvp v87,v158,v159
mf v[132:135],a[232:235],a[12:15],v[132:135]
ds_read_b128 a[228:231],v193 offset:41216
v_exp_f32 v160,v160
mf v[140:143],a[236:239],a[12:15],v[140:143]
v_exp_f32 v164,v164
mf v[136:139],a[236:239],a[8:11],v[136:139]
s_waitcnt lgkmcnt(4)
ds_read_b128 a[232:235],v194 offset:33024
mf v[128:131],a[240:243],a[16:19],v[128:131]
v_exp_f32 v161,v161
mf v[132:135],a[240:243],a[20:23],v[132:135]
ds_read_b128 a[236:239],v194 offset:41216
v_exp_f32 v165,v165
mf v[140:143],a[244:247],a[20:23],v[140:143]
v_exp_f32 v162,v162
mf v[136:139],a[244:247],a[16:19],v[136:139]
s_waitcnt lgkmcnt(4)
ds_read_b128 a[240:243],v195 offset:33024
mf v[128:131],a[248:251],a[24:27],v[128:131]
v_exp_f32 v166,v166
mf v[132:135],a[248:251],a[28:31],v[132:135]
ds_read_b128 a[244:247],v195 offset:41216
v_exp_f32 v163,v163
mf v[140:143],a[252:255],a[28:31],v[140:143]
v_exp_f32 v167,v167
mf v[136:139],a[252:255],a[24:27],v[136:139]
s_waitcnt lgkmcnt(4)
ds_read_b128 a[248:251],v196 offset:33024
mf v[128:131],a[224:227],a[32:35],v[128:131]
cvp v88,v160,v161
mf v[132:135],a[224:227],a[36:39],v[132:135]
v_add_u32 v193,0x10000,v193
ds_read_b128 a[252:255],v196 offset:41216
mf v[140:143],a[228:231],a[36:39],v[140:143]
cvp v92,v164,v165
v_exp_f32 v168,v168
mf v[136:139],a[228:231],a[32:35],v[136:139]
s_waitcnt lgkmcnt(4)
s_barrier
mf v[128:131],a[232:235],a[40:43],v[128:131]
ds_read_b128 a[224:227],v193 offset:16384
v_exp_f32 v172,v172
mf v[132:135],a[232:235],a[44:47],v[132:135]
v_add_u32 v194,0x10000,v194
ds_read_b128 a[228:231],v193 offset:24576
mf v[140:143],a[236:239],a[44:47],v[140:143]
v_exp_f32 v169,v169
v_exp_f32 v173,v173
mf v[136:139],a[236:239],a[40:43],v[136:139]
s_waitcnt lgkmcnt(4)
ds_read_b128 a[232:235],v194 offset:16384
mf v[128:131],a[240:243],a[48:51],v[128:131]
cvp v89,v162,v163
mf v[132:135],a[240:243],a[52:55],v[132:135]
v_add_u32 v195,0x10000,v195
ds_read_b128 a[236:239],v194 offset:24576
mf v[140:143],a[244:247],a[52:55],v[140:143]
cvp v93,v166,v167
v_exp_f32 v170,v170
mf v[136:139],a[244:247],a[48:51],v[136:139]
s_waitcnt lgkmcnt(4)
ds_read_b128 a[240:243],v195 offset:16384
mf v[128:131],a[248:251],a[56:59],v[128:131]
v_exp_f32 v174,v174
mf v[132:135],a[248:251],a[60:63],v[132:135]
v_add_u32 v196,0x10000,v196
ds_read_b128 a[244:247],v195 offset:24576
mf v[140:143],a[252:255],a[60:63],v[140:143]
v_exp_f32 v171,v171
v_exp_f32 v175,v175
mf v[136:139],a[252:255],a[56:59],v[136:139]
s_waitcnt lgkmcnt(4)
ds_read_b128 a[248:251],v196 offset:16384
mf v[144:147],a[224:227],a[0:3],v[226:229]
cvp v90,v168,v169
mf v[148:151],a[224:227],a[4:7],v[230:233]
ds_read_b128 a[252:255],v196 offset:24576
cvp v94,v172,v173
mf v[156:159],a[228:231],a[4:7],v[230:233]
cvp v91,v170,v171
mf v[152:155],a[228:231],a[0:3],v[226:229]
s_waitcnt lgkmcnt(4)
ds_read_b128 a[224:227],v193 offset:16640
mf v[144:147],a[232:235],a[8:11],v[144:147]
cvp v95,v174,v175
mf v[148:151],a[232:235],a[12:15],v[148:151]
ds_read_b128 a[228:231],v193 offset:24832
v_exp_f32 v128,v128
mf v[156:159],a[236:239],a[12:15],v[156:159]
v_exp_f32 v132,v132
mf v[152:155],a[236:239],a[8:11],v[152:155]
s_waitcnt lgkmcnt(4)
ds_read_b128 a[232:235],v194 offset:16640
mf v[144:147],a[240:243],a[16:19],v[144:147]
v_exp_f32 v129,v129
mf v[148:151],a[240:243],a[20:23],v[148:151]
ds_read_b128 a[236:239],v194 offset:24832
v_exp_f32 v133,v133
mf v[156:159],a[244:247],a[20:23],v[156:159]
v_exp_f32 v130,v130
mf v[152:155],a[244:247],a[16:19],v[152:155]
s_waitcnt lgkmcnt(4)
ds_read_b128 a[240:243],v195 offset:16640
mf v[144:147],a[248:251],a[24:27],v[144:147]
v_exp_f32 v134,v134
mf v[148:151],a[248:251],a[28:31],v[148:151]
ds_read_b128 a[244:247],v195 offset:24832
v_exp_f32 v131,v131
mf v[156:159],a[252:255],a[28:31],v[156:159]
v_exp_f32 v135,v135
mf v[152:155],a[252:255],a[24:27],v[152:155]
s_waitcnt lgkmcnt(4)
ds_read_b128 a[248:251],v196 offset:16640
mf v[144:147],a[224:227],a[32:35],v[144:147]
cvp v96,v128,v129
mf v[148:151],a[224:227],a[36:39],v[148:151]
ds_read_b128 a[252:255],v196 offset:24832
cvp v100,v132,v133
mf v[156:159],a[228:231],a[36:39],v[156:159]
v_exp_f32 v136,v136
mf v[152:155],a[228:231],a[32:35],v[152:155]
s_waitcnt lgkmcnt(4)
s_waitcnt vmcnt(16)
s_barrier
mf v[144:147],a[232:235],a[40:43],v[144:147]
ds_read_b128 a[224:227],v193
v_exp_f32 v140,v140
mf v[148:151],a[232:235],a[44:47],v[148:151]
ds_read_b128 a[228:231],v193 offset:8192
s_add_u32 m0,s61,0
s_add_u32 s48,s53,s94
mf v[156:159],a[236:239],a[44:47],v[156:159]
buffer_load_dwordx4 v216,s[36:39],s48 offen lds
v_exp_f32 v137,v137
v_exp_f32 v141,v141
mf v[152:155],a[236:239],a[40:43],v[152:155]
s_waitcnt lgkmcnt(4)
ds_read_b128 a[232:235],v194
mf v[144:147],a[240:243],a[48:51],v[144:147]
cvp v97,v130,v131
mf v[148:151],a[240:243],a[52:55],v[148:151]
ds_read_b128 a[236:239],v194 offset:8192
cvp v101,v134,v135
mf v[156:159],a[244:247],a[52:55],v[156:159]
v_exp_f32 v138,v138
mf v[152:155],a[244:247],a[48:51],v[152:155]
s_waitcnt lgkmcnt(4)
ds_read_b128 a[240:243],v195
mf v[144:147],a[248:251],a[56:59],v[144:147]
buffer_load_dwordx4 v217,s[36:39],s48 offen offset:1024 lds
v_exp_f32 v142,v142
mf v[148:151],a[248:251],a[60:63],v[148:151]
ds_read_b128 a[244:247],v195 offset:8192
v_exp_f32 v139,v139
mf v[156:159],a[252:255],a[60:63],v[156:159]
v_exp_f32 v143,v143
mf v[152:155],a[252:255],a[56:59],v[152:155]
s_waitcnt lgkmcnt(4)
ds_read_b128 a[248:251],v196
mf v[160:163],a[224:227],a[0:3],v[226:229]
cvp v98,v136,v137
mf v[164:167],a[224:227],a[4:7],v[230:233]
ds_read_b128 a[252:255],v196 offset:8192
s_add_u32 m0,s61,8192
s_add_u32 s48,s53,s95
mf v[172:175],a[228:231],a[4:7],v[230:233]
buffer_load_dwordx4 v216,s[36:39],s48 offen lds
cvp v102,v140,v141
cvp v99,v138,v139
mf v[168:171],a[228:231],a[0:3],v[226:229]
s_waitcnt lgkmcnt(4)
ds_read_b128 a[224:227],v193 offset:256
mf v[160:163],a[232:235],a[8:11],v[160:163]
cvp v103,v142,v143
mf v[164:167],a[232:235],a[12:15],v[164:167]
ds_read_b128 a[228:231],v193 offset:8448
v_exp_f32 v144,v144
mf v[172:175],a[236:239],a[12:15],v[172:175]
v_exp_f32 v148,v148
mf v[168:171],a[236:239],a[8:11],v[168:171]
s_waitcnt lgkmcnt(4)
ds_read_b128 a[232:235],v194 offset:256
mf v[160:163],a[240:243],a[16:19],v[160:163]
buffer_load_dwordx4 v217,s[36:39],s48 offen offset:1024 lds
v_exp_f32 v145,v145
mf v[164:167],a[240:243],a[20:23],v[164:167]
ds_read_b128 a[236:239],v194 offset:8448
v_exp_f32 v149,v149
mf v[172:175],a[244:247],a[20:23],v[172:175]
v_exp_f32 v146,v146
mf v[168:171],a[244:247],a[16:19],v[168:171]
s_waitcnt lgkmcnt(4)
ds_read_b128 a[240:243],v195 offset:256
mf v[160:163],a[248:251],a[24:27],v[160:163]
v_exp_f32 v150,v150
mf v[164:167],a[248:251],a[28:31],v[164:167]
ds_read_b128 a[244:247],v195 offset:8448
v_exp_f32 v147,v147
mf v[172:175],a[252:255],a[28:31],v[172:175]
v_exp_f32 v151,v151
mf v[168:171],a[252:255],a[24:27],v[168:171]
s_waitcnt lgkmcnt(4)
ds_read_b128 a[248:251],v196 offset:256
mf v[160:163],a[224:227],a[32:35],v[160:163]
cvp v104,v144,v145
mf v[164:167],a[224:227],a[36:39],v[164:167]
ds_read_b128 a[252:255],v196 offset:8448
cvp v108,v148,v149
mf v[172:175],a[228:231],a[36:39],v[172:175]
v_exp_f32 v152,v152
mf v[168:171],a[228:231],a[32:35],v[168:171]
s_waitcnt lgkmcnt(4)
s_waitcnt vmcnt(16)
s_barrier
mf v[160:163],a[232:235],a[40:43],v[160:163]
ds_read_b128 a[224:227],v193 offset:49152
v_exp_f32 v156,v156
mf v[164:167],a[232:235],a[44:47],v[164:167]
ds_read_b128 a[228:231],v193 offset:57344
s_add_u32 m0,s49,32768
s_add_u32 s48,s51,131072
mf v[172:175],a[236:239],a[44:47],v[172:175]
buffer_load_dwordx4 v212,s[28:31],s48 offen nt lds
v_exp_f32 v153,v153
v_exp_f32 v157,v157
mf v[168:171],a[236:239],a[40:43],v[168:171]
s_waitcnt lgkmcnt(4)
ds_read_b128 a[232:235],v194 offset:49152
mf v[160:163],a[240:243],a[48:51],v[160:163]
cvp v105,v146,v147
mf v[164:167],a[240:243],a[52:55],v[164:167]
ds_read_b128 a[236:239],v194 offset:57344
cvp v109,v150,v151
mf v[172:175],a[244:247],a[52:55],v[172:175]
v_exp_f32 v154,v154
mf v[168:171],a[244:247],a[48:51],v[168:171]
s_waitcnt lgkmcnt(4)
ds_read_b128 a[240:243],v195 offset:49152
mf v[160:163],a[248:251],a[56:59],v[160:163]
buffer_load_dwordx4 v213,s[28:31],s48 offen offset:1024 nt lds
v_exp_f32 v158,v158
mf v[164:167],a[248:251],a[60:63],v[164:167]
ds_read_b128 a[244:247],v195 offset:57344
v_exp_f32 v155,v155
mf v[172:175],a[252:255],a[60:63],v[172:175]
v_exp_f32 v159,v159
mf v[168:171],a[252:255],a[56:59],v[168:171]
s_waitcnt lgkmcnt(4)
ds_read_b128 a[248:251],v196 offset:49152
mf v[176:179],a[224:227],a[0:3],v[226:229]
cvp v106,v152,v153
mf v[180:183],a[224:227],a[4:7],v[230:233]
ds_read_b128 a[252:255],v196 offset:57344
buffer_load_dwordx4 v214,s[28:31],s48 offen offset:2048 nt lds
mf v[188:191],a[228:231],a[4:7],v[230:233]
cvp v110,v156,v157
cvp v107,v154,v155
mf v[184:187],a[228:231],a[0:3],v[226:229]
s_waitcnt lgkmcnt(4)
ds_read_b128 a[224:227],v193 offset:49408
mf v[176:179],a[232:235],a[8:11],v[176:179]
cvp v111,v158,v159
mf v[180:183],a[232:235],a[12:15],v[180:183]
ds_read_b128 a[228:231],v193 offset:57600
v_exp_f32 v160,v160
mf v[188:191],a[236:239],a[12:15],v[188:191]
v_exp_f32 v164,v164
mf v[184:187],a[236:239],a[8:11],v[184:187]
s_waitcnt lgkmcnt(4)
ds_read_b128 a[232:235],v194 offset:49408
buffer_load_dwordx4 v215,s[28:31],s48 offen offset:3072 nt lds
mf v[176:179],a[240:243],a[16:19],v[176:179]
v_exp_f32 v161,v161
v_exp_f32 v165,v165
mf v[180:183],a[240:243],a[20:23],v[180:183]
ds_read_b128 a[236:239],v194 offset:57600
v_exp_f32 v162,v162
mf v[188:191],a[244:247],a[20:23],v[188:191]
v_exp_f32 v166,v166
mf v[184:187],a[244:247],a[16:19],v[184:187]
s_waitcnt lgkmcnt(4)
ds_read_b128 a[240:243],v195 offset:49408
mf v[176:179],a[248:251],a[24:27],v[176:179]
v_exp_f32 v163,v163
v_exp_f32 v167,v167
mf v[180:183],a[248:251],a[28:31],v[180:183]
ds_read_b128 a[244:247],v195 offset:57600
cvp v112,v160,v161
mf v[188:191],a[252:255],a[28:31],v[188:191]
cvp v116,v164,v165
mf v[184:187],a[252:255],a[24:27],v[184:187]
s_waitcnt lgkmcnt(4)
ds_read_b128 a[248:251],v196 offset:49408
mf v[176:179],a[224:227],a[32:35],v[176:179]
v_exp_f32 v168,v168
v_exp_f32 v172,v172
mf v[180:183],a[224:227],a[36:39],v[180:183]
ds_read_b128 a[252:255],v196 offset:57600
mf v[188:191],a[228:231],a[36:39],v[188:191]
v_exp_f32 v169,v169
mf v[184:187],a[228:231],a[32:35],v[184:187]
s_waitcnt lgkmcnt(4)
s_waitcnt vmcnt(16)
s_barrier
trr a[224:225],v201,16384
mf v[176:179],a[232:235],a[40:43],v[176:179]
trr a[226:227],v201,18432
v_exp_f32 v173,v173
cvp v113,v162,v163
mf v[180:183],a[232:235],a[44:47],v[180:183]
trr a[228:229],v202,16384
trr a[230:231],v202,18432
s_add_u32 m0,s61,49152
s_add_u32 s48,s53,s96
mf v[188:191],a[236:239],a[44:47],v[188:191]
buffer_load_dwordx4 v216,s[36:39],s48 offen lds
cvp v117,v166,v167
v_exp_f32 v170,v170
mf v[184:187],a[236:239],a[40:43],v[184:187]
s_waitcnt lgkmcnt(6)
trr a[232:233],v203,16384
trr a[234:235],v203,18432
mf v[176:179],a[240:243],a[48:51],v[176:179]
v_exp_f32 v174,v174
v_exp_f32 v171,v171
mf v[180:183],a[240:243],a[52:55],v[180:183]
trr a[236:237],v204,16384
trr a[238:239],v204,18432
buffer_load_dwordx4 v217,s[36:39],s48 offen offset:1024 lds
mf v[188:191],a[244:247],a[52:55],v[188:191]
v_exp_f32 v175,v175
cvp v114,v168,v169
mf v[184:187],a[244:247],a[48:51],v[184:187]
s_waitcnt lgkmcnt(8)
trr a[240:241],v201,20480
trr a[242:243],v201,22528
mf v[176:179],a[248:251],a[56:59],v[176:179]
cvp v118,v172,v173
cvp v115,v170,v171
mf v[180:183],a[248:251],a[60:63],v[180:183]
trr a[244:245],v202,20480
trr a[246:247],v202,22528
s_add_u32 m0,s61,57344
mf v[188:191],a[252:255],a[60:63],v[188:191]
s_add_u32 s48,s53,s97
buffer_load_dwordx4 v216,s[36:39],s48 offen lds
cvp v119,v174,v175
mf v[184:187],a[252:255],a[56:59],v[184:187]
s_waitcnt lgkmcnt(8)
trr a[248:249],v203,20480
trr a[250:251],v203,22528
v_mov_b32 v168,0x3f803f80
mf v[128:131],a[224:227],v[0:3],0
v_mov_b32 v169,0x3f803f80
v_mov_b32 v170,0x3f803f80
v_mov_b32 v171,0x3f803f80
mf v[132:135],a[224:227],v[4:7],0
trr a[252:253],v204,20480
trr a[254:255],v204,22528
mf v[140:143],a[228:231],v[4:7],0
buffer_load_dwordx4 v217,s[36:39],s48 offen offset:1024 lds
mf v[136:139],a[228:231],v[0:3],0
s_waitcnt lgkmcnt(8)
trr a[224:225],v201,24576
mf v[144:147],a[232:235],v[0:3],0
trr a[226:227],v201,26624
mf v[160:163],v[168:171],v[0:3],0
mf v[148:151],a[232:235],v[4:7],0
trr a[228:229],v202,24576
trr a[230:231],v202,26624
s_add_u32 m0,s49,65536
s_add_u32 s48,s51,196608
mf v[156:159],a[236:239],v[4:7],0
buffer_load_dwordx4 v212,s[28:31],s48 offen nt lds
v_exp_f32 v176,v176
v_exp_f32 v180,v180
mf v[164:167],v[168:171],v[4:7],0
mf v[152:155],a[236:239],v[0:3],0
s_waitcnt lgkmcnt(8)
trr a[232:233],v203,24576
trr a[234:235],v203,26624
mf v[128:131],a[240:243],v[8:11],v[128:131]
v_exp_f32 v177,v177
v_exp_f32 v181,v181
mf v[132:135],a[240:243],v[12:15],v[132:135]
trr a[236:237],v204,24576
trr a[238:239],v204,26624
buffer_load_dwordx4 v213,s[28:31],s48 offen offset:1024 nt lds
mf v[140:143],a[244:247],v[12:15],v[140:143]
v_exp_f32 v178,v178
v_exp_f32 v182,v182
mf v[136:139],a[244:247],v[8:11],v[136:139]
s_waitcnt lgkmcnt(8)
trr a[240:241],v201,28672
trr a[242:243],v201,30720
mf v[144:147],a[248:251],v[8:11],v[144:147]
v_exp_f32 v179,v179
v_exp_f32 v183,v183
mf v[160:163],v[168:171],v[8:11],v[160:163]
mf v[148:151],a[248:251],v[12:15],v[148:151]
trr a[244:245],v202,28672
trr a[246:247],v202,30720
buffer_load_dwordx4 v214,s[28:31],s48 offen offset:2048 nt lds
mf v[156:159],a[252:255],v[12:15],v[156:159]
cvp v120,v176,v177
cvp v124,v180,v181
mf v[164:167],v[168:171],v[12:15],v[164:167]
mf v[152:155],a[252:255],v[8:11],v[152:155]
s_waitcnt lgkmcnt(8)
trr a[248:249],v203,28672
trr a[250:251],v203,30720
mf v[128:131],a[224:227],v[16:19],v[128:131]
v_exp_f32 v184,v184
v_exp_f32 v188,v188
mf v[132:135],a[224:227],v[20:23],v[132:135]
v_add_u32 v201,0x20000,v201
trr a[252:253],v204,28672
trr a[254:255],v204,30720
mf v[140:143],a[228:231],v[20:23],v[140:143]
buffer_load_dwordx4 v215,s[28:31],s48 offen offset:3072 nt lds
v_exp_f32 v185,v185
v_exp_f32 v189,v189
mf v[136:139],a[228:231],v[16:19],v[136:139]
s_waitcnt lgkmcnt(8)
s_waitcnt vmcnt(16)
s_barrier
v_add_u32 v202,0x20000,v202
trr a[224:225],v201,0
mf v[144:147],a[232:235],v[16:19],v[144:147]
trr a[226:227],v201,2048
cvp v121,v178,v179
cvp v125,v182,v183
mf v[160:163],v[168:171],v[16:19],v[160:163]
mf v[148:151],a[232:235],v[20:23],v[148:151]
v_add_u32 v203,0x20000,v203
trr a[228:229],v202,0
trr a[230:231],v202,2048
mf v[156:159],a[236:239],v[20:23],v[156:159]
v_exp_f32 v186,v186
v_exp_f32 v190,v190
mf v[164:167],v[168:171],v[20:23],v[164:167]
mf v[152:155],a[236:239],v[16:19],v[152:155]
s_waitcnt lgkmcnt(8)
v_add_u32 v204,0x20000,v204
trr a[232:233],v203,0
mf v[128:131],a[240:243],v[24:27],v[128:131]
trr a[234:235],v203,2048
v_exp_f32 v187,v187
v_exp_f32 v191,v191
mf v[132:135],a[240:243],v[28:31],v[132:135]
trr a[236:237],v204,0
trr a[238:239],v204,2048
mf v[140:143],a[244:247],v[28:31],v[140:143]
cvp v122,v184,v185
cvp v126,v188,v189
mf v[136:139],a[244:247],v[24:27],v[136:139]
s_waitcnt lgkmcnt(8)
trr a[240:241],v201,4096
trr a[242:243],v201,6144
mf v[144:147],a[248:251],v[24:27],v[144:147]
cvp v123,v186,v187
cvp v127,v190,v191
mf v[160:163],v[168:171],v[24:27],v[160:163]
mf v[148:151],a[248:251],v[28:31],v[148:151]
trr a[244:245],v202,4096
trr a[246:247],v202,6144
mf v[156:159],a[252:255],v[28:31],v[156:159]
mf v[164:167],v[168:171],v[28:31],v[164:167]
mf v[152:155],a[252:255],v[24:27],v[152:155]
s_waitcnt lgkmcnt(8)
trr a[248:249],v203,4096
mf v[128:131],a[224:227],v[32:35],v[128:131]
trr a[250:251],v203,6144
mf v[132:135],a[224:227],v[36:39],v[132:135]
trr a[252:253],v204,4096
mf v[140:143],a[228:231],v[36:39],v[140:143]
trr a[254:255],v204,6144
mf v[136:139],a[228:231],v[32:35],v[136:139]
s_waitcnt lgkmcnt(8)
trr a[224:225],v201,8192
mf v[144:147],a[232:235],v[32:35],v[144:147]
trr a[226:227],v201,10240
mf v[160:163],v[168:171],v[32:35],v[160:163]
mf v[148:151],a[232:235],v[36:39],v[148:151]
trr a[228:229],v202,8192
trr a[230:231],v202,10240
mf v[156:159],a[236:239],v[36:39],v[156:159]
mf v[164:167],v[168:171],v[36:39],v[164:167]
mf v[152:155],a[236:239],v[32:35],v[152:155]
s_waitcnt lgkmcnt(8)
trr a[232:233],v203,8192
mf v[128:131],a[240:243],v[40:43],v[128:131]
trr a[234:235],v203,10240
mf v[132:135],a[240:243],v[44:47],v[132:135]
trr a[236:237],v204,8192
mf v[140:143],a[244:247],v[44:47],v[140:143]
trr a[238:239],v204,10240
mf v[136:139],a[244:247],v[40:43],v[136:139]
s_waitcnt lgkmcnt(8)
trr a[240:241],v201,12288
mf v[144:147],a[248:251],v[40:43],v[144:147]
trr a[242:243],v201,14336
mf v[160:163],v[168:171],v[40:43],v[160:163]
mf v[148:151],a[248:251],v[44:47],v[148:151]
trr a[244:245],v202,12288
trr a[246:247],v202,14336
mf v[156:159],a[252:255],v[44:47],v[156:159]
mf v[164:167],v[168:171],v[44:47],v[164:167]
mf v[152:155],a[252:255],v[40:43],v[152:155]
s_waitcnt lgkmcnt(8)
trr a[248:249],v203,12288
mf v[128:131],a[224:227],v[48:51],v[128:131]
trr a[250:251],v203,14336
mf v[132:135],a[224:227],v[52:55],v[132:135]
v_add_u32 v201,0xfffe0000,v201
trr a[252:253],v204,12288
mf v[140:143],a[228:231],v[52:55],v[140:143]
trr a[254:255],v204,14336
mf v[136:139],a[228:231],v[48:51],v[136:139]
s_waitcnt lgkmcnt(8)
s_waitcnt vmcnt(8)
s_barrier
v_add_u32 v202,0xfffe0000,v202
mf v[144:147],a[232:235],v[48:51],v[144:147]
trr a[224:225],v201,32768
trr a[226:227],v201,34816
mf v[160:163],v[168:171],v[48:51],v[160:163]
mf v[148:151],a[232:235],v[52:55],v[148:151]
v_add_u32 v203,0xfffe0000,v203
trr a[228:229],v202,32768
trr a[230:231],v202,34816
s_add_u32 m0,s61,16384
mf v[156:159],a[236:239],v[52:55],v[156:159]
s_add_u32 s48,s53,s98
buffer_load_dwordx4 v216,s[36:39],s48 offen lds
mf v[164:167],v[168:171],v[52:55],v[164:167]
mf v[152:155],a[236:239],v[48:51],v[152:155]
s_waitcnt lgkmcnt(8)
v_add_u32 v204,0xfffe0000,v204
mf v[128:131],a[240:243],v[56:59],v[128:131]
trr a[232:233],v203,32768
trr a[234:235],v203,34816
mf v[132:135],a[240:243],v[60:63],v[132:135]
trr a[236:237],v204,32768
trr a[238:239],v204,34816
mf v[140:143],a[244:247],v[60:63],v[140:143]
buffer_load_dwordx4 v217,s[36:39],s48 offen offset:1024 lds
mf v[136:139],a[244:247],v[56:59],v[136:139]
s_waitcnt lgkmcnt(8)
trr a[240:241],v201,36864
mf v[144:147],a[248:251],v[56:59],v[144:147]
trr a[242:243],v201,38912
mf v[160:163],v[168:171],v[56:59],v[160:163]
mf v[148:151],a[248:251],v[60:63],v[148:151]
trr a[244:245],v202,36864
trr a[246:247],v202,38912
s_add_u32 m0,s49,81920
mf v[156:159],a[252:255],v[60:63],v[156:159]
s_add_u32 s48,s51,128
buffer_load_dwordx4 v212,s[28:31],s48 offen nt lds
mf v[164:167],v[168:171],v[60:63],v[164:167]
mf v[152:155],a[252:255],v[56:59],v[152:155]
s_waitcnt lgkmcnt(8)
trr a[248:249],v203,36864
mf v[128:131],a[224:227],v[64:67],v[128:131]
trr a[250:251],v203,38912
mf v[132:135],a[224:227],v[68:71],v[132:135]
trr a[252:253],v204,36864
trr a[254:255],v204,38912
mf v[140:143],a[228:231],v[68:71],v[140:143]
buffer_load_dwordx4 v213,s[28:31],s48 offen offset:1024 nt lds
mf v[136:139],a[228:231],v[64:67],v[136:139]
s_waitcnt lgkmcnt(8)
trr a[224:225],v201,40960
mf v[144:147],a[232:235],v[64:67],v[144:147]
trr a[226:227],v201,43008
mf v[160:163],v[168:171],v[64:67],v[160:163]
mf v[148:151],a[232:235],v[68:71],v[148:151]
trr a[228:229],v202,40960
trr a[230:231],v202,43008
mf v[156:159],a[236:239],v[68:71],v[156:159]
buffer_load_dwordx4 v214,s[28:31],s48 offen offset:2048 nt lds
mf v[164:167],v[168:171],v[68:71],v[164:167]
mf v[152:155],a[236:239],v[64:67],v[152:155]
s_waitcnt lgkmcnt(8)
trr a[232:233],v203,40960
mf v[128:131],a[240:243],v[72:75],v[128:131]
trr a[234:235],v203,43008
mf v[132:135],a[240:243],v[76:79],v[132:135]
trr a[236:237],v204,40960
trr a[238:239],v204,43008
mf v[140:143],a[244:247],v[76:79],v[140:143]
buffer_load_dwordx4 v215,s[28:31],s48 offen offset:3072 nt lds
mf v[136:139],a[244:247],v[72:75],v[136:139]
s_waitcnt lgkmcnt(8)
trr a[240:241],v201,45056
mf v[144:147],a[248:251],v[72:75],v[144:147]
trr a[242:243],v201,47104
mf v[160:163],v[168:171],v[72:75],v[160:163]
mf v[148:151],a[248:251],v[76:79],v[148:151]
trr a[244:245],v202,45056
trr a[246:247],v202,47104
mf v[156:159],a[252:255],v[76:79],v[156:159]
mf v[164:167],v[168:171],v[76:79],v[164:167]
mf v[152:155],a[252:255],v[72:75],v[152:155]
s_waitcnt lgkmcnt(8)
trr a[248:249],v203,45056
mf v[128:131],a[224:227],v[80:83],v[128:131]
trr a[250:251],v203,47104
mf v[132:135],a[224:227],v[84:87],v[132:135]
v_add_u32 v201,0x10000,v201
trr a[252:253],v204,45056
mf v[140:143],a[228:231],v[84:87],v[140:143]
trr a[254:255],v204,47104
mf v[136:139],a[228:231],v[80:83],v[136:139]
s_waitcnt lgkmcnt(8)
s_waitcnt vmcnt(6)
s_barrier
v_add_u32 v202,0x10000,v202
mf v[144:147],a[232:235],v[80:83],v[144:147]
trr a[224:225],v201,0
trr a[226:227],v201,2048
mf v[160:163],v[168:171],v[80:83],v[160:163]
mf v[148:151],a[232:235],v[84:87],v[148:151]
trr a[228:229],v202,0
trr a[230:231],v202,2048
s_add_u32 m0,s49,114688
mf v[156:159],a[236:239],v[84:87],v[156:159]
s_add_u32 s48,s51,65664
buffer_load_dwordx4 v212,s[28:31],s48 offen nt lds
mf v[164:167],v[168:171],v[84:87],v[164:167]
mf v[152:155],a[236:239],v[80:83],v[152:155]
s_waitcnt lgkmcnt(8)
trr a[232:233],v201,4096
mf v[128:131],a[240:243],v[88:91],v[128:131]
trr a[234:235],v201,6144
mf v[132:135],a[240:243],v[92:95],v[132:135]
trr a[236:237],v202,4096
mf v[140:143],a[244:247],v[92:95],v[140:143]
trr a[238:239],v202,6144
mf v[136:139],a[244:247],v[88:91],v[136:139]
s_waitcnt lgkmcnt(8)
trr a[240:241],v201,8192
trr a[242:243],v201,10240
mf v[144:147],a[248:251],v[88:91],v[144:147]
buffer_load_dwordx4 v213,s[28:31],s48 offen offset:1024 nt lds
mf v[160:163],v[168:171],v[88:91],v[160:163]
mf v[148:151],a[248:251],v[92:95],v[148:151]
trr a[244:245],v202,8192
trr a[246:247],v202,10240
mf v[156:159],a[252:255],v[92:95],v[156:159]
mf v[164:167],v[168:171],v[92:95],v[164:167]
mf v[152:155],a[252:255],v[88:91],v[152:155]
s_waitcnt lgkmcnt(8)
trr a[248:249],v201,12288
mf v[128:131],a[224:227],v[96:99],v[128:131]
trr a[250:251],v201,14336
mf v[160:163],v[168:171],v[96:99],v[160:163]
mf v[132:135],a[224:227],v[100:103],v[132:135]
v_add_u32 v203,0x10000,v203
trr a[252:253],v202,12288
trr a[254:255],v202,14336
mf v[140:143],a[228:231],v[100:103],v[140:143]
buffer_load_dwordx4 v214,s[28:31],s48 offen offset:2048 nt lds
mf v[164:167],v[168:171],v[100:103],v[164:167]
mf v[136:139],a[228:231],v[96:99],v[136:139]
s_waitcnt lgkmcnt(8)
v_add_u32 v204,0x10000,v204
trr a[224:225],v203,0
mf v[128:131],a[232:235],v[104:107],v[128:131]
trr a[226:227],v203,2048
mf v[160:163],v[168:171],v[104:107],v[160:163]
mf v[132:135],a[232:235],v[108:111],v[132:135]
trr a[228:229],v204,0
trr a[230:231],v204,2048
mf v[140:143],a[236:239],v[108:111],v[140:143]
mf v[164:167],v[168:171],v[108:111],v[164:167]
mf v[136:139],a[236:239],v[104:107],v[136:139]
s_waitcnt lgkmcnt(8)
trr a[232:233],v203,4096
trr a[234:235],v203,6144
mf v[128:131],a[240:243],v[112:115],v[128:131]
buffer_load_dwordx4 v215,s[28:31],s48 offen offset:3072 nt lds
mf v[160:163],v[168:171],v[112:115],v[160:163]
mf v[132:135],a[240:243],v[116:119],v[132:135]
trr a[236:237],v204,4096
trr a[238:239],v204,6144
mf v[140:143],a[244:247],v[116:119],v[140:143]
mf v[164:167],v[168:171],v[116:119],v[164:167]
mf v[136:139],a[244:247],v[112:115],v[136:139]
s_waitcnt lgkmcnt(8)
trr a[240:241],v203,8192
mf v[128:131],a[248:251],v[120:123],v[128:131]
trr a[242:243],v203,10240
mf v[160:163],v[168:171],v[120:123],v[160:163]
mf v[132:135],a[248:251],v[124:127],v[132:135]
trr a[244:245],v204,8192
trr a[246:247],v204,10240
mf v[140:143],a[252:255],v[124:127],v[140:143]
mf v[164:167],v[168:171],v[124:127],v[164:167]
mf v[136:139],a[252:255],v[120:123],v[136:139]
s_waitcnt lgkmcnt(8)
trr a[248:249],v203,12288
mf v[144:147],a[224:227],v[96:99],v[144:147]
trr a[250:251],v203,14336
mf v[148:151],a[224:227],v[100:103],v[148:151]
trr a[252:253],v204,12288
mf v[156:159],a[228:231],v[100:103],v[156:159]
trr a[254:255],v204,14336
mf v[152:155],a[228:231],v[96:99],v[152:155]
s_waitcnt lgkmcnt(8)
s_barrier
trr a[224:225],v201,32768
mf v[144:147],a[232:235],v[104:107],v[144:147]
trr a[226:227],v201,34816
v_rcp_f32 v224,v160
v_rcp_f32 v225,v164
mf v[148:151],a[232:235],v[108:111],v[148:151]
trr a[228:229],v202,32768
trr a[230:231],v202,34816
v_mul_f32 v128,v128,v224
v_mul_f32 v129,v129,v224
mf v[156:159],a[236:239],v[108:111],v[156:159]
v_mul_f32 v130,v130,v224
v_mul_f32 v131,v131,v224
v_mul_f32 v136,v136,v224
mf v[152:155],a[236:239],v[104:107],v[152:155]
s_waitcnt lgkmcnt(8)
trr a[232:233],v203,32768
trr a[234:235],v203,34816
v_mul_f32 v137,v137,v224
mf v[144:147],a[240:243],v[112:115],v[144:147]
v_mul_f32 v138,v138,v224
v_mul_f32 v139,v139,v224
v_mul_f32 v132,v132,v225
v_mul_f32 v133,v133,v225
mf v[148:151],a[240:243],v[116:119],v[148:151]
trr a[236:237],v204,32768
trr a[238:239],v204,34816
v_mul_f32 v134,v134,v225
v_mul_f32 v135,v135,v225
mf v[156:159],a[244:247],v[116:119],v[156:159]
v_mul_f32 v140,v140,v225
v_mul_f32 v141,v141,v225
v_mul_f32 v142,v142,v225
mf v[152:155],a[244:247],v[112:115],v[152:155]
s_waitcnt lgkmcnt(8)
trr a[240:241],v201,36864
trr a[242:243],v201,38912
v_mul_f32 v143,v143,v225
mf v[144:147],a[248:251],v[120:123],v[144:147]
cvp v128,v128,v129
cvp v129,v130,v131
cvp v130,v136,v137
cvp v131,v138,v139
mf v[148:151],a[248:251],v[124:127],v[148:151]
trr a[244:245],v202,36864
trr a[246:247],v202,38912
cvp v132,v132,v133
mf v[156:159],a[252:255],v[124:127],v[156:159]
cvp v133,v134,v135
cvp v134,v140,v141
cvp v135,v142,v143
mf v[152:155],a[252:255],v[120:123],v[152:155]
s_waitcnt lgkmcnt(8)
trr a[248:249],v203,36864
mf a[0:3],a[224:227],v[128:131],0
trr a[250:251],v203,38912
mf a[4:7],a[224:227],v[132:135],0
trr a[252:253],v204,36864
trr a[254:255],v204,38912
v_mul_f32 v144,v144,v224
v_mul_f32 v145,v145,v224
v_mul_f32 v146,v146,v224
mf a[12:15],a[228:231],v[132:135],0
v_mul_f32 v147,v147,v224
v_mul_f32 v152,v152,v224
v_mul_f32 v153,v153,v224
v_mul_f32 v154,v154,v224
v_mul_f32 v155,v155,v224
mf a[8:11],a[228:231],v[128:131],0
s_waitcnt lgkmcnt(8)
trr a[224:225],v201,40960
trr a[226:227],v201,43008
v_mul_f32 v148,v148,v225
v_mul_f32 v149,v149,v225
v_mul_f32 v150,v150,v225
mf a[16:19],a[232:235],v[128:131],0
v_mul_f32 v151,v151,v225
v_mul_f32 v156,v156,v225
v_mul_f32 v157,v157,v225
v_mul_f32 v158,v158,v225
v_mul_f32 v159,v159,v225
mf a[20:23],a[232:235],v[132:135],0
trr a[228:229],v202,40960
trr a[230:231],v202,43008
cvp v136,v144,v145
cvp v137,v146,v147
cvp v138,v152,v153
mf a[28:31],a[236:239],v[132:135],0
cvp v139,v154,v155
cvp v140,v148,v149
cvp v141,v150,v151
cvp v142,v156,v157
cvp v143,v158,v159
mf a[24:27],a[236:239],v[128:131],0
s_waitcnt lgkmcnt(8)
trr a[232:233],v203,40960
mf a[0:3],a[240:243],v[136:139],a[0:3]
trr a[234:235],v203,43008
mf a[4:7],a[240:243],v[140:143],a[4:7]
trr a[236:237],v204,40960
trr a[238:239],v204,43008
mf a[12:15],a[244:247],v[140:143],a[12:15]
v_mov_b32 v234,0x49800000
v_cmp_nlt_f32 vcc,v160,v234
s_nop 3
s_mov_b64 s[56:57],vcc
v_cmp_nlt_f32 vcc,v164,v234
s_nop 3
s_or_b64 vcc,vcc,s[56:57]
s_cbranch_vccz L_safe_ok
s_lshl_b32 s56,s55,4
s_add_u32 s56,s56,s54
v_mov_b32 v234,s56
v_mov_b32 v235,2
global_store_byte v234,v235,s[16:17] sc1
s_waitcnt vmcnt(0)
L_safe_ok:
mf a[8:11],a[244:247],v[136:139],a[8:11]
s_waitcnt lgkmcnt(8)
trr a[240:241],v201,45056
mf a[16:19],a[248:251],v[136:139],a[16:19]
trr a[242:243],v201,47104
mf a[20:23],a[248:251],v[140:143],a[20:23]
trr a[244:245],v202,45056
mf a[28:31],a[252:255],v[140:143],a[28:31]
trr a[246:247],v202,47104
mf a[24:27],a[252:255],v[136:139],a[24:27]
s_waitcnt lgkmcnt(8)
trr a[248:249],v203,45056
mf a[32:35],a[224:227],v[128:131],0
trr a[250:251],v203,47104
mf a[36:39],a[224:227],v[132:135],0
v_add_u32 v201,0xffff0000,v201
trr a[252:253],v204,45056
mf a[44:47],a[228:231],v[132:135],0
trr a[254:255],v204,47104
mf a[40:43],a[228:231],v[128:131],0
s_waitcnt lgkmcnt(8)
s_barrier
mf a[48:51],a[232:235],v[128:131],0
v_add_u32 v202,0xffff0000,v202
trr a[224:225],v201,0
trr a[226:227],v201,2048
mf a[52:55],a[232:235],v[132:135],0
v_add_u32 v203,0xffff0000,v203
trr a[228:229],v202,0
trr a[230:231],v202,2048
s_add_u32 m0,s61,32768
s_add_u32 s48,s53,s92
s_add_u32 s48,s48,57344
mf a[60:63],a[236:239],v[132:135],0
buffer_load_dwordx4 v216,s[36:39],s48 offen lds
s_lshl_b32 s56,s55,4
s_add_u32 s56,s56,s54
v_mov_b32 v235,s56
global_load_ubyte v234,v235,s[16:17] sc1
mf a[56:59],a[236:239],v[128:131],0
s_waitcnt lgkmcnt(8)
v_add_u32 v204,0xffff0000,v204
mf a[32:35],a[240:243],v[136:139],a[32:35]
trr a[232:233],v203,0
trr a[234:235],v203,2048
mf a[36:39],a[240:243],v[140:143],a[36:39]
trr a[236:237],v204,0
trr a[238:239],v204,2048
mf a[44:47],a[244:247],v[140:143],a[44:47]
buffer_load_dwordx4 v217,s[36:39],s48 offen offset:1024 lds
mf a[40:43],a[244:247],v[136:139],a[40:43]
s_waitcnt lgkmcnt(8)
trr a[240:241],v201,4096
mf a[48:51],a[248:251],v[136:139],a[48:51]
trr a[242:243],v201,6144
mf a[52:55],a[248:251],v[140:143],a[52:55]
trr a[244:245],v202,4096
trr a[246:247],v202,6144
s_add_u32 m0,s61,40960
mf a[60:63],a[252:255],v[140:143],a[60:63]
s_add_u32 s48,s53,s93
s_add_u32 s48,s48,57344
buffer_load_dwordx4 v216,s[36:39],s48 offen lds
mf a[56:59],a[252:255],v[136:139],a[56:59]
s_waitcnt lgkmcnt(8)
trr a[248:249],v203,4096
mf a[64:67],a[224:227],v[128:131],0
trr a[250:251],v203,6144
mf a[68:71],a[224:227],v[132:135],0
trr a[252:253],v204,4096
trr a[254:255],v204,6144
mf a[76:79],a[228:231],v[132:135],0
buffer_load_dwordx4 v217,s[36:39],s48 offen offset:1024 lds
mf a[72:75],a[228:231],v[128:131],0
s_waitcnt lgkmcnt(8)
trr a[224:225],v201,8192
mf a[80:83],a[232:235],v[128:131],0
trr a[226:227],v201,10240
mf a[84:87],a[232:235],v[132:135],0
trr a[228:229],v202,8192
trr a[230:231],v202,10240
s_add_u32 m0,s49,65536
mf a[92:95],a[236:239],v[132:135],0
s_add_u32 s48,s51,131200
buffer_load_dwordx4 v212,s[28:31],s48 offen nt lds
mf a[88:91],a[236:239],v[128:131],0
s_waitcnt lgkmcnt(8)
trr a[232:233],v203,8192
mf a[64:67],a[240:243],v[136:139],a[64:67]
trr a[234:235],v203,10240
mf a[68:71],a[240:243],v[140:143],a[68:71]
trr a[236:237],v204,8192
trr a[238:239],v204,10240
mf a[76:79],a[244:247],v[140:143],a[76:79]
buffer_load_dwordx4 v213,s[28:31],s48 offen offset:1024 nt lds
mf a[72:75],a[244:247],v[136:139],a[72:75]
s_waitcnt lgkmcnt(8)
trr a[240:241],v201,12288
mf a[80:83],a[248:251],v[136:139],a[80:83]
trr a[242:243],v201,14336
mf a[84:87],a[248:251],v[140:143],a[84:87]
trr a[244:245],v202,12288
trr a[246:247],v202,14336
mf a[92:95],a[252:255],v[140:143],a[92:95]
buffer_load_dwordx4 v214,s[28:31],s48 offen offset:2048 nt lds
mf a[88:91],a[252:255],v[136:139],a[88:91]
s_waitcnt lgkmcnt(8)
trr a[248:249],v203,12288
mf a[96:99],a[224:227],v[128:131],0
trr a[250:251],v203,14336
mf a[100:103],a[224:227],v[132:135],0
trr a[252:253],v204,12288
trr a[254:255],v204,14336
mf a[108:111],a[228:231],v[132:135],0
buffer_load_dwordx4 v215,s[28:31],s48 offen offset:3072 nt lds
mf a[104:107],a[228:231],v[128:131],0
s_waitcnt lgkmcnt(8)
s_barrier
mf a[112:115],a[232:235],v[128:131],0
trr a[224:225],v201,49152
trr a[226:227],v201,51200
mf a[116:119],a[232:235],v[132:135],0
trr a[228:229],v202,49152
mf a[124:127],a[236:239],v[132:135],0
trr a[230:231],v202,51200
mf a[120:123],a[236:239],v[128:131],0
s_waitcnt lgkmcnt(8)
trr a[232:233],v203,49152
mf a[96:99],a[240:243],v[136:139],a[96:99]
trr a[234:235],v203,51200
mf a[100:103],a[240:243],v[140:143],a[100:103]
trr a[236:237],v204,49152
mf a[108:111],a[244:247],v[140:143],a[108:111]
trr a[238:239],v204,51200
mf a[104:107],a[244:247],v[136:139],a[104:107]
s_waitcnt lgkmcnt(8)
trr a[240:241],v201,53248
mf a[112:115],a[248:251],v[136:139],a[112:115]
trr a[242:243],v201,55296
mf a[116:119],a[248:251],v[140:143],a[116:119]
trr a[244:245],v202,53248
mf a[124:127],a[252:255],v[140:143],a[124:127]
trr a[246:247],v202,55296
mf a[120:123],a[252:255],v[136:139],a[120:123]
s_waitcnt lgkmcnt(8)
trr a[248:249],v203,53248
mf a[128:131],a[224:227],v[128:131],0
trr a[250:251],v203,55296
mf a[132:135],a[224:227],v[132:135],0
trr a[252:253],v204,53248
mf a[140:143],a[228:231],v[132:135],0
trr a[254:255],v204,55296
mf a[136:139],a[228:231],v[128:131],0
s_waitcnt lgkmcnt(8)
trr a[224:225],v201,57344
mf a[144:147],a[232:235],v[128:131],0
trr a[226:227],v201,59392
mf a[148:151],a[232:235],v[132:135],0
trr a[228:229],v202,57344
mf a[156:159],a[236:239],v[132:135],0
trr a[230:231],v202,59392
mf a[152:155],a[236:239],v[128:131],0
s_waitcnt lgkmcnt(8)
trr a[232:233],v203,57344
mf a[128:131],a[240:243],v[136:139],a[128:131]
trr a[234:235],v203,59392
mf a[132:135],a[240:243],v[140:143],a[132:135]
trr a[236:237],v204,57344
mf a[140:143],a[244:247],v[140:143],a[140:143]
trr a[238:239],v204,59392
mf a[136:139],a[244:247],v[136:139],a[136:139]
s_waitcnt lgkmcnt(8)
trr a[240:241],v201,61440
mf a[144:147],a[248:251],v[136:139],a[144:147]
trr a[242:243],v201,63488
mf a[148:151],a[248:251],v[140:143],a[148:151]
trr a[244:245],v202,61440
mf a[156:159],a[252:255],v[140:143],a[156:159]
trr a[246:247],v202,63488
mf a[152:155],a[252:255],v[136:139],a[152:155]
s_waitcnt lgkmcnt(8)
trr a[248:249],v203,61440
mf a[160:163],a[224:227],v[128:131],0
trr a[250:251],v203,63488
mf a[164:167],a[224:227],v[132:135],0
trr a[252:253],v204,61440
mf a[172:175],a[228:231],v[132:135],0
trr a[254:255],v204,63488
mf a[168:171],a[228:231],v[128:131],0
s_waitcnt lgkmcnt(8)
s_waitcnt vmcnt(17)
s_barrier
mf a[176:179],a[232:235],v[128:131],0
trr a[224:225],v201,16384
trr a[226:227],v201,18432
mf a[180:183],a[232:235],v[132:135],0
trr a[228:229],v202,16384
mf a[188:191],a[236:239],v[132:135],0
trr a[230:231],v202,18432
mf a[184:187],a[236:239],v[128:131],0
s_waitcnt lgkmcnt(8)
trr a[232:233],v203,16384
mf a[160:163],a[240:243],v[136:139],a[160:163]
trr a[234:235],v203,18432
mf a[164:167],a[240:243],v[140:143],a[164:167]
trr a[236:237],v204,16384
mf a[172:175],a[244:247],v[140:143],a[172:175]
trr a[238:239],v204,18432
mf a[168:171],a[244:247],v[136:139],a[168:171]
s_waitcnt lgkmcnt(8)
trr a[240:241],v201,20480
mf a[176:179],a[248:251],v[136:139],a[176:179]
trr a[242:243],v201,22528
mf a[180:183],a[248:251],v[140:143],a[180:183]
trr a[244:245],v202,20480
mf a[188:191],a[252:255],v[140:143],a[188:191]
trr a[246:247],v202,22528
mf a[184:187],a[252:255],v[136:139],a[184:187]
s_waitcnt lgkmcnt(8)
trr a[248:249],v203,20480
mf a[192:195],a[224:227],v[128:131],0
trr a[250:251],v203,22528
mf a[196:199],a[224:227],v[132:135],0
v_add_u32 v201,0x10000,v201
trr a[252:253],v204,20480
mf a[204:207],a[228:231],v[132:135],0
trr a[254:255],v204,22528
mf a[200:203],a[228:231],v[128:131],0
s_waitcnt lgkmcnt(8)
s_waitcnt vmcnt(13)
s_barrier
mf a[208:211],a[232:235],v[128:131],0
v_add_u32 v202,0x10000,v202
trr a[224:225],v201,16384
trr a[226:227],v201,18432
mf a[212:215],a[232:235],v[132:135],0
v_add_u32 v203,0x10000,v203
trr a[228:229],v202,16384
trr a[230:231],v202,18432
s_add_u32 m0,s61,0
mf a[220:223],a[236:239],v[132:135],0
s_add_u32 s48,s53,s94
s_add_u32 s48,s48,57344
buffer_load_dwordx4 v216,s[36:39],s48 offen lds
mf a[216:219],a[236:239],v[128:131],0
s_waitcnt lgkmcnt(8)
v_add_u32 v204,0x10000,v204
mf a[192:195],a[240:243],v[136:139],a[192:195]
trr a[232:233],v203,16384
trr a[234:235],v203,18432
mf a[196:199],a[240:243],v[140:143],a[196:199]
trr a[236:237],v204,16384
trr a[238:239],v204,18432
mf a[204:207],a[244:247],v[140:143],a[204:207]
buffer_load_dwordx4 v217,s[36:39],s48 offen offset:1024 lds
mf a[200:203],a[244:247],v[136:139],a[200:203]
s_waitcnt lgkmcnt(8)
trr a[240:241],v201,20480
mf a[208:211],a[248:251],v[136:139],a[208:211]
trr a[242:243],v201,22528
mf a[212:215],a[248:251],v[140:143],a[212:215]
trr a[244:245],v202,20480
trr a[246:247],v202,22528
s_add_u32 m0,s61,8192
mf a[220:223],a[252:255],v[140:143],a[220:223]
s_add_u32 s48,s53,s95
s_add_u32 s48,s48,57344
buffer_load_dwordx4 v216,s[36:39],s48 offen lds
mf a[216:219],a[252:255],v[136:139],a[216:219]
s_waitcnt lgkmcnt(8)
trr a[248:249],v203,20480
mf v[128:131],a[224:227],v[0:3],0
trr a[250:251],v203,22528
mf v[132:135],a[224:227],v[4:7],0
trr a[252:253],v204,20480
trr a[254:255],v204,22528
mf v[140:143],a[228:231],v[4:7],0
buffer_load_dwordx4 v217,s[36:39],s48 offen offset:1024 lds
mf v[136:139],a[228:231],v[0:3],0
s_waitcnt lgkmcnt(8)
trr a[224:225],v201,24576
mf v[144:147],a[232:235],v[0:3],0
trr a[226:227],v201,26624
mf v[148:151],a[232:235],v[4:7],0
trr a[228:229],v202,24576
trr a[230:231],v202,26624
s_add_u32 m0,s49,49152
mf v[156:159],a[236:239],v[4:7],0
s_add_u32 s48,s51,196736
buffer_load_dwordx4 v212,s[28:31],s48 offen nt lds
mf v[152:155],a[236:239],v[0:3],0
s_waitcnt lgkmcnt(8)
trr a[232:233],v203,24576
mf v[128:131],a[240:243],v[8:11],v[128:131]
trr a[234:235],v203,26624
mf v[132:135],a[240:243],v[12:15],v[132:135]
trr a[236:237],v204,24576
trr a[238:239],v204,26624
mf v[140:143],a[244:247],v[12:15],v[140:143]
buffer_load_dwordx4 v213,s[28:31],s48 offen offset:1024 nt lds
mf v[136:139],a[244:247],v[8:11],v[136:139]
s_waitcnt lgkmcnt(8)
trr a[240:241],v201,28672
mf v[144:147],a[248:251],v[8:11],v[144:147]
trr a[242:243],v201,30720
mf v[148:151],a[248:251],v[12:15],v[148:151]
trr a[244:245],v202,28672
trr a[246:247],v202,30720
mf v[156:159],a[252:255],v[12:15],v[156:159]
buffer_load_dwordx4 v214,s[28:31],s48 offen offset:2048 nt lds
mf v[152:155],a[252:255],v[8:11],v[152:155]
s_waitcnt lgkmcnt(8)
trr a[248:249],v203,28672
mf v[128:131],a[224:227],v[16:19],v[128:131]
trr a[250:251],v203,30720
mf v[132:135],a[224:227],v[20:23],v[132:135]
trr a[252:253],v204,28672
trr a[254:255],v204,30720
mf v[140:143],a[228:231],v[20:23],v[140:143]
buffer_load_dwordx4 v215,s[28:31],s48 offen offset:3072 nt lds
mf v[136:139],a[228:231],v[16:19],v[136:139]
s_waitcnt lgkmcnt(8)
s_waitcnt vmcnt(17)
s_barrier
mf v[144:147],a[232:235],v[16:19],v[144:147]
trr a[224:225],v201,49152
trr a[226:227],v201,51200
mf v[148:151],a[232:235],v[20:23],v[148:151]
trr a[228:229],v202,49152
mf v[156:159],a[236:239],v[20:23],v[156:159]
trr a[230:231],v202,51200
mf v[152:155],a[236:239],v[16:19],v[152:155]
s_waitcnt lgkmcnt(8)
trr a[232:233],v203,49152
mf v[128:131],a[240:243],v[24:27],v[128:131]
trr a[234:235],v203,51200
mf v[132:135],a[240:243],v[28:31],v[132:135]
trr a[236:237],v204,49152
mf v[140:143],a[244:247],v[28:31],v[140:143]
trr a[238:239],v204,51200
mf v[136:139],a[244:247],v[24:27],v[136:139]
s_waitcnt lgkmcnt(8)
trr a[240:241],v201,53248
mf v[144:147],a[248:251],v[24:27],v[144:147]
trr a[242:243],v201,55296
mf v[148:151],a[248:251],v[28:31],v[148:151]
trr a[244:245],v202,53248
mf v[156:159],a[252:255],v[28:31],v[156:159]
trr a[246:247],v202,55296
mf v[152:155],a[252:255],v[24:27],v[152:155]
s_waitcnt lgkmcnt(8)
trr a[248:249],v203,53248
mf v[128:131],a[224:227],v[32:35],v[128:131]
trr a[250:251],v203,55296
mf v[132:135],a[224:227],v[36:39],v[132:135]
trr a[252:253],v204,53248
mf v[140:143],a[228:231],v[36:39],v[140:143]
trr a[254:255],v204,55296
mf v[136:139],a[228:231],v[32:35],v[136:139]
s_waitcnt lgkmcnt(8)
trr a[224:225],v201,57344
mf v[144:147],a[232:235],v[32:35],v[144:147]
trr a[226:227],v201,59392
mf v[148:151],a[232:235],v[36:39],v[148:151]
trr a[228:229],v202,57344
mf v[156:159],a[236:239],v[36:39],v[156:159]
trr a[230:231],v202,59392
mf v[152:155],a[236:239],v[32:35],v[152:155]
s_waitcnt lgkmcnt(8)
trr a[232:233],v203,57344
mf v[128:131],a[240:243],v[40:43],v[128:131]
trr a[234:235],v203,59392
mf v[132:135],a[240:243],v[44:47],v[132:135]
trr a[236:237],v204,57344
mf v[140:143],a[244:247],v[44:47],v[140:143]
trr a[238:239],v204,59392
mf v[136:139],a[244:247],v[40:43],v[136:139]
s_waitcnt lgkmcnt(8)
trr a[240:241],v201,61440
mf v[144:147],a[248:251],v[40:43],v[144:147]
trr a[242:243],v201,63488
mf v[148:151],a[248:251],v[44:47],v[148:151]
trr a[244:245],v202,61440
mf v[156:159],a[252:255],v[44:47],v[156:159]
trr a[246:247],v202,63488
mf v[152:155],a[252:255],v[40:43],v[152:155]
s_waitcnt lgkmcnt(8)
trr a[248:249],v203,61440
mf v[128:131],a[224:227],v[48:51],v[128:131]
trr a[250:251],v203,63488
mf v[132:135],a[224:227],v[52:55],v[132:135]
trr a[252:253],v204,61440
mf v[140:143],a[228:231],v[52:55],v[140:143]
trr a[254:255],v204,63488
mf v[136:139],a[228:231],v[48:51],v[136:139]
s_waitcnt lgkmcnt(8)
s_waitcnt vmcnt(8)
s_barrier
mf v[144:147],a[232:235],v[48:51],v[144:147]
trr a[224:225],v201,0
trr a[226:227],v201,2048
mf v[148:151],a[232:235],v[52:55],v[148:151]
trr a[228:229],v202,0
trr a[230:231],v202,2048
s_add_u32 m0,s61,16384
mf v[156:159],a[236:239],v[52:55],v[156:159]
s_add_u32 s48,s53,s96
s_add_u32 s48,s48,57344
buffer_load_dwordx4 v216,s[36:39],s48 offen lds
mf v[152:155],a[236:239],v[48:51],v[152:155]
s_waitcnt lgkmcnt(8)
trr a[232:233],v203,0
mf v[128:131],a[240:243],v[56:59],v[128:131]
trr a[234:235],v203,2048
mf v[132:135],a[240:243],v[60:63],v[132:135]
trr a[236:237],v204,0
trr a[238:239],v204,2048
mf v[140:143],a[244:247],v[60:63],v[140:143]
buffer_load_dwordx4 v217,s[36:39],s48 offen offset:1024 lds
mf v[136:139],a[244:247],v[56:59],v[136:139]
s_waitcnt lgkmcnt(8)
trr a[240:241],v201,4096
mf v[144:147],a[248:251],v[56:59],v[144:147]
trr a[242:243],v201,6144
mf v[148:151],a[248:251],v[60:63],v[148:151]
trr a[244:245],v202,4096
trr a[246:247],v202,6144
s_add_u32 m0,s61,24576
mf v[156:159],a[252:255],v[60:63],v[156:159]
s_add_u32 s48,s53,s97
s_add_u32 s48,s48,57344
buffer_load_dwordx4 v216,s[36:39],s48 offen lds
mf v[152:155],a[252:255],v[56:59],v[152:155]
s_waitcnt lgkmcnt(8)
trr a[248:249],v203,4096
mf v[128:131],a[224:227],v[64:67],v[128:131]
trr a[250:251],v203,6144
mf v[132:135],a[224:227],v[68:71],v[132:135]
trr a[252:253],v204,4096
trr a[254:255],v204,6144
mf v[140:143],a[228:231],v[68:71],v[140:143]
buffer_load_dwordx4 v217,s[36:39],s48 offen offset:1024 lds
mf v[136:139],a[228:231],v[64:67],v[136:139]
s_waitcnt lgkmcnt(8)
trr a[224:225],v201,8192
mf v[144:147],a[232:235],v[64:67],v[144:147]
trr a[226:227],v201,10240
mf v[148:151],a[232:235],v[68:71],v[148:151]
trr a[228:229],v202,8192
trr a[230:231],v202,10240
s_add_u32 m0,s49,81920
mf v[156:159],a[236:239],v[68:71],v[156:159]
s_add_u32 s48,s51,256
buffer_load_dwordx4 v212,s[28:31],s48 offen nt lds
mf v[152:155],a[236:239],v[64:67],v[152:155]
s_waitcnt lgkmcnt(8)
trr a[232:233],v203,8192
mf v[128:131],a[240:243],v[72:75],v[128:131]
trr a[234:235],v203,10240
mf v[132:135],a[240:243],v[76:79],v[132:135]
trr a[236:237],v204,8192
trr a[238:239],v204,10240
mf v[140:143],a[244:247],v[76:79],v[140:143]
buffer_load_dwordx4 v213,s[28:31],s48 offen offset:1024 nt lds
mf v[136:139],a[244:247],v[72:75],v[136:139]
s_waitcnt lgkmcnt(8)
trr a[240:241],v201,12288
mf v[144:147],a[248:251],v[72:75],v[144:147]
trr a[242:243],v201,14336
mf v[148:151],a[248:251],v[76:79],v[148:151]
trr a[244:245],v202,12288
trr a[246:247],v202,14336
mf v[156:159],a[252:255],v[76:79],v[156:159]
buffer_load_dwordx4 v214,s[28:31],s48 offen offset:2048 nt lds
mf v[152:155],a[252:255],v[72:75],v[152:155]
s_waitcnt lgkmcnt(8)
trr a[248:249],v203,12288
mf v[128:131],a[224:227],v[80:83],v[128:131]
trr a[250:251],v203,14336
mf v[132:135],a[224:227],v[84:87],v[132:135]
v_add_u32 v201,0xffff0000,v201
trr a[252:253],v204,12288
mf v[140:143],a[228:231],v[84:87],v[140:143]
trr a[254:255],v204,14336
buffer_load_dwordx4 v215,s[28:31],s48 offen offset:3072 nt lds
mf v[136:139],a[228:231],v[80:83],v[136:139]
s_waitcnt lgkmcnt(8)
s_waitcnt vmcnt(8)
s_barrier
mf v[144:147],a[232:235],v[80:83],v[144:147]
v_add_u32 v202,0xffff0000,v202
trr a[224:225],v201,49152
trr a[226:227],v201,51200
mf v[148:151],a[232:235],v[84:87],v[148:151]
trr a[228:229],v202,49152
trr a[230:231],v202,51200
s_add_u32 m0,s61,98304
mf v[156:159],a[236:239],v[84:87],v[156:159]
s_add_u32 s48,s53,s98
s_add_u32 s48,s48,57344
buffer_load_dwordx4 v216,s[36:39],s48 offen lds
mf v[152:155],a[236:239],v[80:83],v[152:155]
s_waitcnt lgkmcnt(8)
trr a[232:233],v201,53248
mf v[128:131],a[240:243],v[88:91],v[128:131]
trr a[234:235],v201,55296
mf v[132:135],a[240:243],v[92:95],v[132:135]
trr a[236:237],v202,53248
mf v[140:143],a[244:247],v[92:95],v[140:143]
trr a[238:239],v202,55296
mf v[136:139],a[244:247],v[88:91],v[136:139]
s_waitcnt lgkmcnt(8)
trr a[240:241],v201,57344
mf v[144:147],a[248:251],v[88:91],v[144:147]
trr a[242:243],v201,59392
buffer_load_dwordx4 v217,s[36:39],s48 offen offset:1024 lds
mf v[148:151],a[248:251],v[92:95],v[148:151]
trr a[244:245],v202,57344
mf v[156:159],a[252:255],v[92:95],v[156:159]
trr a[246:247],v202,59392
mf v[152:155],a[252:255],v[88:91],v[152:155]
s_waitcnt lgkmcnt(8)
trr a[248:249],v201,61440
mf v[128:131],a[224:227],v[96:99],v[128:131]
trr a[250:251],v201,63488
mf v[132:135],a[224:227],v[100:103],v[132:135]
v_add_u32 v203,0xffff0000,v203
trr a[252:253],v202,61440
mf v[140:143],a[228:231],v[100:103],v[140:143]
trr a[254:255],v202,63488
mf v[136:139],a[228:231],v[96:99],v[136:139]
s_waitcnt lgkmcnt(8)
v_add_u32 v204,0xffff0000,v204
mf v[128:131],a[232:235],v[104:107],v[128:131]
trr a[224:225],v203,49152
trr a[226:227],v203,51200
mf v[132:135],a[232:235],v[108:111],v[132:135]
trr a[228:229],v204,49152
mf v[140:143],a[236:239],v[108:111],v[140:143]
trr a[230:231],v204,51200
mf v[136:139],a[236:239],v[104:107],v[136:139]
s_waitcnt lgkmcnt(8)
trr a[232:233],v203,53248
mf v[128:131],a[240:243],v[112:115],v[128:131]
trr a[234:235],v203,55296
mf v[132:135],a[240:243],v[116:119],v[132:135]
trr a[236:237],v204,53248
mf v[140:143],a[244:247],v[116:119],v[140:143]
trr a[238:239],v204,55296
mf v[136:139],a[244:247],v[112:115],v[136:139]
s_waitcnt lgkmcnt(8)
trr a[240:241],v203,57344
mf v[128:131],a[248:251],v[120:123],v[128:131]
trr a[242:243],v203,59392
mf v[132:135],a[248:251],v[124:127],v[132:135]
trr a[244:245],v204,57344
mf v[140:143],a[252:255],v[124:127],v[140:143]
trr a[246:247],v204,59392
mf v[136:139],a[252:255],v[120:123],v[136:139]
s_waitcnt lgkmcnt(8)
trr a[248:249],v203,61440
mf v[144:147],a[224:227],v[96:99],v[144:147]
trr a[250:251],v203,63488
mf v[148:151],a[224:227],v[100:103],v[148:151]
trr a[252:253],v204,61440
mf v[156:159],a[228:231],v[100:103],v[156:159]
trr a[254:255],v204,63488
mf v[152:155],a[228:231],v[96:99],v[152:155]
s_waitcnt lgkmcnt(8)
s_barrier
mf v[144:147],a[232:235],v[104:107],v[144:147]
trr a[224:225],v201,32768
trr a[226:227],v201,34816
mf v[148:151],a[232:235],v[108:111],v[148:151]
trr a[228:229],v202,32768
trr a[230:231],v202,34816
s_add_u32 m0,s49,65536
s_add_u32 s48,s51,65792
buffer_load_dwordx4 v212,s[28:31],s48 offen nt lds
mf v[156:159],a[236:239],v[108:111],v[156:159]
v_mul_f32 v128,v128,v224
v_mul_f32 v129,v129,v224
v_mul_f32 v130,v130,v224
v_mul_f32 v131,v131,v224
v_mul_f32 v136,v136,v224
mf v[152:155],a[236:239],v[104:107],v[152:155]
s_waitcnt lgkmcnt(8)
trr a[232:233],v203,32768
trr a[234:235],v203,34816
v_mul_f32 v137,v137,v224
mf v[144:147],a[240:243],v[112:115],v[144:147]
v_mul_f32 v138,v138,v224
v_mul_f32 v139,v139,v224
v_mul_f32 v132,v132,v225
v_mul_f32 v133,v133,v225
mf v[148:151],a[240:243],v[116:119],v[148:151]
trr a[236:237],v204,32768
trr a[238:239],v204,34816
v_mul_f32 v134,v134,v225
v_mul_f32 v135,v135,v225
mf v[156:159],a[244:247],v[116:119],v[156:159]
v_mul_f32 v140,v140,v225
v_mul_f32 v141,v141,v225
v_mul_f32 v142,v142,v225
mf v[152:155],a[244:247],v[112:115],v[152:155]
s_waitcnt lgkmcnt(8)
trr a[240:241],v201,36864
trr a[242:243],v201,38912
buffer_load_dwordx4 v213,s[28:31],s48 offen offset:1024 nt lds
v_mul_f32 v143,v143,v225
mf v[144:147],a[248:251],v[120:123],v[144:147]
cvp v128,v128,v129
cvp v129,v130,v131
cvp v130,v136,v137
cvp v131,v138,v139
mf v[148:151],a[248:251],v[124:127],v[148:151]
trr a[244:245],v202,36864
trr a[246:247],v202,38912
cvp v132,v132,v133
mf v[156:159],a[252:255],v[124:127],v[156:159]
cvp v133,v134,v135
cvp v134,v140,v141
cvp v135,v142,v143
mf v[152:155],a[252:255],v[120:123],v[152:155]
s_waitcnt lgkmcnt(8)
trr a[248:249],v203,36864
mf a[0:3],a[224:227],v[128:131],a[0:3]
trr a[250:251],v203,38912
mf a[4:7],a[224:227],v[132:135],a[4:7]
trr a[252:253],v204,36864
trr a[254:255],v204,38912
buffer_load_dwordx4 v214,s[28:31],s48 offen offset:2048 nt lds
v_mul_f32 v144,v144,v224
v_mul_f32 v145,v145,v224
v_mul_f32 v146,v146,v224
mf a[12:15],a[228:231],v[132:135],a[12:15]
v_mul_f32 v147,v147,v224
v_mul_f32 v152,v152,v224
v_mul_f32 v153,v153,v224
v_mul_f32 v154,v154,v224
v_mul_f32 v155,v155,v224
mf a[8:11],a[228:231],v[128:131],a[8:11]
s_waitcnt lgkmcnt(8)
trr a[224:225],v201,40960
trr a[226:227],v201,43008
v_mul_f32 v148,v148,v225
v_mul_f32 v149,v149,v225
v_mul_f32 v150,v150,v225
mf a[16:19],a[232:235],v[128:131],a[16:19]
v_mul_f32 v151,v151,v225
v_mul_f32 v156,v156,v225
v_mul_f32 v157,v157,v225
v_mul_f32 v158,v158,v225
v_mul_f32 v159,v159,v225
mf a[20:23],a[232:235],v[132:135],a[20:23]
trr a[228:229],v202,40960
trr a[230:231],v202,43008
cvp v136,v144,v145
cvp v137,v146,v147
cvp v138,v152,v153
mf a[28:31],a[236:239],v[132:135],a[28:31]
cvp v139,v154,v155
cvp v140,v148,v149
cvp v141,v150,v151
cvp v142,v156,v157
cvp v143,v158,v159
mf a[24:27],a[236:239],v[128:131],a[24:27]
s_waitcnt lgkmcnt(8)
trr a[232:233],v203,40960
mf a[0:3],a[240:243],v[136:139],a[0:3]
trr a[234:235],v203,43008
buffer_load_dwordx4 v215,s[28:31],s48 offen offset:3072 nt lds
mf a[4:7],a[240:243],v[140:143],a[4:7]
trr a[236:237],v204,40960
mf a[12:15],a[244:247],v[140:143],a[12:15]
trr a[238:239],v204,43008
mf a[8:11],a[244:247],v[136:139],a[8:11]
s_waitcnt lgkmcnt(8)
trr a[240:241],v201,45056
mf a[16:19],a[248:251],v[136:139],a[16:19]
trr a[242:243],v201,47104
mf a[20:23],a[248:251],v[140:143],a[20:23]
trr a[244:245],v202,45056
mf a[28:31],a[252:255],v[140:143],a[28:31]
trr a[246:247],v202,47104
mf a[24:27],a[252:255],v[136:139],a[24:27]
s_waitcnt lgkmcnt(8)
trr a[248:249],v203,45056
mf a[32:35],a[224:227],v[128:131],a[32:35]
trr a[250:251],v203,47104
mf a[36:39],a[224:227],v[132:135],a[36:39]
trr a[252:253],v204,45056
mf a[44:47],a[228:231],v[132:135],a[44:47]
trr a[254:255],v204,47104
mf a[40:43],a[228:231],v[128:131],a[40:43]
s_waitcnt lgkmcnt(8)
s_barrier
mf a[48:51],a[232:235],v[128:131],a[48:51]
trr a[224:225],v201,0
trr a[226:227],v201,2048
mf a[52:55],a[232:235],v[132:135],a[52:55]
trr a[228:229],v202,0
trr a[230:231],v202,2048
s_add_u32 m0,s61,49152
mf a[60:63],a[236:239],v[132:135],a[60:63]
s_add_u32 s48,s53,s92
s_add_u32 s48,s48,114688
buffer_load_dwordx4 v216,s[36:39],s48 offen lds
mf a[56:59],a[236:239],v[128:131],a[56:59]
s_waitcnt lgkmcnt(8)
trr a[232:233],v203,0
mf a[32:35],a[240:243],v[136:139],a[32:35]
trr a[234:235],v203,2048
mf a[36:39],a[240:243],v[140:143],a[36:39]
trr a[236:237],v204,0
trr a[238:239],v204,2048
mf a[44:47],a[244:247],v[140:143],a[44:47]
buffer_load_dwordx4 v217,s[36:39],s48 offen offset:1024 lds
mf a[40:43],a[244:247],v[136:139],a[40:43]
s_waitcnt lgkmcnt(8)
trr a[240:241],v201,4096
mf a[48:51],a[248:251],v[136:139],a[48:51]
trr a[242:243],v201,6144
mf a[52:55],a[248:251],v[140:143],a[52:55]
trr a[244:245],v202,4096
trr a[246:247],v202,6144
s_add_u32 m0,s61,57344
mf a[60:63],a[252:255],v[140:143],a[60:63]
s_add_u32 s48,s53,s93
s_add_u32 s48,s48,114688
buffer_load_dwordx4 v216,s[36:39],s48 offen lds
mf a[56:59],a[252:255],v[136:139],a[56:59]
s_waitcnt lgkmcnt(8)
trr a[248:249],v203,4096
mf a[64:67],a[224:227],v[128:131],a[64:67]
trr a[250:251],v203,6144
mf a[68:71],a[224:227],v[132:135],a[68:71]
trr a[252:253],v204,4096
trr a[254:255],v204,6144
mf a[76:79],a[228:231],v[132:135],a[76:79]
buffer_load_dwordx4 v217,s[36:39],s48 offen offset:1024 lds
mf a[72:75],a[228:231],v[128:131],a[72:75]
s_waitcnt lgkmcnt(8)
trr a[224:225],v201,8192
mf a[80:83],a[232:235],v[128:131],a[80:83]
trr a[226:227],v201,10240
mf a[84:87],a[232:235],v[132:135],a[84:87]
trr a[228:229],v202,8192
trr a[230:231],v202,10240
s_add_u32 m0,s49,114688
mf a[92:95],a[236:239],v[132:135],a[92:95]
s_add_u32 s48,s51,131328
buffer_load_dwordx4 v212,s[28:31],s48 offen nt lds
mf a[88:91],a[236:239],v[128:131],a[88:91]
s_waitcnt lgkmcnt(8)
trr a[232:233],v203,8192
mf a[64:67],a[240:243],v[136:139],a[64:67]
trr a[234:235],v203,10240
mf a[68:71],a[240:243],v[140:143],a[68:71]
trr a[236:237],v204,8192
trr a[238:239],v204,10240
mf a[76:79],a[244:247],v[140:143],a[76:79]
buffer_load_dwordx4 v213,s[28:31],s48 offen offset:1024 nt lds
mf a[72:75],a[244:247],v[136:139],a[72:75]
s_waitcnt lgkmcnt(8)
trr a[240:241],v201,12288
mf a[80:83],a[248:251],v[136:139],a[80:83]
trr a[242:243],v201,14336
mf a[84:87],a[248:251],v[140:143],a[84:87]
trr a[244:245],v202,12288
trr a[246:247],v202,14336
mf a[92:95],a[252:255],v[140:143],a[92:95]
buffer_load_dwordx4 v214,s[28:31],s48 offen offset:2048 nt lds
mf a[88:91],a[252:255],v[136:139],a[88:91]
s_waitcnt lgkmcnt(8)
trr a[248:249],v203,12288
mf a[96:99],a[224:227],v[128:131],a[96:99]
trr a[250:251],v203,14336
mf a[100:103],a[224:227],v[132:135],a[100:103]
trr a[252:253],v204,12288
trr a[254:255],v204,14336
mf a[108:111],a[228:231],v[132:135],a[108:111]
buffer_load_dwordx4 v215,s[28:31],s48 offen offset:3072 nt lds
mf a[104:107],a[228:231],v[128:131],a[104:107]
s_waitcnt lgkmcnt(8)
s_waitcnt vmcnt(18)
s_barrier
mf a[112:115],a[232:235],v[128:131],a[112:115]
trr a[224:225],v201,16384
trr a[226:227],v201,18432
mf a[116:119],a[232:235],v[132:135],a[116:119]
trr a[228:229],v202,16384
mf a[124:127],a[236:239],v[132:135],a[124:127]
trr a[230:231],v202,18432
mf a[120:123],a[236:239],v[128:131],a[120:123]
s_waitcnt lgkmcnt(8)
trr a[232:233],v203,16384
mf a[96:99],a[240:243],v[136:139],a[96:99]
trr a[234:235],v203,18432
mf a[100:103],a[240:243],v[140:143],a[100:103]
trr a[236:237],v204,16384
mf a[108:111],a[244:247],v[140:143],a[108:111]
trr a[238:239],v204,18432
mf a[104:107],a[244:247],v[136:139],a[104:107]
s_waitcnt lgkmcnt(8)
trr a[240:241],v201,20480
mf a[112:115],a[248:251],v[136:139],a[112:115]
trr a[242:243],v201,22528
mf a[116:119],a[248:251],v[140:143],a[116:119]
trr a[244:245],v202,20480
mf a[124:127],a[252:255],v[140:143],a[124:127]
trr a[246:247],v202,22528
mf a[120:123],a[252:255],v[136:139],a[120:123]
s_waitcnt lgkmcnt(8)
trr a[248:249],v203,20480
mf a[128:131],a[224:227],v[128:131],a[128:131]
trr a[250:251],v203,22528
mf a[132:135],a[224:227],v[132:135],a[132:135]
trr a[252:253],v204,20480
mf a[140:143],a[228:231],v[132:135],a[140:143]
trr a[254:255],v204,22528
mf a[136:139],a[228:231],v[128:131],a[136:139]
s_waitcnt lgkmcnt(8)
trr a[224:225],v201,24576
mf a[144:147],a[232:235],v[128:131],a[144:147]
trr a[226:227],v201,26624
mf a[148:151],a[232:235],v[132:135],a[148:151]
trr a[228:229],v202,24576
mf a[156:159],a[236:239],v[132:135],a[156:159]
trr a[230:231],v202,26624
mf a[152:155],a[236:239],v[128:131],a[152:155]
s_waitcnt lgkmcnt(8)
trr a[232:233],v203,24576
mf a[128:131],a[240:243],v[136:139],a[128:131]
trr a[234:235],v203,26624
mf a[132:135],a[240:243],v[140:143],a[132:135]
trr a[236:237],v204,24576
mf a[140:143],a[244:247],v[140:143],a[140:143]
trr a[238:239],v204,26624
mf a[136:139],a[244:247],v[136:139],a[136:139]
s_waitcnt lgkmcnt(8)
trr a[240:241],v201,28672
mf a[144:147],a[248:251],v[136:139],a[144:147]
trr a[242:243],v201,30720
mf a[148:151],a[248:251],v[140:143],a[148:151]
trr a[244:245],v202,28672
mf a[156:159],a[252:255],v[140:143],a[156:159]
trr a[246:247],v202,30720
mf a[152:155],a[252:255],v[136:139],a[152:155]
s_waitcnt lgkmcnt(8)
trr a[248:249],v203,28672
mf a[160:163],a[224:227],v[128:131],a[160:163]
trr a[250:251],v203,30720
mf a[164:167],a[224:227],v[132:135],a[164:167]
v_add_u32 v201,0x10000,v201
trr a[252:253],v204,28672
mf a[172:175],a[228:231],v[132:135],a[172:175]
trr a[254:255],v204,30720
mf a[168:171],a[228:231],v[128:131],a[168:171]
s_waitcnt lgkmcnt(8)
s_waitcnt vmcnt(12)
s_barrier
mf a[176:179],a[232:235],v[128:131],a[176:179]
v_add_u32 v202,0x10000,v202
trr a[224:225],v201,32768
trr a[226:227],v201,34816
mf a[180:183],a[232:235],v[132:135],a[180:183]
v_add_u32 v203,0x10000,v203
trr a[228:229],v202,32768
trr a[230:231],v202,34816
s_add_u32 m0,s61,0
mf a[188:191],a[236:239],v[132:135],a[188:191]
s_add_u32 s48,s53,s94
s_add_u32 s48,s48,114688
buffer_load_dwordx4 v216,s[36:39],s48 offen lds
mf a[184:187],a[236:239],v[128:131],a[184:187]
s_waitcnt lgkmcnt(8)
v_add_u32 v204,0x10000,v204
mf a[160:163],a[240:243],v[136:139],a[160:163]
trr a[232:233],v203,32768
trr a[234:235],v203,34816
mf a[164:167],a[240:243],v[140:143],a[164:167]
trr a[236:237],v204,32768
trr a[238:239],v204,34816
mf a[172:175],a[244:247],v[140:143],a[172:175]
buffer_load_dwordx4 v217,s[36:39],s48 offen offset:1024 lds
mf a[168:171],a[244:247],v[136:139],a[168:171]
s_waitcnt lgkmcnt(8)
trr a[240:241],v201,36864
mf a[176:179],a[248:251],v[136:139],a[176:179]
trr a[242:243],v201,38912
mf a[180:183],a[248:251],v[140:143],a[180:183]
trr a[244:245],v202,36864
trr a[246:247],v202,38912
s_add_u32 m0,s61,8192
mf a[188:191],a[252:255],v[140:143],a[188:191]
s_add_u32 s48,s53,s95
s_add_u32 s48,s48,114688
buffer_load_dwordx4 v216,s[36:39],s48 offen lds
mf a[184:187],a[252:255],v[136:139],a[184:187]
s_waitcnt lgkmcnt(8)
trr a[248:249],v203,36864
mf a[192:195],a[224:227],v[128:131],a[192:195]
trr a[250:251],v203,38912
mf a[196:199],a[224:227],v[132:135],a[196:199]
trr a[252:253],v204,36864
trr a[254:255],v204,38912
mf a[204:207],a[228:231],v[132:135],a[204:207]
buffer_load_dwordx4 v217,s[36:39],s48 offen offset:1024 lds
mf a[200:203],a[228:231],v[128:131],a[200:203]
s_waitcnt lgkmcnt(8)
s_barrier
mf a[208:211],a[232:235],v[128:131],a[208:211]
trr a[224:225],v201,16384
trr a[226:227],v201,18432
mf a[212:215],a[232:235],v[132:135],a[212:215]
trr a[228:229],v202,16384
trr a[230:231],v202,18432
s_add_u32 m0,s49,16384
mf a[220:223],a[236:239],v[132:135],a[220:223]
s_add_u32 s48,s51,196864
buffer_load_dwordx4 v212,s[28:31],s48 offen nt lds
mf a[216:219],a[236:239],v[128:131],a[216:219]
s_waitcnt lgkmcnt(8)
trr a[232:233],v203,16384
mf a[192:195],a[240:243],v[136:139],a[192:195]
trr a[234:235],v203,18432
mf a[196:199],a[240:243],v[140:143],a[196:199]
trr a[236:237],v204,16384
mf a[204:207],a[244:247],v[140:143],a[204:207]
trr a[238:239],v204,18432
mf a[200:203],a[244:247],v[136:139],a[200:203]
s_waitcnt lgkmcnt(8)
trr a[240:241],v201,20480
mf a[208:211],a[248:251],v[136:139],a[208:211]
trr a[242:243],v201,22528
buffer_load_dwordx4 v213,s[28:31],s48 offen offset:1024 nt lds
mf a[212:215],a[248:251],v[140:143],a[212:215]
trr a[244:245],v202,20480
mf a[220:223],a[252:255],v[140:143],a[220:223]
trr a[246:247],v202,22528
mf a[216:219],a[252:255],v[136:139],a[216:219]
s_waitcnt lgkmcnt(8)
trr a[248:249],v203,20480
mf v[128:131],a[224:227],v[0:3],0
trr a[250:251],v203,22528
mf v[132:135],a[224:227],v[4:7],0
trr a[252:253],v204,20480
trr a[254:255],v204,22528
mf v[140:143],a[228:231],v[4:7],0
buffer_load_dwordx4 v214,s[28:31],s48 offen offset:2048 nt lds
mf v[136:139],a[228:231],v[0:3],0
s_waitcnt lgkmcnt(8)
trr a[224:225],v201,24576
mf v[144:147],a[232:235],v[0:3],0
trr a[226:227],v201,26624
mf v[148:151],a[232:235],v[4:7],0
trr a[228:229],v202,24576
mf v[156:159],a[236:239],v[4:7],0
trr a[230:231],v202,26624
mf v[152:155],a[236:239],v[0:3],0
s_waitcnt lgkmcnt(8)
trr a[232:233],v203,24576
mf v[128:131],a[240:243],v[8:11],v[128:131]
trr a[234:235],v203,26624
buffer_load_dwordx4 v215,s[28:31],s48 offen offset:3072 nt lds
mf v[132:135],a[240:243],v[12:15],v[132:135]
trr a[236:237],v204,24576
mf v[140:143],a[244:247],v[12:15],v[140:143]
trr a[238:239],v204,26624
mf v[136:139],a[244:247],v[8:11],v[136:139]
s_waitcnt lgkmcnt(8)
trr a[240:241],v201,28672
mf v[144:147],a[248:251],v[8:11],v[144:147]
trr a[242:243],v201,30720
mf v[148:151],a[248:251],v[12:15],v[148:151]
trr a[244:245],v202,28672
mf v[156:159],a[252:255],v[12:15],v[156:159]
trr a[246:247],v202,30720
mf v[152:155],a[252:255],v[8:11],v[152:155]
s_waitcnt lgkmcnt(8)
trr a[248:249],v203,28672
mf v[128:131],a[224:227],v[16:19],v[128:131]
trr a[250:251],v203,30720
mf v[132:135],a[224:227],v[20:23],v[132:135]
trr a[252:253],v204,28672
mf v[140:143],a[228:231],v[20:23],v[140:143]
trr a[254:255],v204,30720
mf v[136:139],a[228:231],v[16:19],v[136:139]
s_waitcnt lgkmcnt(8)
s_waitcnt vmcnt(16)
s_barrier
mf v[144:147],a[232:235],v[16:19],v[144:147]
trr a[224:225],v201,0
trr a[226:227],v201,2048
mf v[148:151],a[232:235],v[20:23],v[148:151]
trr a[228:229],v202,0
trr a[230:231],v202,2048
s_add_u32 m0,s61,32768
mf v[156:159],a[236:239],v[20:23],v[156:159]
s_add_u32 s48,s53,s96
s_add_u32 s48,s48,114688
buffer_load_dwordx4 v216,s[36:39],s48 offen lds
mf v[152:155],a[236:239],v[16:19],v[152:155]
s_waitcnt lgkmcnt(8)
trr a[232:233],v203,0
mf v[128:131],a[240:243],v[24:27],v[128:131]
trr a[234:235],v203,2048
mf v[132:135],a[240:243],v[28:31],v[132:135]
trr a[236:237],v204,0
mf v[140:143],a[244:247],v[28:31],v[140:143]
trr a[238:239],v204,2048
mf v[136:139],a[244:247],v[24:27],v[136:139]
s_waitcnt lgkmcnt(8)
trr a[240:241],v201,4096
mf v[144:147],a[248:251],v[24:27],v[144:147]
trr a[242:243],v201,6144
buffer_load_dwordx4 v217,s[36:39],s48 offen offset:1024 lds
mf v[148:151],a[248:251],v[28:31],v[148:151]
trr a[244:245],v202,4096
mf v[156:159],a[252:255],v[28:31],v[156:159]
trr a[246:247],v202,6144
mf v[152:155],a[252:255],v[24:27],v[152:155]
s_waitcnt lgkmcnt(8)
trr a[248:249],v203,4096
mf v[128:131],a[224:227],v[32:35],v[128:131]
trr a[250:251],v203,6144
mf v[132:135],a[224:227],v[36:39],v[132:135]
trr a[252:253],v204,4096
trr a[254:255],v204,6144
s_add_u32 m0,s61,40960
mf v[140:143],a[228:231],v[36:39],v[140:143]
s_add_u32 s48,s53,s97
s_add_u32 s48,s48,114688
buffer_load_dwordx4 v216,s[36:39],s48 offen lds
mf v[136:139],a[228:231],v[32:35],v[136:139]
s_waitcnt lgkmcnt(8)
trr a[224:225],v201,8192
mf v[144:147],a[232:235],v[32:35],v[144:147]
trr a[226:227],v201,10240
mf v[148:151],a[232:235],v[36:39],v[148:151]
trr a[228:229],v202,8192
mf v[156:159],a[236:239],v[36:39],v[156:159]
trr a[230:231],v202,10240
mf v[152:155],a[236:239],v[32:35],v[152:155]
s_waitcnt lgkmcnt(8)
trr a[232:233],v203,8192
mf v[128:131],a[240:243],v[40:43],v[128:131]
trr a[234:235],v203,10240
buffer_load_dwordx4 v217,s[36:39],s48 offen offset:1024 lds
mf v[132:135],a[240:243],v[44:47],v[132:135]
trr a[236:237],v204,8192
mf v[140:143],a[244:247],v[44:47],v[140:143]
trr a[238:239],v204,10240
mf v[136:139],a[244:247],v[40:43],v[136:139]
s_waitcnt lgkmcnt(8)
trr a[240:241],v201,12288
mf v[144:147],a[248:251],v[40:43],v[144:147]
trr a[242:243],v201,14336
mf v[148:151],a[248:251],v[44:47],v[148:151]
trr a[244:245],v202,12288
mf v[156:159],a[252:255],v[44:47],v[156:159]
trr a[246:247],v202,14336
mf v[152:155],a[252:255],v[40:43],v[152:155]
s_waitcnt lgkmcnt(8)
trr a[248:249],v203,12288
mf v[128:131],a[224:227],v[48:51],v[128:131]
trr a[250:251],v203,14336
mf v[132:135],a[224:227],v[52:55],v[132:135]
trr a[252:253],v204,12288
mf v[140:143],a[228:231],v[52:55],v[140:143]
trr a[254:255],v204,14336
mf v[136:139],a[228:231],v[48:51],v[136:139]
s_waitcnt lgkmcnt(8)
s_waitcnt vmcnt(12)
s_barrier
mf v[144:147],a[232:235],v[48:51],v[144:147]
trr a[224:225],v201,49152
trr a[226:227],v201,51200
mf v[148:151],a[232:235],v[52:55],v[148:151]
trr a[228:229],v202,49152
trr a[230:231],v202,51200
s_add_u32 m0,s49,81920
mf v[156:159],a[236:239],v[52:55],v[156:159]
s_add_u32 s48,s51,384
buffer_load_dwordx4 v212,s[28:31],s48 offen nt lds
mf v[152:155],a[236:239],v[48:51],v[152:155]
s_waitcnt lgkmcnt(8)
trr a[232:233],v203,49152
mf v[128:131],a[240:243],v[56:59],v[128:131]
trr a[234:235],v203,51200
mf v[132:135],a[240:243],v[60:63],v[132:135]
trr a[236:237],v204,49152
mf v[140:143],a[244:247],v[60:63],v[140:143]
trr a[238:239],v204,51200
mf v[136:139],a[244:247],v[56:59],v[136:139]
s_waitcnt lgkmcnt(8)
trr a[240:241],v201,53248
mf v[144:147],a[248:251],v[56:59],v[144:147]
trr a[242:243],v201,55296
buffer_load_dwordx4 v213,s[28:31],s48 offen offset:1024 nt lds
mf v[148:151],a[248:251],v[60:63],v[148:151]
trr a[244:245],v202,53248
mf v[156:159],a[252:255],v[60:63],v[156:159]
trr a[246:247],v202,55296
mf v[152:155],a[252:255],v[56:59],v[152:155]
s_waitcnt lgkmcnt(8)
trr a[248:249],v203,53248
mf v[128:131],a[224:227],v[64:67],v[128:131]
trr a[250:251],v203,55296
mf v[132:135],a[224:227],v[68:71],v[132:135]
trr a[252:253],v204,53248
trr a[254:255],v204,55296
mf v[140:143],a[228:231],v[68:71],v[140:143]
buffer_load_dwordx4 v214,s[28:31],s48 offen offset:2048 nt lds
mf v[136:139],a[228:231],v[64:67],v[136:139]
s_waitcnt lgkmcnt(8)
trr a[224:225],v201,57344
mf v[144:147],a[232:235],v[64:67],v[144:147]
trr a[226:227],v201,59392
mf v[148:151],a[232:235],v[68:71],v[148:151]
trr a[228:229],v202,57344
mf v[156:159],a[236:239],v[68:71],v[156:159]
trr a[230:231],v202,59392
mf v[152:155],a[236:239],v[64:67],v[152:155]
s_waitcnt lgkmcnt(8)
trr a[232:233],v203,57344
mf v[128:131],a[240:243],v[72:75],v[128:131]
trr a[234:235],v203,59392
buffer_load_dwordx4 v215,s[28:31],s48 offen offset:3072 nt lds
mf v[132:135],a[240:243],v[76:79],v[132:135]
trr a[236:237],v204,57344
mf v[140:143],a[244:247],v[76:79],v[140:143]
trr a[238:239],v204,59392
mf v[136:139],a[244:247],v[72:75],v[136:139]
s_waitcnt lgkmcnt(8)
trr a[240:241],v201,61440
mf v[144:147],a[248:251],v[72:75],v[144:147]
trr a[242:243],v201,63488
mf v[148:151],a[248:251],v[76:79],v[148:151]
trr a[244:245],v202,61440
mf v[156:159],a[252:255],v[76:79],v[156:159]
trr a[246:247],v202,63488
mf v[152:155],a[252:255],v[72:75],v[152:155]
s_waitcnt lgkmcnt(8)
trr a[248:249],v203,61440
mf v[128:131],a[224:227],v[80:83],v[128:131]
trr a[250:251],v203,63488
mf v[132:135],a[224:227],v[84:87],v[132:135]
v_add_u32 v201,0xffff0000,v201
trr a[252:253],v204,61440
mf v[140:143],a[228:231],v[84:87],v[140:143]
trr a[254:255],v204,63488
mf v[136:139],a[228:231],v[80:83],v[136:139]
s_waitcnt lgkmcnt(8)
s_waitcnt vmcnt(8)
s_barrier
mf v[144:147],a[232:235],v[80:83],v[144:147]
v_add_u32 v202,0xffff0000,v202
trr a[224:225],v201,16384
trr a[226:227],v201,18432
mf v[148:151],a[232:235],v[84:87],v[148:151]
trr a[228:229],v202,16384
trr a[230:231],v202,18432
s_add_u32 m0,s49,65536
mf v[156:159],a[236:239],v[84:87],v[156:159]
s_add_u32 s48,s51,65920
buffer_load_dwordx4 v212,s[28:31],s48 offen nt lds
mf v[152:155],a[236:239],v[80:83],v[152:155]
s_waitcnt lgkmcnt(8)
trr a[232:233],v201,20480
mf v[128:131],a[240:243],v[88:91],v[128:131]
trr a[234:235],v201,22528
mf v[132:135],a[240:243],v[92:95],v[132:135]
trr a[236:237],v202,20480
mf v[140:143],a[244:247],v[92:95],v[140:143]
trr a[238:239],v202,22528
mf v[136:139],a[244:247],v[88:91],v[136:139]
s_waitcnt lgkmcnt(8)
trr a[240:241],v201,24576
mf v[144:147],a[248:251],v[88:91],v[144:147]
trr a[242:243],v201,26624
buffer_load_dwordx4 v213,s[28:31],s48 offen offset:1024 nt lds
mf v[148:151],a[248:251],v[92:95],v[148:151]
trr a[244:245],v202,24576
mf v[156:159],a[252:255],v[92:95],v[156:159]
trr a[246:247],v202,26624
mf v[152:155],a[252:255],v[88:91],v[152:155]
s_waitcnt lgkmcnt(8)
trr a[248:249],v201,28672
mf v[128:131],a[224:227],v[96:99],v[128:131]
trr a[250:251],v201,30720
mf v[132:135],a[224:227],v[100:103],v[132:135]
v_add_u32 v203,0xffff0000,v203
trr a[252:253],v202,28672
mf v[140:143],a[228:231],v[100:103],v[140:143]
trr a[254:255],v202,30720
buffer_load_dwordx4 v214,s[28:31],s48 offen offset:2048 nt lds
mf v[136:139],a[228:231],v[96:99],v[136:139]
s_waitcnt lgkmcnt(8)
v_add_u32 v204,0xffff0000,v204
mf v[128:131],a[232:235],v[104:107],v[128:131]
trr a[224:225],v203,16384
trr a[226:227],v203,18432
mf v[132:135],a[232:235],v[108:111],v[132:135]
trr a[228:229],v204,16384
mf v[140:143],a[236:239],v[108:111],v[140:143]
trr a[230:231],v204,18432
mf v[136:139],a[236:239],v[104:107],v[136:139]
s_waitcnt lgkmcnt(8)
trr a[232:233],v203,20480
mf v[128:131],a[240:243],v[112:115],v[128:131]
trr a[234:235],v203,22528
buffer_load_dwordx4 v215,s[28:31],s48 offen offset:3072 nt lds
mf v[132:135],a[240:243],v[116:119],v[132:135]
trr a[236:237],v204,20480
mf v[140:143],a[244:247],v[116:119],v[140:143]
trr a[238:239],v204,22528
mf v[136:139],a[244:247],v[112:115],v[136:139]
s_waitcnt lgkmcnt(8)
trr a[240:241],v203,24576
mf v[128:131],a[248:251],v[120:123],v[128:131]
trr a[242:243],v203,26624
mf v[132:135],a[248:251],v[124:127],v[132:135]
trr a[244:245],v204,24576
mf v[140:143],a[252:255],v[124:127],v[140:143]
trr a[246:247],v204,26624
mf v[136:139],a[252:255],v[120:123],v[136:139]
s_waitcnt lgkmcnt(8)
trr a[248:249],v203,28672
mf v[144:147],a[224:227],v[96:99],v[144:147]
trr a[250:251],v203,30720
mf v[148:151],a[224:227],v[100:103],v[148:151]
trr a[252:253],v204,28672
mf v[156:159],a[228:231],v[100:103],v[156:159]
trr a[254:255],v204,30720
mf v[152:155],a[228:231],v[96:99],v[152:155]
s_waitcnt lgkmcnt(8)
s_barrier
mf v[144:147],a[232:235],v[104:107],v[144:147]
trr a[224:225],v201,49152
trr a[226:227],v201,51200
mf v[148:151],a[232:235],v[108:111],v[148:151]
trr a[228:229],v202,49152
trr a[230:231],v202,51200
s_add_u32 m0,s61,98304
s_add_u32 s48,s53,s98
s_add_u32 s48,s48,114688
buffer_load_dwordx4 v216,s[36:39],s48 offen lds
mf v[156:159],a[236:239],v[108:111],v[156:159]
v_mul_f32 v128,v128,v224
v_mul_f32 v129,v129,v224
v_mul_f32 v130,v130,v224
v_mul_f32 v131,v131,v224
v_mul_f32 v136,v136,v224
mf v[152:155],a[236:239],v[104:107],v[152:155]
s_waitcnt lgkmcnt(8)
trr a[232:233],v203,49152
trr a[234:235],v203,51200
v_mul_f32 v137,v137,v224
mf v[144:147],a[240:243],v[112:115],v[144:147]
v_mul_f32 v138,v138,v224
v_mul_f32 v139,v139,v224
v_mul_f32 v132,v132,v225
v_mul_f32 v133,v133,v225
mf v[148:151],a[240:243],v[116:119],v[148:151]
trr a[236:237],v204,49152
trr a[238:239],v204,51200
v_mul_f32 v134,v134,v225
v_mul_f32 v135,v135,v225
mf v[156:159],a[244:247],v[116:119],v[156:159]
v_mul_f32 v140,v140,v225
v_mul_f32 v141,v141,v225
v_mul_f32 v142,v142,v225
mf v[152:155],a[244:247],v[112:115],v[152:155]
s_waitcnt lgkmcnt(8)
trr a[240:241],v201,53248
trr a[242:243],v201,55296
buffer_load_dwordx4 v217,s[36:39],s48 offen offset:1024 lds
v_mul_f32 v143,v143,v225
mf v[144:147],a[248:251],v[120:123],v[144:147]
cvp v128,v128,v129
cvp v129,v130,v131
cvp v130,v136,v137
cvp v131,v138,v139
mf v[148:151],a[248:251],v[124:127],v[148:151]
trr a[244:245],v202,53248
trr a[246:247],v202,55296
cvp v132,v132,v133
mf v[156:159],a[252:255],v[124:127],v[156:159]
cvp v133,v134,v135
cvp v134,v140,v141
cvp v135,v142,v143
mf v[152:155],a[252:255],v[120:123],v[152:155]
s_waitcnt lgkmcnt(8)
trr a[248:249],v203,53248
mf a[0:3],a[224:227],v[128:131],a[0:3]
trr a[250:251],v203,55296
mf a[4:7],a[224:227],v[132:135],a[4:7]
trr a[252:253],v204,53248
trr a[254:255],v204,55296
v_mul_f32 v144,v144,v224
v_mul_f32 v145,v145,v224
v_mul_f32 v146,v146,v224
mf a[12:15],a[228:231],v[132:135],a[12:15]
v_mul_f32 v147,v147,v224
v_mul_f32 v152,v152,v224
v_mul_f32 v153,v153,v224
v_mul_f32 v154,v154,v224
v_mul_f32 v155,v155,v224
mf a[8:11],a[228:231],v[128:131],a[8:11]
s_waitcnt lgkmcnt(8)
trr a[224:225],v201,57344
trr a[226:227],v201,59392
v_mul_f32 v148,v148,v225
v_mul_f32 v149,v149,v225
v_mul_f32 v150,v150,v225
mf a[16:19],a[232:235],v[128:131],a[16:19]
v_mul_f32 v151,v151,v225
v_mul_f32 v156,v156,v225
v_mul_f32 v157,v157,v225
v_mul_f32 v158,v158,v225
v_mul_f32 v159,v159,v225
mf a[20:23],a[232:235],v[132:135],a[20:23]
trr a[228:229],v202,57344
trr a[230:231],v202,59392
cvp v136,v144,v145
cvp v137,v146,v147
cvp v138,v152,v153
mf a[28:31],a[236:239],v[132:135],a[28:31]
cvp v139,v154,v155
cvp v140,v148,v149
cvp v141,v150,v151
cvp v142,v156,v157
cvp v143,v158,v159
mf a[24:27],a[236:239],v[128:131],a[24:27]
s_waitcnt lgkmcnt(8)
trr a[232:233],v203,57344
mf a[0:3],a[240:243],v[136:139],a[0:3]
trr a[234:235],v203,59392
mf a[4:7],a[240:243],v[140:143],a[4:7]
trr a[236:237],v204,57344
mf a[12:15],a[244:247],v[140:143],a[12:15]
trr a[238:239],v204,59392
mf a[8:11],a[244:247],v[136:139],a[8:11]
s_waitcnt lgkmcnt(8)
trr a[240:241],v201,61440
mf a[16:19],a[248:251],v[136:139],a[16:19]
trr a[242:243],v201,63488
mf a[20:23],a[248:251],v[140:143],a[20:23]
trr a[244:245],v202,61440
mf a[28:31],a[252:255],v[140:143],a[28:31]
trr a[246:247],v202,63488
mf a[24:27],a[252:255],v[136:139],a[24:27]
s_waitcnt lgkmcnt(8)
trr a[248:249],v203,61440
mf a[32:35],a[224:227],v[128:131],a[32:35]
trr a[250:251],v203,63488
mf a[36:39],a[224:227],v[132:135],a[36:39]
trr a[252:253],v204,61440
mf a[44:47],a[228:231],v[132:135],a[44:47]
trr a[254:255],v204,63488
mf a[40:43],a[228:231],v[128:131],a[40:43]
s_waitcnt lgkmcnt(8)
s_barrier
mf a[48:51],a[232:235],v[128:131],a[48:51]
trr a[224:225],v201,0
trr a[226:227],v201,2048
mf a[52:55],a[232:235],v[132:135],a[52:55]
trr a[228:229],v202,0
trr a[230:231],v202,2048
s_add_u32 m0,s49,16384
mf a[60:63],a[236:239],v[132:135],a[60:63]
s_add_u32 s48,s51,131456
buffer_load_dwordx4 v212,s[28:31],s48 offen nt lds
mf a[56:59],a[236:239],v[128:131],a[56:59]
s_waitcnt lgkmcnt(8)
trr a[232:233],v203,0
mf a[32:35],a[240:243],v[136:139],a[32:35]
trr a[234:235],v203,2048
mf a[36:39],a[240:243],v[140:143],a[36:39]
trr a[236:237],v204,0
mf a[44:47],a[244:247],v[140:143],a[44:47]
trr a[238:239],v204,2048
mf a[40:43],a[244:247],v[136:139],a[40:43]
s_waitcnt lgkmcnt(8)
trr a[240:241],v201,4096
mf a[48:51],a[248:251],v[136:139],a[48:51]
trr a[242:243],v201,6144
buffer_load_dwordx4 v213,s[28:31],s48 offen offset:1024 nt lds
mf a[52:55],a[248:251],v[140:143],a[52:55]
trr a[244:245],v202,4096
mf a[60:63],a[252:255],v[140:143],a[60:63]
trr a[246:247],v202,6144
mf a[56:59],a[252:255],v[136:139],a[56:59]
s_waitcnt lgkmcnt(8)
trr a[248:249],v203,4096
mf a[64:67],a[224:227],v[128:131],a[64:67]
trr a[250:251],v203,6144
mf a[68:71],a[224:227],v[132:135],a[68:71]
trr a[252:253],v204,4096
trr a[254:255],v204,6144
mf a[76:79],a[228:231],v[132:135],a[76:79]
buffer_load_dwordx4 v214,s[28:31],s48 offen offset:2048 nt lds
mf a[72:75],a[228:231],v[128:131],a[72:75]
s_waitcnt lgkmcnt(8)
trr a[224:225],v201,8192
mf a[80:83],a[232:235],v[128:131],a[80:83]
trr a[226:227],v201,10240
mf a[84:87],a[232:235],v[132:135],a[84:87]
trr a[228:229],v202,8192
mf a[92:95],a[236:239],v[132:135],a[92:95]
trr a[230:231],v202,10240
mf a[88:91],a[236:239],v[128:131],a[88:91]
s_waitcnt lgkmcnt(8)
trr a[232:233],v203,8192
mf a[64:67],a[240:243],v[136:139],a[64:67]
trr a[234:235],v203,10240
buffer_load_dwordx4 v215,s[28:31],s48 offen offset:3072 nt lds
mf a[68:71],a[240:243],v[140:143],a[68:71]
trr a[236:237],v204,8192
mf a[76:79],a[244:247],v[140:143],a[76:79]
trr a[238:239],v204,10240
mf a[72:75],a[244:247],v[136:139],a[72:75]
s_waitcnt lgkmcnt(8)
trr a[240:241],v201,12288
mf a[80:83],a[248:251],v[136:139],a[80:83]
trr a[242:243],v201,14336
mf a[84:87],a[248:251],v[140:143],a[84:87]
trr a[244:245],v202,12288
mf a[92:95],a[252:255],v[140:143],a[92:95]
trr a[246:247],v202,14336
mf a[88:91],a[252:255],v[136:139],a[88:91]
s_waitcnt lgkmcnt(8)
trr a[248:249],v203,12288
mf a[96:99],a[224:227],v[128:131],a[96:99]
trr a[250:251],v203,14336
mf a[100:103],a[224:227],v[132:135],a[100:103]
trr a[252:253],v204,12288
mf a[108:111],a[228:231],v[132:135],a[108:111]
trr a[254:255],v204,14336
mf a[104:107],a[228:231],v[128:131],a[104:107]
s_waitcnt lgkmcnt(8)
s_waitcnt vmcnt(14)
s_barrier
mf a[112:115],a[232:235],v[128:131],a[112:115]
trr a[224:225],v201,32768
trr a[226:227],v201,34816
mf a[116:119],a[232:235],v[132:135],a[116:119]
trr a[228:229],v202,32768
mf a[124:127],a[236:239],v[132:135],a[124:127]
trr a[230:231],v202,34816
mf a[120:123],a[236:239],v[128:131],a[120:123]
s_waitcnt lgkmcnt(8)
trr a[232:233],v203,32768
mf a[96:99],a[240:243],v[136:139],a[96:99]
trr a[234:235],v203,34816
mf a[100:103],a[240:243],v[140:143],a[100:103]
trr a[236:237],v204,32768
mf a[108:111],a[244:247],v[140:143],a[108:111]
trr a[238:239],v204,34816
mf a[104:107],a[244:247],v[136:139],a[104:107]
s_waitcnt lgkmcnt(8)
trr a[240:241],v201,36864
mf a[112:115],a[248:251],v[136:139],a[112:115]
trr a[242:243],v201,38912
mf a[116:119],a[248:251],v[140:143],a[116:119]
trr a[244:245],v202,36864
mf a[124:127],a[252:255],v[140:143],a[124:127]
trr a[246:247],v202,38912
mf a[120:123],a[252:255],v[136:139],a[120:123]
s_waitcnt lgkmcnt(8)
trr a[248:249],v203,36864
mf a[128:131],a[224:227],v[128:131],a[128:131]
trr a[250:251],v203,38912
mf a[132:135],a[224:227],v[132:135],a[132:135]
trr a[252:253],v204,36864
mf a[140:143],a[228:231],v[132:135],a[140:143]
trr a[254:255],v204,38912
mf a[136:139],a[228:231],v[128:131],a[136:139]
s_waitcnt lgkmcnt(8)
trr a[224:225],v201,40960
mf a[144:147],a[232:235],v[128:131],a[144:147]
trr a[226:227],v201,43008
mf a[148:151],a[232:235],v[132:135],a[148:151]
trr a[228:229],v202,40960
mf a[156:159],a[236:239],v[132:135],a[156:159]
trr a[230:231],v202,43008
mf a[152:155],a[236:239],v[128:131],a[152:155]
s_waitcnt lgkmcnt(8)
trr a[232:233],v203,40960
mf a[128:131],a[240:243],v[136:139],a[128:131]
trr a[234:235],v203,43008
mf a[132:135],a[240:243],v[140:143],a[132:135]
trr a[236:237],v204,40960
mf a[140:143],a[244:247],v[140:143],a[140:143]
trr a[238:239],v204,43008
mf a[136:139],a[244:247],v[136:139],a[136:139]
s_waitcnt lgkmcnt(8)
trr a[240:241],v201,45056
mf a[144:147],a[248:251],v[136:139],a[144:147]
trr a[242:243],v201,47104
mf a[148:151],a[248:251],v[140:143],a[148:151]
trr a[244:245],v202,45056
mf a[156:159],a[252:255],v[140:143],a[156:159]
trr a[246:247],v202,47104
mf a[152:155],a[252:255],v[136:139],a[152:155]
s_waitcnt lgkmcnt(8)
trr a[248:249],v203,45056
mf a[160:163],a[224:227],v[128:131],a[160:163]
trr a[250:251],v203,47104
mf a[164:167],a[224:227],v[132:135],a[164:167]
v_add_u32 v201,0x10000,v201
trr a[252:253],v204,45056
mf a[172:175],a[228:231],v[132:135],a[172:175]
trr a[254:255],v204,47104
mf a[168:171],a[228:231],v[128:131],a[168:171]
s_waitcnt lgkmcnt(8)
s_waitcnt vmcnt(4)
s_barrier
mf a[176:179],a[232:235],v[128:131],a[176:179]
v_add_u32 v202,0x10000,v202
trr a[224:225],v201,32768
trr a[226:227],v201,34816
mf a[180:183],a[232:235],v[132:135],a[180:183]
v_add_u32 v203,0x10000,v203
trr a[228:229],v202,32768
trr a[230:231],v202,34816
s_add_u32 m0,s61,0
mf a[188:191],a[236:239],v[132:135],a[188:191]
s_add_u32 s48,s53,s92
s_add_u32 s48,s48,172032
buffer_load_dwordx4 v216,s[36:39],s48 offen lds
mf a[184:187],a[236:239],v[128:131],a[184:187]
s_waitcnt lgkmcnt(8)
v_add_u32 v204,0x10000,v204
mf a[160:163],a[240:243],v[136:139],a[160:163]
trr a[232:233],v203,32768
trr a[234:235],v203,34816
mf a[164:167],a[240:243],v[140:143],a[164:167]
trr a[236:237],v204,32768
trr a[238:239],v204,34816
mf a[172:175],a[244:247],v[140:143],a[172:175]
buffer_load_dwordx4 v217,s[36:39],s48 offen offset:1024 lds
mf a[168:171],a[244:247],v[136:139],a[168:171]
s_waitcnt lgkmcnt(8)
trr a[240:241],v201,36864
mf a[176:179],a[248:251],v[136:139],a[176:179]
trr a[242:243],v201,38912
mf a[180:183],a[248:251],v[140:143],a[180:183]
trr a[244:245],v202,36864
trr a[246:247],v202,38912
s_add_u32 m0,s61,8192
mf a[188:191],a[252:255],v[140:143],a[188:191]
s_add_u32 s48,s53,s93
s_add_u32 s48,s48,172032
buffer_load_dwordx4 v216,s[36:39],s48 offen lds
mf a[184:187],a[252:255],v[136:139],a[184:187]
s_waitcnt lgkmcnt(8)
trr a[248:249],v203,36864
mf a[192:195],a[224:227],v[128:131],a[192:195]
trr a[250:251],v203,38912
mf a[196:199],a[224:227],v[132:135],a[196:199]
trr a[252:253],v204,36864
trr a[254:255],v204,38912
mf a[204:207],a[228:231],v[132:135],a[204:207]
buffer_load_dwordx4 v217,s[36:39],s48 offen offset:1024 lds
mf a[200:203],a[228:231],v[128:131],a[200:203]
s_waitcnt lgkmcnt(8)
s_barrier
mf a[208:211],a[232:235],v[128:131],a[208:211]
trr a[224:225],v201,16384
trr a[226:227],v201,18432
mf a[212:215],a[232:235],v[132:135],a[212:215]
trr a[228:229],v202,16384
trr a[230:231],v202,18432
s_add_u32 m0,s49,32768
mf a[220:223],a[236:239],v[132:135],a[220:223]
s_add_u32 s48,s51,196992
buffer_load_dwordx4 v212,s[28:31],s48 offen nt lds
mf a[216:219],a[236:239],v[128:131],a[216:219]
s_waitcnt lgkmcnt(8)
trr a[232:233],v203,16384
mf a[192:195],a[240:243],v[136:139],a[192:195]
trr a[234:235],v203,18432
mf a[196:199],a[240:243],v[140:143],a[196:199]
trr a[236:237],v204,16384
mf a[204:207],a[244:247],v[140:143],a[204:207]
trr a[238:239],v204,18432
mf a[200:203],a[244:247],v[136:139],a[200:203]
s_waitcnt lgkmcnt(8)
trr a[240:241],v201,20480
mf a[208:211],a[248:251],v[136:139],a[208:211]
trr a[242:243],v201,22528
buffer_load_dwordx4 v213,s[28:31],s48 offen offset:1024 nt lds
mf a[212:215],a[248:251],v[140:143],a[212:215]
trr a[244:245],v202,20480
mf a[220:223],a[252:255],v[140:143],a[220:223]
trr a[246:247],v202,22528
mf a[216:219],a[252:255],v[136:139],a[216:219]
s_waitcnt lgkmcnt(8)
trr a[248:249],v203,20480
mf v[128:131],a[224:227],v[0:3],0
trr a[250:251],v203,22528
mf v[132:135],a[224:227],v[4:7],0
trr a[252:253],v204,20480
trr a[254:255],v204,22528
mf v[140:143],a[228:231],v[4:7],0
buffer_load_dwordx4 v214,s[28:31],s48 offen offset:2048 nt lds
mf v[136:139],a[228:231],v[0:3],0
s_waitcnt lgkmcnt(8)
trr a[224:225],v201,24576
mf v[144:147],a[232:235],v[0:3],0
trr a[226:227],v201,26624
mf v[148:151],a[232:235],v[4:7],0
trr a[228:229],v202,24576
mf v[156:159],a[236:239],v[4:7],0
trr a[230:231],v202,26624
mf v[152:155],a[236:239],v[0:3],0
s_waitcnt lgkmcnt(8)
trr a[232:233],v203,24576
mf v[128:131],a[240:243],v[8:11],v[128:131]
trr a[234:235],v203,26624
buffer_load_dwordx4 v215,s[28:31],s48 offen offset:3072 nt lds
mf v[132:135],a[240:243],v[12:15],v[132:135]
trr a[236:237],v204,24576
mf v[140:143],a[244:247],v[12:15],v[140:143]
trr a[238:239],v204,26624
mf v[136:139],a[244:247],v[8:11],v[136:139]
s_waitcnt lgkmcnt(8)
trr a[240:241],v201,28672
mf v[144:147],a[248:251],v[8:11],v[144:147]
trr a[242:243],v201,30720
mf v[148:151],a[248:251],v[12:15],v[148:151]
trr a[244:245],v202,28672
mf v[156:159],a[252:255],v[12:15],v[156:159]
trr a[246:247],v202,30720
mf v[152:155],a[252:255],v[8:11],v[152:155]
s_waitcnt lgkmcnt(8)
trr a[248:249],v203,28672
mf v[128:131],a[224:227],v[16:19],v[128:131]
trr a[250:251],v203,30720
mf v[132:135],a[224:227],v[20:23],v[132:135]
trr a[252:253],v204,28672
mf v[140:143],a[228:231],v[20:23],v[140:143]
trr a[254:255],v204,30720
mf v[136:139],a[228:231],v[16:19],v[136:139]
s_waitcnt lgkmcnt(8)
s_barrier
mf v[144:147],a[232:235],v[16:19],v[144:147]
trr a[224:225],v201,0
trr a[226:227],v201,2048
mf v[148:151],a[232:235],v[20:23],v[148:151]
trr a[228:229],v202,0
trr a[230:231],v202,2048
s_add_u32 m0,s61,49152
mf v[156:159],a[236:239],v[20:23],v[156:159]
s_add_u32 s48,s53,s94
s_add_u32 s48,s48,172032
buffer_load_dwordx4 v216,s[36:39],s48 offen lds
mf v[152:155],a[236:239],v[16:19],v[152:155]
s_waitcnt lgkmcnt(8)
trr a[232:233],v203,0
mf v[128:131],a[240:243],v[24:27],v[128:131]
trr a[234:235],v203,2048
mf v[132:135],a[240:243],v[28:31],v[132:135]
trr a[236:237],v204,0
mf v[140:143],a[244:247],v[28:31],v[140:143]
trr a[238:239],v204,2048
mf v[136:139],a[244:247],v[24:27],v[136:139]
s_waitcnt lgkmcnt(8)
trr a[240:241],v201,4096
mf v[144:147],a[248:251],v[24:27],v[144:147]
trr a[242:243],v201,6144
buffer_load_dwordx4 v217,s[36:39],s48 offen offset:1024 lds
mf v[148:151],a[248:251],v[28:31],v[148:151]
trr a[244:245],v202,4096
mf v[156:159],a[252:255],v[28:31],v[156:159]
trr a[246:247],v202,6144
mf v[152:155],a[252:255],v[24:27],v[152:155]
s_waitcnt lgkmcnt(8)
trr a[248:249],v203,4096
mf v[128:131],a[224:227],v[32:35],v[128:131]
trr a[250:251],v203,6144
mf v[132:135],a[224:227],v[36:39],v[132:135]
trr a[252:253],v204,4096
trr a[254:255],v204,6144
s_add_u32 m0,s61,57344
mf v[140:143],a[228:231],v[36:39],v[140:143]
s_add_u32 s48,s53,s95
s_add_u32 s48,s48,172032
buffer_load_dwordx4 v216,s[36:39],s48 offen lds
mf v[136:139],a[228:231],v[32:35],v[136:139]
s_waitcnt lgkmcnt(8)
trr a[224:225],v201,8192
mf v[144:147],a[232:235],v[32:35],v[144:147]
trr a[226:227],v201,10240
mf v[148:151],a[232:235],v[36:39],v[148:151]
trr a[228:229],v202,8192
mf v[156:159],a[236:239],v[36:39],v[156:159]
trr a[230:231],v202,10240
mf v[152:155],a[236:239],v[32:35],v[152:155]
s_waitcnt lgkmcnt(8)
trr a[232:233],v203,8192
mf v[128:131],a[240:243],v[40:43],v[128:131]
trr a[234:235],v203,10240
buffer_load_dwordx4 v217,s[36:39],s48 offen offset:1024 lds
mf v[132:135],a[240:243],v[44:47],v[132:135]
trr a[236:237],v204,8192
mf v[140:143],a[244:247],v[44:47],v[140:143]
trr a[238:239],v204,10240
mf v[136:139],a[244:247],v[40:43],v[136:139]
s_waitcnt lgkmcnt(8)
trr a[240:241],v201,12288
mf v[144:147],a[248:251],v[40:43],v[144:147]
trr a[242:243],v201,14336
mf v[148:151],a[248:251],v[44:47],v[148:151]
trr a[244:245],v202,12288
mf v[156:159],a[252:255],v[44:47],v[156:159]
trr a[246:247],v202,14336
mf v[152:155],a[252:255],v[40:43],v[152:155]
s_waitcnt lgkmcnt(8)
trr a[248:249],v203,12288
mf v[128:131],a[224:227],v[48:51],v[128:131]
trr a[250:251],v203,14336
mf v[132:135],a[224:227],v[52:55],v[132:135]
v_add_u32 v201,0xffff0000,v201
trr a[252:253],v204,12288
mf v[140:143],a[228:231],v[52:55],v[140:143]
trr a[254:255],v204,14336
mf v[136:139],a[228:231],v[48:51],v[136:139]
s_waitcnt lgkmcnt(8)
s_waitcnt vmcnt(12)
s_barrier
mf v[144:147],a[232:235],v[48:51],v[144:147]
v_add_u32 v202,0xffff0000,v202
trr a[224:225],v201,16384
trr a[226:227],v201,18432
mf v[148:151],a[232:235],v[52:55],v[148:151]
v_add_u32 v203,0xffff0000,v203
trr a[228:229],v202,16384
trr a[230:231],v202,18432
s_add_u32 m0,s61,81920
mf v[156:159],a[236:239],v[52:55],v[156:159]
s_add_u32 s48,s53,s96
s_add_u32 s48,s48,172032
buffer_load_dwordx4 v216,s[36:39],s48 offen lds
mf v[152:155],a[236:239],v[48:51],v[152:155]
s_waitcnt lgkmcnt(8)
v_add_u32 v204,0xffff0000,v204
mf v[128:131],a[240:243],v[56:59],v[128:131]
trr a[232:233],v203,16384
trr a[234:235],v203,18432
mf v[132:135],a[240:243],v[60:63],v[132:135]
trr a[236:237],v204,16384
mf v[140:143],a[244:247],v[60:63],v[140:143]
trr a[238:239],v204,18432
mf v[136:139],a[244:247],v[56:59],v[136:139]
s_waitcnt lgkmcnt(8)
trr a[240:241],v201,20480
mf v[144:147],a[248:251],v[56:59],v[144:147]
trr a[242:243],v201,22528
buffer_load_dwordx4 v217,s[36:39],s48 offen offset:1024 lds
mf v[148:151],a[248:251],v[60:63],v[148:151]
trr a[244:245],v202,20480
mf v[156:159],a[252:255],v[60:63],v[156:159]
trr a[246:247],v202,22528
mf v[152:155],a[252:255],v[56:59],v[152:155]
s_waitcnt lgkmcnt(8)
trr a[248:249],v203,20480
mf v[128:131],a[224:227],v[64:67],v[128:131]
trr a[250:251],v203,22528
mf v[132:135],a[224:227],v[68:71],v[132:135]
trr a[252:253],v204,20480
trr a[254:255],v204,22528
s_add_u32 m0,s61,90112
mf v[140:143],a[228:231],v[68:71],v[140:143]
s_add_u32 s48,s53,s97
s_add_u32 s48,s48,172032
buffer_load_dwordx4 v216,s[36:39],s48 offen lds
mf v[136:139],a[228:231],v[64:67],v[136:139]
s_waitcnt lgkmcnt(8)
trr a[224:225],v201,24576
mf v[144:147],a[232:235],v[64:67],v[144:147]
trr a[226:227],v201,26624
mf v[148:151],a[232:235],v[68:71],v[148:151]
trr a[228:229],v202,24576
mf v[156:159],a[236:239],v[68:71],v[156:159]
trr a[230:231],v202,26624
mf v[152:155],a[236:239],v[64:67],v[152:155]
s_waitcnt lgkmcnt(8)
trr a[232:233],v203,24576
mf v[128:131],a[240:243],v[72:75],v[128:131]
trr a[234:235],v203,26624
buffer_load_dwordx4 v217,s[36:39],s48 offen offset:1024 lds
mf v[132:135],a[240:243],v[76:79],v[132:135]
trr a[236:237],v204,24576
mf v[140:143],a[244:247],v[76:79],v[140:143]
trr a[238:239],v204,26624
mf v[136:139],a[244:247],v[72:75],v[136:139]
s_waitcnt lgkmcnt(8)
trr a[240:241],v201,28672
mf v[144:147],a[248:251],v[72:75],v[144:147]
trr a[242:243],v201,30720
mf v[148:151],a[248:251],v[76:79],v[148:151]
trr a[244:245],v202,28672
mf v[156:159],a[252:255],v[76:79],v[156:159]
trr a[246:247],v202,30720
mf v[152:155],a[252:255],v[72:75],v[152:155]
s_waitcnt lgkmcnt(8)
trr a[248:249],v203,28672
mf v[128:131],a[224:227],v[80:83],v[128:131]
trr a[250:251],v203,30720
mf v[132:135],a[224:227],v[84:87],v[132:135]
trr a[252:253],v204,28672
mf v[140:143],a[228:231],v[84:87],v[140:143]
trr a[254:255],v204,30720
mf v[136:139],a[228:231],v[80:83],v[136:139]
s_waitcnt lgkmcnt(8)
s_waitcnt vmcnt(8)
s_barrier
mf v[144:147],a[232:235],v[80:83],v[144:147]
trr a[224:225],v201,32768
trr a[226:227],v201,34816
mf v[148:151],a[232:235],v[84:87],v[148:151]
trr a[228:229],v202,32768
mf v[156:159],a[236:239],v[84:87],v[156:159]
trr a[230:231],v202,34816
mf v[152:155],a[236:239],v[80:83],v[152:155]
s_waitcnt lgkmcnt(8)
trr a[232:233],v201,36864
mf v[128:131],a[240:243],v[88:91],v[128:131]
trr a[234:235],v201,38912
mf v[132:135],a[240:243],v[92:95],v[132:135]
trr a[236:237],v202,36864
mf v[140:143],a[244:247],v[92:95],v[140:143]
trr a[238:239],v202,38912
mf v[136:139],a[244:247],v[88:91],v[136:139]
s_waitcnt lgkmcnt(8)
trr a[240:241],v201,40960
mf v[144:147],a[248:251],v[88:91],v[144:147]
trr a[242:243],v201,43008
mf v[148:151],a[248:251],v[92:95],v[148:151]
trr a[244:245],v202,40960
mf v[156:159],a[252:255],v[92:95],v[156:159]
trr a[246:247],v202,43008
mf v[152:155],a[252:255],v[88:91],v[152:155]
s_waitcnt lgkmcnt(8)
trr a[248:249],v201,45056
mf v[128:131],a[224:227],v[96:99],v[128:131]
trr a[250:251],v201,47104
mf v[132:135],a[224:227],v[100:103],v[132:135]
trr a[252:253],v202,45056
mf v[140:143],a[228:231],v[100:103],v[140:143]
trr a[254:255],v202,47104
mf v[136:139],a[228:231],v[96:99],v[136:139]
s_waitcnt lgkmcnt(8)
trr a[224:225],v203,32768
mf v[128:131],a[232:235],v[104:107],v[128:131]
trr a[226:227],v203,34816
mf v[132:135],a[232:235],v[108:111],v[132:135]
trr a[228:229],v204,32768
mf v[140:143],a[236:239],v[108:111],v[140:143]
trr a[230:231],v204,34816
mf v[136:139],a[236:239],v[104:107],v[136:139]
s_waitcnt lgkmcnt(8)
trr a[232:233],v203,36864
mf v[128:131],a[240:243],v[112:115],v[128:131]
trr a[234:235],v203,38912
mf v[132:135],a[240:243],v[116:119],v[132:135]
trr a[236:237],v204,36864
mf v[140:143],a[244:247],v[116:119],v[140:143]
trr a[238:239],v204,38912
mf v[136:139],a[244:247],v[112:115],v[136:139]
s_waitcnt lgkmcnt(8)
trr a[240:241],v203,40960
mf v[128:131],a[248:251],v[120:123],v[128:131]
trr a[242:243],v203,43008
mf v[132:135],a[248:251],v[124:127],v[132:135]
trr a[244:245],v204,40960
mf v[140:143],a[252:255],v[124:127],v[140:143]
trr a[246:247],v204,43008
mf v[136:139],a[252:255],v[120:123],v[136:139]
s_waitcnt lgkmcnt(8)
trr a[248:249],v203,45056
mf v[144:147],a[224:227],v[96:99],v[144:147]
trr a[250:251],v203,47104
mf v[148:151],a[224:227],v[100:103],v[148:151]
trr a[252:253],v204,45056
mf v[156:159],a[228:231],v[100:103],v[156:159]
trr a[254:255],v204,47104
mf v[152:155],a[228:231],v[96:99],v[152:155]
s_waitcnt lgkmcnt(8)
s_barrier
mf v[144:147],a[232:235],v[104:107],v[144:147]
trr a[224:225],v201,0
trr a[226:227],v201,2048
mf v[148:151],a[232:235],v[108:111],v[148:151]
trr a[228:229],v202,0
trr a[230:231],v202,2048
v_mul_f32 v128,v128,v224
v_mul_f32 v129,v129,v224
mf v[156:159],a[236:239],v[108:111],v[156:159]
v_mul_f32 v130,v130,v224
v_mul_f32 v131,v131,v224
v_mul_f32 v136,v136,v224
mf v[152:155],a[236:239],v[104:107],v[152:155]
s_waitcnt lgkmcnt(8)
trr a[232:233],v203,0
trr a[234:235],v203,2048
v_mul_f32 v137,v137,v224
mf v[144:147],a[240:243],v[112:115],v[144:147]
v_mul_f32 v138,v138,v224
v_mul_f32 v139,v139,v224
v_mul_f32 v132,v132,v225
v_mul_f32 v133,v133,v225
mf v[148:151],a[240:243],v[116:119],v[148:151]
trr a[236:237],v204,0
trr a[238:239],v204,2048
v_mul_f32 v134,v134,v225
v_mul_f32 v135,v135,v225
mf v[156:159],a[244:247],v[116:119],v[156:159]
v_mul_f32 v140,v140,v225
v_mul_f32 v141,v141,v225
v_mul_f32 v142,v142,v225
mf v[152:155],a[244:247],v[112:115],v[152:155]
s_waitcnt lgkmcnt(8)
trr a[240:241],v201,4096
trr a[242:243],v201,6144
v_mul_f32 v143,v143,v225
mf v[144:147],a[248:251],v[120:123],v[144:147]
cvp v128,v128,v129
cvp v129,v130,v131
cvp v130,v136,v137
cvp v131,v138,v139
mf v[148:151],a[248:251],v[124:127],v[148:151]
trr a[244:245],v202,4096
trr a[246:247],v202,6144
cvp v132,v132,v133
mf v[156:159],a[252:255],v[124:127],v[156:159]
cvp v133,v134,v135
cvp v134,v140,v141
cvp v135,v142,v143
mf v[152:155],a[252:255],v[120:123],v[152:155]
s_waitcnt lgkmcnt(8)
trr a[248:249],v203,4096
mf a[0:3],a[224:227],v[128:131],a[0:3]
trr a[250:251],v203,6144
v_readfirstlane_b32 s56,v234
s_nop 3
s_cmp_lg_u32 s56,0
s_cbranch_scc1 L_restart
mf a[4:7],a[224:227],v[132:135],a[4:7]
trr a[252:253],v204,4096
trr a[254:255],v204,6144
v_mul_f32 v144,v144,v224
v_mul_f32 v145,v145,v224
v_mul_f32 v146,v146,v224
mf a[12:15],a[228:231],v[132:135],a[12:15]
v_mul_f32 v147,v147,v224
v_mul_f32 v152,v152,v224
v_mul_f32 v153,v153,v224
v_mul_f32 v154,v154,v224
v_mul_f32 v155,v155,v224
mf a[8:11],a[228:231],v[128:131],a[8:11]
s_waitcnt lgkmcnt(8)
trr a[224:225],v201,8192
trr a[226:227],v201,10240
v_mul_f32 v148,v148,v225
v_mul_f32 v149,v149,v225
v_mul_f32 v150,v150,v225
mf a[16:19],a[232:235],v[128:131],a[16:19]
v_mul_f32 v151,v151,v225
v_mul_f32 v156,v156,v225
v_mul_f32 v157,v157,v225
v_mul_f32 v158,v158,v225
v_mul_f32 v159,v159,v225
mf a[20:23],a[232:235],v[132:135],a[20:23]
trr a[228:229],v202,8192
trr a[230:231],v202,10240
cvp v136,v144,v145
cvp v137,v146,v147
cvp v138,v152,v153
mf a[28:31],a[236:239],v[132:135],a[28:31]
cvp v139,v154,v155
cvp v140,v148,v149
cvp v141,v150,v151
cvp v142,v156,v157
cvp v143,v158,v159
mf a[24:27],a[236:239],v[128:131],a[24:27]
s_waitcnt lgkmcnt(8)
trr a[232:233],v203,8192
mf a[0:3],a[240:243],v[136:139],a[0:3]
trr a[234:235],v203,10240
mf a[4:7],a[240:243],v[140:143],a[4:7]
trr a[236:237],v204,8192
mf a[12:15],a[244:247],v[140:143],a[12:15]
trr a[238:239],v204,10240
mf a[8:11],a[244:247],v[136:139],a[8:11]
s_waitcnt lgkmcnt(8)
trr a[240:241],v201,12288
mf a[16:19],a[248:251],v[136:139],a[16:19]
trr a[242:243],v201,14336
mf a[20:23],a[248:251],v[140:143],a[20:23]
trr a[244:245],v202,12288
mf a[28:31],a[252:255],v[140:143],a[28:31]
trr a[246:247],v202,14336
mf a[24:27],a[252:255],v[136:139],a[24:27]
s_waitcnt lgkmcnt(8)
trr a[248:249],v203,12288
mf a[32:35],a[224:227],v[128:131],a[32:35]
trr a[250:251],v203,14336
mf a[36:39],a[224:227],v[132:135],a[36:39]
trr a[252:253],v204,12288
trr a[254:255],v204,14336
s_lshl_b32 s60,s92,5
ard v0,a0
ard v1,a1
mf a[44:47],a[228:231],v[132:135],a[44:47]
ard v2,a2
ard v3,a3
ard v4,a8
ard v5,a9
mf a[40:43],a[228:231],v[128:131],a[40:43]
s_waitcnt lgkmcnt(8)
s_waitcnt vmcnt(4)
s_barrier
trr a[224:225],v201,49152
trr a[226:227],v201,51200
ard v6,a10
mf a[48:51],a[232:235],v[128:131],a[48:51]
ard v7,a11
cvp v0,v0,v1
cvp v1,v2,v3
cvp v2,v4,v5
cvp v3,v6,v7
buffer_store_dwordx4 v[0:3],v220,s[40:43],s60 offen nt
mf a[52:55],a[232:235],v[132:135],a[52:55]
trr a[228:229],v202,49152
trr a[230:231],v202,51200
s_add_u32 m0,s61,16384
s_add_u32 s48,s53,s98
s_add_u32 s48,s48,172032
buffer_load_dwordx4 v216,s[36:39],s48 offen lds
mf a[60:63],a[236:239],v[132:135],a[60:63]
ard v8,a4
ard v9,a5
ard v10,a6
ard v11,a7
ard v12,a12
ard v13,a13
mf a[56:59],a[236:239],v[128:131],a[56:59]
s_waitcnt lgkmcnt(8)
trr a[232:233],v203,49152
trr a[234:235],v203,51200
ard v14,a14
ard v15,a15
mf a[32:35],a[240:243],v[136:139],a[32:35]
cvp v8,v8,v9
cvp v9,v10,v11
cvp v10,v12,v13
cvp v11,v14,v15
buffer_store_dwordx4 v[8:11],v221,s[40:43],s60 offen nt
mf a[36:39],a[240:243],v[140:143],a[36:39]
trr a[236:237],v204,49152
trr a[238:239],v204,51200
ard v16,a16
ard v17,a17
ard v18,a18
mf a[44:47],a[244:247],v[140:143],a[44:47]
ard v19,a19
ard v20,a24
ard v21,a25
ard v22,a26
mf a[40:43],a[244:247],v[136:139],a[40:43]
s_waitcnt lgkmcnt(8)
trr a[240:241],v201,53248
trr a[242:243],v201,55296
buffer_load_dwordx4 v217,s[36:39],s48 offen offset:1024 lds
ard v23,a27
mf a[48:51],a[248:251],v[136:139],a[48:51]
cvp v16,v16,v17
cvp v17,v18,v19
cvp v18,v20,v21
cvp v19,v22,v23
buffer_store_dwordx4 v[16:19],v220,s[40:43],s60 offen offset:2048 nt
mf a[52:55],a[248:251],v[140:143],a[52:55]
trr a[244:245],v202,53248
trr a[246:247],v202,55296
ard v24,a20
ard v25,a21
ard v26,a22
mf a[60:63],a[252:255],v[140:143],a[60:63]
ard v27,a23
ard v28,a28
ard v29,a29
ard v30,a30
mf a[56:59],a[252:255],v[136:139],a[56:59]
s_waitcnt lgkmcnt(8)
trr a[248:249],v203,53248
trr a[250:251],v203,55296
ard v31,a31
cvp v24,v24,v25
mf a[64:67],a[224:227],v[128:131],a[64:67]
cvp v25,v26,v27
cvp v26,v28,v29
cvp v27,v30,v31
buffer_store_dwordx4 v[24:27],v221,s[40:43],s60 offen offset:2048 nt
mf a[68:71],a[224:227],v[132:135],a[68:71]
trr a[252:253],v204,53248
trr a[254:255],v204,55296
s_lshl_b32 s60,s93,5
ard v32,a32
ard v33,a33
mf a[76:79],a[228:231],v[132:135],a[76:79]
ard v34,a34
ard v35,a35
ard v36,a40
ard v37,a41
mf a[72:75],a[228:231],v[128:131],a[72:75]
s_waitcnt lgkmcnt(8)
trr a[224:225],v201,57344
trr a[226:227],v201,59392
ard v38,a42
ard v39,a43
mf a[80:83],a[232:235],v[128:131],a[80:83]
cvp v32,v32,v33
cvp v33,v34,v35
cvp v34,v36,v37
cvp v35,v38,v39
buffer_store_dwordx4 v[32:35],v220,s[40:43],s60 offen nt
mf a[84:87],a[232:235],v[132:135],a[84:87]
trr a[228:229],v202,57344
trr a[230:231],v202,59392
ard v40,a36
ard v41,a37
mf a[92:95],a[236:239],v[132:135],a[92:95]
ard v42,a38
ard v43,a39
ard v44,a44
ard v45,a45
mf a[88:91],a[236:239],v[128:131],a[88:91]
s_waitcnt lgkmcnt(8)
trr a[232:233],v203,57344
trr a[234:235],v203,59392
ard v46,a46
ard v47,a47
mf a[64:67],a[240:243],v[136:139],a[64:67]
cvp v40,v40,v41
cvp v41,v42,v43
cvp v42,v44,v45
cvp v43,v46,v47
buffer_store_dwordx4 v[40:43],v221,s[40:43],s60 offen nt
mf a[68:71],a[240:243],v[140:143],a[68:71]
trr a[236:237],v204,57344
trr a[238:239],v204,59392
ard v48,a48
ard v49,a49
ard v50,a50
mf a[76:79],a[244:247],v[140:143],a[76:79]
ard v51,a51
ard v52,a56
ard v53,a57
ard v54,a58
mf a[72:75],a[244:247],v[136:139],a[72:75]
s_waitcnt lgkmcnt(8)
trr a[240:241],v201,61440
trr a[242:243],v201,63488
ard v55,a59
cvp v48,v48,v49
mf a[80:83],a[248:251],v[136:139],a[80:83]
cvp v49,v50,v51
cvp v50,v52,v53
cvp v51,v54,v55
buffer_store_dwordx4 v[48:51],v220,s[40:43],s60 offen offset:2048 nt
mf a[84:87],a[248:251],v[140:143],a[84:87]
trr a[244:245],v202,61440
trr a[246:247],v202,63488
ard v56,a52
ard v57,a53
ard v58,a54
mf a[92:95],a[252:255],v[140:143],a[92:95]
ard v59,a55
ard v60,a60
ard v61,a61
ard v62,a62
mf a[88:91],a[252:255],v[136:139],a[88:91]
s_waitcnt lgkmcnt(8)
trr a[248:249],v203,61440
trr a[250:251],v203,63488
ard v63,a63
cvp v56,v56,v57
mf a[96:99],a[224:227],v[128:131],a[96:99]
cvp v57,v58,v59
cvp v58,v60,v61
cvp v59,v62,v63
buffer_store_dwordx4 v[56:59],v221,s[40:43],s60 offen offset:2048 nt
mf a[100:103],a[224:227],v[132:135],a[100:103]
v_add_u32 v201,0x10000,v201
trr a[252:253],v204,61440
trr a[254:255],v204,63488
s_lshl_b32 s60,s94,5
ard v0,a64
mf a[108:111],a[228:231],v[132:135],a[108:111]
ard v1,a65
ard v2,a66
ard v3,a67
ard v4,a72
ard v5,a73
mf a[104:107],a[228:231],v[128:131],a[104:107]
s_waitcnt lgkmcnt(8)
s_waitcnt vmcnt(10)
s_barrier
v_add_u32 v202,0x10000,v202
trr a[224:225],v201,16384
trr a[226:227],v201,18432
ard v6,a74
mf a[112:115],a[232:235],v[128:131],a[112:115]
ard v7,a75
cvp v0,v0,v1
cvp v1,v2,v3
cvp v2,v4,v5
cvp v3,v6,v7
buffer_store_dwordx4 v[0:3],v220,s[40:43],s60 offen nt
mf a[116:119],a[232:235],v[132:135],a[116:119]
v_add_u32 v203,0x10000,v203
trr a[228:229],v202,16384
trr a[230:231],v202,18432
ard v8,a68
ard v9,a69
mf a[124:127],a[236:239],v[132:135],a[124:127]
ard v10,a70
ard v11,a71
ard v12,a76
ard v13,a77
mf a[120:123],a[236:239],v[128:131],a[120:123]
s_waitcnt lgkmcnt(8)
v_add_u32 v204,0x10000,v204
trr a[232:233],v203,16384
trr a[234:235],v203,18432
ard v14,a78
ard v15,a79
mf a[96:99],a[240:243],v[136:139],a[96:99]
cvp v8,v8,v9
cvp v9,v10,v11
cvp v10,v12,v13
cvp v11,v14,v15
buffer_store_dwordx4 v[8:11],v221,s[40:43],s60 offen nt
mf a[100:103],a[240:243],v[140:143],a[100:103]
trr a[236:237],v204,16384
trr a[238:239],v204,18432
ard v16,a80
ard v17,a81
ard v18,a82
mf a[108:111],a[244:247],v[140:143],a[108:111]
ard v19,a83
ard v20,a88
ard v21,a89
ard v22,a90
mf a[104:107],a[244:247],v[136:139],a[104:107]
s_waitcnt lgkmcnt(8)
trr a[240:241],v201,20480
trr a[242:243],v201,22528
ard v23,a91
cvp v16,v16,v17
mf a[112:115],a[248:251],v[136:139],a[112:115]
cvp v17,v18,v19
cvp v18,v20,v21
cvp v19,v22,v23
buffer_store_dwordx4 v[16:19],v220,s[40:43],s60 offen offset:2048 nt
mf a[116:119],a[248:251],v[140:143],a[116:119]
trr a[244:245],v202,20480
trr a[246:247],v202,22528
ard v24,a84
ard v25,a85
ard v26,a86
mf a[124:127],a[252:255],v[140:143],a[124:127]
ard v27,a87
ard v28,a92
ard v29,a93
ard v30,a94
mf a[120:123],a[252:255],v[136:139],a[120:123]
s_waitcnt lgkmcnt(8)
trr a[248:249],v203,20480
trr a[250:251],v203,22528
ard v31,a95
cvp v24,v24,v25
mf a[128:131],a[224:227],v[128:131],a[128:131]
cvp v25,v26,v27
cvp v26,v28,v29
cvp v27,v30,v31
buffer_store_dwordx4 v[24:27],v221,s[40:43],s60 offen offset:2048 nt
mf a[132:135],a[224:227],v[132:135],a[132:135]
trr a[252:253],v204,20480
trr a[254:255],v204,22528
s_lshl_b32 s60,s95,5
ard v32,a96
ard v33,a97
mf a[140:143],a[228:231],v[132:135],a[140:143]
ard v34,a98
ard v35,a99
ard v36,a104
ard v37,a105
mf a[136:139],a[228:231],v[128:131],a[136:139]
s_waitcnt lgkmcnt(8)
trr a[224:225],v201,24576
trr a[226:227],v201,26624
ard v38,a106
ard v39,a107
mf a[144:147],a[232:235],v[128:131],a[144:147]
cvp v32,v32,v33
cvp v33,v34,v35
cvp v34,v36,v37
cvp v35,v38,v39
buffer_store_dwordx4 v[32:35],v220,s[40:43],s60 offen nt
mf a[148:151],a[232:235],v[132:135],a[148:151]
trr a[228:229],v202,24576
trr a[230:231],v202,26624
ard v40,a100
ard v41,a101
mf a[156:159],a[236:239],v[132:135],a[156:159]
ard v42,a102
ard v43,a103
ard v44,a108
ard v45,a109
mf a[152:155],a[236:239],v[128:131],a[152:155]
s_waitcnt lgkmcnt(8)
trr a[232:233],v203,24576
trr a[234:235],v203,26624
ard v46,a110
ard v47,a111
mf a[128:131],a[240:243],v[136:139],a[128:131]
cvp v40,v40,v41
cvp v41,v42,v43
cvp v42,v44,v45
cvp v43,v46,v47
buffer_store_dwordx4 v[40:43],v221,s[40:43],s60 offen nt
mf a[132:135],a[240:243],v[140:143],a[132:135]
trr a[236:237],v204,24576
trr a[238:239],v204,26624
ard v48,a112
ard v49,a113
ard v50,a114
mf a[140:143],a[244:247],v[140:143],a[140:143]
ard v51,a115
ard v52,a120
ard v53,a121
ard v54,a122
mf a[136:139],a[244:247],v[136:139],a[136:139]
s_waitcnt lgkmcnt(8)
trr a[240:241],v201,28672
trr a[242:243],v201,30720
ard v55,a123
cvp v48,v48,v49
mf a[144:147],a[248:251],v[136:139],a[144:147]
cvp v49,v50,v51
cvp v50,v52,v53
cvp v51,v54,v55
buffer_store_dwordx4 v[48:51],v220,s[40:43],s60 offen offset:2048 nt
mf a[148:151],a[248:251],v[140:143],a[148:151]
trr a[244:245],v202,28672
trr a[246:247],v202,30720
ard v56,a116
ard v57,a117
ard v58,a118
mf a[156:159],a[252:255],v[140:143],a[156:159]
ard v59,a119
ard v60,a124
ard v61,a125
ard v62,a126
mf a[152:155],a[252:255],v[136:139],a[152:155]
s_waitcnt lgkmcnt(8)
trr a[248:249],v203,28672
trr a[250:251],v203,30720
ard v63,a127
cvp v56,v56,v57
mf a[160:163],a[224:227],v[128:131],a[160:163]
cvp v57,v58,v59
cvp v58,v60,v61
cvp v59,v62,v63
buffer_store_dwordx4 v[56:59],v221,s[40:43],s60 offen offset:2048 nt
mf a[164:167],a[224:227],v[132:135],a[164:167]
v_add_u32 v201,0xffff0000,v201
trr a[252:253],v204,28672
trr a[254:255],v204,30720
s_lshl_b32 s60,s96,5
ard v0,a128
mf a[172:175],a[228:231],v[132:135],a[172:175]
ard v1,a129
ard v2,a130
ard v3,a131
ard v4,a136
ard v5,a137
mf a[168:171],a[228:231],v[128:131],a[168:171]
s_waitcnt lgkmcnt(8)
s_waitcnt vmcnt(14)
s_barrier
v_add_u32 v202,0xffff0000,v202
trr a[224:225],v201,16384
trr a[226:227],v201,18432
ard v6,a138
mf a[176:179],a[232:235],v[128:131],a[176:179]
ard v7,a139
cvp v0,v0,v1
cvp v1,v2,v3
cvp v2,v4,v5
cvp v3,v6,v7
buffer_store_dwordx4 v[0:3],v220,s[40:43],s60 offen nt
mf a[180:183],a[232:235],v[132:135],a[180:183]
v_add_u32 v203,0xffff0000,v203
trr a[228:229],v202,16384
trr a[230:231],v202,18432
ard v8,a132
ard v9,a133
mf a[188:191],a[236:239],v[132:135],a[188:191]
ard v10,a134
ard v11,a135
ard v12,a140
ard v13,a141
mf a[184:187],a[236:239],v[128:131],a[184:187]
s_waitcnt lgkmcnt(8)
v_add_u32 v204,0xffff0000,v204
trr a[232:233],v203,16384
trr a[234:235],v203,18432
ard v14,a142
ard v15,a143
mf a[160:163],a[240:243],v[136:139],a[160:163]
cvp v8,v8,v9
cvp v9,v10,v11
cvp v10,v12,v13
cvp v11,v14,v15
buffer_store_dwordx4 v[8:11],v221,s[40:43],s60 offen nt
mf a[164:167],a[240:243],v[140:143],a[164:167]
trr a[236:237],v204,16384
trr a[238:239],v204,18432
ard v16,a144
ard v17,a145
ard v18,a146
mf a[172:175],a[244:247],v[140:143],a[172:175]
ard v19,a147
ard v20,a152
ard v21,a153
ard v22,a154
mf a[168:171],a[244:247],v[136:139],a[168:171]
s_waitcnt lgkmcnt(8)
trr a[240:241],v201,20480
trr a[242:243],v201,22528
ard v23,a155
cvp v16,v16,v17
mf a[176:179],a[248:251],v[136:139],a[176:179]
cvp v17,v18,v19
cvp v18,v20,v21
cvp v19,v22,v23
buffer_store_dwordx4 v[16:19],v220,s[40:43],s60 offen offset:2048 nt
mf a[180:183],a[248:251],v[140:143],a[180:183]
trr a[244:245],v202,20480
trr a[246:247],v202,22528
ard v24,a148
ard v25,a149
ard v26,a150
mf a[188:191],a[252:255],v[140:143],a[188:191]
ard v27,a151
ard v28,a156
ard v29,a157
ard v30,a158
mf a[184:187],a[252:255],v[136:139],a[184:187]
s_waitcnt lgkmcnt(8)
trr a[248:249],v203,20480
trr a[250:251],v203,22528
ard v31,a159
cvp v24,v24,v25
mf a[192:195],a[224:227],v[128:131],a[192:195]
cvp v25,v26,v27
cvp v26,v28,v29
cvp v27,v30,v31
buffer_store_dwordx4 v[24:27],v221,s[40:43],s60 offen offset:2048 nt
mf a[196:199],a[224:227],v[132:135],a[196:199]
trr a[252:253],v204,20480
trr a[254:255],v204,22528
s_lshl_b32 s60,s97,5
ard v32,a160
ard v33,a161
mf a[204:207],a[228:231],v[132:135],a[204:207]
ard v34,a162
ard v35,a163
ard v36,a168
ard v37,a169
ard v38,a170
mf a[200:203],a[228:231],v[128:131],a[200:203]
s_waitcnt lgkmcnt(8)
ard v39,a171
cvp v32,v32,v33
cvp v33,v34,v35
cvp v34,v36,v37
mf a[208:211],a[232:235],v[128:131],a[208:211]
cvp v35,v38,v39
buffer_store_dwordx4 v[32:35],v220,s[40:43],s60 offen nt
ard v40,a164
ard v41,a165
mf a[212:215],a[232:235],v[132:135],a[212:215]
ard v42,a166
ard v43,a167
ard v44,a172
ard v45,a173
mf a[220:223],a[236:239],v[132:135],a[220:223]
ard v46,a174
ard v47,a175
cvp v40,v40,v41
mf a[216:219],a[236:239],v[128:131],a[216:219]
s_waitcnt lgkmcnt(4)
cvp v41,v42,v43
cvp v42,v44,v45
cvp v43,v46,v47
buffer_store_dwordx4 v[40:43],v221,s[40:43],s60 offen nt
mf a[192:195],a[240:243],v[136:139],a[192:195]
ard v48,a176
ard v49,a177
ard v50,a178
ard v51,a179
mf a[196:199],a[240:243],v[140:143],a[196:199]
ard v52,a184
ard v53,a185
ard v54,a186
ard v55,a187
mf a[204:207],a[244:247],v[140:143],a[204:207]
cvp v48,v48,v49
cvp v49,v50,v51
cvp v50,v52,v53
mf a[200:203],a[244:247],v[136:139],a[200:203]
s_waitcnt lgkmcnt(0)
cvp v51,v54,v55
buffer_store_dwordx4 v[48:51],v220,s[40:43],s60 offen offset:2048 nt
ard v56,a180
ard v57,a181
mf a[208:211],a[248:251],v[136:139],a[208:211]
ard v58,a182
ard v59,a183
ard v60,a188
ard v61,a189
mf a[212:215],a[248:251],v[140:143],a[212:215]
ard v62,a190
ard v63,a191
cvp v56,v56,v57
cvp v57,v58,v59
mf a[220:223],a[252:255],v[140:143],a[220:223]
cvp v58,v60,v61
cvp v59,v62,v63
buffer_store_dwordx4 v[56:59],v221,s[40:43],s60 offen offset:2048 nt
mf a[216:219],a[252:255],v[136:139],a[216:219]
s_lshl_b32 s60,s98,5
ard v0,a192
ard v1,a193
ard v2,a194
ard v3,a195
ard v4,a200
ard v5,a201
ard v6,a202
ard v7,a203
cvp v0,v0,v1
cvp v1,v2,v3
cvp v2,v4,v5
cvp v3,v6,v7
buffer_store_dwordx4 v[0:3],v220,s[40:43],s60 offen nt
ard v8,a196
ard v9,a197
ard v10,a198
ard v11,a199
ard v12,a204
ard v13,a205
ard v14,a206
ard v15,a207
cvp v8,v8,v9
cvp v9,v10,v11
cvp v10,v12,v13
cvp v11,v14,v15
buffer_store_dwordx4 v[8:11],v221,s[40:43],s60 offen nt
ard v16,a208
ard v17,a209
ard v18,a210
ard v19,a211
ard v20,a216
ard v21,a217
ard v22,a218
ard v23,a219
cvp v16,v16,v17
cvp v17,v18,v19
cvp v18,v20,v21
cvp v19,v22,v23
buffer_store_dwordx4 v[16:19],v220,s[40:43],s60 offen offset:2048 nt
ard v24,a212
ard v25,a213
ard v26,a214
ard v27,a215
ard v28,a220
ard v29,a221
ard v30,a222
ard v31,a223
cvp v24,v24,v25
cvp v25,v26,v27
cvp v26,v28,v29
cvp v27,v30,v31
buffer_store_dwordx4 v[24:27],v221,s[40:43],s60 offen offset:2048 nt
s_getpc_b64 s[54:55]
L_k2pf:
s_add_u32 s54,s54,mha_reduce_kernel-L_k2pf
s_addc_u32 s55,s55,0
v_lshlrev_b32 v0,6,v192
v_min_u32 v0,K2_LAST,v0
global_load_dword v1,v0,s[54:55]
s_endpgm
L_wave3:
s_waitcnt lgkmcnt(8)
trr a[248:249],v199,16384
trr a[250:251],v199,18432
mf v[0:3],a[224:227],a[64:67],0
trr a[252:253],v200,16384
trr a[254:255],v200,18432
s_add_u32 m0,s49,65536
s_add_u32 s48,s45,s93
buffer_load_dwordx4 v212,s[20:23],s48 offen lds
mf v[8:11],a[228:231],a[64:67],0
s_waitcnt lgkmcnt(8)
trr a[224:225],v193,16640
trr a[226:227],v193,18688
buffer_load_dwordx4 v213,s[20:23],s48 offen offset:1024 lds
mf v[16:19],a[232:235],a[64:67],0
trr a[228:229],v194,16640
trr a[230:231],v194,18688
buffer_load_dwordx4 v214,s[20:23],s48 offen offset:2048 lds
mf v[24:27],a[236:239],a[64:67],0
s_waitcnt lgkmcnt(8)
trr a[232:233],v195,16640
trr a[234:235],v195,18688
buffer_load_dwordx4 v215,s[20:23],s48 offen offset:3072 lds
mf v[32:35],a[240:243],a[64:67],0
trr a[236:237],v196,16640
trr a[238:239],v196,18688
s_add_u32 m0,s49,81920
s_lshl_b32 s48,s93,12
s_add_u32 s48,s48,s52
buffer_load_dwordx4 v216,s[32:35],s48 offen lds
mf v[40:43],a[244:247],a[64:67],0
s_waitcnt lgkmcnt(8)
trr a[240:241],v197,16640
trr a[242:243],v197,18688
buffer_load_dwordx4 v217,s[32:35],s48 offen offset:1024 lds
mf v[48:51],a[248:251],a[64:67],0
trr a[244:245],v198,16640
trr a[246:247],v198,18688
buffer_load_dwordx4 v218,s[32:35],s48 offen offset:2048 lds
mf v[56:59],a[252:255],a[64:67],0
s_waitcnt lgkmcnt(8)
trr a[248:249],v199,16640
trr a[250:251],v199,18688
buffer_load_dwordx4 v219,s[32:35],s48 offen offset:3072 lds
mf v[64:67],a[224:227],a[64:67],0
trr a[252:253],v200,16640
trr a[254:255],v200,18688
mf v[72:75],a[228:231],a[64:67],0
s_waitcnt lgkmcnt(8)
s_waitcnt vmcnt(12)
s_barrier
trr a[224:225],v193,32768
trr a[226:227],v193,34816
mf v[80:83],a[232:235],a[64:67],0
trr a[228:229],v194,32768
trr a[230:231],v194,34816
s_add_u32 m0,s49,0
s_lshl_b32 s48,s93,12
s_add_u32 s48,s48,s52
s_add_u32 s48,s48,262144
buffer_load_dwordx4 v216,s[32:35],s48 offen lds
mf v[88:91],a[236:239],a[64:67],0
s_waitcnt lgkmcnt(8)
trr a[232:233],v195,32768
trr a[234:235],v195,34816
mf v[96:99],a[240:243],a[64:67],0
trr a[236:237],v196,32768
trr a[238:239],v196,34816
mf v[104:107],a[244:247],a[64:67],0
s_waitcnt lgkmcnt(8)
trr a[240:241],v197,32768
trr a[242:243],v197,34816
buffer_load_dwordx4 v217,s[32:35],s48 offen offset:1024 lds
mf v[112:115],a[248:251],a[64:67],0
trr a[244:245],v198,32768
trr a[246:247],v198,34816
mf v[120:123],a[252:255],a[64:67],0
s_waitcnt lgkmcnt(8)
trr a[248:249],v199,32768
trr a[250:251],v199,34816
mf v[0:3],a[224:227],a[72:75],v[0:3]
trr a[252:253],v200,32768
trr a[254:255],v200,34816
buffer_load_dwordx4 v218,s[32:35],s48 offen offset:2048 lds
mf v[8:11],a[228:231],a[72:75],v[8:11]
s_waitcnt lgkmcnt(8)
trr a[224:225],v193,33024
trr a[226:227],v193,35072
mf v[16:19],a[232:235],a[72:75],v[16:19]
trr a[228:229],v194,33024
trr a[230:231],v194,35072
mf v[24:27],a[236:239],a[72:75],v[24:27]
s_waitcnt lgkmcnt(8)
trr a[232:233],v195,33024
trr a[234:235],v195,35072
buffer_load_dwordx4 v219,s[32:35],s48 offen offset:3072 lds
mf v[32:35],a[240:243],a[72:75],v[32:35]
trr a[236:237],v196,33024
trr a[238:239],v196,35072
mf v[40:43],a[244:247],a[72:75],v[40:43]
s_waitcnt lgkmcnt(8)
trr a[240:241],v197,33024
trr a[242:243],v197,35072
mf v[48:51],a[248:251],a[72:75],v[48:51]
trr a[244:245],v198,33024
trr a[246:247],v198,35072
mf v[56:59],a[252:255],a[72:75],v[56:59]
s_waitcnt lgkmcnt(8)
trr a[248:249],v199,33024
trr a[250:251],v199,35072
mf v[64:67],a[224:227],a[72:75],v[64:67]
v_add_u32 v193,0x10000,v193
trr a[252:253],v200,33024
trr a[254:255],v200,35072
mf v[72:75],a[228:231],a[72:75],v[72:75]
s_waitcnt lgkmcnt(8)
s_waitcnt vmcnt(4)
s_barrier
v_add_u32 v194,0x10000,v194
trr a[224:225],v193,16384
trr a[226:227],v193,18432
mf v[80:83],a[232:235],a[72:75],v[80:83]
v_add_u32 v205,0x10000,v205
v_add_u32 v206,0x10000,v206
v_add_u32 v195,0x10000,v195
trr a[228:229],v194,16384
trr a[230:231],v194,18432
s_add_u32 m0,s49,16384
s_add_u32 s48,s45,s94
buffer_load_dwordx4 v212,s[20:23],s48 offen lds
mf v[88:91],a[236:239],a[72:75],v[88:91]
s_waitcnt lgkmcnt(8)
ds_read_b128 a[80:83],v205
v_add_u32 v196,0x10000,v196
trr a[232:233],v195,16384
trr a[234:235],v195,18432
buffer_load_dwordx4 v213,s[20:23],s48 offen offset:1024 lds
mf v[96:99],a[240:243],a[72:75],v[96:99]
ds_read_b128 a[88:91],v206
v_add_u32 v197,0x10000,v197
trr a[236:237],v196,16384
trr a[238:239],v196,18432
buffer_load_dwordx4 v214,s[20:23],s48 offen offset:2048 lds
mf v[104:107],a[244:247],a[72:75],v[104:107]
s_waitcnt lgkmcnt(10)
v_add_u32 v198,0x10000,v198
trr a[240:241],v197,16384
trr a[242:243],v197,18432
buffer_load_dwordx4 v215,s[20:23],s48 offen offset:3072 lds
mf v[112:115],a[248:251],a[72:75],v[112:115]
v_add_u32 v199,0x10000,v199
trr a[244:245],v198,16384
trr a[246:247],v198,18432
s_add_u32 m0,s49,98304
s_lshl_b32 s48,s94,12
s_add_u32 s48,s48,s52
buffer_load_dwordx4 v216,s[32:35],s48 offen lds
mf v[120:123],a[252:255],a[72:75],v[120:123]
s_waitcnt lgkmcnt(10)
v_add_u32 v200,0x10000,v200
trr a[248:249],v199,16384
trr a[250:251],v199,18432
buffer_load_dwordx4 v217,s[32:35],s48 offen offset:1024 lds
s_waitcnt lgkmcnt(11)
mf v[0:3],a[224:227],a[80:83],v[0:3]
trr a[252:253],v200,16384
trr a[254:255],v200,18432
buffer_load_dwordx4 v218,s[32:35],s48 offen offset:2048 lds
mf v[8:11],a[228:231],a[80:83],v[8:11]
s_waitcnt lgkmcnt(8)
trr a[224:225],v193,16640
trr a[226:227],v193,18688
buffer_load_dwordx4 v219,s[32:35],s48 offen offset:3072 lds
mf v[16:19],a[232:235],a[80:83],v[16:19]
trr a[228:229],v194,16640
trr a[230:231],v194,18688
s_add_u32 s48,s50,16384
buffer_load_dwordx4 a[96:99],v208,s[24:27],s48 offen nt
mf v[24:27],a[236:239],a[80:83],v[24:27]
s_waitcnt lgkmcnt(8)
trr a[232:233],v195,16640
trr a[234:235],v195,18688
buffer_load_dwordx4 a[100:103],v209,s[24:27],s48 offen offset:1024 nt
mf v[32:35],a[240:243],a[80:83],v[32:35]
trr a[236:237],v196,16640
trr a[238:239],v196,18688
buffer_load_dwordx4 a[104:107],v210,s[24:27],s48 offen offset:2048 nt
mf v[40:43],a[244:247],a[80:83],v[40:43]
s_waitcnt lgkmcnt(8)
trr a[240:241],v197,16640
trr a[242:243],v197,18688
buffer_load_dwordx4 a[108:111],v211,s[24:27],s48 offen offset:3072 nt
mf v[48:51],a[248:251],a[80:83],v[48:51]
trr a[244:245],v198,16640
trr a[246:247],v198,18688
mf v[56:59],a[252:255],a[80:83],v[56:59]
s_waitcnt lgkmcnt(8)
trr a[248:249],v199,16640
trr a[250:251],v199,18688
mf v[64:67],a[224:227],a[80:83],v[64:67]
v_add_u32 v193,0xffff0000,v193
trr a[252:253],v200,16640
trr a[254:255],v200,18688
mf v[72:75],a[228:231],a[80:83],v[72:75]
s_waitcnt lgkmcnt(8)
s_waitcnt vmcnt(12)
s_barrier
v_add_u32 v194,0xffff0000,v194
trr a[224:225],v193,0
trr a[226:227],v193,2048
mf v[80:83],a[232:235],a[80:83],v[80:83]
v_add_u32 v195,0xffff0000,v195
trr a[228:229],v194,0
trr a[230:231],v194,2048
s_add_u32 m0,s49,32768
s_lshl_b32 s48,s94,12
s_add_u32 s48,s48,s52
s_add_u32 s48,s48,262144
buffer_load_dwordx4 v216,s[32:35],s48 offen lds
mf v[88:91],a[236:239],a[80:83],v[88:91]
s_waitcnt lgkmcnt(8)
v_add_u32 v196,0xffff0000,v196
trr a[232:233],v195,0
trr a[234:235],v195,2048
mf v[96:99],a[240:243],a[80:83],v[96:99]
v_add_u32 v197,0xffff0000,v197
trr a[236:237],v196,0
trr a[238:239],v196,2048
mf v[104:107],a[244:247],a[80:83],v[104:107]
s_waitcnt lgkmcnt(8)
v_add_u32 v198,0xffff0000,v198
trr a[240:241],v197,0
trr a[242:243],v197,2048
buffer_load_dwordx4 v217,s[32:35],s48 offen offset:1024 lds
mf v[112:115],a[248:251],a[80:83],v[112:115]
v_add_u32 v199,0xffff0000,v199
trr a[244:245],v198,0
trr a[246:247],v198,2048
mf v[120:123],a[252:255],a[80:83],v[120:123]
s_waitcnt lgkmcnt(8)
v_add_u32 v200,0xffff0000,v200
trr a[248:249],v199,0
trr a[250:251],v199,2048
mf v[0:3],a[224:227],a[88:91],v[0:3]
trr a[252:253],v200,0
trr a[254:255],v200,2048
buffer_load_dwordx4 v218,s[32:35],s48 offen offset:2048 lds
mf v[8:11],a[228:231],a[88:91],v[8:11]
s_waitcnt lgkmcnt(8)
trr a[224:225],v193,256
trr a[226:227],v193,2304
mf v[16:19],a[232:235],a[88:91],v[16:19]
trr a[228:229],v194,256
trr a[230:231],v194,2304
mf v[24:27],a[236:239],a[88:91],v[24:27]
s_waitcnt lgkmcnt(8)
trr a[232:233],v195,256
trr a[234:235],v195,2304
buffer_load_dwordx4 v219,s[32:35],s48 offen offset:3072 lds
mf v[32:35],a[240:243],a[88:91],v[32:35]
trr a[236:237],v196,256
trr a[238:239],v196,2304
mf v[40:43],a[244:247],a[88:91],v[40:43]
s_waitcnt lgkmcnt(8)
trr a[240:241],v197,256
trr a[242:243],v197,2304
mf v[48:51],a[248:251],a[88:91],v[48:51]
trr a[244:245],v198,256
trr a[246:247],v198,2304
mf v[56:59],a[252:255],a[88:91],v[56:59]
s_waitcnt lgkmcnt(8)
trr a[248:249],v199,256
trr a[250:251],v199,2304
mf v[64:67],a[224:227],a[88:91],v[64:67]
v_add_u32 v193,0x10000,v193
trr a[252:253],v200,256
trr a[254:255],v200,2304
mf v[72:75],a[228:231],a[88:91],v[72:75]
s_waitcnt lgkmcnt(8)
s_waitcnt vmcnt(8)
s_barrier
v_add_u32 v194,0x10000,v194
trr a[224:225],v193,32768
trr a[226:227],v193,34816
mf v[80:83],a[232:235],a[88:91],v[80:83]
v_add_u32 v205,0xffff0000,v205
v_add_u32 v206,0xffff0000,v206
v_add_u32 v195,0x10000,v195
trr a[228:229],v194,32768
trr a[230:231],v194,34816
s_add_u32 m0,s49,65536
s_add_u32 s48,s45,s95
buffer_load_dwordx4 v212,s[20:23],s48 offen lds
mf v[88:91],a[236:239],a[88:91],v[88:91]
s_waitcnt lgkmcnt(8)
ds_read_b128 a[64:67],v205 offset:16384
v_add_u32 v196,0x10000,v196
trr a[232:233],v195,32768
trr a[234:235],v195,34816
buffer_load_dwordx4 v213,s[20:23],s48 offen offset:1024 lds
mf v[96:99],a[240:243],a[88:91],v[96:99]
ds_read_b128 a[72:75],v206 offset:16384
v_add_u32 v197,0x10000,v197
trr a[236:237],v196,32768
trr a[238:239],v196,34816
buffer_load_dwordx4 v214,s[20:23],s48 offen offset:2048 lds
mf v[104:107],a[244:247],a[88:91],v[104:107]
s_waitcnt lgkmcnt(10)
v_add_u32 v198,0x10000,v198
trr a[240:241],v197,32768
trr a[242:243],v197,34816
buffer_load_dwordx4 v215,s[20:23],s48 offen offset:3072 lds
mf v[112:115],a[248:251],a[88:91],v[112:115]
v_add_u32 v199,0x10000,v199
trr a[244:245],v198,32768
trr a[246:247],v198,34816
s_add_u32 m0,s49,81920
s_lshl_b32 s48,s95,12
s_add_u32 s48,s48,s52
buffer_load_dwordx4 v216,s[32:35],s48 offen lds
mf v[120:123],a[252:255],a[88:91],v[120:123]
s_waitcnt lgkmcnt(10)
v_add_u32 v200,0x10000,v200
trr a[248:249],v199,32768
trr a[250:251],v199,34816
buffer_load_dwordx4 v217,s[32:35],s48 offen offset:1024 lds
s_waitcnt lgkmcnt(11)
mf v[0:3],a[224:227],a[64:67],v[0:3]
trr a[252:253],v200,32768
trr a[254:255],v200,34816
buffer_load_dwordx4 v218,s[32:35],s48 offen offset:2048 lds
mf v[8:11],a[228:231],a[64:67],v[8:11]
s_waitcnt lgkmcnt(8)
trr a[224:225],v193,33024
trr a[226:227],v193,35072
buffer_load_dwordx4 v219,s[32:35],s48 offen offset:3072 lds
mf v[16:19],a[232:235],a[64:67],v[16:19]
trr a[228:229],v194,33024
trr a[230:231],v194,35072
s_add_u32 m0,s49,114688
s_add_u32 s48,s50,32768
buffer_load_dwordx4 v208,s[24:27],s48 offen nt lds
mf v[24:27],a[236:239],a[64:67],v[24:27]
s_waitcnt lgkmcnt(8)
trr a[232:233],v195,33024
trr a[234:235],v195,35072
buffer_load_dwordx4 v209,s[24:27],s48 offen offset:1024 nt lds
mf v[32:35],a[240:243],a[64:67],v[32:35]
trr a[236:237],v196,33024
trr a[238:239],v196,35072
buffer_load_dwordx4 v210,s[24:27],s48 offen offset:2048 nt lds
mf v[40:43],a[244:247],a[64:67],v[40:43]
s_waitcnt lgkmcnt(8)
trr a[240:241],v197,33024
trr a[242:243],v197,35072
buffer_load_dwordx4 v211,s[24:27],s48 offen offset:3072 nt lds
mf v[48:51],a[248:251],a[64:67],v[48:51]
trr a[244:245],v198,33024
trr a[246:247],v198,35072
mf v[56:59],a[252:255],a[64:67],v[56:59]
s_waitcnt lgkmcnt(8)
trr a[248:249],v199,33024
trr a[250:251],v199,35072
mf v[64:67],a[224:227],a[64:67],v[64:67]
v_add_u32 v193,0xffff0000,v193
trr a[252:253],v200,33024
trr a[254:255],v200,35072
mf v[72:75],a[228:231],a[64:67],v[72:75]
s_waitcnt lgkmcnt(8)
s_waitcnt vmcnt(12)
s_barrier
v_add_u32 v194,0xffff0000,v194
trr a[224:225],v193,32768
trr a[226:227],v193,34816
mf v[80:83],a[232:235],a[64:67],v[80:83]
v_add_u32 v195,0xffff0000,v195
trr a[228:229],v194,32768
trr a[230:231],v194,34816
s_add_u32 m0,s49,0
s_lshl_b32 s48,s95,12
s_add_u32 s48,s48,s52
s_add_u32 s48,s48,262144
buffer_load_dwordx4 v216,s[32:35],s48 offen lds
mf v[88:91],a[236:239],a[64:67],v[88:91]
s_waitcnt lgkmcnt(8)
v_add_u32 v196,0xffff0000,v196
trr a[232:233],v195,32768
trr a[234:235],v195,34816
mf v[96:99],a[240:243],a[64:67],v[96:99]
v_add_u32 v197,0xffff0000,v197
trr a[236:237],v196,32768
trr a[238:239],v196,34816
mf v[104:107],a[244:247],a[64:67],v[104:107]
s_waitcnt lgkmcnt(8)
v_add_u32 v198,0xffff0000,v198
trr a[240:241],v197,32768
trr a[242:243],v197,34816
buffer_load_dwordx4 v217,s[32:35],s48 offen offset:1024 lds
mf v[112:115],a[248:251],a[64:67],v[112:115]
v_add_u32 v199,0xffff0000,v199
trr a[244:245],v198,32768
trr a[246:247],v198,34816
mf v[120:123],a[252:255],a[64:67],v[120:123]
s_waitcnt lgkmcnt(8)
v_add_u32 v200,0xffff0000,v200
trr a[248:249],v199,32768
trr a[250:251],v199,34816
mf v[0:3],a[224:227],a[72:75],v[0:3]
trr a[252:253],v200,32768
trr a[254:255],v200,34816
buffer_load_dwordx4 v218,s[32:35],s48 offen offset:2048 lds
mf v[8:11],a[228:231],a[72:75],v[8:11]
s_waitcnt lgkmcnt(8)
trr a[224:225],v193,33024
trr a[226:227],v193,35072
mf v[16:19],a[232:235],a[72:75],v[16:19]
trr a[228:229],v194,33024
trr a[230:231],v194,35072
mf v[24:27],a[236:239],a[72:75],v[24:27]
s_waitcnt lgkmcnt(8)
trr a[232:233],v195,33024
trr a[234:235],v195,35072
buffer_load_dwordx4 v219,s[32:35],s48 offen offset:3072 lds
mf v[32:35],a[240:243],a[72:75],v[32:35]
trr a[236:237],v196,33024
trr a[238:239],v196,35072
mf v[40:43],a[244:247],a[72:75],v[40:43]
s_waitcnt lgkmcnt(8)
trr a[240:241],v197,33024
trr a[242:243],v197,35072
mf v[48:51],a[248:251],a[72:75],v[48:51]
trr a[244:245],v198,33024
trr a[246:247],v198,35072
mf v[56:59],a[252:255],a[72:75],v[56:59]
s_waitcnt lgkmcnt(8)
trr a[248:249],v199,33024
trr a[250:251],v199,35072
mf v[64:67],a[224:227],a[72:75],v[64:67]
v_add_u32 v193,0x10000,v193
trr a[252:253],v200,33024
trr a[254:255],v200,35072
mf v[72:75],a[228:231],a[72:75],v[72:75]
s_waitcnt lgkmcnt(8)
s_waitcnt vmcnt(8)
s_barrier
v_add_u32 v194,0x10000,v194
trr a[224:225],v193,16384
trr a[226:227],v193,18432
mf v[80:83],a[232:235],a[72:75],v[80:83]
v_add_u32 v205,0x10000,v205
v_add_u32 v206,0x10000,v206
v_add_u32 v195,0x10000,v195
trr a[228:229],v194,16384
trr a[230:231],v194,18432
s_add_u32 m0,s49,16384
s_add_u32 s48,s45,s96
buffer_load_dwordx4 v212,s[20:23],s48 offen lds
mf v[88:91],a[236:239],a[72:75],v[88:91]
s_waitcnt lgkmcnt(8)
ds_read_b128 a[80:83],v205
v_add_u32 v196,0x10000,v196
trr a[232:233],v195,16384
trr a[234:235],v195,18432
buffer_load_dwordx4 v213,s[20:23],s48 offen offset:1024 lds
mf v[96:99],a[240:243],a[72:75],v[96:99]
ds_read_b128 a[88:91],v206
v_add_u32 v197,0x10000,v197
trr a[236:237],v196,16384
trr a[238:239],v196,18432
buffer_load_dwordx4 v214,s[20:23],s48 offen offset:2048 lds
mf v[104:107],a[244:247],a[72:75],v[104:107]
s_waitcnt lgkmcnt(10)
v_add_u32 v198,0x10000,v198
trr a[240:241],v197,16384
trr a[242:243],v197,18432
buffer_load_dwordx4 v215,s[20:23],s48 offen offset:3072 lds
mf v[112:115],a[248:251],a[72:75],v[112:115]
v_add_u32 v199,0x10000,v199
trr a[244:245],v198,16384
trr a[246:247],v198,18432
s_add_u32 m0,s49,98304
s_lshl_b32 s48,s96,12
s_add_u32 s48,s48,s52
buffer_load_dwordx4 v216,s[32:35],s48 offen lds
mf v[120:123],a[252:255],a[72:75],v[120:123]
s_waitcnt lgkmcnt(10)
v_add_u32 v200,0x10000,v200
trr a[248:249],v199,16384
trr a[250:251],v199,18432
buffer_load_dwordx4 v217,s[32:35],s48 offen offset:1024 lds
s_waitcnt lgkmcnt(11)
mf v[0:3],a[224:227],a[80:83],v[0:3]
trr a[252:253],v200,16384
trr a[254:255],v200,18432
buffer_load_dwordx4 v218,s[32:35],s48 offen offset:2048 lds
mf v[8:11],a[228:231],a[80:83],v[8:11]
s_waitcnt lgkmcnt(8)
trr a[224:225],v193,16640
trr a[226:227],v193,18688
buffer_load_dwordx4 v219,s[32:35],s48 offen offset:3072 lds
mf v[16:19],a[232:235],a[80:83],v[16:19]
trr a[228:229],v194,16640
trr a[230:231],v194,18688
s_add_u32 s48,s50,49152
buffer_load_dwordx4 a[112:115],v208,s[24:27],s48 offen nt
mf v[24:27],a[236:239],a[80:83],v[24:27]
s_waitcnt lgkmcnt(8)
trr a[232:233],v195,16640
trr a[234:235],v195,18688
buffer_load_dwordx4 a[116:119],v209,s[24:27],s48 offen offset:1024 nt
mf v[32:35],a[240:243],a[80:83],v[32:35]
trr a[236:237],v196,16640
trr a[238:239],v196,18688
buffer_load_dwordx4 a[120:123],v210,s[24:27],s48 offen offset:2048 nt
mf v[40:43],a[244:247],a[80:83],v[40:43]
s_waitcnt lgkmcnt(8)
trr a[240:241],v197,16640
trr a[242:243],v197,18688
buffer_load_dwordx4 a[124:127],v211,s[24:27],s48 offen offset:3072 nt
mf v[48:51],a[248:251],a[80:83],v[48:51]
trr a[244:245],v198,16640
trr a[246:247],v198,18688
mf v[56:59],a[252:255],a[80:83],v[56:59]
s_waitcnt lgkmcnt(8)
trr a[248:249],v199,16640
trr a[250:251],v199,18688
mf v[64:67],a[224:227],a[80:83],v[64:67]
v_add_u32 v193,0xffff0000,v193
trr a[252:253],v200,16640
trr a[254:255],v200,18688
mf v[72:75],a[228:231],a[80:83],v[72:75]
s_waitcnt lgkmcnt(8)
s_waitcnt vmcnt(12)
s_barrier
v_add_u32 v194,0xffff0000,v194
trr a[224:225],v193,0
trr a[226:227],v193,2048
mf v[80:83],a[232:235],a[80:83],v[80:83]
v_add_u32 v195,0xffff0000,v195
trr a[228:229],v194,0
trr a[230:231],v194,2048
s_add_u32 m0,s49,32768
s_lshl_b32 s48,s96,12
s_add_u32 s48,s48,s52
s_add_u32 s48,s48,262144
buffer_load_dwordx4 v216,s[32:35],s48 offen lds
mf v[88:91],a[236:239],a[80:83],v[88:91]
s_waitcnt lgkmcnt(8)
v_add_u32 v196,0xffff0000,v196
trr a[232:233],v195,0
trr a[234:235],v195,2048
mf v[96:99],a[240:243],a[80:83],v[96:99]
v_add_u32 v197,0xffff0000,v197
trr a[236:237],v196,0
trr a[238:239],v196,2048
mf v[104:107],a[244:247],a[80:83],v[104:107]
s_waitcnt lgkmcnt(8)
v_add_u32 v198,0xffff0000,v198
trr a[240:241],v197,0
trr a[242:243],v197,2048
buffer_load_dwordx4 v217,s[32:35],s48 offen offset:1024 lds
mf v[112:115],a[248:251],a[80:83],v[112:115]
v_add_u32 v199,0xffff0000,v199
trr a[244:245],v198,0
trr a[246:247],v198,2048
mf v[120:123],a[252:255],a[80:83],v[120:123]
s_waitcnt lgkmcnt(8)
v_add_u32 v200,0xffff0000,v200
trr a[248:249],v199,0
trr a[250:251],v199,2048
mf v[0:3],a[224:227],a[88:91],v[0:3]
trr a[252:253],v200,0
trr a[254:255],v200,2048
buffer_load_dwordx4 v218,s[32:35],s48 offen offset:2048 lds
mf v[8:11],a[228:231],a[88:91],v[8:11]
s_waitcnt lgkmcnt(8)
trr a[224:225],v193,256
trr a[226:227],v193,2304
mf v[16:19],a[232:235],a[88:91],v[16:19]
trr a[228:229],v194,256
trr a[230:231],v194,2304
mf v[24:27],a[236:239],a[88:91],v[24:27]
s_waitcnt lgkmcnt(8)
trr a[232:233],v195,256
trr a[234:235],v195,2304
buffer_load_dwordx4 v219,s[32:35],s48 offen offset:3072 lds
mf v[32:35],a[240:243],a[88:91],v[32:35]
trr a[236:237],v196,256
trr a[238:239],v196,2304
mf v[40:43],a[244:247],a[88:91],v[40:43]
s_waitcnt lgkmcnt(8)
trr a[240:241],v197,256
trr a[242:243],v197,2304
mf v[48:51],a[248:251],a[88:91],v[48:51]
trr a[244:245],v198,256
trr a[246:247],v198,2304
mf v[56:59],a[252:255],a[88:91],v[56:59]
s_waitcnt lgkmcnt(8)
trr a[248:249],v199,256
trr a[250:251],v199,2304
mf v[64:67],a[224:227],a[88:91],v[64:67]
v_add_u32 v193,0x10000,v193
trr a[252:253],v200,256
trr a[254:255],v200,2304
mf v[72:75],a[228:231],a[88:91],v[72:75]
s_waitcnt lgkmcnt(8)
s_waitcnt vmcnt(8)
s_barrier
v_add_u32 v194,0x10000,v194
trr a[224:225],v193,32768
trr a[226:227],v193,34816
mf v[80:83],a[232:235],a[88:91],v[80:83]
v_add_u32 v205,0xffff0000,v205
v_add_u32 v206,0xffff0000,v206
v_add_u32 v195,0x10000,v195
trr a[228:229],v194,32768
trr a[230:231],v194,34816
s_add_u32 m0,s49,65536
s_add_u32 s48,s45,s97
buffer_load_dwordx4 v212,s[20:23],s48 offen lds
mf v[88:91],a[236:239],a[88:91],v[88:91]
s_waitcnt lgkmcnt(8)
ds_read_b128 a[64:67],v205 offset:16384
v_add_u32 v196,0x10000,v196
trr a[232:233],v195,32768
trr a[234:235],v195,34816
buffer_load_dwordx4 v213,s[20:23],s48 offen offset:1024 lds
mf v[96:99],a[240:243],a[88:91],v[96:99]
ds_read_b128 a[72:75],v206 offset:16384
v_add_u32 v197,0x10000,v197
trr a[236:237],v196,32768
trr a[238:239],v196,34816
buffer_load_dwordx4 v214,s[20:23],s48 offen offset:2048 lds
mf v[104:107],a[244:247],a[88:91],v[104:107]
s_waitcnt lgkmcnt(10)
v_add_u32 v198,0x10000,v198
trr a[240:241],v197,32768
trr a[242:243],v197,34816
buffer_load_dwordx4 v215,s[20:23],s48 offen offset:3072 lds
mf v[112:115],a[248:251],a[88:91],v[112:115]
v_add_u32 v199,0x10000,v199
trr a[244:245],v198,32768
trr a[246:247],v198,34816
s_add_u32 m0,s49,81920
s_lshl_b32 s48,s97,12
s_add_u32 s48,s48,s52
buffer_load_dwordx4 v216,s[32:35],s48 offen lds
mf v[120:123],a[252:255],a[88:91],v[120:123]
s_waitcnt lgkmcnt(10)
v_add_u32 v200,0x10000,v200
trr a[248:249],v199,32768
trr a[250:251],v199,34816
buffer_load_dwordx4 v217,s[32:35],s48 offen offset:1024 lds
s_waitcnt lgkmcnt(11)
mf v[0:3],a[224:227],a[64:67],v[0:3]
trr a[252:253],v200,32768
trr a[254:255],v200,34816
buffer_load_dwordx4 v218,s[32:35],s48 offen offset:2048 lds
mf v[8:11],a[228:231],a[64:67],v[8:11]
s_waitcnt lgkmcnt(8)
trr a[224:225],v193,33024
trr a[226:227],v193,35072
buffer_load_dwordx4 v219,s[32:35],s48 offen offset:3072 lds
mf v[16:19],a[232:235],a[64:67],v[16:19]
trr a[228:229],v194,33024
trr a[230:231],v194,35072
s_add_u32 m0,s49,131072
s_add_u32 s48,s50,65536
buffer_load_dwordx4 v208,s[24:27],s48 offen nt lds
mf v[24:27],a[236:239],a[64:67],v[24:27]
s_waitcnt lgkmcnt(8)
trr a[232:233],v195,33024
trr a[234:235],v195,35072
buffer_load_dwordx4 v209,s[24:27],s48 offen offset:1024 nt lds
mf v[32:35],a[240:243],a[64:67],v[32:35]
trr a[236:237],v196,33024
trr a[238:239],v196,35072
buffer_load_dwordx4 v210,s[24:27],s48 offen offset:2048 nt lds
mf v[40:43],a[244:247],a[64:67],v[40:43]
s_waitcnt lgkmcnt(8)
trr a[240:241],v197,33024
trr a[242:243],v197,35072
buffer_load_dwordx4 v211,s[24:27],s48 offen offset:3072 nt lds
mf v[48:51],a[248:251],a[64:67],v[48:51]
trr a[244:245],v198,33024
trr a[246:247],v198,35072
mf v[56:59],a[252:255],a[64:67],v[56:59]
s_waitcnt lgkmcnt(8)
trr a[248:249],v199,33024
trr a[250:251],v199,35072
mf v[64:67],a[224:227],a[64:67],v[64:67]
v_add_u32 v193,0xffff0000,v193
trr a[252:253],v200,33024
trr a[254:255],v200,35072
mf v[72:75],a[228:231],a[64:67],v[72:75]
s_waitcnt lgkmcnt(8)
s_waitcnt vmcnt(12)
s_barrier
v_add_u32 v194,0xffff0000,v194
trr a[224:225],v193,32768
trr a[226:227],v193,34816
mf v[80:83],a[232:235],a[64:67],v[80:83]
v_add_u32 v195,0xffff0000,v195
trr a[228:229],v194,32768
trr a[230:231],v194,34816
ds_write_b128 v207,a[112:115]
s_add_u32 m0,s49,16384
s_lshl_b32 s48,s97,12
s_add_u32 s48,s48,s52
s_add_u32 s48,s48,262144
buffer_load_dwordx4 v216,s[32:35],s48 offen lds
mf v[88:91],a[236:239],a[64:67],v[88:91]
s_waitcnt lgkmcnt(9)
v_add_u32 v196,0xffff0000,v196
trr a[232:233],v195,32768
trr a[234:235],v195,34816
mf v[96:99],a[240:243],a[64:67],v[96:99]
v_add_u32 v197,0xffff0000,v197
trr a[236:237],v196,32768
trr a[238:239],v196,34816
ds_write_b128 v207,a[116:119] offset:1024
buffer_load_dwordx4 v217,s[32:35],s48 offen offset:1024 lds
mf v[104:107],a[244:247],a[64:67],v[104:107]
s_waitcnt lgkmcnt(10)
v_add_u32 v198,0xffff0000,v198
trr a[240:241],v197,32768
trr a[242:243],v197,34816
mf v[112:115],a[248:251],a[64:67],v[112:115]
v_add_u32 v199,0xffff0000,v199
trr a[244:245],v198,32768
trr a[246:247],v198,34816
ds_write_b128 v207,a[120:123] offset:2048
buffer_load_dwordx4 v218,s[32:35],s48 offen offset:2048 lds
mf v[120:123],a[252:255],a[64:67],v[120:123]
s_waitcnt lgkmcnt(11)
v_add_u32 v200,0xffff0000,v200
trr a[248:249],v199,32768
trr a[250:251],v199,34816
mf v[0:3],a[224:227],a[72:75],v[0:3]
trr a[252:253],v200,32768
trr a[254:255],v200,34816
s_waitcnt lgkmcnt(14)
ds_write_b128 v207,a[124:127] offset:3072
buffer_load_dwordx4 v219,s[32:35],s48 offen offset:3072 lds
mf v[8:11],a[228:231],a[72:75],v[8:11]
s_waitcnt lgkmcnt(11)
trr a[224:225],v193,33024
trr a[226:227],v193,35072
mf v[16:19],a[232:235],a[72:75],v[16:19]
trr a[228:229],v194,33024
trr a[230:231],v194,35072
s_add_u32 s48,s50,81920
buffer_load_dwordx4 a[128:131],v208,s[24:27],s48 offen nt
mf v[24:27],a[236:239],a[72:75],v[24:27]
s_waitcnt lgkmcnt(10)
trr a[232:233],v195,33024
trr a[234:235],v195,35072
mf v[32:35],a[240:243],a[72:75],v[32:35]
trr a[236:237],v196,33024
trr a[238:239],v196,35072
buffer_load_dwordx4 a[132:135],v209,s[24:27],s48 offen offset:1024 nt
mf v[40:43],a[244:247],a[72:75],v[40:43]
s_waitcnt lgkmcnt(9)
trr a[240:241],v197,33024
trr a[242:243],v197,35072
mf v[48:51],a[248:251],a[72:75],v[48:51]
trr a[244:245],v198,33024
trr a[246:247],v198,35072
buffer_load_dwordx4 a[136:139],v210,s[24:27],s48 offen offset:2048 nt
mf v[56:59],a[252:255],a[72:75],v[56:59]
s_waitcnt lgkmcnt(8)
trr a[248:249],v199,33024
trr a[250:251],v199,35072
mf v[64:67],a[224:227],a[72:75],v[64:67]
v_add_u32 v193,0x10000,v193
trr a[252:253],v200,33024
trr a[254:255],v200,35072
buffer_load_dwordx4 a[140:143],v211,s[24:27],s48 offen offset:3072 nt
mf v[72:75],a[228:231],a[72:75],v[72:75]
s_waitcnt lgkmcnt(8)
s_waitcnt vmcnt(12)
s_barrier
v_add_u32 v194,0x10000,v194
trr a[224:225],v193,16384
trr a[226:227],v193,18432
mf v[80:83],a[232:235],a[72:75],v[80:83]
v_add_u32 v205,0x10000,v205
v_add_u32 v206,0x10000,v206
v_add_u32 v195,0x10000,v195
trr a[228:229],v194,16384
trr a[230:231],v194,18432
s_add_u32 m0,s49,98304
s_add_u32 s48,s45,s98
buffer_load_dwordx4 v212,s[20:23],s48 offen lds
mf v[88:91],a[236:239],a[72:75],v[88:91]
s_waitcnt lgkmcnt(8)
ds_read_b128 a[80:83],v205
v_add_u32 v196,0x10000,v196
trr a[232:233],v195,16384
trr a[234:235],v195,18432
buffer_load_dwordx4 v213,s[20:23],s48 offen offset:1024 lds
mf v[96:99],a[240:243],a[72:75],v[96:99]
ds_read_b128 a[88:91],v206
v_add_u32 v197,0x10000,v197
trr a[236:237],v196,16384
trr a[238:239],v196,18432
buffer_load_dwordx4 v214,s[20:23],s48 offen offset:2048 lds
mf v[104:107],a[244:247],a[72:75],v[104:107]
s_waitcnt lgkmcnt(10)
v_add_u32 v198,0x10000,v198
trr a[240:241],v197,16384
trr a[242:243],v197,18432
buffer_load_dwordx4 v215,s[20:23],s48 offen offset:3072 lds
mf v[112:115],a[248:251],a[72:75],v[112:115]
v_add_u32 v199,0x10000,v199
trr a[244:245],v198,16384
trr a[246:247],v198,18432
s_add_u32 m0,s49,147456
s_lshl_b32 s48,s98,12
s_add_u32 s48,s48,s52
buffer_load_dwordx4 v216,s[32:35],s48 offen lds
mf v[120:123],a[252:255],a[72:75],v[120:123]
s_waitcnt lgkmcnt(10)
v_add_u32 v200,0x10000,v200
trr a[248:249],v199,16384
trr a[250:251],v199,18432
buffer_load_dwordx4 v217,s[32:35],s48 offen offset:1024 lds
s_waitcnt lgkmcnt(11)
mf v[0:3],a[224:227],a[80:83],v[0:3]
trr a[252:253],v200,16384
trr a[254:255],v200,18432
buffer_load_dwordx4 v218,s[32:35],s48 offen offset:2048 lds
mf v[8:11],a[228:231],a[80:83],v[8:11]
s_waitcnt lgkmcnt(8)
trr a[224:225],v193,16640
trr a[226:227],v193,18688
buffer_load_dwordx4 v219,s[32:35],s48 offen offset:3072 lds
mf v[16:19],a[232:235],a[80:83],v[16:19]
trr a[228:229],v194,16640
trr a[230:231],v194,18688
s_add_u32 s48,s50,98304
buffer_load_dwordx4 a[144:147],v208,s[24:27],s48 offen nt
mf v[24:27],a[236:239],a[80:83],v[24:27]
s_waitcnt lgkmcnt(8)
trr a[232:233],v195,16640
trr a[234:235],v195,18688
buffer_load_dwordx4 a[148:151],v209,s[24:27],s48 offen offset:1024 nt
mf v[32:35],a[240:243],a[80:83],v[32:35]
trr a[236:237],v196,16640
trr a[238:239],v196,18688
buffer_load_dwordx4 a[152:155],v210,s[24:27],s48 offen offset:2048 nt
mf v[40:43],a[244:247],a[80:83],v[40:43]
s_waitcnt lgkmcnt(8)
trr a[240:241],v197,16640
trr a[242:243],v197,18688
buffer_load_dwordx4 a[156:159],v211,s[24:27],s48 offen offset:3072 nt
mf v[48:51],a[248:251],a[80:83],v[48:51]
trr a[244:245],v198,16640
trr a[246:247],v198,18688
mf v[56:59],a[252:255],a[80:83],v[56:59]
s_waitcnt lgkmcnt(8)
trr a[248:249],v199,16640
trr a[250:251],v199,18688
mf v[64:67],a[224:227],a[80:83],v[64:67]
v_add_u32 v193,0xffff0000,v193
trr a[252:253],v200,16640
trr a[254:255],v200,18688
mf v[72:75],a[228:231],a[80:83],v[72:75]
s_waitcnt lgkmcnt(8)
s_waitcnt vmcnt(16)
s_barrier
v_add_u32 v194,0xffff0000,v194
trr a[224:225],v193,16384
trr a[226:227],v193,18432
mf v[80:83],a[232:235],a[80:83],v[80:83]
v_add_u32 v195,0xffff0000,v195
trr a[228:229],v194,16384
trr a[230:231],v194,18432
s_add_u32 m0,s49,32768
s_lshl_b32 s48,s98,12
s_add_u32 s48,s48,s52
s_add_u32 s48,s48,262144
buffer_load_dwordx4 v216,s[32:35],s48 offen lds
mf v[88:91],a[236:239],a[80:83],v[88:91]
s_waitcnt lgkmcnt(8)
v_add_u32 v196,0xffff0000,v196
trr a[232:233],v195,16384
trr a[234:235],v195,18432
mf v[96:99],a[240:243],a[80:83],v[96:99]
v_add_u32 v197,0xffff0000,v197
trr a[236:237],v196,16384
trr a[238:239],v196,18432
buffer_load_dwordx4 v217,s[32:35],s48 offen offset:1024 lds
mf v[104:107],a[244:247],a[80:83],v[104:107]
s_waitcnt lgkmcnt(8)
v_add_u32 v198,0xffff0000,v198
trr a[240:241],v197,16384
trr a[242:243],v197,18432
mf v[112:115],a[248:251],a[80:83],v[112:115]
v_add_u32 v199,0xffff0000,v199
trr a[244:245],v198,16384
trr a[246:247],v198,18432
buffer_load_dwordx4 v218,s[32:35],s48 offen offset:2048 lds
mf v[120:123],a[252:255],a[80:83],v[120:123]
s_waitcnt lgkmcnt(8)
v_add_u32 v200,0xffff0000,v200
trr a[248:249],v199,16384
trr a[250:251],v199,18432
mf v[0:3],a[224:227],a[88:91],v[0:3]
trr a[252:253],v200,16384
trr a[254:255],v200,18432
buffer_load_dwordx4 v219,s[32:35],s48 offen offset:3072 lds
mf v[8:11],a[228:231],a[88:91],v[8:11]
s_waitcnt lgkmcnt(8)
trr a[224:225],v193,16640
trr a[226:227],v193,18688
mf v[16:19],a[232:235],a[88:91],v[16:19]
trr a[228:229],v194,16640
trr a[230:231],v194,18688
s_add_u32 s48,s50,114688
buffer_load_dwordx4 a[160:163],v208,s[24:27],s48 offen nt
mf v[24:27],a[236:239],a[88:91],v[24:27]
s_waitcnt lgkmcnt(8)
trr a[232:233],v195,16640
trr a[234:235],v195,18688
mf v[32:35],a[240:243],a[88:91],v[32:35]
trr a[236:237],v196,16640
trr a[238:239],v196,18688
buffer_load_dwordx4 a[164:167],v209,s[24:27],s48 offen offset:1024 nt
mf v[40:43],a[244:247],a[88:91],v[40:43]
s_waitcnt lgkmcnt(8)
trr a[240:241],v197,16640
trr a[242:243],v197,18688
mf v[48:51],a[248:251],a[88:91],v[48:51]
trr a[244:245],v198,16640
trr a[246:247],v198,18688
buffer_load_dwordx4 a[168:171],v210,s[24:27],s48 offen offset:2048 nt
mf v[56:59],a[252:255],a[88:91],v[56:59]
s_waitcnt lgkmcnt(8)
trr a[248:249],v199,16640
trr a[250:251],v199,18688
mf v[64:67],a[224:227],a[88:91],v[64:67]
v_add_u32 v193,0x20000,v193
trr a[252:253],v200,16640
trr a[254:255],v200,18688
buffer_load_dwordx4 a[172:175],v211,s[24:27],s48 offen offset:3072 nt
mf v[72:75],a[228:231],a[88:91],v[72:75]
s_waitcnt lgkmcnt(8)
s_waitcnt vmcnt(12)
s_barrier
v_add_u32 v194,0x20000,v194
trr a[224:225],v193,16384
trr a[226:227],v193,18432
mf v[80:83],a[232:235],a[88:91],v[80:83]
v_add_u32 v195,0x20000,v195
trr a[228:229],v194,16384
trr a[230:231],v194,18432
v_add_u32 v191,0x10000,v207
ds_write_b128 v191,a[96:99]
mf v[88:91],a[236:239],a[88:91],v[88:91]
s_waitcnt lgkmcnt(9)
ds_read_b128 a[64:67],v205 offset:32768
v_add_u32 v196,0x20000,v196
trr a[232:233],v195,16384
trr a[234:235],v195,18432
mf v[96:99],a[240:243],a[88:91],v[96:99]
ds_read_b128 a[72:75],v206 offset:32768
v_add_u32 v197,0x20000,v197
trr a[236:237],v196,16384
trr a[238:239],v196,18432
s_waitcnt lgkmcnt(14)
ds_write_b128 v191,a[100:103] offset:1024
mf v[104:107],a[244:247],a[88:91],v[104:107]
s_waitcnt lgkmcnt(12)
v_add_u32 v198,0x20000,v198
trr a[240:241],v197,16384
trr a[242:243],v197,18432
mf v[112:115],a[248:251],a[88:91],v[112:115]
v_add_u32 v199,0x20000,v199
trr a[244:245],v198,16384
s_waitcnt lgkmcnt(14)
trr a[246:247],v198,18432
s_waitcnt lgkmcnt(14)
ds_write_b128 v191,a[104:107] offset:2048
mf v[120:123],a[252:255],a[88:91],v[120:123]
s_waitcnt lgkmcnt(13)
v_add_u32 v200,0x20000,v200
trr a[248:249],v199,16384
trr a[250:251],v199,18432
v_lshrrev_b32 v186,3,v192
s_waitcnt lgkmcnt(13)
mf v[0:3],a[224:227],a[64:67],v[0:3]
trr a[252:253],v200,16384
trr a[254:255],v200,18432
s_waitcnt lgkmcnt(14)
ds_write_b128 v191,a[108:111] offset:3072
v_lshlrev_b32 v186,9,v186
mf v[8:11],a[228:231],a[64:67],v[8:11]
s_waitcnt lgkmcnt(11)
trr a[224:225],v193,16640
trr a[226:227],v193,18688
v_lshrrev_b32 v187,4,v192
mf v[16:19],a[232:235],a[64:67],v[16:19]
trr a[228:229],v194,16640
trr a[230:231],v194,18688
v_lshlrev_b32 v187,1,v187
mf v[24:27],a[236:239],a[64:67],v[24:27]
s_waitcnt lgkmcnt(10)
trr a[232:233],v195,16640
trr a[234:235],v195,18688
v_and_b32 v188,7,v192
mf v[32:35],a[240:243],a[64:67],v[32:35]
trr a[236:237],v196,16640
trr a[238:239],v196,18688
v_xor_b32 v187,v187,v188
mf v[40:43],a[244:247],a[64:67],v[40:43]
s_waitcnt lgkmcnt(9)
trr a[240:241],v197,16640
trr a[242:243],v197,18688
v_lshl_add_u32 v212,v187,4,v186
mf v[48:51],a[248:251],a[64:67],v[48:51]
trr a[244:245],v198,16640
trr a[246:247],v198,18688
v_add_u32 v213,3072,v212
mf v[56:59],a[252:255],a[64:67],v[56:59]
s_waitcnt lgkmcnt(8)
trr a[248:249],v199,16640
trr a[250:251],v199,18688
v_add_u32 v214,6144,v212
mf v[64:67],a[224:227],a[64:67],v[64:67]
v_add_u32 v193,0xfffe0000,v193
trr a[252:253],v200,16640
trr a[254:255],v200,18688
v_add_u32 v215,9216,v212
mf v[72:75],a[228:231],a[64:67],v[72:75]
s_waitcnt lgkmcnt(8)
s_waitcnt vmcnt(4)
s_barrier
v_add_u32 v194,0xfffe0000,v194
trr a[224:225],v193,32768
trr a[226:227],v193,34816
s_lshl_b32 s51,s44,14
mf v[80:83],a[232:235],a[64:67],v[80:83]
v_add_u32 v195,0xfffe0000,v195
trr a[228:229],v194,32768
trr a[230:231],v194,34816
s_add_u32 m0,s49,16384
s_add_u32 s48,s50,131072
buffer_load_dwordx4 v208,s[24:27],s48 offen nt lds
v_lshrrev_b32 v186,3,v192
v_mul_u32_u24 v186,896,v186
mf v[88:91],a[236:239],a[64:67],v[88:91]
s_waitcnt lgkmcnt(8)
v_add_u32 v196,0xfffe0000,v196
trr a[232:233],v195,32768
trr a[234:235],v195,34816
v_lshrrev_b32 v187,4,v192
v_lshlrev_b32 v187,1,v187
mf v[96:99],a[240:243],a[64:67],v[96:99]
v_add_u32 v197,0xfffe0000,v197
trr a[236:237],v196,32768
trr a[238:239],v196,34816
v_and_b32 v188,7,v192
v_xor_b32 v187,v187,v188
mf v[104:107],a[244:247],a[64:67],v[104:107]
s_waitcnt lgkmcnt(8)
v_add_u32 v198,0xfffe0000,v198
trr a[240:241],v197,32768
trr a[242:243],v197,34816
buffer_load_dwordx4 v209,s[24:27],s48 offen offset:1024 nt lds
v_lshl_add_u32 v216,v187,4,v186
v_add_u32 v217,6144,v216
mf v[112:115],a[248:251],a[64:67],v[112:115]
v_add_u32 v199,0xfffe0000,v199
trr a[244:245],v198,32768
trr a[246:247],v198,34816
s_mul_i32 s53,s44,14336
s_lshl_b32 s61,s44,11
mf v[120:123],a[252:255],a[64:67],v[120:123]
s_waitcnt lgkmcnt(8)
v_add_u32 v200,0xfffe0000,v200
trr a[248:249],v199,32768
trr a[250:251],v199,34816
mf v[0:3],a[224:227],a[72:75],v[0:3]
trr a[252:253],v200,32768
trr a[254:255],v200,34816
buffer_load_dwordx4 v210,s[24:27],s48 offen offset:2048 nt lds
mf v[8:11],a[228:231],a[72:75],v[8:11]
s_waitcnt lgkmcnt(8)
trr a[224:225],v193,33024
trr a[226:227],v193,35072
mf v[16:19],a[232:235],a[72:75],v[16:19]
trr a[228:229],v194,33024
trr a[230:231],v194,35072
mf v[24:27],a[236:239],a[72:75],v[24:27]
s_waitcnt lgkmcnt(8)
trr a[232:233],v195,33024
trr a[234:235],v195,35072
buffer_load_dwordx4 v211,s[24:27],s48 offen offset:3072 nt lds
v_mul_f32 v0,s46,v0
v_mul_f32 v1,s46,v1
v_mul_f32 v2,s46,v2
v_mul_f32 v3,s46,v3
v_mul_f32 v8,s46,v8
v_mul_f32 v9,s46,v9
v_mul_f32 v10,s46,v10
v_mul_f32 v11,s46,v11
cvp v180,v0,v1
cvp v181,v2,v3
cvp v182,v8,v9
cvp v183,v10,v11
s_nop 0
v_permlane32_swap_b32 v180,v182
v_permlane32_swap_b32 v181,v183
s_nop 0
v_permlane16_swap_b32 v180,v182
v_permlane16_swap_b32 v181,v183
awr a0,v180
awr a1,v181
awr a2,v182
awr a3,v183
mf v[32:35],a[240:243],a[72:75],v[32:35]
trr a[236:237],v196,33024
trr a[238:239],v196,35072
mf v[40:43],a[244:247],a[72:75],v[40:43]
s_waitcnt lgkmcnt(8)
trr a[240:241],v197,33024
trr a[242:243],v197,35072
v_mul_f32 v16,s46,v16
v_mul_f32 v17,s46,v17
v_mul_f32 v18,s46,v18
v_mul_f32 v19,s46,v19
v_mul_f32 v24,s46,v24
v_mul_f32 v25,s46,v25
v_mul_f32 v26,s46,v26
v_mul_f32 v27,s46,v27
cvp v180,v16,v17
cvp v181,v18,v19
cvp v182,v24,v25
cvp v183,v26,v27
s_nop 0
v_permlane32_swap_b32 v180,v182
v_permlane32_swap_b32 v181,v183
s_nop 0
v_permlane16_swap_b32 v180,v182
v_permlane16_swap_b32 v181,v183
awr a8,v180
awr a9,v181
awr a10,v182
awr a11,v183
mf v[48:51],a[248:251],a[72:75],v[48:51]
trr a[244:245],v198,33024
trr a[246:247],v198,35072
mf v[56:59],a[252:255],a[72:75],v[56:59]
s_waitcnt lgkmcnt(8)
trr a[248:249],v199,33024
trr a[250:251],v199,35072
v_mul_f32 v32,s46,v32
v_mul_f32 v33,s46,v33
v_mul_f32 v34,s46,v34
v_mul_f32 v35,s46,v35
v_mul_f32 v40,s46,v40
v_mul_f32 v41,s46,v41
v_mul_f32 v42,s46,v42
v_mul_f32 v43,s46,v43
cvp v180,v32,v33
cvp v181,v34,v35
cvp v182,v40,v41
cvp v183,v42,v43
s_nop 0
v_permlane32_swap_b32 v180,v182
v_permlane32_swap_b32 v181,v183
s_nop 0
v_permlane16_swap_b32 v180,v182
v_permlane16_swap_b32 v181,v183
awr a16,v180
awr a17,v181
awr a18,v182
awr a19,v183
mf v[64:67],a[224:227],a[72:75],v[64:67]
trr a[252:253],v200,33024
trr a[254:255],v200,35072
mf v[72:75],a[228:231],a[72:75],v[72:75]
s_waitcnt lgkmcnt(8)
s_barrier
v_and_b32 v176,15,v192
v_lshrrev_b32 v177,4,v192
v_xor_b32 v177,v177,v176
v_lshlrev_b32 v177,4,v177
v_lshl_add_u32 v177,v176,9,v177
v_xor_b32 v193,0,v177
v_xor_b32 v194,64,v177
v_xor_b32 v195,128,v177
v_xor_b32 v196,192,v177
ds_read_b128 a[224:227],v193 offset:49152
v_mul_f32 v48,s46,v48
v_mul_f32 v49,s46,v49
v_mul_f32 v50,s46,v50
v_mul_f32 v51,s46,v51
v_mul_f32 v56,s46,v56
v_mul_f32 v57,s46,v57
v_mul_f32 v58,s46,v58
v_mul_f32 v59,s46,v59
cvp v180,v48,v49
cvp v181,v50,v51
cvp v182,v56,v57
cvp v183,v58,v59
s_nop 0
v_permlane32_swap_b32 v180,v182
v_permlane32_swap_b32 v181,v183
s_nop 0
v_permlane16_swap_b32 v180,v182
v_permlane16_swap_b32 v181,v183
awr a24,v180
awr a25,v181
awr a26,v182
awr a27,v183
mf v[80:83],a[232:235],a[72:75],v[80:83]
ds_read_b128 a[228:231],v193 offset:57344
s_waitcnt vmcnt(4)
v_add_u32 v191,0x10000,v207
ds_write_b128 v191,a[160:163] offset:16384
s_add_u32 m0,s49,98304
s_add_u32 s48,s50,147456
buffer_load_dwordx4 v208,s[24:27],s48 offen nt lds
mf v[88:91],a[236:239],a[72:75],v[88:91]
s_waitcnt lgkmcnt(7)
ds_read_b128 a[232:235],v194 offset:49152
v_mul_f32 v64,s46,v64
v_mul_f32 v65,s46,v65
v_mul_f32 v66,s46,v66
v_mul_f32 v67,s46,v67
v_mul_f32 v72,s46,v72
v_mul_f32 v73,s46,v73
v_mul_f32 v74,s46,v74
v_mul_f32 v75,s46,v75
cvp v180,v64,v65
cvp v181,v66,v67
cvp v182,v72,v73
cvp v183,v74,v75
s_nop 0
v_permlane32_swap_b32 v180,v182
v_permlane32_swap_b32 v181,v183
s_nop 0
v_permlane16_swap_b32 v180,v182
v_permlane16_swap_b32 v181,v183
awr a32,v180
awr a33,v181
awr a34,v182
awr a35,v183
mf v[96:99],a[240:243],a[72:75],v[96:99]
ds_read_b128 a[236:239],v194 offset:57344
ds_write_b128 v191,a[164:167] offset:17408
mf v[104:107],a[244:247],a[72:75],v[104:107]
s_waitcnt lgkmcnt(6)
ds_read_b128 a[240:243],v195 offset:49152
buffer_load_dwordx4 v209,s[24:27],s48 offen offset:1024 nt lds
v_mul_f32 v80,s46,v80
v_mul_f32 v81,s46,v81
v_mul_f32 v82,s46,v82
v_mul_f32 v83,s46,v83
v_mul_f32 v88,s46,v88
v_mul_f32 v89,s46,v89
v_mul_f32 v90,s46,v90
v_mul_f32 v91,s46,v91
cvp v180,v80,v81
cvp v181,v82,v83
cvp v182,v88,v89
cvp v183,v90,v91
s_nop 0
v_permlane32_swap_b32 v180,v182
v_permlane32_swap_b32 v181,v183
s_nop 0
v_permlane16_swap_b32 v180,v182
v_permlane16_swap_b32 v181,v183
awr a40,v180
awr a41,v181
awr a42,v182
awr a43,v183
mf v[112:115],a[248:251],a[72:75],v[112:115]
ds_read_b128 a[244:247],v195 offset:57344
ds_write_b128 v191,a[168:171] offset:18432
mf v[120:123],a[252:255],a[72:75],v[120:123]
s_waitcnt lgkmcnt(7)
ds_read_b128 a[248:251],v196 offset:49152
v_mul_f32 v96,s46,v96
v_mul_f32 v97,s46,v97
v_mul_f32 v98,s46,v98
v_mul_f32 v99,s46,v99
v_mul_f32 v104,s46,v104
v_mul_f32 v105,s46,v105
v_mul_f32 v106,s46,v106
v_mul_f32 v107,s46,v107
cvp v180,v96,v97
cvp v181,v98,v99
cvp v182,v104,v105
cvp v183,v106,v107
s_nop 0
v_permlane32_swap_b32 v180,v182
v_permlane32_swap_b32 v181,v183
s_nop 0
v_permlane16_swap_b32 v180,v182
v_permlane16_swap_b32 v181,v183
awr a48,v180
awr a49,v181
awr a50,v182
awr a51,v183
mf v[128:131],a[224:227],a[0:3],0
ds_read_b128 a[252:255],v196 offset:57344
ds_write_b128 v191,a[172:175] offset:19456
buffer_load_dwordx4 v210,s[24:27],s48 offen offset:2048 nt lds
mf v[136:139],a[228:231],a[0:3],0
s_waitcnt lgkmcnt(7)
ds_read_b128 a[224:227],v193 offset:49408
v_mul_f32 v112,s46,v112
v_mul_f32 v113,s46,v113
v_mul_f32 v114,s46,v114
v_mul_f32 v115,s46,v115
v_mul_f32 v120,s46,v120
v_mul_f32 v121,s46,v121
v_mul_f32 v122,s46,v122
v_mul_f32 v123,s46,v123
cvp v180,v112,v113
cvp v181,v114,v115
cvp v182,v120,v121
cvp v183,v122,v123
s_nop 0
v_permlane32_swap_b32 v180,v182
v_permlane32_swap_b32 v181,v183
s_nop 0
v_permlane16_swap_b32 v180,v182
v_permlane16_swap_b32 v181,v183
awr a56,v180
awr a57,v181
awr a58,v182
awr a59,v183
mf v[128:131],a[232:235],a[8:11],v[128:131]
ds_read_b128 a[228:231],v193 offset:57600
mf v[136:139],a[236:239],a[8:11],v[136:139]
s_waitcnt lgkmcnt(6)
ds_read_b128 a[232:235],v194 offset:49408
buffer_load_dwordx4 v211,s[24:27],s48 offen offset:3072 nt lds
mf v[128:131],a[240:243],a[16:19],v[128:131]
ds_read_b128 a[236:239],v194 offset:57600
mf v[136:139],a[244:247],a[16:19],v[136:139]
s_waitcnt lgkmcnt(5)
ds_read_b128 a[240:243],v195 offset:49408
mf v[128:131],a[248:251],a[24:27],v[128:131]
ds_read_b128 a[244:247],v195 offset:57600
mf v[136:139],a[252:255],a[24:27],v[136:139]
s_waitcnt lgkmcnt(4)
ds_read_b128 a[248:251],v196 offset:49408
mf v[128:131],a[224:227],a[32:35],v[128:131]
v_add_u32 v193,0x10000,v193
ds_read_b128 a[252:255],v196 offset:57600
mf v[136:139],a[228:231],a[32:35],v[136:139]
s_waitcnt lgkmcnt(4)
s_barrier
ds_read_b128 a[224:227],v193
mf v[128:131],a[232:235],a[40:43],v[128:131]
v_add_u32 v194,0x10000,v194
ds_read_b128 a[228:231],v193 offset:8192
ds_write_b128 v207,a[128:131] offset:32768
s_add_u32 s48,s50,163840
buffer_load_dwordx4 a[176:179],v208,s[24:27],s48 offen nt
mf v[136:139],a[236:239],a[40:43],v[136:139]
s_waitcnt lgkmcnt(5)
ds_read_b128 a[232:235],v194
mf v[128:131],a[240:243],a[48:51],v[128:131]
v_add_u32 v195,0x10000,v195
ds_read_b128 a[236:239],v194 offset:8192
ds_write_b128 v207,a[132:135] offset:33792
mf v[136:139],a[244:247],a[48:51],v[136:139]
s_waitcnt lgkmcnt(6)
ds_read_b128 a[240:243],v195
buffer_load_dwordx4 a[180:183],v209,s[24:27],s48 offen offset:1024 nt
mf v[128:131],a[248:251],a[56:59],v[128:131]
v_add_u32 v196,0x10000,v196
ds_read_b128 a[244:247],v195 offset:8192
ds_write_b128 v207,a[136:139] offset:34816
mf v[136:139],a[252:255],a[56:59],v[136:139]
s_waitcnt lgkmcnt(7)
ds_read_b128 a[248:251],v196
mf v[144:147],a[224:227],a[0:3],0
ds_read_b128 a[252:255],v196 offset:8192
ds_write_b128 v207,a[140:143] offset:35840
buffer_load_dwordx4 a[184:187],v210,s[24:27],s48 offen offset:2048 nt
mf v[152:155],a[228:231],a[0:3],0
s_waitcnt lgkmcnt(7)
ds_read_b128 a[224:227],v193 offset:256
mf v[144:147],a[232:235],a[8:11],v[144:147]
ds_read_b128 a[228:231],v193 offset:8448
v_add_u32 v191,0x20000,v207
ds_write_b128 v191,a[144:147] offset:16384
v_max3_f32 v222,v128,v129,v130
v_max3_f32 v222,v222,v131,v136
v_max3_f32 v222,v222,v137,v138
mf v[152:155],a[236:239],a[8:11],v[152:155]
s_waitcnt lgkmcnt(7)
ds_read_b128 a[232:235],v194 offset:256
buffer_load_dwordx4 a[188:191],v211,s[24:27],s48 offen offset:3072 nt
v_max_f32 v222,v222,v139
v_mov_b32 v176,v222
s_nop 1
v_permlane32_swap_b32 v176,v222
mf v[144:147],a[240:243],a[16:19],v[144:147]
ds_read_b128 a[236:239],v194 offset:8448
ds_write_b128 v191,a[148:151] offset:17408
v_max_f32 v222,v222,v176
v_mov_b32 v176,v222
s_nop 1
v_permlane16_swap_b32 v176,v222
mf v[152:155],a[244:247],a[16:19],v[152:155]
s_waitcnt lgkmcnt(7)
ds_read_b128 a[240:243],v195 offset:256
v_max_f32 v222,v222,v176
v_ceil_f32 v222,v222
mf v[144:147],a[248:251],a[24:27],v[144:147]
ds_read_b128 a[244:247],v195 offset:8448
ds_write_b128 v191,a[152:155] offset:18432
v_sub_f32 v226,0,v222
v_sub_f32 v227,0,v222
v_sub_f32 v228,0,v222
mf v[152:155],a[252:255],a[24:27],v[152:155]
s_waitcnt lgkmcnt(7)
ds_read_b128 a[248:251],v196 offset:256
v_sub_f32 v229,0,v222
v_sub_f32 v128,v128,v222
v_sub_f32 v129,v129,v222
mf v[144:147],a[224:227],a[32:35],v[144:147]
ds_read_b128 a[252:255],v196 offset:8448
ds_write_b128 v191,a[156:159] offset:19456
v_sub_f32 v130,v130,v222
v_exp_f32 v128,v128
mf v[152:155],a[228:231],a[32:35],v[152:155]
s_waitcnt lgkmcnt(7)
s_barrier
ds_read_b128 a[224:227],v193 offset:49152
v_sub_f32 v131,v131,v222
v_exp_f32 v129,v129
v_sub_f32 v136,v136,v222
mf v[144:147],a[232:235],a[40:43],v[144:147]
ds_read_b128 a[228:231],v193 offset:57344
s_add_u32 m0,s49,49152
s_add_u32 s48,s50,180224
buffer_load_dwordx4 v208,s[24:27],s48 offen nt lds
v_exp_f32 v130,v130
v_sub_f32 v137,v137,v222
v_exp_f32 v131,v131
mf v[152:155],a[236:239],a[40:43],v[152:155]
s_waitcnt lgkmcnt(6)
ds_read_b128 a[232:235],v194 offset:49152
cvp v0,v128,v129
v_sub_f32 v138,v138,v222
mf v[144:147],a[240:243],a[48:51],v[144:147]
ds_read_b128 a[236:239],v194 offset:57344
buffer_load_dwordx4 v209,s[24:27],s48 offen offset:1024 nt lds
v_exp_f32 v136,v136
v_sub_f32 v139,v139,v222
v_exp_f32 v137,v137
mf v[152:155],a[244:247],a[48:51],v[152:155]
s_waitcnt lgkmcnt(5)
ds_read_b128 a[240:243],v195 offset:49152
cvp v1,v130,v131
v_exp_f32 v138,v138
v_exp_f32 v139,v139
mf v[144:147],a[248:251],a[56:59],v[144:147]
ds_read_b128 a[244:247],v195 offset:57344
buffer_load_dwordx4 v210,s[24:27],s48 offen offset:2048 nt lds
cvp v2,v136,v137
cvp v3,v138,v139
mf v[152:155],a[252:255],a[56:59],v[152:155]
s_waitcnt lgkmcnt(4)
ds_read_b128 a[248:251],v196 offset:49152
mf v[160:163],a[224:227],a[0:3],v[226:229]
ds_read_b128 a[252:255],v196 offset:57344
buffer_load_dwordx4 v211,s[24:27],s48 offen offset:3072 nt lds
mf v[168:171],a[228:231],a[0:3],v[226:229]
s_waitcnt lgkmcnt(4)
ds_read_b128 a[224:227],v193 offset:49408
mf v[160:163],a[232:235],a[8:11],v[160:163]
ds_read_b128 a[228:231],v193 offset:57600
s_add_u32 s48,s50,196608
buffer_load_dwordx4 a[192:195],v208,s[24:27],s48 offen nt
v_sub_f32 v144,v144,v222
v_sub_f32 v145,v145,v222
mf v[168:171],a[236:239],a[8:11],v[168:171]
s_waitcnt lgkmcnt(4)
ds_read_b128 a[232:235],v194 offset:49408
v_sub_f32 v146,v146,v222
mf v[160:163],a[240:243],a[16:19],v[160:163]
ds_read_b128 a[236:239],v194 offset:57600
buffer_load_dwordx4 a[196:199],v209,s[24:27],s48 offen offset:1024 nt
v_exp_f32 v144,v144
mf v[168:171],a[244:247],a[16:19],v[168:171]
s_waitcnt lgkmcnt(4)
ds_read_b128 a[240:243],v195 offset:49408
v_sub_f32 v147,v147,v222
mf v[160:163],a[248:251],a[24:27],v[160:163]
ds_read_b128 a[244:247],v195 offset:57600
buffer_load_dwordx4 a[200:203],v210,s[24:27],s48 offen offset:2048 nt
v_exp_f32 v145,v145
v_sub_f32 v152,v152,v222
mf v[168:171],a[252:255],a[24:27],v[168:171]
s_waitcnt lgkmcnt(4)
ds_read_b128 a[248:251],v196 offset:49408
v_exp_f32 v146,v146
mf v[160:163],a[224:227],a[32:35],v[160:163]
v_add_u32 v193,0xffff0000,v193
ds_read_b128 a[252:255],v196 offset:57600
buffer_load_dwordx4 a[204:207],v211,s[24:27],s48 offen offset:3072 nt
v_sub_f32 v153,v153,v222
mf v[168:171],a[228:231],a[32:35],v[168:171]
s_waitcnt lgkmcnt(4)
s_barrier
ds_read_b128 a[224:227],v193
v_exp_f32 v147,v147
mf v[160:163],a[232:235],a[40:43],v[160:163]
v_add_u32 v194,0xffff0000,v194
ds_read_b128 a[228:231],v193 offset:8192
cvp v8,v144,v145
v_sub_f32 v154,v154,v222
mf v[168:171],a[236:239],a[40:43],v[168:171]
s_waitcnt lgkmcnt(4)
ds_read_b128 a[232:235],v194
v_exp_f32 v152,v152
mf v[160:163],a[240:243],a[48:51],v[160:163]
v_add_u32 v195,0xffff0000,v195
ds_read_b128 a[236:239],v194 offset:8192
v_sub_f32 v155,v155,v222
mf v[168:171],a[244:247],a[48:51],v[168:171]
s_waitcnt lgkmcnt(4)
ds_read_b128 a[240:243],v195
v_exp_f32 v153,v153
mf v[160:163],a[248:251],a[56:59],v[160:163]
v_add_u32 v196,0xffff0000,v196
ds_read_b128 a[244:247],v195 offset:8192
cvp v9,v146,v147
v_exp_f32 v154,v154
mf v[168:171],a[252:255],a[56:59],v[168:171]
s_waitcnt lgkmcnt(4)
ds_read_b128 a[248:251],v196
v_exp_f32 v155,v155
mf v[128:131],a[224:227],a[0:3],v[226:229]
ds_read_b128 a[252:255],v196 offset:8192
cvp v10,v152,v153
mf v[136:139],a[228:231],a[0:3],v[226:229]
s_waitcnt lgkmcnt(4)
ds_read_b128 a[224:227],v193 offset:256
cvp v11,v154,v155
mf v[128:131],a[232:235],a[8:11],v[128:131]
ds_read_b128 a[228:231],v193 offset:8448
v_exp_f32 v160,v160
mf v[136:139],a[236:239],a[8:11],v[136:139]
s_waitcnt lgkmcnt(4)
ds_read_b128 a[232:235],v194 offset:256
v_exp_f32 v161,v161
mf v[128:131],a[240:243],a[16:19],v[128:131]
ds_read_b128 a[236:239],v194 offset:8448
v_exp_f32 v162,v162
mf v[136:139],a[244:247],a[16:19],v[136:139]
s_waitcnt lgkmcnt(4)
ds_read_b128 a[240:243],v195 offset:256
mf v[128:131],a[248:251],a[24:27],v[128:131]
ds_read_b128 a[244:247],v195 offset:8448
v_exp_f32 v163,v163
mf v[136:139],a[252:255],a[24:27],v[136:139]
s_waitcnt lgkmcnt(4)
ds_read_b128 a[248:251],v196 offset:256
cvp v16,v160,v161
mf v[128:131],a[224:227],a[32:35],v[128:131]
v_add_u32 v193,0x20000,v193
ds_read_b128 a[252:255],v196 offset:8448
v_exp_f32 v168,v168
mf v[136:139],a[228:231],a[32:35],v[136:139]
s_waitcnt lgkmcnt(4)
s_barrier
ds_read_b128 a[224:227],v193
mf v[128:131],a[232:235],a[40:43],v[128:131]
v_add_u32 v194,0x20000,v194
ds_read_b128 a[228:231],v193 offset:8192
v_exp_f32 v169,v169
mf v[136:139],a[236:239],a[40:43],v[136:139]
s_waitcnt lgkmcnt(4)
ds_read_b128 a[232:235],v194
cvp v17,v162,v163
mf v[128:131],a[240:243],a[48:51],v[128:131]
v_add_u32 v195,0x20000,v195
ds_read_b128 a[236:239],v194 offset:8192
v_exp_f32 v170,v170
mf v[136:139],a[244:247],a[48:51],v[136:139]
s_waitcnt lgkmcnt(4)
ds_read_b128 a[240:243],v195
mf v[128:131],a[248:251],a[56:59],v[128:131]
v_add_u32 v196,0x20000,v196
ds_read_b128 a[244:247],v195 offset:8192
v_exp_f32 v171,v171
mf v[136:139],a[252:255],a[56:59],v[136:139]
s_waitcnt lgkmcnt(4)
ds_read_b128 a[248:251],v196
cvp v18,v168,v169
mf v[144:147],a[224:227],a[0:3],v[226:229]
ds_read_b128 a[252:255],v196 offset:8192
cvp v19,v170,v171
mf v[152:155],a[228:231],a[0:3],v[226:229]
s_waitcnt lgkmcnt(4)
ds_read_b128 a[224:227],v193 offset:256
mf v[144:147],a[232:235],a[8:11],v[144:147]
ds_read_b128 a[228:231],v193 offset:8448
v_exp_f32 v128,v128
mf v[152:155],a[236:239],a[8:11],v[152:155]
s_waitcnt lgkmcnt(4)
ds_read_b128 a[232:235],v194 offset:256
v_exp_f32 v129,v129
mf v[144:147],a[240:243],a[16:19],v[144:147]
ds_read_b128 a[236:239],v194 offset:8448
v_exp_f32 v130,v130
mf v[152:155],a[244:247],a[16:19],v[152:155]
s_waitcnt lgkmcnt(4)
ds_read_b128 a[240:243],v195 offset:256
mf v[144:147],a[248:251],a[24:27],v[144:147]
ds_read_b128 a[244:247],v195 offset:8448
v_exp_f32 v131,v131
mf v[152:155],a[252:255],a[24:27],v[152:155]
s_waitcnt lgkmcnt(4)
ds_read_b128 a[248:251],v196 offset:256
cvp v24,v128,v129
mf v[144:147],a[224:227],a[32:35],v[144:147]
v_add_u32 v193,0xfffe0000,v193
ds_read_b128 a[252:255],v196 offset:8448
v_exp_f32 v136,v136
mf v[152:155],a[228:231],a[32:35],v[152:155]
s_waitcnt lgkmcnt(4)
s_barrier
ds_read_b128 a[224:227],v193 offset:32768
mf v[144:147],a[232:235],a[40:43],v[144:147]
v_add_u32 v194,0xfffe0000,v194
ds_read_b128 a[228:231],v193 offset:40960
s_waitcnt vmcnt(8)
ds_write_b128 v207,a[176:179]
s_add_u32 s48,s50,212992
buffer_load_dwordx4 a[208:211],v208,s[24:27],s48 offen nt
v_exp_f32 v137,v137
mf v[152:155],a[236:239],a[40:43],v[152:155]
s_waitcnt lgkmcnt(5)
ds_read_b128 a[232:235],v194 offset:32768
cvp v25,v130,v131
mf v[144:147],a[240:243],a[48:51],v[144:147]
v_add_u32 v195,0xfffe0000,v195
ds_read_b128 a[236:239],v194 offset:40960
ds_write_b128 v207,a[180:183] offset:1024
v_exp_f32 v138,v138
mf v[152:155],a[244:247],a[48:51],v[152:155]
s_waitcnt lgkmcnt(6)
ds_read_b128 a[240:243],v195 offset:32768
buffer_load_dwordx4 a[212:215],v209,s[24:27],s48 offen offset:1024 nt
mf v[144:147],a[248:251],a[56:59],v[144:147]
v_add_u32 v196,0xfffe0000,v196
ds_read_b128 a[244:247],v195 offset:40960
ds_write_b128 v207,a[184:187] offset:2048
v_exp_f32 v139,v139
mf v[152:155],a[252:255],a[56:59],v[152:155]
s_waitcnt lgkmcnt(7)
ds_read_b128 a[248:251],v196 offset:32768
cvp v26,v136,v137
mf v[160:163],a[224:227],a[0:3],v[226:229]
ds_read_b128 a[252:255],v196 offset:40960
ds_write_b128 v207,a[188:191] offset:3072
buffer_load_dwordx4 a[216:219],v210,s[24:27],s48 offen offset:2048 nt
cvp v27,v138,v139
mf v[168:171],a[228:231],a[0:3],v[226:229]
s_waitcnt lgkmcnt(7)
ds_read_b128 a[224:227],v193 offset:33024
mf v[160:163],a[232:235],a[8:11],v[160:163]
ds_read_b128 a[228:231],v193 offset:41216
v_exp_f32 v144,v144
mf v[168:171],a[236:239],a[8:11],v[168:171]
s_waitcnt lgkmcnt(6)
ds_read_b128 a[232:235],v194 offset:33024
buffer_load_dwordx4 a[220:223],v211,s[24:27],s48 offen offset:3072 nt
v_exp_f32 v145,v145
mf v[160:163],a[240:243],a[16:19],v[160:163]
ds_read_b128 a[236:239],v194 offset:41216
v_exp_f32 v146,v146
mf v[168:171],a[244:247],a[16:19],v[168:171]
s_waitcnt lgkmcnt(5)
ds_read_b128 a[240:243],v195 offset:33024
mf v[160:163],a[248:251],a[24:27],v[160:163]
ds_read_b128 a[244:247],v195 offset:41216
v_exp_f32 v147,v147
mf v[168:171],a[252:255],a[24:27],v[168:171]
s_waitcnt lgkmcnt(4)
ds_read_b128 a[248:251],v196 offset:33024
cvp v32,v144,v145
mf v[160:163],a[224:227],a[32:35],v[160:163]
v_add_u32 v193,0x20000,v193
ds_read_b128 a[252:255],v196 offset:41216
v_exp_f32 v152,v152
mf v[168:171],a[228:231],a[32:35],v[168:171]
s_waitcnt lgkmcnt(4)
s_barrier
ds_read_b128 a[224:227],v193 offset:16384
mf v[160:163],a[232:235],a[40:43],v[160:163]
v_add_u32 v194,0x20000,v194
ds_read_b128 a[228:231],v193 offset:24576
s_add_u32 m0,s49,65536
s_add_u32 s48,s50,229376
buffer_load_dwordx4 v208,s[24:27],s48 offen nt lds
v_exp_f32 v153,v153
mf v[168:171],a[236:239],a[40:43],v[168:171]
s_waitcnt lgkmcnt(4)
ds_read_b128 a[232:235],v194 offset:16384
cvp v33,v146,v147
mf v[160:163],a[240:243],a[48:51],v[160:163]
v_add_u32 v195,0x20000,v195
ds_read_b128 a[236:239],v194 offset:24576
v_exp_f32 v154,v154
mf v[168:171],a[244:247],a[48:51],v[168:171]
s_waitcnt lgkmcnt(4)
ds_read_b128 a[240:243],v195 offset:16384
buffer_load_dwordx4 v209,s[24:27],s48 offen offset:1024 nt lds
mf v[160:163],a[248:251],a[56:59],v[160:163]
v_add_u32 v196,0x20000,v196
ds_read_b128 a[244:247],v195 offset:24576
v_exp_f32 v155,v155
mf v[168:171],a[252:255],a[56:59],v[168:171]
s_waitcnt lgkmcnt(4)
ds_read_b128 a[248:251],v196 offset:16384
cvp v34,v152,v153
mf v[128:131],a[224:227],a[0:3],v[226:229]
ds_read_b128 a[252:255],v196 offset:24576
buffer_load_dwordx4 v210,s[24:27],s48 offen offset:2048 nt lds
cvp v35,v154,v155
mf v[136:139],a[228:231],a[0:3],v[226:229]
s_waitcnt lgkmcnt(4)
ds_read_b128 a[224:227],v193 offset:16640
mf v[128:131],a[232:235],a[8:11],v[128:131]
ds_read_b128 a[228:231],v193 offset:24832
v_exp_f32 v160,v160
mf v[136:139],a[236:239],a[8:11],v[136:139]
s_waitcnt lgkmcnt(4)
ds_read_b128 a[232:235],v194 offset:16640
buffer_load_dwordx4 v211,s[24:27],s48 offen offset:3072 nt lds
v_exp_f32 v161,v161
mf v[128:131],a[240:243],a[16:19],v[128:131]
ds_read_b128 a[236:239],v194 offset:24832
v_exp_f32 v162,v162
mf v[136:139],a[244:247],a[16:19],v[136:139]
s_waitcnt lgkmcnt(4)
ds_read_b128 a[240:243],v195 offset:16640
mf v[128:131],a[248:251],a[24:27],v[128:131]
ds_read_b128 a[244:247],v195 offset:24832
v_exp_f32 v163,v163
mf v[136:139],a[252:255],a[24:27],v[136:139]
s_waitcnt lgkmcnt(4)
ds_read_b128 a[248:251],v196 offset:16640
cvp v40,v160,v161
mf v[128:131],a[224:227],a[32:35],v[128:131]
v_add_u32 v193,0xffff0000,v193
ds_read_b128 a[252:255],v196 offset:24832
v_exp_f32 v168,v168
mf v[136:139],a[228:231],a[32:35],v[136:139]
s_waitcnt lgkmcnt(4)
s_barrier
ds_read_b128 a[224:227],v193 offset:16384
mf v[128:131],a[232:235],a[40:43],v[128:131]
v_add_u32 v194,0xffff0000,v194
ds_read_b128 a[228:231],v193 offset:24576
s_waitcnt vmcnt(8)
ds_write_b128 v207,a[192:195] offset:32768
v_exp_f32 v169,v169
mf v[136:139],a[236:239],a[40:43],v[136:139]
s_waitcnt lgkmcnt(5)
ds_read_b128 a[232:235],v194 offset:16384
cvp v41,v162,v163
mf v[128:131],a[240:243],a[48:51],v[128:131]
v_add_u32 v195,0xffff0000,v195
ds_read_b128 a[236:239],v194 offset:24576
ds_write_b128 v207,a[196:199] offset:33792
v_exp_f32 v170,v170
mf v[136:139],a[244:247],a[48:51],v[136:139]
s_waitcnt lgkmcnt(6)
ds_read_b128 a[240:243],v195 offset:16384
mf v[128:131],a[248:251],a[56:59],v[128:131]
v_add_u32 v196,0xffff0000,v196
ds_read_b128 a[244:247],v195 offset:24576
ds_write_b128 v207,a[200:203] offset:34816
v_exp_f32 v171,v171
mf v[136:139],a[252:255],a[56:59],v[136:139]
s_waitcnt lgkmcnt(7)
ds_read_b128 a[248:251],v196 offset:16384
cvp v42,v168,v169
mf v[144:147],a[224:227],a[0:3],v[226:229]
ds_read_b128 a[252:255],v196 offset:24576
ds_write_b128 v207,a[204:207] offset:35840
cvp v43,v170,v171
mf v[152:155],a[228:231],a[0:3],v[226:229]
s_waitcnt lgkmcnt(7)
ds_read_b128 a[224:227],v193 offset:16640
mf v[144:147],a[232:235],a[8:11],v[144:147]
ds_read_b128 a[228:231],v193 offset:24832
v_exp_f32 v128,v128
mf v[152:155],a[236:239],a[8:11],v[152:155]
s_waitcnt lgkmcnt(6)
ds_read_b128 a[232:235],v194 offset:16640
v_exp_f32 v129,v129
mf v[144:147],a[240:243],a[16:19],v[144:147]
ds_read_b128 a[236:239],v194 offset:24832
v_exp_f32 v130,v130
mf v[152:155],a[244:247],a[16:19],v[152:155]
s_waitcnt lgkmcnt(5)
ds_read_b128 a[240:243],v195 offset:16640
mf v[144:147],a[248:251],a[24:27],v[144:147]
ds_read_b128 a[244:247],v195 offset:24832
v_exp_f32 v131,v131
mf v[152:155],a[252:255],a[24:27],v[152:155]
s_waitcnt lgkmcnt(4)
ds_read_b128 a[248:251],v196 offset:16640
cvp v48,v128,v129
mf v[144:147],a[224:227],a[32:35],v[144:147]
v_add_u32 v193,0xffff0000,v193
ds_read_b128 a[252:255],v196 offset:24832
v_exp_f32 v136,v136
mf v[152:155],a[228:231],a[32:35],v[152:155]
s_waitcnt lgkmcnt(4)
s_barrier
ds_read_b128 a[224:227],v193 offset:16384
mf v[144:147],a[232:235],a[40:43],v[144:147]
v_add_u32 v194,0xffff0000,v194
ds_read_b128 a[228:231],v193 offset:24576
s_add_u32 m0,s49,114688
s_add_u32 s48,s50,245760
buffer_load_dwordx4 v208,s[24:27],s48 offen nt lds
v_exp_f32 v137,v137
mf v[152:155],a[236:239],a[40:43],v[152:155]
s_waitcnt lgkmcnt(4)
ds_read_b128 a[232:235],v194 offset:16384
cvp v49,v130,v131
mf v[144:147],a[240:243],a[48:51],v[144:147]
v_add_u32 v195,0xffff0000,v195
ds_read_b128 a[236:239],v194 offset:24576
v_exp_f32 v138,v138
mf v[152:155],a[244:247],a[48:51],v[152:155]
s_waitcnt lgkmcnt(4)
ds_read_b128 a[240:243],v195 offset:16384
buffer_load_dwordx4 v209,s[24:27],s48 offen offset:1024 nt lds
mf v[144:147],a[248:251],a[56:59],v[144:147]
v_add_u32 v196,0xffff0000,v196
ds_read_b128 a[244:247],v195 offset:24576
v_exp_f32 v139,v139
mf v[152:155],a[252:255],a[56:59],v[152:155]
s_waitcnt lgkmcnt(4)
ds_read_b128 a[248:251],v196 offset:16384
cvp v50,v136,v137
mf v[160:163],a[224:227],a[0:3],v[226:229]
ds_read_b128 a[252:255],v196 offset:24576
buffer_load_dwordx4 v210,s[24:27],s48 offen offset:2048 nt lds
cvp v51,v138,v139
mf v[168:171],a[228:231],a[0:3],v[226:229]
s_waitcnt lgkmcnt(4)
ds_read_b128 a[224:227],v193 offset:16640
mf v[160:163],a[232:235],a[8:11],v[160:163]
ds_read_b128 a[228:231],v193 offset:24832
v_exp_f32 v144,v144
mf v[168:171],a[236:239],a[8:11],v[168:171]
s_waitcnt lgkmcnt(4)
ds_read_b128 a[232:235],v194 offset:16640
buffer_load_dwordx4 v211,s[24:27],s48 offen offset:3072 nt lds
v_exp_f32 v145,v145
mf v[160:163],a[240:243],a[16:19],v[160:163]
ds_read_b128 a[236:239],v194 offset:24832
v_exp_f32 v146,v146
mf v[168:171],a[244:247],a[16:19],v[168:171]
s_waitcnt lgkmcnt(4)
ds_read_b128 a[240:243],v195 offset:16640
mf v[160:163],a[248:251],a[24:27],v[160:163]
ds_read_b128 a[244:247],v195 offset:24832
v_exp_f32 v147,v147
mf v[168:171],a[252:255],a[24:27],v[168:171]
s_waitcnt lgkmcnt(4)
ds_read_b128 a[248:251],v196 offset:16640
cvp v56,v144,v145
mf v[160:163],a[224:227],a[32:35],v[160:163]
v_add_u32 v193,0x10000,v193
ds_read_b128 a[252:255],v196 offset:24832
v_exp_f32 v152,v152
mf v[168:171],a[228:231],a[32:35],v[168:171]
s_waitcnt lgkmcnt(4)
s_barrier
ds_read_b128 a[224:227],v193 offset:32768
mf v[160:163],a[232:235],a[40:43],v[160:163]
v_add_u32 v194,0x10000,v194
ds_read_b128 a[228:231],v193 offset:40960
s_waitcnt vmcnt(8)
v_add_u32 v191,0x10000,v207
ds_write_b128 v191,a[208:211] offset:16384
v_exp_f32 v153,v153
mf v[168:171],a[236:239],a[40:43],v[168:171]
s_waitcnt lgkmcnt(5)
ds_read_b128 a[232:235],v194 offset:32768
cvp v57,v146,v147
mf v[160:163],a[240:243],a[48:51],v[160:163]
v_add_u32 v195,0x10000,v195
ds_read_b128 a[236:239],v194 offset:40960
ds_write_b128 v191,a[212:215] offset:17408
v_exp_f32 v154,v154
mf v[168:171],a[244:247],a[48:51],v[168:171]
s_waitcnt lgkmcnt(6)
ds_read_b128 a[240:243],v195 offset:32768
mf v[160:163],a[248:251],a[56:59],v[160:163]
v_add_u32 v196,0x10000,v196
ds_read_b128 a[244:247],v195 offset:40960
ds_write_b128 v191,a[216:219] offset:18432
v_exp_f32 v155,v155
mf v[168:171],a[252:255],a[56:59],v[168:171]
s_waitcnt lgkmcnt(7)
ds_read_b128 a[248:251],v196 offset:32768
cvp v58,v152,v153
mf v[128:131],a[224:227],a[0:3],v[226:229]
ds_read_b128 a[252:255],v196 offset:40960
ds_write_b128 v191,a[220:223] offset:19456
cvp v59,v154,v155
mf v[136:139],a[228:231],a[0:3],v[226:229]
s_waitcnt lgkmcnt(7)
ds_read_b128 a[224:227],v193 offset:33024
mf v[128:131],a[232:235],a[8:11],v[128:131]
ds_read_b128 a[228:231],v193 offset:41216
v_exp_f32 v160,v160
mf v[136:139],a[236:239],a[8:11],v[136:139]
s_waitcnt lgkmcnt(6)
ds_read_b128 a[232:235],v194 offset:33024
v_exp_f32 v161,v161
mf v[128:131],a[240:243],a[16:19],v[128:131]
ds_read_b128 a[236:239],v194 offset:41216
v_exp_f32 v162,v162
mf v[136:139],a[244:247],a[16:19],v[136:139]
s_waitcnt lgkmcnt(5)
ds_read_b128 a[240:243],v195 offset:33024
mf v[128:131],a[248:251],a[24:27],v[128:131]
ds_read_b128 a[244:247],v195 offset:41216
v_exp_f32 v163,v163
mf v[136:139],a[252:255],a[24:27],v[136:139]
s_waitcnt lgkmcnt(4)
ds_read_b128 a[248:251],v196 offset:33024
cvp v64,v160,v161
mf v[128:131],a[224:227],a[32:35],v[128:131]
v_add_u32 v193,0xffff0000,v193
ds_read_b128 a[252:255],v196 offset:41216
v_exp_f32 v168,v168
mf v[136:139],a[228:231],a[32:35],v[136:139]
s_waitcnt lgkmcnt(4)
s_barrier
ds_read_b128 a[224:227],v193
mf v[128:131],a[232:235],a[40:43],v[128:131]
v_add_u32 v194,0xffff0000,v194
ds_read_b128 a[228:231],v193 offset:8192
s_add_u32 m0,s49,16384
s_add_u32 s48,s51,0
buffer_load_dwordx4 v212,s[28:31],s48 offen nt lds
v_exp_f32 v169,v169
mf v[136:139],a[236:239],a[40:43],v[136:139]
s_waitcnt lgkmcnt(4)
ds_read_b128 a[232:235],v194
cvp v65,v162,v163
mf v[128:131],a[240:243],a[48:51],v[128:131]
v_add_u32 v195,0xffff0000,v195
ds_read_b128 a[236:239],v194 offset:8192
v_exp_f32 v170,v170
mf v[136:139],a[244:247],a[48:51],v[136:139]
s_waitcnt lgkmcnt(4)
ds_read_b128 a[240:243],v195
buffer_load_dwordx4 v213,s[28:31],s48 offen offset:1024 nt lds
mf v[128:131],a[248:251],a[56:59],v[128:131]
v_add_u32 v196,0xffff0000,v196
ds_read_b128 a[244:247],v195 offset:8192
v_exp_f32 v171,v171
mf v[136:139],a[252:255],a[56:59],v[136:139]
s_waitcnt lgkmcnt(4)
ds_read_b128 a[248:251],v196
cvp v66,v168,v169
mf v[144:147],a[224:227],a[0:3],v[226:229]
ds_read_b128 a[252:255],v196 offset:8192
buffer_load_dwordx4 v214,s[28:31],s48 offen offset:2048 nt lds
cvp v67,v170,v171
mf v[152:155],a[228:231],a[0:3],v[226:229]
s_waitcnt lgkmcnt(4)
ds_read_b128 a[224:227],v193 offset:256
mf v[144:147],a[232:235],a[8:11],v[144:147]
ds_read_b128 a[228:231],v193 offset:8448
v_exp_f32 v128,v128
mf v[152:155],a[236:239],a[8:11],v[152:155]
s_waitcnt lgkmcnt(4)
ds_read_b128 a[232:235],v194 offset:256
buffer_load_dwordx4 v215,s[28:31],s48 offen offset:3072 nt lds
v_exp_f32 v129,v129
mf v[144:147],a[240:243],a[16:19],v[144:147]
ds_read_b128 a[236:239],v194 offset:8448
v_exp_f32 v130,v130
mf v[152:155],a[244:247],a[16:19],v[152:155]
s_waitcnt lgkmcnt(4)
ds_read_b128 a[240:243],v195 offset:256
mf v[144:147],a[248:251],a[24:27],v[144:147]
ds_read_b128 a[244:247],v195 offset:8448
v_exp_f32 v131,v131
mf v[152:155],a[252:255],a[24:27],v[152:155]
s_waitcnt lgkmcnt(4)
ds_read_b128 a[248:251],v196 offset:256
cvp v72,v128,v129
mf v[144:147],a[224:227],a[32:35],v[144:147]
ds_read_b128 a[252:255],v196 offset:8448
v_exp_f32 v136,v136
mf v[152:155],a[228:231],a[32:35],v[152:155]
s_waitcnt lgkmcnt(4)
s_barrier
ds_read_b128 a[224:227],v193 offset:49152
mf v[144:147],a[232:235],a[40:43],v[144:147]
ds_read_b128 a[228:231],v193 offset:57344
s_add_u32 m0,s61,98304
s_add_u32 s48,s53,s92
buffer_load_dwordx4 v216,s[36:39],s48 offen lds
v_exp_f32 v137,v137
mf v[152:155],a[236:239],a[40:43],v[152:155]
s_waitcnt lgkmcnt(4)
ds_read_b128 a[232:235],v194 offset:49152
cvp v73,v130,v131
mf v[144:147],a[240:243],a[48:51],v[144:147]
ds_read_b128 a[236:239],v194 offset:57344
buffer_load_dwordx4 v217,s[36:39],s48 offen offset:1024 lds
v_exp_f32 v138,v138
mf v[152:155],a[244:247],a[48:51],v[152:155]
s_waitcnt lgkmcnt(4)
ds_read_b128 a[240:243],v195 offset:49152
mf v[144:147],a[248:251],a[56:59],v[144:147]
ds_read_b128 a[244:247],v195 offset:57344
s_add_u32 m0,s61,106496
s_add_u32 s48,s53,s93
buffer_load_dwordx4 v216,s[36:39],s48 offen lds
v_exp_f32 v139,v139
mf v[152:155],a[252:255],a[56:59],v[152:155]
s_waitcnt lgkmcnt(4)
ds_read_b128 a[248:251],v196 offset:49152
cvp v74,v136,v137
mf v[160:163],a[224:227],a[0:3],v[226:229]
ds_read_b128 a[252:255],v196 offset:57344
buffer_load_dwordx4 v217,s[36:39],s48 offen offset:1024 lds
cvp v75,v138,v139
mf v[168:171],a[228:231],a[0:3],v[226:229]
s_waitcnt lgkmcnt(4)
ds_read_b128 a[224:227],v193 offset:49408
mf v[160:163],a[232:235],a[8:11],v[160:163]
ds_read_b128 a[228:231],v193 offset:57600
s_add_u32 m0,s49,131072
s_add_u32 s48,s51,65536
buffer_load_dwordx4 v212,s[28:31],s48 offen nt lds
v_exp_f32 v144,v144
mf v[168:171],a[236:239],a[8:11],v[168:171]
s_waitcnt lgkmcnt(4)
ds_read_b128 a[232:235],v194 offset:49408
v_exp_f32 v145,v145
mf v[160:163],a[240:243],a[16:19],v[160:163]
ds_read_b128 a[236:239],v194 offset:57600
buffer_load_dwordx4 v213,s[28:31],s48 offen offset:1024 nt lds
v_exp_f32 v146,v146
mf v[168:171],a[244:247],a[16:19],v[168:171]
s_waitcnt lgkmcnt(4)
ds_read_b128 a[240:243],v195 offset:49408
mf v[160:163],a[248:251],a[24:27],v[160:163]
ds_read_b128 a[244:247],v195 offset:57600
buffer_load_dwordx4 v214,s[28:31],s48 offen offset:2048 nt lds
v_exp_f32 v147,v147
mf v[168:171],a[252:255],a[24:27],v[168:171]
s_waitcnt lgkmcnt(4)
ds_read_b128 a[248:251],v196 offset:49408
cvp v80,v144,v145
mf v[160:163],a[224:227],a[32:35],v[160:163]
ds_read_b128 a[252:255],v196 offset:57600
buffer_load_dwordx4 v215,s[28:31],s48 offen offset:3072 nt lds
v_exp_f32 v152,v152
mf v[168:171],a[228:231],a[32:35],v[168:171]
s_waitcnt lgkmcnt(4)
s_barrier
ds_read_b128 a[224:227],v193 offset:32768
mf v[160:163],a[232:235],a[40:43],v[160:163]
ds_read_b128 a[228:231],v193 offset:40960
v_exp_f32 v153,v153
mf v[168:171],a[236:239],a[40:43],v[168:171]
s_waitcnt lgkmcnt(4)
ds_read_b128 a[232:235],v194 offset:32768
cvp v81,v146,v147
mf v[160:163],a[240:243],a[48:51],v[160:163]
ds_read_b128 a[236:239],v194 offset:40960
v_exp_f32 v154,v154
mf v[168:171],a[244:247],a[48:51],v[168:171]
s_waitcnt lgkmcnt(4)
ds_read_b128 a[240:243],v195 offset:32768
mf v[160:163],a[248:251],a[56:59],v[160:163]
ds_read_b128 a[244:247],v195 offset:40960
v_exp_f32 v155,v155
mf v[168:171],a[252:255],a[56:59],v[168:171]
s_waitcnt lgkmcnt(4)
ds_read_b128 a[248:251],v196 offset:32768
cvp v82,v152,v153
mf v[128:131],a[224:227],a[0:3],v[226:229]
ds_read_b128 a[252:255],v196 offset:40960
cvp v83,v154,v155
mf v[136:139],a[228:231],a[0:3],v[226:229]
s_waitcnt lgkmcnt(4)
ds_read_b128 a[224:227],v193 offset:33024
mf v[128:131],a[232:235],a[8:11],v[128:131]
ds_read_b128 a[228:231],v193 offset:41216
v_exp_f32 v160,v160
mf v[136:139],a[236:239],a[8:11],v[136:139]
s_waitcnt lgkmcnt(4)
ds_read_b128 a[232:235],v194 offset:33024
v_exp_f32 v161,v161
mf v[128:131],a[240:243],a[16:19],v[128:131]
ds_read_b128 a[236:239],v194 offset:41216
v_exp_f32 v162,v162
mf v[136:139],a[244:247],a[16:19],v[136:139]
s_waitcnt lgkmcnt(4)
ds_read_b128 a[240:243],v195 offset:33024
mf v[128:131],a[248:251],a[24:27],v[128:131]
ds_read_b128 a[244:247],v195 offset:41216
v_exp_f32 v163,v163
mf v[136:139],a[252:255],a[24:27],v[136:139]
s_waitcnt lgkmcnt(4)
ds_read_b128 a[248:251],v196 offset:33024
cvp v88,v160,v161
mf v[128:131],a[224:227],a[32:35],v[128:131]
v_add_u32 v193,0x10000,v193
ds_read_b128 a[252:255],v196 offset:41216
v_exp_f32 v168,v168
mf v[136:139],a[228:231],a[32:35],v[136:139]
s_waitcnt lgkmcnt(4)
s_barrier
ds_read_b128 a[224:227],v193 offset:16384
mf v[128:131],a[232:235],a[40:43],v[128:131]
v_add_u32 v194,0x10000,v194
ds_read_b128 a[228:231],v193 offset:24576
v_exp_f32 v169,v169
mf v[136:139],a[236:239],a[40:43],v[136:139]
s_waitcnt lgkmcnt(4)
ds_read_b128 a[232:235],v194 offset:16384
cvp v89,v162,v163
mf v[128:131],a[240:243],a[48:51],v[128:131]
v_add_u32 v195,0x10000,v195
ds_read_b128 a[236:239],v194 offset:24576
v_exp_f32 v170,v170
mf v[136:139],a[244:247],a[48:51],v[136:139]
s_waitcnt lgkmcnt(4)
ds_read_b128 a[240:243],v195 offset:16384
mf v[128:131],a[248:251],a[56:59],v[128:131]
v_add_u32 v196,0x10000,v196
ds_read_b128 a[244:247],v195 offset:24576
v_exp_f32 v171,v171
mf v[136:139],a[252:255],a[56:59],v[136:139]
s_waitcnt lgkmcnt(4)
ds_read_b128 a[248:251],v196 offset:16384
cvp v90,v168,v169
mf v[144:147],a[224:227],a[0:3],v[226:229]
ds_read_b128 a[252:255],v196 offset:24576
cvp v91,v170,v171
mf v[152:155],a[228:231],a[0:3],v[226:229]
s_waitcnt lgkmcnt(4)
ds_read_b128 a[224:227],v193 offset:16640
mf v[144:147],a[232:235],a[8:11],v[144:147]
ds_read_b128 a[228:231],v193 offset:24832
v_exp_f32 v128,v128
mf v[152:155],a[236:239],a[8:11],v[152:155]
s_waitcnt lgkmcnt(4)
ds_read_b128 a[232:235],v194 offset:16640
v_exp_f32 v129,v129
mf v[144:147],a[240:243],a[16:19],v[144:147]
ds_read_b128 a[236:239],v194 offset:24832
v_exp_f32 v130,v130
mf v[152:155],a[244:247],a[16:19],v[152:155]
s_waitcnt lgkmcnt(4)
ds_read_b128 a[240:243],v195 offset:16640
mf v[144:147],a[248:251],a[24:27],v[144:147]
ds_read_b128 a[244:247],v195 offset:24832
v_exp_f32 v131,v131
mf v[152:155],a[252:255],a[24:27],v[152:155]
s_waitcnt lgkmcnt(4)
ds_read_b128 a[248:251],v196 offset:16640
cvp v96,v128,v129
mf v[144:147],a[224:227],a[32:35],v[144:147]
ds_read_b128 a[252:255],v196 offset:24832
v_exp_f32 v136,v136
mf v[152:155],a[228:231],a[32:35],v[152:155]
s_waitcnt lgkmcnt(4)
s_waitcnt vmcnt(16)
s_barrier
ds_read_b128 a[224:227],v193
mf v[144:147],a[232:235],a[40:43],v[144:147]
ds_read_b128 a[228:231],v193 offset:8192
s_add_u32 m0,s61,0
s_add_u32 s48,s53,s94
buffer_load_dwordx4 v216,s[36:39],s48 offen lds
v_exp_f32 v137,v137
mf v[152:155],a[236:239],a[40:43],v[152:155]
s_waitcnt lgkmcnt(4)
ds_read_b128 a[232:235],v194
cvp v97,v130,v131
mf v[144:147],a[240:243],a[48:51],v[144:147]
ds_read_b128 a[236:239],v194 offset:8192
v_exp_f32 v138,v138
mf v[152:155],a[244:247],a[48:51],v[152:155]
s_waitcnt lgkmcnt(4)
ds_read_b128 a[240:243],v195
buffer_load_dwordx4 v217,s[36:39],s48 offen offset:1024 lds
mf v[144:147],a[248:251],a[56:59],v[144:147]
ds_read_b128 a[244:247],v195 offset:8192
v_exp_f32 v139,v139
mf v[152:155],a[252:255],a[56:59],v[152:155]
s_waitcnt lgkmcnt(4)
ds_read_b128 a[248:251],v196
cvp v98,v136,v137
mf v[160:163],a[224:227],a[0:3],v[226:229]
ds_read_b128 a[252:255],v196 offset:8192
s_add_u32 m0,s61,8192
s_add_u32 s48,s53,s95
buffer_load_dwordx4 v216,s[36:39],s48 offen lds
cvp v99,v138,v139
mf v[168:171],a[228:231],a[0:3],v[226:229]
s_waitcnt lgkmcnt(4)
ds_read_b128 a[224:227],v193 offset:256
mf v[160:163],a[232:235],a[8:11],v[160:163]
ds_read_b128 a[228:231],v193 offset:8448
v_exp_f32 v144,v144
mf v[168:171],a[236:239],a[8:11],v[168:171]
s_waitcnt lgkmcnt(4)
ds_read_b128 a[232:235],v194 offset:256
buffer_load_dwordx4 v217,s[36:39],s48 offen offset:1024 lds
v_exp_f32 v145,v145
mf v[160:163],a[240:243],a[16:19],v[160:163]
ds_read_b128 a[236:239],v194 offset:8448
v_exp_f32 v146,v146
mf v[168:171],a[244:247],a[16:19],v[168:171]
s_waitcnt lgkmcnt(4)
ds_read_b128 a[240:243],v195 offset:256
mf v[160:163],a[248:251],a[24:27],v[160:163]
ds_read_b128 a[244:247],v195 offset:8448
v_exp_f32 v147,v147
mf v[168:171],a[252:255],a[24:27],v[168:171]
s_waitcnt lgkmcnt(4)
ds_read_b128 a[248:251],v196 offset:256
cvp v104,v144,v145
mf v[160:163],a[224:227],a[32:35],v[160:163]
ds_read_b128 a[252:255],v196 offset:8448
v_exp_f32 v152,v152
mf v[168:171],a[228:231],a[32:35],v[168:171]
s_waitcnt lgkmcnt(4)
s_waitcnt vmcnt(16)
s_barrier
ds_read_b128 a[224:227],v193 offset:49152
mf v[160:163],a[232:235],a[40:43],v[160:163]
ds_read_b128 a[228:231],v193 offset:57344
s_add_u32 m0,s49,32768
s_add_u32 s48,s51,131072
buffer_load_dwordx4 v212,s[28:31],s48 offen nt lds
v_exp_f32 v153,v153
mf v[168:171],a[236:239],a[40:43],v[168:171]
s_waitcnt lgkmcnt(4)
ds_read_b128 a[232:235],v194 offset:49152
cvp v105,v146,v147
mf v[160:163],a[240:243],a[48:51],v[160:163]
ds_read_b128 a[236:239],v194 offset:57344
v_exp_f32 v154,v154
mf v[168:171],a[244:247],a[48:51],v[168:171]
s_waitcnt lgkmcnt(4)
ds_read_b128 a[240:243],v195 offset:49152
buffer_load_dwordx4 v213,s[28:31],s48 offen offset:1024 nt lds
mf v[160:163],a[248:251],a[56:59],v[160:163]
ds_read_b128 a[244:247],v195 offset:57344
v_exp_f32 v155,v155
mf v[168:171],a[252:255],a[56:59],v[168:171]
s_waitcnt lgkmcnt(4)
ds_read_b128 a[248:251],v196 offset:49152
cvp v106,v152,v153
mf v[176:179],a[224:227],a[0:3],v[226:229]
ds_read_b128 a[252:255],v196 offset:57344
buffer_load_dwordx4 v214,s[28:31],s48 offen offset:2048 nt lds
cvp v107,v154,v155
mf v[184:187],a[228:231],a[0:3],v[226:229]
s_waitcnt lgkmcnt(4)
ds_read_b128 a[224:227],v193 offset:49408
mf v[176:179],a[232:235],a[8:11],v[176:179]
ds_read_b128 a[228:231],v193 offset:57600
v_exp_f32 v160,v160
mf v[184:187],a[236:239],a[8:11],v[184:187]
s_waitcnt lgkmcnt(4)
ds_read_b128 a[232:235],v194 offset:49408
buffer_load_dwordx4 v215,s[28:31],s48 offen offset:3072 nt lds
v_exp_f32 v161,v161
mf v[176:179],a[240:243],a[16:19],v[176:179]
ds_read_b128 a[236:239],v194 offset:57600
v_exp_f32 v162,v162
mf v[184:187],a[244:247],a[16:19],v[184:187]
s_waitcnt lgkmcnt(4)
ds_read_b128 a[240:243],v195 offset:49408
v_exp_f32 v163,v163
mf v[176:179],a[248:251],a[24:27],v[176:179]
ds_read_b128 a[244:247],v195 offset:57600
cvp v112,v160,v161
mf v[184:187],a[252:255],a[24:27],v[184:187]
s_waitcnt lgkmcnt(4)
ds_read_b128 a[248:251],v196 offset:49408
v_exp_f32 v168,v168
mf v[176:179],a[224:227],a[32:35],v[176:179]
ds_read_b128 a[252:255],v196 offset:57600
v_exp_f32 v169,v169
mf v[184:187],a[228:231],a[32:35],v[184:187]
s_waitcnt lgkmcnt(4)
s_waitcnt vmcnt(16)
s_barrier
trr a[224:225],v201,16384
trr a[226:227],v201,18432
cvp v113,v162,v163
mf v[176:179],a[232:235],a[40:43],v[176:179]
trr a[228:229],v202,16384
trr a[230:231],v202,18432
s_add_u32 m0,s61,49152
s_add_u32 s48,s53,s96
buffer_load_dwordx4 v216,s[36:39],s48 offen lds
v_exp_f32 v170,v170
mf v[184:187],a[236:239],a[40:43],v[184:187]
s_waitcnt lgkmcnt(6)
trr a[232:233],v203,16384
trr a[234:235],v203,18432
v_exp_f32 v171,v171
mf v[176:179],a[240:243],a[48:51],v[176:179]
trr a[236:237],v204,16384
trr a[238:239],v204,18432
buffer_load_dwordx4 v217,s[36:39],s48 offen offset:1024 lds
cvp v114,v168,v169
mf v[184:187],a[244:247],a[48:51],v[184:187]
s_waitcnt lgkmcnt(8)
trr a[240:241],v201,20480
trr a[242:243],v201,22528
cvp v115,v170,v171
mf v[176:179],a[248:251],a[56:59],v[176:179]
trr a[244:245],v202,20480
trr a[246:247],v202,22528
s_add_u32 m0,s61,57344
s_add_u32 s48,s53,s97
buffer_load_dwordx4 v216,s[36:39],s48 offen lds
mf v[184:187],a[252:255],a[56:59],v[184:187]
s_waitcnt lgkmcnt(8)
trr a[248:249],v203,20480
trr a[250:251],v203,22528
v_mov_b32 v168,0x3f803f80
v_mov_b32 v169,0x3f803f80
v_mov_b32 v170,0x3f803f80
v_mov_b32 v171,0x3f803f80
mf v[128:131],a[224:227],v[0:3],0
trr a[252:253],v204,20480
trr a[254:255],v204,22528
buffer_load_dwordx4 v217,s[36:39],s48 offen offset:1024 lds
mf v[136:139],a[228:231],v[0:3],0
s_waitcnt lgkmcnt(8)
trr a[224:225],v201,24576
trr a[226:227],v201,26624
mf v[160:163],v[168:171],v[0:3],0
mf v[144:147],a[232:235],v[0:3],0
trr a[228:229],v202,24576
trr a[230:231],v202,26624
s_add_u32 m0,s49,65536
s_add_u32 s48,s51,196608
buffer_load_dwordx4 v212,s[28:31],s48 offen nt lds
v_exp_f32 v176,v176
mf v[152:155],a[236:239],v[0:3],0
s_waitcnt lgkmcnt(8)
trr a[232:233],v203,24576
trr a[234:235],v203,26624
v_exp_f32 v177,v177
mf v[128:131],a[240:243],v[8:11],v[128:131]
trr a[236:237],v204,24576
trr a[238:239],v204,26624
buffer_load_dwordx4 v213,s[28:31],s48 offen offset:1024 nt lds
v_exp_f32 v178,v178
mf v[136:139],a[244:247],v[8:11],v[136:139]
s_waitcnt lgkmcnt(8)
trr a[240:241],v201,28672
trr a[242:243],v201,30720
v_exp_f32 v179,v179
mf v[160:163],v[168:171],v[8:11],v[160:163]
mf v[144:147],a[248:251],v[8:11],v[144:147]
trr a[244:245],v202,28672
trr a[246:247],v202,30720
buffer_load_dwordx4 v214,s[28:31],s48 offen offset:2048 nt lds
cvp v120,v176,v177
mf v[152:155],a[252:255],v[8:11],v[152:155]
s_waitcnt lgkmcnt(8)
trr a[248:249],v203,28672
trr a[250:251],v203,30720
v_exp_f32 v184,v184
mf v[128:131],a[224:227],v[16:19],v[128:131]
v_add_u32 v201,0x20000,v201
trr a[252:253],v204,28672
trr a[254:255],v204,30720
buffer_load_dwordx4 v215,s[28:31],s48 offen offset:3072 nt lds
v_exp_f32 v185,v185
mf v[136:139],a[228:231],v[16:19],v[136:139]
s_waitcnt lgkmcnt(8)
s_waitcnt vmcnt(16)
s_barrier
v_add_u32 v202,0x20000,v202
trr a[224:225],v201,0
trr a[226:227],v201,2048
cvp v121,v178,v179
mf v[160:163],v[168:171],v[16:19],v[160:163]
mf v[144:147],a[232:235],v[16:19],v[144:147]
v_add_u32 v203,0x20000,v203
trr a[228:229],v202,0
trr a[230:231],v202,2048
v_exp_f32 v186,v186
mf v[152:155],a[236:239],v[16:19],v[152:155]
s_waitcnt lgkmcnt(8)
v_add_u32 v204,0x20000,v204
trr a[232:233],v203,0
trr a[234:235],v203,2048
v_exp_f32 v187,v187
mf v[128:131],a[240:243],v[24:27],v[128:131]
trr a[236:237],v204,0
trr a[238:239],v204,2048
cvp v122,v184,v185
mf v[136:139],a[244:247],v[24:27],v[136:139]
s_waitcnt lgkmcnt(8)
trr a[240:241],v201,4096
trr a[242:243],v201,6144
cvp v123,v186,v187
mf v[160:163],v[168:171],v[24:27],v[160:163]
mf v[144:147],a[248:251],v[24:27],v[144:147]
trr a[244:245],v202,4096
trr a[246:247],v202,6144
mf v[152:155],a[252:255],v[24:27],v[152:155]
s_waitcnt lgkmcnt(8)
trr a[248:249],v203,4096
trr a[250:251],v203,6144
mf v[128:131],a[224:227],v[32:35],v[128:131]
trr a[252:253],v204,4096
trr a[254:255],v204,6144
mf v[136:139],a[228:231],v[32:35],v[136:139]
s_waitcnt lgkmcnt(8)
trr a[224:225],v201,8192
trr a[226:227],v201,10240
mf v[160:163],v[168:171],v[32:35],v[160:163]
mf v[144:147],a[232:235],v[32:35],v[144:147]
trr a[228:229],v202,8192
trr a[230:231],v202,10240
mf v[152:155],a[236:239],v[32:35],v[152:155]
s_waitcnt lgkmcnt(8)
trr a[232:233],v203,8192
trr a[234:235],v203,10240
mf v[128:131],a[240:243],v[40:43],v[128:131]
trr a[236:237],v204,8192
trr a[238:239],v204,10240
mf v[136:139],a[244:247],v[40:43],v[136:139]
s_waitcnt lgkmcnt(8)
trr a[240:241],v201,12288
trr a[242:243],v201,14336
mf v[160:163],v[168:171],v[40:43],v[160:163]
mf v[144:147],a[248:251],v[40:43],v[144:147]
trr a[244:245],v202,12288
trr a[246:247],v202,14336
mf v[152:155],a[252:255],v[40:43],v[152:155]
s_waitcnt lgkmcnt(8)
trr a[248:249],v203,12288
trr a[250:251],v203,14336
mf v[128:131],a[224:227],v[48:51],v[128:131]
v_add_u32 v201,0xfffe0000,v201
trr a[252:253],v204,12288
trr a[254:255],v204,14336
mf v[136:139],a[228:231],v[48:51],v[136:139]
s_waitcnt lgkmcnt(8)
s_waitcnt vmcnt(8)
s_barrier
v_add_u32 v202,0xfffe0000,v202
trr a[224:225],v201,32768
trr a[226:227],v201,34816
mf v[160:163],v[168:171],v[48:51],v[160:163]
mf v[144:147],a[232:235],v[48:51],v[144:147]
v_add_u32 v203,0xfffe0000,v203
trr a[228:229],v202,32768
trr a[230:231],v202,34816
s_add_u32 m0,s61,16384
s_add_u32 s48,s53,s98
buffer_load_dwordx4 v216,s[36:39],s48 offen lds
mf v[152:155],a[236:239],v[48:51],v[152:155]
s_waitcnt lgkmcnt(8)
v_add_u32 v204,0xfffe0000,v204
trr a[232:233],v203,32768
trr a[234:235],v203,34816
mf v[128:131],a[240:243],v[56:59],v[128:131]
trr a[236:237],v204,32768
trr a[238:239],v204,34816
buffer_load_dwordx4 v217,s[36:39],s48 offen offset:1024 lds
mf v[136:139],a[244:247],v[56:59],v[136:139]
s_waitcnt lgkmcnt(8)
trr a[240:241],v201,36864
trr a[242:243],v201,38912
mf v[160:163],v[168:171],v[56:59],v[160:163]
mf v[144:147],a[248:251],v[56:59],v[144:147]
trr a[244:245],v202,36864
trr a[246:247],v202,38912
s_add_u32 m0,s49,81920
s_add_u32 s48,s51,128
buffer_load_dwordx4 v212,s[28:31],s48 offen nt lds
mf v[152:155],a[252:255],v[56:59],v[152:155]
s_waitcnt lgkmcnt(8)
trr a[248:249],v203,36864
trr a[250:251],v203,38912
mf v[128:131],a[224:227],v[64:67],v[128:131]
trr a[252:253],v204,36864
trr a[254:255],v204,38912
buffer_load_dwordx4 v213,s[28:31],s48 offen offset:1024 nt lds
mf v[136:139],a[228:231],v[64:67],v[136:139]
s_waitcnt lgkmcnt(8)
trr a[224:225],v201,40960
trr a[226:227],v201,43008
mf v[160:163],v[168:171],v[64:67],v[160:163]
mf v[144:147],a[232:235],v[64:67],v[144:147]
trr a[228:229],v202,40960
trr a[230:231],v202,43008
buffer_load_dwordx4 v214,s[28:31],s48 offen offset:2048 nt lds
mf v[152:155],a[236:239],v[64:67],v[152:155]
s_waitcnt lgkmcnt(8)
trr a[232:233],v203,40960
trr a[234:235],v203,43008
mf v[128:131],a[240:243],v[72:75],v[128:131]
trr a[236:237],v204,40960
trr a[238:239],v204,43008
buffer_load_dwordx4 v215,s[28:31],s48 offen offset:3072 nt lds
mf v[136:139],a[244:247],v[72:75],v[136:139]
s_waitcnt lgkmcnt(8)
trr a[240:241],v201,45056
trr a[242:243],v201,47104
mf v[160:163],v[168:171],v[72:75],v[160:163]
mf v[144:147],a[248:251],v[72:75],v[144:147]
trr a[244:245],v202,45056
trr a[246:247],v202,47104
mf v[152:155],a[252:255],v[72:75],v[152:155]
s_waitcnt lgkmcnt(8)
trr a[248:249],v203,45056
trr a[250:251],v203,47104
mf v[128:131],a[224:227],v[80:83],v[128:131]
v_add_u32 v201,0x10000,v201
trr a[252:253],v204,45056
trr a[254:255],v204,47104
mf v[136:139],a[228:231],v[80:83],v[136:139]
s_waitcnt lgkmcnt(8)
s_waitcnt vmcnt(6)
s_barrier
v_add_u32 v202,0x10000,v202
trr a[224:225],v201,0
trr a[226:227],v201,2048
mf v[160:163],v[168:171],v[80:83],v[160:163]
mf v[144:147],a[232:235],v[80:83],v[144:147]
trr a[228:229],v202,0
trr a[230:231],v202,2048
s_add_u32 m0,s49,114688
s_add_u32 s48,s51,65664
buffer_load_dwordx4 v212,s[28:31],s48 offen nt lds
mf v[152:155],a[236:239],v[80:83],v[152:155]
s_waitcnt lgkmcnt(8)
trr a[232:233],v201,4096
trr a[234:235],v201,6144
mf v[128:131],a[240:243],v[88:91],v[128:131]
trr a[236:237],v202,4096
trr a[238:239],v202,6144
mf v[136:139],a[244:247],v[88:91],v[136:139]
s_waitcnt lgkmcnt(8)
trr a[240:241],v201,8192
trr a[242:243],v201,10240
buffer_load_dwordx4 v213,s[28:31],s48 offen offset:1024 nt lds
mf v[160:163],v[168:171],v[88:91],v[160:163]
mf v[144:147],a[248:251],v[88:91],v[144:147]
trr a[244:245],v202,8192
trr a[246:247],v202,10240
mf v[152:155],a[252:255],v[88:91],v[152:155]
s_waitcnt lgkmcnt(8)
trr a[248:249],v201,12288
trr a[250:251],v201,14336
mf v[160:163],v[168:171],v[96:99],v[160:163]
mf v[128:131],a[224:227],v[96:99],v[128:131]
v_add_u32 v203,0x10000,v203
trr a[252:253],v202,12288
trr a[254:255],v202,14336
buffer_load_dwordx4 v214,s[28:31],s48 offen offset:2048 nt lds
mf v[136:139],a[228:231],v[96:99],v[136:139]
s_waitcnt lgkmcnt(8)
v_add_u32 v204,0x10000,v204
trr a[224:225],v203,0
trr a[226:227],v203,2048
mf v[160:163],v[168:171],v[104:107],v[160:163]
mf v[128:131],a[232:235],v[104:107],v[128:131]
trr a[228:229],v204,0
trr a[230:231],v204,2048
mf v[136:139],a[236:239],v[104:107],v[136:139]
s_waitcnt lgkmcnt(8)
trr a[232:233],v203,4096
trr a[234:235],v203,6144
buffer_load_dwordx4 v215,s[28:31],s48 offen offset:3072 nt lds
mf v[160:163],v[168:171],v[112:115],v[160:163]
mf v[128:131],a[240:243],v[112:115],v[128:131]
trr a[236:237],v204,4096
trr a[238:239],v204,6144
mf v[136:139],a[244:247],v[112:115],v[136:139]
s_waitcnt lgkmcnt(8)
trr a[240:241],v203,8192
trr a[242:243],v203,10240
mf v[160:163],v[168:171],v[120:123],v[160:163]
mf v[128:131],a[248:251],v[120:123],v[128:131]
trr a[244:245],v204,8192
trr a[246:247],v204,10240
mf v[136:139],a[252:255],v[120:123],v[136:139]
s_waitcnt lgkmcnt(8)
trr a[248:249],v203,12288
trr a[250:251],v203,14336
mf v[144:147],a[224:227],v[96:99],v[144:147]
trr a[252:253],v204,12288
trr a[254:255],v204,14336
mf v[152:155],a[228:231],v[96:99],v[152:155]
s_waitcnt lgkmcnt(8)
s_barrier
trr a[224:225],v201,32768
trr a[226:227],v201,34816
v_rcp_f32 v224,v160
mf v[144:147],a[232:235],v[104:107],v[144:147]
trr a[228:229],v202,32768
trr a[230:231],v202,34816
v_mul_f32 v128,v128,v224
v_mul_f32 v129,v129,v224
v_mul_f32 v130,v130,v224
mf v[152:155],a[236:239],v[104:107],v[152:155]
s_waitcnt lgkmcnt(8)
trr a[232:233],v203,32768
trr a[234:235],v203,34816
v_mul_f32 v131,v131,v224
v_mul_f32 v136,v136,v224
mf v[144:147],a[240:243],v[112:115],v[144:147]
trr a[236:237],v204,32768
trr a[238:239],v204,34816
v_mul_f32 v137,v137,v224
v_mul_f32 v138,v138,v224
v_mul_f32 v139,v139,v224
mf v[152:155],a[244:247],v[112:115],v[152:155]
s_waitcnt lgkmcnt(8)
trr a[240:241],v201,36864
trr a[242:243],v201,38912
cvp v128,v128,v129
cvp v129,v130,v131
mf v[144:147],a[248:251],v[120:123],v[144:147]
trr a[244:245],v202,36864
trr a[246:247],v202,38912
cvp v130,v136,v137
cvp v131,v138,v139
mf v[152:155],a[252:255],v[120:123],v[152:155]
s_waitcnt lgkmcnt(8)
trr a[248:249],v203,36864
trr a[250:251],v203,38912
mf a[0:3],a[224:227],v[128:131],0
trr a[252:253],v204,36864
trr a[254:255],v204,38912
v_mul_f32 v144,v144,v224
v_mul_f32 v145,v145,v224
v_mul_f32 v146,v146,v224
v_mul_f32 v147,v147,v224
mf a[8:11],a[228:231],v[128:131],0
s_waitcnt lgkmcnt(8)
trr a[224:225],v201,40960
trr a[226:227],v201,43008
v_mul_f32 v152,v152,v224
v_mul_f32 v153,v153,v224
v_mul_f32 v154,v154,v224
v_mul_f32 v155,v155,v224
mf a[16:19],a[232:235],v[128:131],0
trr a[228:229],v202,40960
trr a[230:231],v202,43008
cvp v136,v144,v145
cvp v137,v146,v147
cvp v138,v152,v153
cvp v139,v154,v155
mf a[24:27],a[236:239],v[128:131],0
s_waitcnt lgkmcnt(8)
trr a[232:233],v203,40960
trr a[234:235],v203,43008
mf a[0:3],a[240:243],v[136:139],a[0:3]
trr a[236:237],v204,40960
trr a[238:239],v204,43008
v_mov_b32 v234,0x49800000
v_cmp_nlt_f32 vcc,v160,v234
s_nop 3
s_mov_b64 s[56:57],vcc
s_cbranch_vccz L_safe_ok_w3
s_lshl_b32 s56,s55,4
s_add_u32 s56,s56,s54
v_mov_b32 v234,s56
v_mov_b32 v235,2
global_store_byte v234,v235,s[16:17] sc1
s_waitcnt vmcnt(0)
L_safe_ok_w3:
mf a[8:11],a[244:247],v[136:139],a[8:11]
s_waitcnt lgkmcnt(8)
trr a[240:241],v201,45056
trr a[242:243],v201,47104
mf a[16:19],a[248:251],v[136:139],a[16:19]
trr a[244:245],v202,45056
trr a[246:247],v202,47104
mf a[24:27],a[252:255],v[136:139],a[24:27]
s_waitcnt lgkmcnt(8)
trr a[248:249],v203,45056
trr a[250:251],v203,47104
mf a[32:35],a[224:227],v[128:131],0
v_add_u32 v201,0xffff0000,v201
trr a[252:253],v204,45056
trr a[254:255],v204,47104
mf a[40:43],a[228:231],v[128:131],0
s_waitcnt lgkmcnt(8)
s_barrier
v_add_u32 v202,0xffff0000,v202
trr a[224:225],v201,0
trr a[226:227],v201,2048
mf a[48:51],a[232:235],v[128:131],0
v_add_u32 v203,0xffff0000,v203
trr a[228:229],v202,0
trr a[230:231],v202,2048
s_add_u32 m0,s61,32768
s_add_u32 s48,s53,s92
s_add_u32 s48,s48,57344
buffer_load_dwordx4 v216,s[36:39],s48 offen lds
s_lshl_b32 s56,s55,4
s_add_u32 s56,s56,s54
v_mov_b32 v235,s56
global_load_ubyte v234,v235,s[16:17] sc1
mf a[56:59],a[236:239],v[128:131],0
s_waitcnt lgkmcnt(8)
v_add_u32 v204,0xffff0000,v204
trr a[232:233],v203,0
trr a[234:235],v203,2048
mf a[32:35],a[240:243],v[136:139],a[32:35]
trr a[236:237],v204,0
trr a[238:239],v204,2048
buffer_load_dwordx4 v217,s[36:39],s48 offen offset:1024 lds
mf a[40:43],a[244:247],v[136:139],a[40:43]
s_waitcnt lgkmcnt(8)
trr a[240:241],v201,4096
trr a[242:243],v201,6144
mf a[48:51],a[248:251],v[136:139],a[48:51]
trr a[244:245],v202,4096
trr a[246:247],v202,6144
s_add_u32 m0,s61,40960
s_add_u32 s48,s53,s93
s_add_u32 s48,s48,57344
buffer_load_dwordx4 v216,s[36:39],s48 offen lds
mf a[56:59],a[252:255],v[136:139],a[56:59]
s_waitcnt lgkmcnt(8)
trr a[248:249],v203,4096
trr a[250:251],v203,6144
mf a[64:67],a[224:227],v[128:131],0
trr a[252:253],v204,4096
trr a[254:255],v204,6144
buffer_load_dwordx4 v217,s[36:39],s48 offen offset:1024 lds
mf a[72:75],a[228:231],v[128:131],0
s_waitcnt lgkmcnt(8)
trr a[224:225],v201,8192
trr a[226:227],v201,10240
mf a[80:83],a[232:235],v[128:131],0
trr a[228:229],v202,8192
trr a[230:231],v202,10240
s_add_u32 m0,s49,65536
s_add_u32 s48,s51,131200
buffer_load_dwordx4 v212,s[28:31],s48 offen nt lds
mf a[88:91],a[236:239],v[128:131],0
s_waitcnt lgkmcnt(8)
trr a[232:233],v203,8192
trr a[234:235],v203,10240
mf a[64:67],a[240:243],v[136:139],a[64:67]
trr a[236:237],v204,8192
trr a[238:239],v204,10240
buffer_load_dwordx4 v213,s[28:31],s48 offen offset:1024 nt lds
mf a[72:75],a[244:247],v[136:139],a[72:75]
s_waitcnt lgkmcnt(8)
trr a[240:241],v201,12288
trr a[242:243],v201,14336
mf a[80:83],a[248:251],v[136:139],a[80:83]
trr a[244:245],v202,12288
trr a[246:247],v202,14336
buffer_load_dwordx4 v214,s[28:31],s48 offen offset:2048 nt lds
mf a[88:91],a[252:255],v[136:139],a[88:91]
s_waitcnt lgkmcnt(8)
trr a[248:249],v203,12288
trr a[250:251],v203,14336
mf a[96:99],a[224:227],v[128:131],0
trr a[252:253],v204,12288
trr a[254:255],v204,14336
buffer_load_dwordx4 v215,s[28:31],s48 offen offset:3072 nt lds
mf a[104:107],a[228:231],v[128:131],0
s_waitcnt lgkmcnt(8)
s_barrier
trr a[224:225],v201,49152
trr a[226:227],v201,51200
mf a[112:115],a[232:235],v[128:131],0
trr a[228:229],v202,49152
trr a[230:231],v202,51200
mf a[120:123],a[236:239],v[128:131],0
s_waitcnt lgkmcnt(8)
trr a[232:233],v203,49152
trr a[234:235],v203,51200
mf a[96:99],a[240:243],v[136:139],a[96:99]
trr a[236:237],v204,49152
trr a[238:239],v204,51200
mf a[104:107],a[244:247],v[136:139],a[104:107]
s_waitcnt lgkmcnt(8)
trr a[240:241],v201,53248
trr a[242:243],v201,55296
mf a[112:115],a[248:251],v[136:139],a[112:115]
trr a[244:245],v202,53248
trr a[246:247],v202,55296
mf a[120:123],a[252:255],v[136:139],a[120:123]
s_waitcnt lgkmcnt(8)
trr a[248:249],v203,53248
trr a[250:251],v203,55296
mf a[128:131],a[224:227],v[128:131],0
trr a[252:253],v204,53248
trr a[254:255],v204,55296
mf a[136:139],a[228:231],v[128:131],0
s_waitcnt lgkmcnt(8)
trr a[224:225],v201,57344
trr a[226:227],v201,59392
mf a[144:147],a[232:235],v[128:131],0
trr a[228:229],v202,57344
trr a[230:231],v202,59392
mf a[152:155],a[236:239],v[128:131],0
s_waitcnt lgkmcnt(8)
trr a[232:233],v203,57344
trr a[234:235],v203,59392
mf a[128:131],a[240:243],v[136:139],a[128:131]
trr a[236:237],v204,57344
trr a[238:239],v204,59392
mf a[136:139],a[244:247],v[136:139],a[136:139]
s_waitcnt lgkmcnt(8)
trr a[240:241],v201,61440
trr a[242:243],v201,63488
mf a[144:147],a[248:251],v[136:139],a[144:147]
trr a[244:245],v202,61440
trr a[246:247],v202,63488
mf a[152:155],a[252:255],v[136:139],a[152:155]
s_waitcnt lgkmcnt(8)
trr a[248:249],v203,61440
trr a[250:251],v203,63488
mf a[160:163],a[224:227],v[128:131],0
trr a[252:253],v204,61440
trr a[254:255],v204,63488
mf a[168:171],a[228:231],v[128:131],0
s_waitcnt lgkmcnt(8)
s_waitcnt vmcnt(17)
s_barrier
trr a[224:225],v201,16384
trr a[226:227],v201,18432
mf a[176:179],a[232:235],v[128:131],0
trr a[228:229],v202,16384
trr a[230:231],v202,18432
mf a[184:187],a[236:239],v[128:131],0
s_waitcnt lgkmcnt(8)
trr a[232:233],v203,16384
trr a[234:235],v203,18432
mf a[160:163],a[240:243],v[136:139],a[160:163]
trr a[236:237],v204,16384
trr a[238:239],v204,18432
mf a[168:171],a[244:247],v[136:139],a[168:171]
s_waitcnt lgkmcnt(8)
trr a[240:241],v201,20480
trr a[242:243],v201,22528
mf a[176:179],a[248:251],v[136:139],a[176:179]
trr a[244:245],v202,20480
trr a[246:247],v202,22528
mf a[184:187],a[252:255],v[136:139],a[184:187]
s_waitcnt lgkmcnt(8)
trr a[248:249],v203,20480
trr a[250:251],v203,22528
mf a[192:195],a[224:227],v[128:131],0
v_add_u32 v201,0x10000,v201
trr a[252:253],v204,20480
trr a[254:255],v204,22528
mf a[200:203],a[228:231],v[128:131],0
s_waitcnt lgkmcnt(8)
s_waitcnt vmcnt(13)
s_barrier
v_add_u32 v202,0x10000,v202
trr a[224:225],v201,16384
trr a[226:227],v201,18432
mf a[208:211],a[232:235],v[128:131],0
v_add_u32 v203,0x10000,v203
trr a[228:229],v202,16384
trr a[230:231],v202,18432
s_add_u32 m0,s61,0
s_add_u32 s48,s53,s94
s_add_u32 s48,s48,57344
buffer_load_dwordx4 v216,s[36:39],s48 offen lds
mf a[216:219],a[236:239],v[128:131],0
s_waitcnt lgkmcnt(8)
v_add_u32 v204,0x10000,v204
trr a[232:233],v203,16384
trr a[234:235],v203,18432
mf a[192:195],a[240:243],v[136:139],a[192:195]
trr a[236:237],v204,16384
trr a[238:239],v204,18432
buffer_load_dwordx4 v217,s[36:39],s48 offen offset:1024 lds
mf a[200:203],a[244:247],v[136:139],a[200:203]
s_waitcnt lgkmcnt(8)
trr a[240:241],v201,20480
trr a[242:243],v201,22528
mf a[208:211],a[248:251],v[136:139],a[208:211]
trr a[244:245],v202,20480
trr a[246:247],v202,22528
s_add_u32 m0,s61,8192
s_add_u32 s48,s53,s95
s_add_u32 s48,s48,57344
buffer_load_dwordx4 v216,s[36:39],s48 offen lds
mf a[216:219],a[252:255],v[136:139],a[216:219]
s_waitcnt lgkmcnt(8)
trr a[248:249],v203,20480
trr a[250:251],v203,22528
mf v[128:131],a[224:227],v[0:3],0
trr a[252:253],v204,20480
trr a[254:255],v204,22528
buffer_load_dwordx4 v217,s[36:39],s48 offen offset:1024 lds
mf v[136:139],a[228:231],v[0:3],0
s_waitcnt lgkmcnt(8)
trr a[224:225],v201,24576
trr a[226:227],v201,26624
mf v[144:147],a[232:235],v[0:3],0
trr a[228:229],v202,24576
trr a[230:231],v202,26624
s_add_u32 m0,s49,49152
s_add_u32 s48,s51,196736
buffer_load_dwordx4 v212,s[28:31],s48 offen nt lds
mf v[152:155],a[236:239],v[0:3],0
s_waitcnt lgkmcnt(8)
trr a[232:233],v203,24576
trr a[234:235],v203,26624
mf v[128:131],a[240:243],v[8:11],v[128:131]
trr a[236:237],v204,24576
trr a[238:239],v204,26624
buffer_load_dwordx4 v213,s[28:31],s48 offen offset:1024 nt lds
mf v[136:139],a[244:247],v[8:11],v[136:139]
s_waitcnt lgkmcnt(8)
trr a[240:241],v201,28672
trr a[242:243],v201,30720
mf v[144:147],a[248:251],v[8:11],v[144:147]
trr a[244:245],v202,28672
trr a[246:247],v202,30720
buffer_load_dwordx4 v214,s[28:31],s48 offen offset:2048 nt lds
mf v[152:155],a[252:255],v[8:11],v[152:155]
s_waitcnt lgkmcnt(8)
trr a[248:249],v203,28672
trr a[250:251],v203,30720
mf v[128:131],a[224:227],v[16:19],v[128:131]
trr a[252:253],v204,28672
trr a[254:255],v204,30720
buffer_load_dwordx4 v215,s[28:31],s48 offen offset:3072 nt lds
mf v[136:139],a[228:231],v[16:19],v[136:139]
s_waitcnt lgkmcnt(8)
s_waitcnt vmcnt(17)
s_barrier
trr a[224:225],v201,49152
trr a[226:227],v201,51200
mf v[144:147],a[232:235],v[16:19],v[144:147]
trr a[228:229],v202,49152
trr a[230:231],v202,51200
mf v[152:155],a[236:239],v[16:19],v[152:155]
s_waitcnt lgkmcnt(8)
trr a[232:233],v203,49152
trr a[234:235],v203,51200
mf v[128:131],a[240:243],v[24:27],v[128:131]
trr a[236:237],v204,49152
trr a[238:239],v204,51200
mf v[136:139],a[244:247],v[24:27],v[136:139]
s_waitcnt lgkmcnt(8)
trr a[240:241],v201,53248
trr a[242:243],v201,55296
mf v[144:147],a[248:251],v[24:27],v[144:147]
trr a[244:245],v202,53248
trr a[246:247],v202,55296
mf v[152:155],a[252:255],v[24:27],v[152:155]
s_waitcnt lgkmcnt(8)
trr a[248:249],v203,53248
trr a[250:251],v203,55296
mf v[128:131],a[224:227],v[32:35],v[128:131]
trr a[252:253],v204,53248
trr a[254:255],v204,55296
mf v[136:139],a[228:231],v[32:35],v[136:139]
s_waitcnt lgkmcnt(8)
trr a[224:225],v201,57344
trr a[226:227],v201,59392
mf v[144:147],a[232:235],v[32:35],v[144:147]
trr a[228:229],v202,57344
trr a[230:231],v202,59392
mf v[152:155],a[236:239],v[32:35],v[152:155]
s_waitcnt lgkmcnt(8)
trr a[232:233],v203,57344
trr a[234:235],v203,59392
mf v[128:131],a[240:243],v[40:43],v[128:131]
trr a[236:237],v204,57344
trr a[238:239],v204,59392
mf v[136:139],a[244:247],v[40:43],v[136:139]
s_waitcnt lgkmcnt(8)
trr a[240:241],v201,61440
trr a[242:243],v201,63488
mf v[144:147],a[248:251],v[40:43],v[144:147]
trr a[244:245],v202,61440
trr a[246:247],v202,63488
mf v[152:155],a[252:255],v[40:43],v[152:155]
s_waitcnt lgkmcnt(8)
trr a[248:249],v203,61440
trr a[250:251],v203,63488
mf v[128:131],a[224:227],v[48:51],v[128:131]
trr a[252:253],v204,61440
trr a[254:255],v204,63488
mf v[136:139],a[228:231],v[48:51],v[136:139]
s_waitcnt lgkmcnt(8)
s_waitcnt vmcnt(8)
s_barrier
trr a[224:225],v201,0
trr a[226:227],v201,2048
mf v[144:147],a[232:235],v[48:51],v[144:147]
trr a[228:229],v202,0
trr a[230:231],v202,2048
s_add_u32 m0,s61,16384
s_add_u32 s48,s53,s96
s_add_u32 s48,s48,57344
buffer_load_dwordx4 v216,s[36:39],s48 offen lds
mf v[152:155],a[236:239],v[48:51],v[152:155]
s_waitcnt lgkmcnt(8)
trr a[232:233],v203,0
trr a[234:235],v203,2048
mf v[128:131],a[240:243],v[56:59],v[128:131]
trr a[236:237],v204,0
trr a[238:239],v204,2048
buffer_load_dwordx4 v217,s[36:39],s48 offen offset:1024 lds
mf v[136:139],a[244:247],v[56:59],v[136:139]
s_waitcnt lgkmcnt(8)
trr a[240:241],v201,4096
trr a[242:243],v201,6144
mf v[144:147],a[248:251],v[56:59],v[144:147]
trr a[244:245],v202,4096
trr a[246:247],v202,6144
s_add_u32 m0,s61,24576
s_add_u32 s48,s53,s97
s_add_u32 s48,s48,57344
buffer_load_dwordx4 v216,s[36:39],s48 offen lds
mf v[152:155],a[252:255],v[56:59],v[152:155]
s_waitcnt lgkmcnt(8)
trr a[248:249],v203,4096
trr a[250:251],v203,6144
mf v[128:131],a[224:227],v[64:67],v[128:131]
trr a[252:253],v204,4096
trr a[254:255],v204,6144
buffer_load_dwordx4 v217,s[36:39],s48 offen offset:1024 lds
mf v[136:139],a[228:231],v[64:67],v[136:139]
s_waitcnt lgkmcnt(8)
trr a[224:225],v201,8192
trr a[226:227],v201,10240
mf v[144:147],a[232:235],v[64:67],v[144:147]
trr a[228:229],v202,8192
trr a[230:231],v202,10240
s_add_u32 m0,s49,81920
s_add_u32 s48,s51,256
buffer_load_dwordx4 v212,s[28:31],s48 offen nt lds
mf v[152:155],a[236:239],v[64:67],v[152:155]
s_waitcnt lgkmcnt(8)
trr a[232:233],v203,8192
trr a[234:235],v203,10240
mf v[128:131],a[240:243],v[72:75],v[128:131]
trr a[236:237],v204,8192
trr a[238:239],v204,10240
buffer_load_dwordx4 v213,s[28:31],s48 offen offset:1024 nt lds
mf v[136:139],a[244:247],v[72:75],v[136:139]
s_waitcnt lgkmcnt(8)
trr a[240:241],v201,12288
trr a[242:243],v201,14336
mf v[144:147],a[248:251],v[72:75],v[144:147]
trr a[244:245],v202,12288
trr a[246:247],v202,14336
buffer_load_dwordx4 v214,s[28:31],s48 offen offset:2048 nt lds
mf v[152:155],a[252:255],v[72:75],v[152:155]
s_waitcnt lgkmcnt(8)
trr a[248:249],v203,12288
trr a[250:251],v203,14336
mf v[128:131],a[224:227],v[80:83],v[128:131]
v_add_u32 v201,0xffff0000,v201
trr a[252:253],v204,12288
trr a[254:255],v204,14336
buffer_load_dwordx4 v215,s[28:31],s48 offen offset:3072 nt lds
mf v[136:139],a[228:231],v[80:83],v[136:139]
s_waitcnt lgkmcnt(8)
s_waitcnt vmcnt(8)
s_barrier
v_add_u32 v202,0xffff0000,v202
trr a[224:225],v201,49152
trr a[226:227],v201,51200
mf v[144:147],a[232:235],v[80:83],v[144:147]
trr a[228:229],v202,49152
trr a[230:231],v202,51200
s_add_u32 m0,s61,98304
s_add_u32 s48,s53,s98
s_add_u32 s48,s48,57344
buffer_load_dwordx4 v216,s[36:39],s48 offen lds
mf v[152:155],a[236:239],v[80:83],v[152:155]
s_waitcnt lgkmcnt(8)
trr a[232:233],v201,53248
trr a[234:235],v201,55296
mf v[128:131],a[240:243],v[88:91],v[128:131]
trr a[236:237],v202,53248
trr a[238:239],v202,55296
mf v[136:139],a[244:247],v[88:91],v[136:139]
s_waitcnt lgkmcnt(8)
trr a[240:241],v201,57344
trr a[242:243],v201,59392
buffer_load_dwordx4 v217,s[36:39],s48 offen offset:1024 lds
mf v[144:147],a[248:251],v[88:91],v[144:147]
trr a[244:245],v202,57344
trr a[246:247],v202,59392
mf v[152:155],a[252:255],v[88:91],v[152:155]
s_waitcnt lgkmcnt(8)
trr a[248:249],v201,61440
trr a[250:251],v201,63488
mf v[128:131],a[224:227],v[96:99],v[128:131]
v_add_u32 v203,0xffff0000,v203
trr a[252:253],v202,61440
trr a[254:255],v202,63488
mf v[136:139],a[228:231],v[96:99],v[136:139]
s_waitcnt lgkmcnt(8)
v_add_u32 v204,0xffff0000,v204
trr a[224:225],v203,49152
trr a[226:227],v203,51200
mf v[128:131],a[232:235],v[104:107],v[128:131]
trr a[228:229],v204,49152
trr a[230:231],v204,51200
mf v[136:139],a[236:239],v[104:107],v[136:139]
s_waitcnt lgkmcnt(8)
trr a[232:233],v203,53248
trr a[234:235],v203,55296
mf v[128:131],a[240:243],v[112:115],v[128:131]
trr a[236:237],v204,53248
trr a[238:239],v204,55296
mf v[136:139],a[244:247],v[112:115],v[136:139]
s_waitcnt lgkmcnt(8)
trr a[240:241],v203,57344
trr a[242:243],v203,59392
mf v[128:131],a[248:251],v[120:123],v[128:131]
trr a[244:245],v204,57344
trr a[246:247],v204,59392
mf v[136:139],a[252:255],v[120:123],v[136:139]
s_waitcnt lgkmcnt(8)
trr a[248:249],v203,61440
trr a[250:251],v203,63488
mf v[144:147],a[224:227],v[96:99],v[144:147]
trr a[252:253],v204,61440
trr a[254:255],v204,63488
mf v[152:155],a[228:231],v[96:99],v[152:155]
s_waitcnt lgkmcnt(8)
s_barrier
trr a[224:225],v201,32768
trr a[226:227],v201,34816
mf v[144:147],a[232:235],v[104:107],v[144:147]
trr a[228:229],v202,32768
trr a[230:231],v202,34816
s_add_u32 m0,s49,65536
s_add_u32 s48,s51,65792
buffer_load_dwordx4 v212,s[28:31],s48 offen nt lds
v_mul_f32 v128,v128,v224
v_mul_f32 v129,v129,v224
v_mul_f32 v130,v130,v224
mf v[152:155],a[236:239],v[104:107],v[152:155]
s_waitcnt lgkmcnt(8)
trr a[232:233],v203,32768
trr a[234:235],v203,34816
v_mul_f32 v131,v131,v224
v_mul_f32 v136,v136,v224
mf v[144:147],a[240:243],v[112:115],v[144:147]
trr a[236:237],v204,32768
trr a[238:239],v204,34816
v_mul_f32 v137,v137,v224
v_mul_f32 v138,v138,v224
v_mul_f32 v139,v139,v224
mf v[152:155],a[244:247],v[112:115],v[152:155]
s_waitcnt lgkmcnt(8)
trr a[240:241],v201,36864
trr a[242:243],v201,38912
buffer_load_dwordx4 v213,s[28:31],s48 offen offset:1024 nt lds
cvp v128,v128,v129
cvp v129,v130,v131
mf v[144:147],a[248:251],v[120:123],v[144:147]
trr a[244:245],v202,36864
trr a[246:247],v202,38912
cvp v130,v136,v137
cvp v131,v138,v139
mf v[152:155],a[252:255],v[120:123],v[152:155]
s_waitcnt lgkmcnt(8)
trr a[248:249],v203,36864
trr a[250:251],v203,38912
mf a[0:3],a[224:227],v[128:131],a[0:3]
trr a[252:253],v204,36864
trr a[254:255],v204,38912
buffer_load_dwordx4 v214,s[28:31],s48 offen offset:2048 nt lds
v_mul_f32 v144,v144,v224
v_mul_f32 v145,v145,v224
v_mul_f32 v146,v146,v224
v_mul_f32 v147,v147,v224
mf a[8:11],a[228:231],v[128:131],a[8:11]
s_waitcnt lgkmcnt(8)
trr a[224:225],v201,40960
trr a[226:227],v201,43008
v_mul_f32 v152,v152,v224
v_mul_f32 v153,v153,v224
v_mul_f32 v154,v154,v224
v_mul_f32 v155,v155,v224
mf a[16:19],a[232:235],v[128:131],a[16:19]
trr a[228:229],v202,40960
trr a[230:231],v202,43008
cvp v136,v144,v145
cvp v137,v146,v147
cvp v138,v152,v153
cvp v139,v154,v155
mf a[24:27],a[236:239],v[128:131],a[24:27]
s_waitcnt lgkmcnt(8)
trr a[232:233],v203,40960
trr a[234:235],v203,43008
buffer_load_dwordx4 v215,s[28:31],s48 offen offset:3072 nt lds
mf a[0:3],a[240:243],v[136:139],a[0:3]
trr a[236:237],v204,40960
trr a[238:239],v204,43008
mf a[8:11],a[244:247],v[136:139],a[8:11]
s_waitcnt lgkmcnt(8)
trr a[240:241],v201,45056
trr a[242:243],v201,47104
mf a[16:19],a[248:251],v[136:139],a[16:19]
trr a[244:245],v202,45056
trr a[246:247],v202,47104
mf a[24:27],a[252:255],v[136:139],a[24:27]
s_waitcnt lgkmcnt(8)
trr a[248:249],v203,45056
trr a[250:251],v203,47104
mf a[32:35],a[224:227],v[128:131],a[32:35]
trr a[252:253],v204,45056
trr a[254:255],v204,47104
mf a[40:43],a[228:231],v[128:131],a[40:43]
s_waitcnt lgkmcnt(8)
s_barrier
trr a[224:225],v201,0
trr a[226:227],v201,2048
mf a[48:51],a[232:235],v[128:131],a[48:51]
trr a[228:229],v202,0
trr a[230:231],v202,2048
s_add_u32 m0,s61,49152
s_add_u32 s48,s53,s92
s_add_u32 s48,s48,114688
buffer_load_dwordx4 v216,s[36:39],s48 offen lds
mf a[56:59],a[236:239],v[128:131],a[56:59]
s_waitcnt lgkmcnt(8)
trr a[232:233],v203,0
trr a[234:235],v203,2048
mf a[32:35],a[240:243],v[136:139],a[32:35]
trr a[236:237],v204,0
trr a[238:239],v204,2048
buffer_load_dwordx4 v217,s[36:39],s48 offen offset:1024 lds
mf a[40:43],a[244:247],v[136:139],a[40:43]
s_waitcnt lgkmcnt(8)
trr a[240:241],v201,4096
trr a[242:243],v201,6144
mf a[48:51],a[248:251],v[136:139],a[48:51]
trr a[244:245],v202,4096
trr a[246:247],v202,6144
s_add_u32 m0,s61,57344
s_add_u32 s48,s53,s93
s_add_u32 s48,s48,114688
buffer_load_dwordx4 v216,s[36:39],s48 offen lds
mf a[56:59],a[252:255],v[136:139],a[56:59]
s_waitcnt lgkmcnt(8)
trr a[248:249],v203,4096
trr a[250:251],v203,6144
mf a[64:67],a[224:227],v[128:131],a[64:67]
trr a[252:253],v204,4096
trr a[254:255],v204,6144
buffer_load_dwordx4 v217,s[36:39],s48 offen offset:1024 lds
mf a[72:75],a[228:231],v[128:131],a[72:75]
s_waitcnt lgkmcnt(8)
trr a[224:225],v201,8192
trr a[226:227],v201,10240
mf a[80:83],a[232:235],v[128:131],a[80:83]
trr a[228:229],v202,8192
trr a[230:231],v202,10240
s_add_u32 m0,s49,114688
s_add_u32 s48,s51,131328
buffer_load_dwordx4 v212,s[28:31],s48 offen nt lds
mf a[88:91],a[236:239],v[128:131],a[88:91]
s_waitcnt lgkmcnt(8)
trr a[232:233],v203,8192
trr a[234:235],v203,10240
mf a[64:67],a[240:243],v[136:139],a[64:67]
trr a[236:237],v204,8192
trr a[238:239],v204,10240
buffer_load_dwordx4 v213,s[28:31],s48 offen offset:1024 nt lds
mf a[72:75],a[244:247],v[136:139],a[72:75]
s_waitcnt lgkmcnt(8)
trr a[240:241],v201,12288
trr a[242:243],v201,14336
mf a[80:83],a[248:251],v[136:139],a[80:83]
trr a[244:245],v202,12288
trr a[246:247],v202,14336
buffer_load_dwordx4 v214,s[28:31],s48 offen offset:2048 nt lds
mf a[88:91],a[252:255],v[136:139],a[88:91]
s_waitcnt lgkmcnt(8)
trr a[248:249],v203,12288
trr a[250:251],v203,14336
mf a[96:99],a[224:227],v[128:131],a[96:99]
trr a[252:253],v204,12288
trr a[254:255],v204,14336
buffer_load_dwordx4 v215,s[28:31],s48 offen offset:3072 nt lds
mf a[104:107],a[228:231],v[128:131],a[104:107]
s_waitcnt lgkmcnt(8)
s_waitcnt vmcnt(18)
s_barrier
trr a[224:225],v201,16384
trr a[226:227],v201,18432
mf a[112:115],a[232:235],v[128:131],a[112:115]
trr a[228:229],v202,16384
trr a[230:231],v202,18432
mf a[120:123],a[236:239],v[128:131],a[120:123]
s_waitcnt lgkmcnt(8)
trr a[232:233],v203,16384
trr a[234:235],v203,18432
mf a[96:99],a[240:243],v[136:139],a[96:99]
trr a[236:237],v204,16384
trr a[238:239],v204,18432
mf a[104:107],a[244:247],v[136:139],a[104:107]
s_waitcnt lgkmcnt(8)
trr a[240:241],v201,20480
trr a[242:243],v201,22528
mf a[112:115],a[248:251],v[136:139],a[112:115]
trr a[244:245],v202,20480
trr a[246:247],v202,22528
mf a[120:123],a[252:255],v[136:139],a[120:123]
s_waitcnt lgkmcnt(8)
trr a[248:249],v203,20480
trr a[250:251],v203,22528
mf a[128:131],a[224:227],v[128:131],a[128:131]
trr a[252:253],v204,20480
trr a[254:255],v204,22528
mf a[136:139],a[228:231],v[128:131],a[136:139]
s_waitcnt lgkmcnt(8)
trr a[224:225],v201,24576
trr a[226:227],v201,26624
mf a[144:147],a[232:235],v[128:131],a[144:147]
trr a[228:229],v202,24576
trr a[230:231],v202,26624
mf a[152:155],a[236:239],v[128:131],a[152:155]
s_waitcnt lgkmcnt(8)
trr a[232:233],v203,24576
trr a[234:235],v203,26624
mf a[128:131],a[240:243],v[136:139],a[128:131]
trr a[236:237],v204,24576
trr a[238:239],v204,26624
mf a[136:139],a[244:247],v[136:139],a[136:139]
s_waitcnt lgkmcnt(8)
trr a[240:241],v201,28672
trr a[242:243],v201,30720
mf a[144:147],a[248:251],v[136:139],a[144:147]
trr a[244:245],v202,28672
trr a[246:247],v202,30720
mf a[152:155],a[252:255],v[136:139],a[152:155]
s_waitcnt lgkmcnt(8)
trr a[248:249],v203,28672
trr a[250:251],v203,30720
mf a[160:163],a[224:227],v[128:131],a[160:163]
v_add_u32 v201,0x10000,v201
trr a[252:253],v204,28672
trr a[254:255],v204,30720
mf a[168:171],a[228:231],v[128:131],a[168:171]
s_waitcnt lgkmcnt(8)
s_waitcnt vmcnt(12)
s_barrier
v_add_u32 v202,0x10000,v202
trr a[224:225],v201,32768
trr a[226:227],v201,34816
mf a[176:179],a[232:235],v[128:131],a[176:179]
v_add_u32 v203,0x10000,v203
trr a[228:229],v202,32768
trr a[230:231],v202,34816
s_add_u32 m0,s61,0
s_add_u32 s48,s53,s94
s_add_u32 s48,s48,114688
buffer_load_dwordx4 v216,s[36:39],s48 offen lds
mf a[184:187],a[236:239],v[128:131],a[184:187]
s_waitcnt lgkmcnt(8)
v_add_u32 v204,0x10000,v204
trr a[232:233],v203,32768
trr a[234:235],v203,34816
mf a[160:163],a[240:243],v[136:139],a[160:163]
trr a[236:237],v204,32768
trr a[238:239],v204,34816
buffer_load_dwordx4 v217,s[36:39],s48 offen offset:1024 lds
mf a[168:171],a[244:247],v[136:139],a[168:171]
s_waitcnt lgkmcnt(8)
trr a[240:241],v201,36864
trr a[242:243],v201,38912
mf a[176:179],a[248:251],v[136:139],a[176:179]
trr a[244:245],v202,36864
trr a[246:247],v202,38912
s_add_u32 m0,s61,8192
s_add_u32 s48,s53,s95
s_add_u32 s48,s48,114688
buffer_load_dwordx4 v216,s[36:39],s48 offen lds
mf a[184:187],a[252:255],v[136:139],a[184:187]
s_waitcnt lgkmcnt(8)
trr a[248:249],v203,36864
trr a[250:251],v203,38912
mf a[192:195],a[224:227],v[128:131],a[192:195]
trr a[252:253],v204,36864
trr a[254:255],v204,38912
buffer_load_dwordx4 v217,s[36:39],s48 offen offset:1024 lds
mf a[200:203],a[228:231],v[128:131],a[200:203]
s_waitcnt lgkmcnt(8)
s_barrier
trr a[224:225],v201,16384
trr a[226:227],v201,18432
mf a[208:211],a[232:235],v[128:131],a[208:211]
trr a[228:229],v202,16384
trr a[230:231],v202,18432
s_add_u32 m0,s49,16384
s_add_u32 s48,s51,196864
buffer_load_dwordx4 v212,s[28:31],s48 offen nt lds
mf a[216:219],a[236:239],v[128:131],a[216:219]
s_waitcnt lgkmcnt(8)
trr a[232:233],v203,16384
trr a[234:235],v203,18432
mf a[192:195],a[240:243],v[136:139],a[192:195]
trr a[236:237],v204,16384
trr a[238:239],v204,18432
mf a[200:203],a[244:247],v[136:139],a[200:203]
s_waitcnt lgkmcnt(8)
trr a[240:241],v201,20480
trr a[242:243],v201,22528
buffer_load_dwordx4 v213,s[28:31],s48 offen offset:1024 nt lds
mf a[208:211],a[248:251],v[136:139],a[208:211]
trr a[244:245],v202,20480
trr a[246:247],v202,22528
mf a[216:219],a[252:255],v[136:139],a[216:219]
s_waitcnt lgkmcnt(8)
trr a[248:249],v203,20480
trr a[250:251],v203,22528
mf v[128:131],a[224:227],v[0:3],0
trr a[252:253],v204,20480
trr a[254:255],v204,22528
buffer_load_dwordx4 v214,s[28:31],s48 offen offset:2048 nt lds
mf v[136:139],a[228:231],v[0:3],0
s_waitcnt lgkmcnt(8)
trr a[224:225],v201,24576
trr a[226:227],v201,26624
mf v[144:147],a[232:235],v[0:3],0
trr a[228:229],v202,24576
trr a[230:231],v202,26624
mf v[152:155],a[236:239],v[0:3],0
s_waitcnt lgkmcnt(8)
trr a[232:233],v203,24576
trr a[234:235],v203,26624
buffer_load_dwordx4 v215,s[28:31],s48 offen offset:3072 nt lds
mf v[128:131],a[240:243],v[8:11],v[128:131]
trr a[236:237],v204,24576
trr a[238:239],v204,26624
mf v[136:139],a[244:247],v[8:11],v[136:139]
s_waitcnt lgkmcnt(8)
trr a[240:241],v201,28672
trr a[242:243],v201,30720
mf v[144:147],a[248:251],v[8:11],v[144:147]
trr a[244:245],v202,28672
trr a[246:247],v202,30720
mf v[152:155],a[252:255],v[8:11],v[152:155]
s_waitcnt lgkmcnt(8)
trr a[248:249],v203,28672
trr a[250:251],v203,30720
mf v[128:131],a[224:227],v[16:19],v[128:131]
trr a[252:253],v204,28672
trr a[254:255],v204,30720
mf v[136:139],a[228:231],v[16:19],v[136:139]
s_waitcnt lgkmcnt(8)
s_waitcnt vmcnt(16)
s_barrier
trr a[224:225],v201,0
trr a[226:227],v201,2048
mf v[144:147],a[232:235],v[16:19],v[144:147]
trr a[228:229],v202,0
trr a[230:231],v202,2048
s_add_u32 m0,s61,32768
s_add_u32 s48,s53,s96
s_add_u32 s48,s48,114688
buffer_load_dwordx4 v216,s[36:39],s48 offen lds
mf v[152:155],a[236:239],v[16:19],v[152:155]
s_waitcnt lgkmcnt(8)
trr a[232:233],v203,0
trr a[234:235],v203,2048
mf v[128:131],a[240:243],v[24:27],v[128:131]
trr a[236:237],v204,0
trr a[238:239],v204,2048
mf v[136:139],a[244:247],v[24:27],v[136:139]
s_waitcnt lgkmcnt(8)
trr a[240:241],v201,4096
trr a[242:243],v201,6144
buffer_load_dwordx4 v217,s[36:39],s48 offen offset:1024 lds
mf v[144:147],a[248:251],v[24:27],v[144:147]
trr a[244:245],v202,4096
trr a[246:247],v202,6144
mf v[152:155],a[252:255],v[24:27],v[152:155]
s_waitcnt lgkmcnt(8)
trr a[248:249],v203,4096
trr a[250:251],v203,6144
mf v[128:131],a[224:227],v[32:35],v[128:131]
trr a[252:253],v204,4096
trr a[254:255],v204,6144
s_add_u32 m0,s61,40960
s_add_u32 s48,s53,s97
s_add_u32 s48,s48,114688
buffer_load_dwordx4 v216,s[36:39],s48 offen lds
mf v[136:139],a[228:231],v[32:35],v[136:139]
s_waitcnt lgkmcnt(8)
trr a[224:225],v201,8192
trr a[226:227],v201,10240
mf v[144:147],a[232:235],v[32:35],v[144:147]
trr a[228:229],v202,8192
trr a[230:231],v202,10240
mf v[152:155],a[236:239],v[32:35],v[152:155]
s_waitcnt lgkmcnt(8)
trr a[232:233],v203,8192
trr a[234:235],v203,10240
buffer_load_dwordx4 v217,s[36:39],s48 offen offset:1024 lds
mf v[128:131],a[240:243],v[40:43],v[128:131]
trr a[236:237],v204,8192
trr a[238:239],v204,10240
mf v[136:139],a[244:247],v[40:43],v[136:139]
s_waitcnt lgkmcnt(8)
trr a[240:241],v201,12288
trr a[242:243],v201,14336
mf v[144:147],a[248:251],v[40:43],v[144:147]
trr a[244:245],v202,12288
trr a[246:247],v202,14336
mf v[152:155],a[252:255],v[40:43],v[152:155]
s_waitcnt lgkmcnt(8)
trr a[248:249],v203,12288
trr a[250:251],v203,14336
mf v[128:131],a[224:227],v[48:51],v[128:131]
trr a[252:253],v204,12288
trr a[254:255],v204,14336
mf v[136:139],a[228:231],v[48:51],v[136:139]
s_waitcnt lgkmcnt(8)
s_waitcnt vmcnt(12)
s_barrier
trr a[224:225],v201,49152
trr a[226:227],v201,51200
mf v[144:147],a[232:235],v[48:51],v[144:147]
trr a[228:229],v202,49152
trr a[230:231],v202,51200
s_add_u32 m0,s49,81920
s_add_u32 s48,s51,384
buffer_load_dwordx4 v212,s[28:31],s48 offen nt lds
mf v[152:155],a[236:239],v[48:51],v[152:155]
s_waitcnt lgkmcnt(8)
trr a[232:233],v203,49152
trr a[234:235],v203,51200
mf v[128:131],a[240:243],v[56:59],v[128:131]
trr a[236:237],v204,49152
trr a[238:239],v204,51200
mf v[136:139],a[244:247],v[56:59],v[136:139]
s_waitcnt lgkmcnt(8)
trr a[240:241],v201,53248
trr a[242:243],v201,55296
buffer_load_dwordx4 v213,s[28:31],s48 offen offset:1024 nt lds
mf v[144:147],a[248:251],v[56:59],v[144:147]
trr a[244:245],v202,53248
trr a[246:247],v202,55296
mf v[152:155],a[252:255],v[56:59],v[152:155]
s_waitcnt lgkmcnt(8)
trr a[248:249],v203,53248
trr a[250:251],v203,55296
mf v[128:131],a[224:227],v[64:67],v[128:131]
trr a[252:253],v204,53248
trr a[254:255],v204,55296
buffer_load_dwordx4 v214,s[28:31],s48 offen offset:2048 nt lds
mf v[136:139],a[228:231],v[64:67],v[136:139]
s_waitcnt lgkmcnt(8)
trr a[224:225],v201,57344
trr a[226:227],v201,59392
mf v[144:147],a[232:235],v[64:67],v[144:147]
trr a[228:229],v202,57344
trr a[230:231],v202,59392
mf v[152:155],a[236:239],v[64:67],v[152:155]
s_waitcnt lgkmcnt(8)
trr a[232:233],v203,57344
trr a[234:235],v203,59392
buffer_load_dwordx4 v215,s[28:31],s48 offen offset:3072 nt lds
mf v[128:131],a[240:243],v[72:75],v[128:131]
trr a[236:237],v204,57344
trr a[238:239],v204,59392
mf v[136:139],a[244:247],v[72:75],v[136:139]
s_waitcnt lgkmcnt(8)
trr a[240:241],v201,61440
trr a[242:243],v201,63488
mf v[144:147],a[248:251],v[72:75],v[144:147]
trr a[244:245],v202,61440
trr a[246:247],v202,63488
mf v[152:155],a[252:255],v[72:75],v[152:155]
s_waitcnt lgkmcnt(8)
trr a[248:249],v203,61440
trr a[250:251],v203,63488
mf v[128:131],a[224:227],v[80:83],v[128:131]
v_add_u32 v201,0xffff0000,v201
trr a[252:253],v204,61440
trr a[254:255],v204,63488
mf v[136:139],a[228:231],v[80:83],v[136:139]
s_waitcnt lgkmcnt(8)
s_waitcnt vmcnt(8)
s_barrier
v_add_u32 v202,0xffff0000,v202
trr a[224:225],v201,16384
trr a[226:227],v201,18432
mf v[144:147],a[232:235],v[80:83],v[144:147]
trr a[228:229],v202,16384
trr a[230:231],v202,18432
s_add_u32 m0,s49,65536
s_add_u32 s48,s51,65920
buffer_load_dwordx4 v212,s[28:31],s48 offen nt lds
mf v[152:155],a[236:239],v[80:83],v[152:155]
s_waitcnt lgkmcnt(8)
trr a[232:233],v201,20480
trr a[234:235],v201,22528
mf v[128:131],a[240:243],v[88:91],v[128:131]
trr a[236:237],v202,20480
trr a[238:239],v202,22528
mf v[136:139],a[244:247],v[88:91],v[136:139]
s_waitcnt lgkmcnt(8)
trr a[240:241],v201,24576
trr a[242:243],v201,26624
buffer_load_dwordx4 v213,s[28:31],s48 offen offset:1024 nt lds
mf v[144:147],a[248:251],v[88:91],v[144:147]
trr a[244:245],v202,24576
trr a[246:247],v202,26624
mf v[152:155],a[252:255],v[88:91],v[152:155]
s_waitcnt lgkmcnt(8)
trr a[248:249],v201,28672
trr a[250:251],v201,30720
mf v[128:131],a[224:227],v[96:99],v[128:131]
v_add_u32 v203,0xffff0000,v203
trr a[252:253],v202,28672
trr a[254:255],v202,30720
buffer_load_dwordx4 v214,s[28:31],s48 offen offset:2048 nt lds
mf v[136:139],a[228:231],v[96:99],v[136:139]
s_waitcnt lgkmcnt(8)
v_add_u32 v204,0xffff0000,v204
trr a[224:225],v203,16384
trr a[226:227],v203,18432
mf v[128:131],a[232:235],v[104:107],v[128:131]
trr a[228:229],v204,16384
trr a[230:231],v204,18432
mf v[136:139],a[236:239],v[104:107],v[136:139]
s_waitcnt lgkmcnt(8)
trr a[232:233],v203,20480
trr a[234:235],v203,22528
buffer_load_dwordx4 v215,s[28:31],s48 offen offset:3072 nt lds
mf v[128:131],a[240:243],v[112:115],v[128:131]
trr a[236:237],v204,20480
trr a[238:239],v204,22528
mf v[136:139],a[244:247],v[112:115],v[136:139]
s_waitcnt lgkmcnt(8)
trr a[240:241],v203,24576
trr a[242:243],v203,26624
mf v[128:131],a[248:251],v[120:123],v[128:131]
trr a[244:245],v204,24576
trr a[246:247],v204,26624
mf v[136:139],a[252:255],v[120:123],v[136:139]
s_waitcnt lgkmcnt(8)
trr a[248:249],v203,28672
trr a[250:251],v203,30720
mf v[144:147],a[224:227],v[96:99],v[144:147]
trr a[252:253],v204,28672
trr a[254:255],v204,30720
mf v[152:155],a[228:231],v[96:99],v[152:155]
s_waitcnt lgkmcnt(8)
s_barrier
trr a[224:225],v201,49152
trr a[226:227],v201,51200
mf v[144:147],a[232:235],v[104:107],v[144:147]
trr a[228:229],v202,49152
trr a[230:231],v202,51200
s_add_u32 m0,s61,98304
s_add_u32 s48,s53,s98
s_add_u32 s48,s48,114688
buffer_load_dwordx4 v216,s[36:39],s48 offen lds
v_mul_f32 v128,v128,v224
v_mul_f32 v129,v129,v224
v_mul_f32 v130,v130,v224
mf v[152:155],a[236:239],v[104:107],v[152:155]
s_waitcnt lgkmcnt(8)
trr a[232:233],v203,49152
trr a[234:235],v203,51200
v_mul_f32 v131,v131,v224
v_mul_f32 v136,v136,v224
mf v[144:147],a[240:243],v[112:115],v[144:147]
trr a[236:237],v204,49152
trr a[238:239],v204,51200
v_mul_f32 v137,v137,v224
v_mul_f32 v138,v138,v224
v_mul_f32 v139,v139,v224
mf v[152:155],a[244:247],v[112:115],v[152:155]
s_waitcnt lgkmcnt(8)
trr a[240:241],v201,53248
trr a[242:243],v201,55296
buffer_load_dwordx4 v217,s[36:39],s48 offen offset:1024 lds
cvp v128,v128,v129
cvp v129,v130,v131
mf v[144:147],a[248:251],v[120:123],v[144:147]
trr a[244:245],v202,53248
trr a[246:247],v202,55296
cvp v130,v136,v137
cvp v131,v138,v139
mf v[152:155],a[252:255],v[120:123],v[152:155]
s_waitcnt lgkmcnt(8)
trr a[248:249],v203,53248
trr a[250:251],v203,55296
mf a[0:3],a[224:227],v[128:131],a[0:3]
trr a[252:253],v204,53248
trr a[254:255],v204,55296
v_mul_f32 v144,v144,v224
v_mul_f32 v145,v145,v224
v_mul_f32 v146,v146,v224
v_mul_f32 v147,v147,v224
mf a[8:11],a[228:231],v[128:131],a[8:11]
s_waitcnt lgkmcnt(8)
trr a[224:225],v201,57344
trr a[226:227],v201,59392
v_mul_f32 v152,v152,v224
v_mul_f32 v153,v153,v224
v_mul_f32 v154,v154,v224
v_mul_f32 v155,v155,v224
mf a[16:19],a[232:235],v[128:131],a[16:19]
trr a[228:229],v202,57344
trr a[230:231],v202,59392
cvp v136,v144,v145
cvp v137,v146,v147
cvp v138,v152,v153
cvp v139,v154,v155
mf a[24:27],a[236:239],v[128:131],a[24:27]
s_waitcnt lgkmcnt(8)
trr a[232:233],v203,57344
trr a[234:235],v203,59392
mf a[0:3],a[240:243],v[136:139],a[0:3]
trr a[236:237],v204,57344
trr a[238:239],v204,59392
mf a[8:11],a[244:247],v[136:139],a[8:11]
s_waitcnt lgkmcnt(8)
trr a[240:241],v201,61440
trr a[242:243],v201,63488
mf a[16:19],a[248:251],v[136:139],a[16:19]
trr a[244:245],v202,61440
trr a[246:247],v202,63488
mf a[24:27],a[252:255],v[136:139],a[24:27]
s_waitcnt lgkmcnt(8)
trr a[248:249],v203,61440
trr a[250:251],v203,63488
mf a[32:35],a[224:227],v[128:131],a[32:35]
trr a[252:253],v204,61440
trr a[254:255],v204,63488
mf a[40:43],a[228:231],v[128:131],a[40:43]
s_waitcnt lgkmcnt(8)
s_barrier
trr a[224:225],v201,0
trr a[226:227],v201,2048
mf a[48:51],a[232:235],v[128:131],a[48:51]
trr a[228:229],v202,0
trr a[230:231],v202,2048
s_add_u32 m0,s49,16384
s_add_u32 s48,s51,131456
buffer_load_dwordx4 v212,s[28:31],s48 offen nt lds
mf a[56:59],a[236:239],v[128:131],a[56:59]
s_waitcnt lgkmcnt(8)
trr a[232:233],v203,0
trr a[234:235],v203,2048
mf a[32:35],a[240:243],v[136:139],a[32:35]
trr a[236:237],v204,0
trr a[238:239],v204,2048
mf a[40:43],a[244:247],v[136:139],a[40:43]
s_waitcnt lgkmcnt(8)
trr a[240:241],v201,4096
trr a[242:243],v201,6144
buffer_load_dwordx4 v213,s[28:31],s48 offen offset:1024 nt lds
mf a[48:51],a[248:251],v[136:139],a[48:51]
trr a[244:245],v202,4096
trr a[246:247],v202,6144
mf a[56:59],a[252:255],v[136:139],a[56:59]
s_waitcnt lgkmcnt(8)
trr a[248:249],v203,4096
trr a[250:251],v203,6144
mf a[64:67],a[224:227],v[128:131],a[64:67]
trr a[252:253],v204,4096
trr a[254:255],v204,6144
buffer_load_dwordx4 v214,s[28:31],s48 offen offset:2048 nt lds
mf a[72:75],a[228:231],v[128:131],a[72:75]
s_waitcnt lgkmcnt(8)
trr a[224:225],v201,8192
trr a[226:227],v201,10240
mf a[80:83],a[232:235],v[128:131],a[80:83]
trr a[228:229],v202,8192
trr a[230:231],v202,10240
mf a[88:91],a[236:239],v[128:131],a[88:91]
s_waitcnt lgkmcnt(8)
trr a[232:233],v203,8192
trr a[234:235],v203,10240
buffer_load_dwordx4 v215,s[28:31],s48 offen offset:3072 nt lds
mf a[64:67],a[240:243],v[136:139],a[64:67]
trr a[236:237],v204,8192
trr a[238:239],v204,10240
mf a[72:75],a[244:247],v[136:139],a[72:75]
s_waitcnt lgkmcnt(8)
trr a[240:241],v201,12288
trr a[242:243],v201,14336
mf a[80:83],a[248:251],v[136:139],a[80:83]
trr a[244:245],v202,12288
trr a[246:247],v202,14336
mf a[88:91],a[252:255],v[136:139],a[88:91]
s_waitcnt lgkmcnt(8)
trr a[248:249],v203,12288
trr a[250:251],v203,14336
mf a[96:99],a[224:227],v[128:131],a[96:99]
trr a[252:253],v204,12288
trr a[254:255],v204,14336
mf a[104:107],a[228:231],v[128:131],a[104:107]
s_waitcnt lgkmcnt(8)
s_waitcnt vmcnt(14)
s_barrier
trr a[224:225],v201,32768
trr a[226:227],v201,34816
mf a[112:115],a[232:235],v[128:131],a[112:115]
trr a[228:229],v202,32768
trr a[230:231],v202,34816
mf a[120:123],a[236:239],v[128:131],a[120:123]
s_waitcnt lgkmcnt(8)
trr a[232:233],v203,32768
trr a[234:235],v203,34816
mf a[96:99],a[240:243],v[136:139],a[96:99]
trr a[236:237],v204,32768
trr a[238:239],v204,34816
mf a[104:107],a[244:247],v[136:139],a[104:107]
s_waitcnt lgkmcnt(8)
trr a[240:241],v201,36864
trr a[242:243],v201,38912
mf a[112:115],a[248:251],v[136:139],a[112:115]
trr a[244:245],v202,36864
trr a[246:247],v202,38912
mf a[120:123],a[252:255],v[136:139],a[120:123]
s_waitcnt lgkmcnt(8)
trr a[248:249],v203,36864
trr a[250:251],v203,38912
mf a[128:131],a[224:227],v[128:131],a[128:131]
trr a[252:253],v204,36864
trr a[254:255],v204,38912
mf a[136:139],a[228:231],v[128:131],a[136:139]
s_waitcnt lgkmcnt(8)
trr a[224:225],v201,40960
trr a[226:227],v201,43008
mf a[144:147],a[232:235],v[128:131],a[144:147]
trr a[228:229],v202,40960
trr a[230:231],v202,43008
mf a[152:155],a[236:239],v[128:131],a[152:155]
s_waitcnt lgkmcnt(8)
trr a[232:233],v203,40960
trr a[234:235],v203,43008
mf a[128:131],a[240:243],v[136:139],a[128:131]
trr a[236:237],v204,40960
trr a[238:239],v204,43008
mf a[136:139],a[244:247],v[136:139],a[136:139]
s_waitcnt lgkmcnt(8)
trr a[240:241],v201,45056
trr a[242:243],v201,47104
mf a[144:147],a[248:251],v[136:139],a[144:147]
trr a[244:245],v202,45056
trr a[246:247],v202,47104
mf a[152:155],a[252:255],v[136:139],a[152:155]
s_waitcnt lgkmcnt(8)
trr a[248:249],v203,45056
trr a[250:251],v203,47104
mf a[160:163],a[224:227],v[128:131],a[160:163]
v_add_u32 v201,0x10000,v201
trr a[252:253],v204,45056
trr a[254:255],v204,47104
mf a[168:171],a[228:231],v[128:131],a[168:171]
s_waitcnt lgkmcnt(8)
s_waitcnt vmcnt(4)
s_barrier
v_add_u32 v202,0x10000,v202
trr a[224:225],v201,32768
trr a[226:227],v201,34816
mf a[176:179],a[232:235],v[128:131],a[176:179]
v_add_u32 v203,0x10000,v203
trr a[228:229],v202,32768
trr a[230:231],v202,34816
s_add_u32 m0,s61,0
s_add_u32 s48,s53,s92
s_add_u32 s48,s48,172032
buffer_load_dwordx4 v216,s[36:39],s48 offen lds
mf a[184:187],a[236:239],v[128:131],a[184:187]
s_waitcnt lgkmcnt(8)
v_add_u32 v204,0x10000,v204
trr a[232:233],v203,32768
trr a[234:235],v203,34816
mf a[160:163],a[240:243],v[136:139],a[160:163]
trr a[236:237],v204,32768
trr a[238:239],v204,34816
buffer_load_dwordx4 v217,s[36:39],s48 offen offset:1024 lds
mf a[168:171],a[244:247],v[136:139],a[168:171]
s_waitcnt lgkmcnt(8)
trr a[240:241],v201,36864
trr a[242:243],v201,38912
mf a[176:179],a[248:251],v[136:139],a[176:179]
trr a[244:245],v202,36864
trr a[246:247],v202,38912
s_add_u32 m0,s61,8192
s_add_u32 s48,s53,s93
s_add_u32 s48,s48,172032
buffer_load_dwordx4 v216,s[36:39],s48 offen lds
mf a[184:187],a[252:255],v[136:139],a[184:187]
s_waitcnt lgkmcnt(8)
trr a[248:249],v203,36864
trr a[250:251],v203,38912
mf a[192:195],a[224:227],v[128:131],a[192:195]
trr a[252:253],v204,36864
trr a[254:255],v204,38912
buffer_load_dwordx4 v217,s[36:39],s48 offen offset:1024 lds
mf a[200:203],a[228:231],v[128:131],a[200:203]
s_waitcnt lgkmcnt(8)
s_barrier
trr a[224:225],v201,16384
trr a[226:227],v201,18432
mf a[208:211],a[232:235],v[128:131],a[208:211]
trr a[228:229],v202,16384
trr a[230:231],v202,18432
s_add_u32 m0,s49,32768
s_add_u32 s48,s51,196992
buffer_load_dwordx4 v212,s[28:31],s48 offen nt lds
mf a[216:219],a[236:239],v[128:131],a[216:219]
s_waitcnt lgkmcnt(8)
trr a[232:233],v203,16384
trr a[234:235],v203,18432
mf a[192:195],a[240:243],v[136:139],a[192:195]
trr a[236:237],v204,16384
trr a[238:239],v204,18432
mf a[200:203],a[244:247],v[136:139],a[200:203]
s_waitcnt lgkmcnt(8)
trr a[240:241],v201,20480
trr a[242:243],v201,22528
buffer_load_dwordx4 v213,s[28:31],s48 offen offset:1024 nt lds
mf a[208:211],a[248:251],v[136:139],a[208:211]
trr a[244:245],v202,20480
trr a[246:247],v202,22528
mf a[216:219],a[252:255],v[136:139],a[216:219]
s_waitcnt lgkmcnt(8)
trr a[248:249],v203,20480
trr a[250:251],v203,22528
mf v[128:131],a[224:227],v[0:3],0
trr a[252:253],v204,20480
trr a[254:255],v204,22528
buffer_load_dwordx4 v214,s[28:31],s48 offen offset:2048 nt lds
mf v[136:139],a[228:231],v[0:3],0
s_waitcnt lgkmcnt(8)
trr a[224:225],v201,24576
trr a[226:227],v201,26624
mf v[144:147],a[232:235],v[0:3],0
trr a[228:229],v202,24576
trr a[230:231],v202,26624
mf v[152:155],a[236:239],v[0:3],0
s_waitcnt lgkmcnt(8)
trr a[232:233],v203,24576
trr a[234:235],v203,26624
buffer_load_dwordx4 v215,s[28:31],s48 offen offset:3072 nt lds
mf v[128:131],a[240:243],v[8:11],v[128:131]
trr a[236:237],v204,24576
trr a[238:239],v204,26624
mf v[136:139],a[244:247],v[8:11],v[136:139]
s_waitcnt lgkmcnt(8)
trr a[240:241],v201,28672
trr a[242:243],v201,30720
mf v[144:147],a[248:251],v[8:11],v[144:147]
trr a[244:245],v202,28672
trr a[246:247],v202,30720
mf v[152:155],a[252:255],v[8:11],v[152:155]
s_waitcnt lgkmcnt(8)
trr a[248:249],v203,28672
trr a[250:251],v203,30720
mf v[128:131],a[224:227],v[16:19],v[128:131]
trr a[252:253],v204,28672
trr a[254:255],v204,30720
mf v[136:139],a[228:231],v[16:19],v[136:139]
s_waitcnt lgkmcnt(8)
s_barrier
trr a[224:225],v201,0
trr a[226:227],v201,2048
mf v[144:147],a[232:235],v[16:19],v[144:147]
trr a[228:229],v202,0
trr a[230:231],v202,2048
s_add_u32 m0,s61,49152
s_add_u32 s48,s53,s94
s_add_u32 s48,s48,172032
buffer_load_dwordx4 v216,s[36:39],s48 offen lds
mf v[152:155],a[236:239],v[16:19],v[152:155]
s_waitcnt lgkmcnt(8)
trr a[232:233],v203,0
trr a[234:235],v203,2048
mf v[128:131],a[240:243],v[24:27],v[128:131]
trr a[236:237],v204,0
trr a[238:239],v204,2048
mf v[136:139],a[244:247],v[24:27],v[136:139]
s_waitcnt lgkmcnt(8)
trr a[240:241],v201,4096
trr a[242:243],v201,6144
buffer_load_dwordx4 v217,s[36:39],s48 offen offset:1024 lds
mf v[144:147],a[248:251],v[24:27],v[144:147]
trr a[244:245],v202,4096
trr a[246:247],v202,6144
mf v[152:155],a[252:255],v[24:27],v[152:155]
s_waitcnt lgkmcnt(8)
trr a[248:249],v203,4096
trr a[250:251],v203,6144
mf v[128:131],a[224:227],v[32:35],v[128:131]
trr a[252:253],v204,4096
trr a[254:255],v204,6144
s_add_u32 m0,s61,57344
s_add_u32 s48,s53,s95
s_add_u32 s48,s48,172032
buffer_load_dwordx4 v216,s[36:39],s48 offen lds
mf v[136:139],a[228:231],v[32:35],v[136:139]
s_waitcnt lgkmcnt(8)
trr a[224:225],v201,8192
trr a[226:227],v201,10240
mf v[144:147],a[232:235],v[32:35],v[144:147]
trr a[228:229],v202,8192
trr a[230:231],v202,10240
mf v[152:155],a[236:239],v[32:35],v[152:155]
s_waitcnt lgkmcnt(8)
trr a[232:233],v203,8192
trr a[234:235],v203,10240
buffer_load_dwordx4 v217,s[36:39],s48 offen offset:1024 lds
mf v[128:131],a[240:243],v[40:43],v[128:131]
trr a[236:237],v204,8192
trr a[238:239],v204,10240
mf v[136:139],a[244:247],v[40:43],v[136:139]
s_waitcnt lgkmcnt(8)
trr a[240:241],v201,12288
trr a[242:243],v201,14336
mf v[144:147],a[248:251],v[40:43],v[144:147]
trr a[244:245],v202,12288
trr a[246:247],v202,14336
mf v[152:155],a[252:255],v[40:43],v[152:155]
s_waitcnt lgkmcnt(8)
trr a[248:249],v203,12288
trr a[250:251],v203,14336
mf v[128:131],a[224:227],v[48:51],v[128:131]
v_add_u32 v201,0xffff0000,v201
trr a[252:253],v204,12288
trr a[254:255],v204,14336
mf v[136:139],a[228:231],v[48:51],v[136:139]
s_waitcnt lgkmcnt(8)
s_waitcnt vmcnt(12)
s_barrier
v_add_u32 v202,0xffff0000,v202
trr a[224:225],v201,16384
trr a[226:227],v201,18432
mf v[144:147],a[232:235],v[48:51],v[144:147]
v_add_u32 v203,0xffff0000,v203
trr a[228:229],v202,16384
trr a[230:231],v202,18432
s_add_u32 m0,s61,81920
s_add_u32 s48,s53,s96
s_add_u32 s48,s48,172032
buffer_load_dwordx4 v216,s[36:39],s48 offen lds
mf v[152:155],a[236:239],v[48:51],v[152:155]
s_waitcnt lgkmcnt(8)
v_add_u32 v204,0xffff0000,v204
trr a[232:233],v203,16384
trr a[234:235],v203,18432
mf v[128:131],a[240:243],v[56:59],v[128:131]
trr a[236:237],v204,16384
trr a[238:239],v204,18432
mf v[136:139],a[244:247],v[56:59],v[136:139]
s_waitcnt lgkmcnt(8)
trr a[240:241],v201,20480
trr a[242:243],v201,22528
buffer_load_dwordx4 v217,s[36:39],s48 offen offset:1024 lds
mf v[144:147],a[248:251],v[56:59],v[144:147]
trr a[244:245],v202,20480
trr a[246:247],v202,22528
mf v[152:155],a[252:255],v[56:59],v[152:155]
s_waitcnt lgkmcnt(8)
trr a[248:249],v203,20480
trr a[250:251],v203,22528
mf v[128:131],a[224:227],v[64:67],v[128:131]
trr a[252:253],v204,20480
trr a[254:255],v204,22528
s_add_u32 m0,s61,90112
s_add_u32 s48,s53,s97
s_add_u32 s48,s48,172032
buffer_load_dwordx4 v216,s[36:39],s48 offen lds
mf v[136:139],a[228:231],v[64:67],v[136:139]
s_waitcnt lgkmcnt(8)
trr a[224:225],v201,24576
trr a[226:227],v201,26624
mf v[144:147],a[232:235],v[64:67],v[144:147]
trr a[228:229],v202,24576
trr a[230:231],v202,26624
mf v[152:155],a[236:239],v[64:67],v[152:155]
s_waitcnt lgkmcnt(8)
trr a[232:233],v203,24576
trr a[234:235],v203,26624
buffer_load_dwordx4 v217,s[36:39],s48 offen offset:1024 lds
mf v[128:131],a[240:243],v[72:75],v[128:131]
trr a[236:237],v204,24576
trr a[238:239],v204,26624
mf v[136:139],a[244:247],v[72:75],v[136:139]
s_waitcnt lgkmcnt(8)
trr a[240:241],v201,28672
trr a[242:243],v201,30720
mf v[144:147],a[248:251],v[72:75],v[144:147]
trr a[244:245],v202,28672
trr a[246:247],v202,30720
mf v[152:155],a[252:255],v[72:75],v[152:155]
s_waitcnt lgkmcnt(8)
trr a[248:249],v203,28672
trr a[250:251],v203,30720
mf v[128:131],a[224:227],v[80:83],v[128:131]
trr a[252:253],v204,28672
trr a[254:255],v204,30720
mf v[136:139],a[228:231],v[80:83],v[136:139]
s_waitcnt lgkmcnt(8)
s_waitcnt vmcnt(8)
s_barrier
trr a[224:225],v201,32768
trr a[226:227],v201,34816
mf v[144:147],a[232:235],v[80:83],v[144:147]
trr a[228:229],v202,32768
trr a[230:231],v202,34816
mf v[152:155],a[236:239],v[80:83],v[152:155]
s_waitcnt lgkmcnt(8)
trr a[232:233],v201,36864
trr a[234:235],v201,38912
mf v[128:131],a[240:243],v[88:91],v[128:131]
trr a[236:237],v202,36864
trr a[238:239],v202,38912
mf v[136:139],a[244:247],v[88:91],v[136:139]
s_waitcnt lgkmcnt(8)
trr a[240:241],v201,40960
trr a[242:243],v201,43008
mf v[144:147],a[248:251],v[88:91],v[144:147]
trr a[244:245],v202,40960
trr a[246:247],v202,43008
mf v[152:155],a[252:255],v[88:91],v[152:155]
s_waitcnt lgkmcnt(8)
trr a[248:249],v201,45056
trr a[250:251],v201,47104
mf v[128:131],a[224:227],v[96:99],v[128:131]
trr a[252:253],v202,45056
trr a[254:255],v202,47104
mf v[136:139],a[228:231],v[96:99],v[136:139]
s_waitcnt lgkmcnt(8)
trr a[224:225],v203,32768
trr a[226:227],v203,34816
mf v[128:131],a[232:235],v[104:107],v[128:131]
trr a[228:229],v204,32768
trr a[230:231],v204,34816
mf v[136:139],a[236:239],v[104:107],v[136:139]
s_waitcnt lgkmcnt(8)
trr a[232:233],v203,36864
trr a[234:235],v203,38912
mf v[128:131],a[240:243],v[112:115],v[128:131]
trr a[236:237],v204,36864
trr a[238:239],v204,38912
mf v[136:139],a[244:247],v[112:115],v[136:139]
s_waitcnt lgkmcnt(8)
trr a[240:241],v203,40960
trr a[242:243],v203,43008
mf v[128:131],a[248:251],v[120:123],v[128:131]
trr a[244:245],v204,40960
trr a[246:247],v204,43008
mf v[136:139],a[252:255],v[120:123],v[136:139]
s_waitcnt lgkmcnt(8)
trr a[248:249],v203,45056
trr a[250:251],v203,47104
mf v[144:147],a[224:227],v[96:99],v[144:147]
trr a[252:253],v204,45056
trr a[254:255],v204,47104
mf v[152:155],a[228:231],v[96:99],v[152:155]
s_waitcnt lgkmcnt(8)
s_barrier
trr a[224:225],v201,0
trr a[226:227],v201,2048
mf v[144:147],a[232:235],v[104:107],v[144:147]
trr a[228:229],v202,0
trr a[230:231],v202,2048
v_mul_f32 v128,v128,v224
v_mul_f32 v129,v129,v224
v_mul_f32 v130,v130,v224
mf v[152:155],a[236:239],v[104:107],v[152:155]
s_waitcnt lgkmcnt(8)
trr a[232:233],v203,0
trr a[234:235],v203,2048
v_mul_f32 v131,v131,v224
v_mul_f32 v136,v136,v224
mf v[144:147],a[240:243],v[112:115],v[144:147]
trr a[236:237],v204,0
trr a[238:239],v204,2048
v_mul_f32 v137,v137,v224
v_mul_f32 v138,v138,v224
v_mul_f32 v139,v139,v224
mf v[152:155],a[244:247],v[112:115],v[152:155]
s_waitcnt lgkmcnt(8)
trr a[240:241],v201,4096
trr a[242:243],v201,6144
cvp v128,v128,v129
cvp v129,v130,v131
mf v[144:147],a[248:251],v[120:123],v[144:147]
trr a[244:245],v202,4096
trr a[246:247],v202,6144
cvp v130,v136,v137
cvp v131,v138,v139
mf v[152:155],a[252:255],v[120:123],v[152:155]
s_waitcnt lgkmcnt(8)
trr a[248:249],v203,4096
trr a[250:251],v203,6144
v_readfirstlane_b32 s56,v234
s_nop 3
s_cmp_lg_u32 s56,0
s_cbranch_scc1 L_restart
mf a[0:3],a[224:227],v[128:131],a[0:3]
trr a[252:253],v204,4096
trr a[254:255],v204,6144
v_mul_f32 v144,v144,v224
v_mul_f32 v145,v145,v224
v_mul_f32 v146,v146,v224
v_mul_f32 v147,v147,v224
mf a[8:11],a[228:231],v[128:131],a[8:11]
s_waitcnt lgkmcnt(8)
trr a[224:225],v201,8192
trr a[226:227],v201,10240
v_mul_f32 v152,v152,v224
v_mul_f32 v153,v153,v224
v_mul_f32 v154,v154,v224
v_mul_f32 v155,v155,v224
mf a[16:19],a[232:235],v[128:131],a[16:19]
trr a[228:229],v202,8192
trr a[230:231],v202,10240
cvp v136,v144,v145
cvp v137,v146,v147
cvp v138,v152,v153
cvp v139,v154,v155
mf a[24:27],a[236:239],v[128:131],a[24:27]
s_waitcnt lgkmcnt(8)
trr a[232:233],v203,8192
trr a[234:235],v203,10240
mf a[0:3],a[240:243],v[136:139],a[0:3]
trr a[236:237],v204,8192
trr a[238:239],v204,10240
mf a[8:11],a[244:247],v[136:139],a[8:11]
s_waitcnt lgkmcnt(8)
trr a[240:241],v201,12288
trr a[242:243],v201,14336
mf a[16:19],a[248:251],v[136:139],a[16:19]
trr a[244:245],v202,12288
trr a[246:247],v202,14336
mf a[24:27],a[252:255],v[136:139],a[24:27]
s_waitcnt lgkmcnt(8)
trr a[248:249],v203,12288
trr a[250:251],v203,14336
mf a[32:35],a[224:227],v[128:131],a[32:35]
trr a[252:253],v204,12288
trr a[254:255],v204,14336
s_lshl_b32 s60,s92,5
ard v0,a0
ard v1,a1
ard v2,a2
mf a[40:43],a[228:231],v[128:131],a[40:43]
s_waitcnt lgkmcnt(8)
s_waitcnt vmcnt(4)
s_barrier
trr a[224:225],v201,49152
trr a[226:227],v201,51200
ard v3,a3
ard v4,a8
ard v5,a9
mf a[48:51],a[232:235],v[128:131],a[48:51]
trr a[228:229],v202,49152
trr a[230:231],v202,51200
s_add_u32 m0,s61,16384
s_add_u32 s48,s53,s98
s_add_u32 s48,s48,172032
buffer_load_dwordx4 v216,s[36:39],s48 offen lds
ard v6,a10
ard v7,a11
cvp v0,v0,v1
cvp v1,v2,v3
mf a[56:59],a[236:239],v[128:131],a[56:59]
s_waitcnt lgkmcnt(8)
trr a[232:233],v203,49152
trr a[234:235],v203,51200
cvp v2,v4,v5
cvp v3,v6,v7
buffer_store_dwordx4 v[0:3],v220,s[40:43],s60 offen nt
mf a[32:35],a[240:243],v[136:139],a[32:35]
trr a[236:237],v204,49152
trr a[238:239],v204,51200
ard v16,a16
ard v17,a17
ard v18,a18
mf a[40:43],a[244:247],v[136:139],a[40:43]
s_waitcnt lgkmcnt(8)
trr a[240:241],v201,53248
trr a[242:243],v201,55296
buffer_load_dwordx4 v217,s[36:39],s48 offen offset:1024 lds
ard v19,a19
ard v20,a24
ard v21,a25
ard v22,a26
mf a[48:51],a[248:251],v[136:139],a[48:51]
trr a[244:245],v202,53248
trr a[246:247],v202,55296
ard v23,a27
cvp v16,v16,v17
cvp v17,v18,v19
mf a[56:59],a[252:255],v[136:139],a[56:59]
s_waitcnt lgkmcnt(8)
trr a[248:249],v203,53248
trr a[250:251],v203,55296
cvp v18,v20,v21
cvp v19,v22,v23
buffer_store_dwordx4 v[16:19],v220,s[40:43],s60 offen offset:2048 nt
mf a[64:67],a[224:227],v[128:131],a[64:67]
trr a[252:253],v204,53248
trr a[254:255],v204,55296
s_lshl_b32 s60,s93,5
ard v32,a32
ard v33,a33
ard v34,a34
mf a[72:75],a[228:231],v[128:131],a[72:75]
s_waitcnt lgkmcnt(8)
trr a[224:225],v201,57344
trr a[226:227],v201,59392
ard v35,a35
ard v36,a40
ard v37,a41
mf a[80:83],a[232:235],v[128:131],a[80:83]
trr a[228:229],v202,57344
trr a[230:231],v202,59392
ard v38,a42
ard v39,a43
cvp v32,v32,v33
cvp v33,v34,v35
mf a[88:91],a[236:239],v[128:131],a[88:91]
s_waitcnt lgkmcnt(8)
trr a[232:233],v203,57344
trr a[234:235],v203,59392
cvp v34,v36,v37
cvp v35,v38,v39
buffer_store_dwordx4 v[32:35],v220,s[40:43],s60 offen nt
mf a[64:67],a[240:243],v[136:139],a[64:67]
trr a[236:237],v204,57344
trr a[238:239],v204,59392
ard v48,a48
ard v49,a49
ard v50,a50
mf a[72:75],a[244:247],v[136:139],a[72:75]
s_waitcnt lgkmcnt(8)
trr a[240:241],v201,61440
trr a[242:243],v201,63488
ard v51,a51
ard v52,a56
ard v53,a57
ard v54,a58
mf a[80:83],a[248:251],v[136:139],a[80:83]
trr a[244:245],v202,61440
trr a[246:247],v202,63488
ard v55,a59
cvp v48,v48,v49
cvp v49,v50,v51
mf a[88:91],a[252:255],v[136:139],a[88:91]
s_waitcnt lgkmcnt(8)
trr a[248:249],v203,61440
trr a[250:251],v203,63488
cvp v50,v52,v53
cvp v51,v54,v55
buffer_store_dwordx4 v[48:51],v220,s[40:43],s60 offen offset:2048 nt
mf a[96:99],a[224:227],v[128:131],a[96:99]
v_add_u32 v201,0x10000,v201
trr a[252:253],v204,61440
trr a[254:255],v204,63488
s_lshl_b32 s60,s94,5
ard v0,a64
ard v1,a65
ard v2,a66
mf a[104:107],a[228:231],v[128:131],a[104:107]
s_waitcnt lgkmcnt(8)
s_waitcnt vmcnt(6)
s_barrier
v_add_u32 v202,0x10000,v202
trr a[224:225],v201,16384
trr a[226:227],v201,18432
ard v3,a67
ard v4,a72
ard v5,a73
mf a[112:115],a[232:235],v[128:131],a[112:115]
v_add_u32 v203,0x10000,v203
trr a[228:229],v202,16384
trr a[230:231],v202,18432
ard v6,a74
ard v7,a75
cvp v0,v0,v1
cvp v1,v2,v3
mf a[120:123],a[236:239],v[128:131],a[120:123]
s_waitcnt lgkmcnt(8)
v_add_u32 v204,0x10000,v204
trr a[232:233],v203,16384
trr a[234:235],v203,18432
cvp v2,v4,v5
cvp v3,v6,v7
buffer_store_dwordx4 v[0:3],v220,s[40:43],s60 offen nt
mf a[96:99],a[240:243],v[136:139],a[96:99]
trr a[236:237],v204,16384
trr a[238:239],v204,18432
ard v16,a80
ard v17,a81
ard v18,a82
mf a[104:107],a[244:247],v[136:139],a[104:107]
s_waitcnt lgkmcnt(8)
trr a[240:241],v201,20480
trr a[242:243],v201,22528
ard v19,a83
ard v20,a88
ard v21,a89
ard v22,a90
mf a[112:115],a[248:251],v[136:139],a[112:115]
trr a[244:245],v202,20480
trr a[246:247],v202,22528
ard v23,a91
cvp v16,v16,v17
cvp v17,v18,v19
mf a[120:123],a[252:255],v[136:139],a[120:123]
s_waitcnt lgkmcnt(8)
trr a[248:249],v203,20480
trr a[250:251],v203,22528
cvp v18,v20,v21
cvp v19,v22,v23
buffer_store_dwordx4 v[16:19],v220,s[40:43],s60 offen offset:2048 nt
mf a[128:131],a[224:227],v[128:131],a[128:131]
trr a[252:253],v204,20480
trr a[254:255],v204,22528
s_lshl_b32 s60,s95,5
ard v32,a96
ard v33,a97
ard v34,a98
mf a[136:139],a[228:231],v[128:131],a[136:139]
s_waitcnt lgkmcnt(8)
trr a[224:225],v201,24576
trr a[226:227],v201,26624
ard v35,a99
ard v36,a104
ard v37,a105
mf a[144:147],a[232:235],v[128:131],a[144:147]
trr a[228:229],v202,24576
trr a[230:231],v202,26624
ard v38,a106
ard v39,a107
cvp v32,v32,v33
cvp v33,v34,v35
mf a[152:155],a[236:239],v[128:131],a[152:155]
s_waitcnt lgkmcnt(8)
trr a[232:233],v203,24576
trr a[234:235],v203,26624
cvp v34,v36,v37
cvp v35,v38,v39
buffer_store_dwordx4 v[32:35],v220,s[40:43],s60 offen nt
mf a[128:131],a[240:243],v[136:139],a[128:131]
trr a[236:237],v204,24576
trr a[238:239],v204,26624
ard v48,a112
ard v49,a113
ard v50,a114
mf a[136:139],a[244:247],v[136:139],a[136:139]
s_waitcnt lgkmcnt(8)
trr a[240:241],v201,28672
trr a[242:243],v201,30720
ard v51,a115
ard v52,a120
ard v53,a121
ard v54,a122
mf a[144:147],a[248:251],v[136:139],a[144:147]
trr a[244:245],v202,28672
trr a[246:247],v202,30720
ard v55,a123
cvp v48,v48,v49
cvp v49,v50,v51
mf a[152:155],a[252:255],v[136:139],a[152:155]
s_waitcnt lgkmcnt(8)
trr a[248:249],v203,28672
trr a[250:251],v203,30720
cvp v50,v52,v53
cvp v51,v54,v55
buffer_store_dwordx4 v[48:51],v220,s[40:43],s60 offen offset:2048 nt
mf a[160:163],a[224:227],v[128:131],a[160:163]
v_add_u32 v201,0xffff0000,v201
trr a[252:253],v204,28672
trr a[254:255],v204,30720
s_lshl_b32 s60,s96,5
ard v0,a128
ard v1,a129
ard v2,a130
mf a[168:171],a[228:231],v[128:131],a[168:171]
s_waitcnt lgkmcnt(8)
s_waitcnt vmcnt(7)
s_barrier
v_add_u32 v202,0xffff0000,v202
trr a[224:225],v201,16384
trr a[226:227],v201,18432
ard v3,a131
ard v4,a136
ard v5,a137
mf a[176:179],a[232:235],v[128:131],a[176:179]
v_add_u32 v203,0xffff0000,v203
trr a[228:229],v202,16384
trr a[230:231],v202,18432
ard v6,a138
ard v7,a139
cvp v0,v0,v1
cvp v1,v2,v3
mf a[184:187],a[236:239],v[128:131],a[184:187]
s_waitcnt lgkmcnt(8)
v_add_u32 v204,0xffff0000,v204
trr a[232:233],v203,16384
trr a[234:235],v203,18432
cvp v2,v4,v5
cvp v3,v6,v7
buffer_store_dwordx4 v[0:3],v220,s[40:43],s60 offen nt
mf a[160:163],a[240:243],v[136:139],a[160:163]
trr a[236:237],v204,16384
trr a[238:239],v204,18432
ard v16,a144
ard v17,a145
ard v18,a146
mf a[168:171],a[244:247],v[136:139],a[168:171]
s_waitcnt lgkmcnt(8)
trr a[240:241],v201,20480
trr a[242:243],v201,22528
ard v19,a147
ard v20,a152
ard v21,a153
ard v22,a154
mf a[176:179],a[248:251],v[136:139],a[176:179]
trr a[244:245],v202,20480
trr a[246:247],v202,22528
ard v23,a155
cvp v16,v16,v17
cvp v17,v18,v19
mf a[184:187],a[252:255],v[136:139],a[184:187]
s_waitcnt lgkmcnt(8)
trr a[248:249],v203,20480
trr a[250:251],v203,22528
cvp v18,v20,v21
cvp v19,v22,v23
buffer_store_dwordx4 v[16:19],v220,s[40:43],s60 offen offset:2048 nt
mf a[192:195],a[224:227],v[128:131],a[192:195]
trr a[252:253],v204,20480
trr a[254:255],v204,22528
s_lshl_b32 s60,s97,5
ard v32,a160
ard v33,a161
ard v34,a162
mf a[200:203],a[228:231],v[128:131],a[200:203]
s_waitcnt lgkmcnt(8)
ard v35,a163
ard v36,a168
ard v37,a169
ard v38,a170
mf a[208:211],a[232:235],v[128:131],a[208:211]
ard v39,a171
cvp v32,v32,v33
cvp v33,v34,v35
cvp v34,v36,v37
mf a[216:219],a[236:239],v[128:131],a[216:219]
s_waitcnt lgkmcnt(4)
cvp v35,v38,v39
buffer_store_dwordx4 v[32:35],v220,s[40:43],s60 offen nt
ard v48,a176
ard v49,a177
mf a[192:195],a[240:243],v[136:139],a[192:195]
ard v50,a178
ard v51,a179
ard v52,a184
ard v53,a185
mf a[200:203],a[244:247],v[136:139],a[200:203]
s_waitcnt lgkmcnt(0)
ard v54,a186
ard v55,a187
cvp v48,v48,v49
cvp v49,v50,v51
mf a[208:211],a[248:251],v[136:139],a[208:211]
cvp v50,v52,v53
cvp v51,v54,v55
buffer_store_dwordx4 v[48:51],v220,s[40:43],s60 offen offset:2048 nt
mf a[216:219],a[252:255],v[136:139],a[216:219]
s_lshl_b32 s60,s98,5
ard v0,a192
ard v1,a193
ard v2,a194
ard v3,a195
ard v4,a200
ard v5,a201
ard v6,a202
ard v7,a203
cvp v0,v0,v1
cvp v1,v2,v3
cvp v2,v4,v5
cvp v3,v6,v7
buffer_store_dwordx4 v[0:3],v220,s[40:43],s60 offen nt
ard v16,a208
ard v17,a209
ard v18,a210
ard v19,a211
ard v20,a216
ard v21,a217
ard v22,a218
ard v23,a219
cvp v16,v16,v17
cvp v17,v18,v19
cvp v18,v20,v21
cvp v19,v22,v23
buffer_store_dwordx4 v[16:19],v220,s[40:43],s60 offen offset:2048 nt
s_getpc_b64 s[54:55]
L_k2pf_w3:
s_add_u32 s54,s54,mha_reduce_kernel-L_k2pf_w3
s_addc_u32 s55,s55,0
v_lshlrev_b32 v0,6,v192
v_min_u32 v0,K2_LAST,v0
global_load_dword v1,v0,s[54:55]
s_endpgm
L_pf_end:
L_restart:
s_waitcnt vmcnt(0) lgkmcnt(0)
s_barrier
s_lshl_b32 s3,s44,6
v_add_u32 v0,s3,v192
s_load_dwordx16 s[4:19],s[0:1],0
v_and_b32 v192,63,v0
v_lshrrev_b32 v176,6,v0
s_nop 0
v_readfirstlane_b32 s44,v176
s_and_b32 s54,s2,3
s_lshl_b32 s54,s54,2
s_bfe_u32 s56,s2,0x20003
s_add_u32 s54,s54,s56
s_bfe_u32 s55,s2,0x10002
s_lshl_b32 s55,s55,3
s_lshr_b32 s56,s2,5
s_add_u32 s55,s55,s56
s_and_b32 s59,s54,3
s_lshl_b32 s59,s59,1
s_add_u32 s59,s59,s55
s_mul_i32 s56,s59,9363
s_lshr_b32 s56,s56,16
s_mul_i32 s56,s56,7
s_sub_u32 s56,s59,s56
s_lshl_b32 s92,s56,7
s_lshl_b32 s49,s44,12
s_mul_i32 s45,s44,28672
v_lshrrev_b32 v178,3,v192
v_mul_u32_u24 v178,896,v178
v_lshrrev_b32 v179,4,v192
v_and_b32 v180,7,v192
v_xor_b32 v180,v180,v179
v_lshl_add_u32 v212,v180,4,v178
v_xor_b32 v180,4,v180
v_lshl_add_u32 v213,v180,4,v178
v_add_u32 v214,12288,v212
v_add_u32 v213,6144,v213
v_add_u32 v215,12288,v213
s_mul_i32 s58,s55,100352
s_mov_b32 s22,100352
s_mov_b32 s23,0x20000
s_waitcnt lgkmcnt(0)
s_add_u32 s20,s4,s58
s_addc_u32 s21,s5,0
s_add_u32 m0,s49,0
s_add_u32 s48,s45,s92
buffer_load_dwordx4 v212,s[20:23],s48 offen lds
buffer_load_dwordx4 v213,s[20:23],s48 offen offset:1024 lds
buffer_load_dwordx4 v214,s[20:23],s48 offen offset:2048 lds
buffer_load_dwordx4 v215,s[20:23],s48 offen offset:3072 lds
s_lshl_b32 s52,s44,16
v_and_b32 v176,31,v192
v_lshrrev_b32 v177,5,v192
s_and_b32 s58,s44,1
s_lshl_b32 s58,s58,2
v_or_b32 v181,s58,v177
v_or_b32 v178,0,v181
v_lshlrev_b32 v178,1,v178
v_xor_b32 v178,v178,v176
v_lshlrev_b32 v178,4,v178
v_lshl_add_u32 v178,v177,13,v178
v_mov_b32 v216,v178
v_or_b32 v178,2,v181
v_lshlrev_b32 v178,1,v178
v_xor_b32 v178,v178,v176
v_lshlrev_b32 v178,4,v178
v_lshl_add_u32 v178,v177,13,v178
v_add_u32 v217,15360,v178
v_add_u32 v218,30720,v216
v_add_u32 v219,30720,v217
s_lshl_b32 s59,s54,9
s_sub_u32 s34,3670016,s59
s_mov_b32 s35,0x20000
s_add_u32 s32,s10,s59
s_addc_u32 s33,s11,0
s_add_u32 m0,s49,16384
s_lshl_b32 s48,s92,12
s_add_u32 s48,s48,s52
buffer_load_dwordx4 v216,s[32:35],s48 offen lds
buffer_load_dwordx4 v217,s[32:35],s48 offen offset:1024 lds
buffer_load_dwordx4 v218,s[32:35],s48 offen offset:2048 lds
buffer_load_dwordx4 v219,s[32:35],s48 offen offset:3072 lds
s_add_u32 m0,s49,32768
s_lshl_b32 s48,s92,12
s_add_u32 s48,s48,s52
s_add_u32 s48,s48,262144
buffer_load_dwordx4 v216,s[32:35],s48 offen lds
buffer_load_dwordx4 v217,s[32:35],s48 offen offset:1024 lds
buffer_load_dwordx4 v218,s[32:35],s48 offen offset:2048 lds
buffer_load_dwordx4 v219,s[32:35],s48 offen offset:3072 lds
s_add_u32 s56,s56,1
s_cmp_eq_u32 s56,7
s_cselect_b32 s56,0,s56
s_lshl_b32 s93,s56,7
s_add_u32 s56,s56,1
s_cmp_eq_u32 s56,7
s_cselect_b32 s56,0,s56
s_lshl_b32 s94,s56,7
s_add_u32 s56,s56,1
s_cmp_eq_u32 s56,7
s_cselect_b32 s56,0,s56
s_lshl_b32 s95,s56,7
s_add_u32 s56,s56,1
s_cmp_eq_u32 s56,7
s_cselect_b32 s56,0,s56
s_lshl_b32 s96,s56,7
s_add_u32 s56,s56,1
s_cmp_eq_u32 s56,7
s_cselect_b32 s56,0,s56
s_lshl_b32 s97,s56,7
s_add_u32 s56,s56,1
s_cmp_eq_u32 s56,7
s_cselect_b32 s56,0,s56
s_lshl_b32 s98,s56,7
s_lshl_b32 s57,s55,4
s_add_u32 s57,s57,s54
s_lshl_b32 s58,s57,18
s_add_u32 s24,s6,s58
s_addc_u32 s25,s7,0
s_mov_b32 s26,0x40000
s_mov_b32 s27,0x20000
s_mov_b32 s50,s49
s_and_b32 s56,s44,1
s_lshl_b32 s56,s56,3
v_add_u32 v179,s56,v177
v_add_u32 v178,0,v179
v_xor_b32 v178,v178,v176
v_lshlrev_b32 v178,4,v178
v_lshl_add_u32 v208,v177,9,v178
v_add_u32 v178,2,v179
v_xor_b32 v178,v178,v176
v_lshlrev_b32 v178,4,v178
v_lshl_add_u32 v209,v177,9,v178
v_add_u32 v178,4,v179
v_xor_b32 v178,v178,v176
v_lshlrev_b32 v178,4,v178
v_lshl_add_u32 v210,v177,9,v178
v_add_u32 v178,6,v179
v_xor_b32 v178,v178,v176
v_lshlrev_b32 v178,4,v178
v_lshl_add_u32 v211,v177,9,v178
s_add_u32 m0,s49,49152
s_add_u32 s48,s50,0
buffer_load_dwordx4 v208,s[24:27],s48 offen nt lds
buffer_load_dwordx4 v209,s[24:27],s48 offen offset:1024 nt lds
buffer_load_dwordx4 v210,s[24:27],s48 offen offset:2048 nt lds
buffer_load_dwordx4 v211,s[24:27],s48 offen offset:3072 nt lds
s_add_u32 s28,s8,s58
s_addc_u32 s29,s9,0
s_mov_b32 s30,0x40000
s_mov_b32 s31,0x20000
s_lshl_b32 s51,s44,13
s_mul_i32 s58,s54,229376
s_add_u32 s36,s12,s58
s_addc_u32 s37,s13,0
s_mov_b32 s38,229376
s_mov_b32 s39,0x20000
s_mul_i32 s53,s44,28672
s_mul_i32 s58,s57,114688
s_add_u32 s40,s18,s58
s_addc_u32 s41,s19,0
s_mov_b32 s42,114688
s_mov_b32 s43,0x20000
s_mov_b32 s46,0x3db8aa3b
s_mov_b32 s47,0x3db8aa3b
v_lshlrev_b32 v144,4,v192
v_add_u32 v207,s49,v144
v_bfe_u32 v178,v192,2,2
v_and_b32 v179,3,v192
v_lshrrev_b32 v180,4,v192
v_and_b32 v181,1,v180
v_lshl_or_b32 v181,v181,2,v178
v_lshl_add_u32 v182,v180,3,v178
v_lshlrev_b32 v182,9,v182
v_lshl_add_u32 v182,v179,3,v182
v_lshl_add_u32 v182,v181,5,v182
v_xor_b32 v193,0,v182
v_xor_b32 v194,32,v182
v_xor_b32 v195,64,v182
v_xor_b32 v196,96,v182
v_xor_b32 v197,128,v182
v_xor_b32 v198,160,v182
v_xor_b32 v199,192,v182
v_xor_b32 v200,224,v182
v_and_b32 v181,1,v180
v_lshrrev_b32 v183,1,v178
v_lshl_or_b32 v181,v181,1,v183
v_lshl_add_u32 v182,v180,2,v178
v_lshlrev_b32 v182,7,v182
v_lshl_add_u32 v182,v179,3,v182
v_lshl_add_u32 v182,v181,5,v182
v_xor_b32 v201,0,v182
v_xor_b32 v202,32,v182
v_xor_b32 v203,64,v182
v_xor_b32 v204,96,v182
v_bfe_u32 v181,v192,1,3
v_xor_b32 v181,v181,v180
v_lshlrev_b32 v181,4,v181
v_and_b32 v182,15,v192
v_lshl_add_u32 v181,v182,7,v181
v_add_u32 v205,s49,v181
v_xor_b32 v206,64,v205
s_mul_i32 s58,s44,28672
v_add_u32 v220,s58,v144
s_cmp_eq_u32 s44,3
s_mov_b32 s58,1024
s_cselect_b32 s58,0x7ff00000,s58
v_add_u32 v221,s58,v220
v_mov_b32 v222,0xff800000
s_mov_b32 s58,0xff800000
s_cselect_b32 s58,0x45800000,s58
v_mov_b32 v223,s58
s_waitcnt vmcnt(12)
s_waitcnt vmcnt(8)
s_barrier
ds_read_b128 a[64:67],v205
ds_read_b128 a[68:71],v205 offset:2048
ds_read_b128 a[72:75],v206
ds_read_b128 a[76:79],v206 offset:2048
trr a[224:225],v193,16384
trr a[226:227],v193,18432
trr a[228:229],v194,16384
trr a[230:231],v194,18432
trr a[232:233],v195,16384
trr a[234:235],v195,18432
trr a[236:237],v196,16384
trr a[238:239],v196,18432
trr a[240:241],v197,16384
trr a[242:243],v197,18432
trr a[244:245],v198,16384
s_waitcnt lgkmcnt(14)
trr a[246:247],v198,18432
s_waitcnt lgkmcnt(8)
trr a[248:249],v199,16384
mf v[0:3],a[224:227],a[64:67],0
trr a[250:251],v199,18432
mf v[4:7],a[224:227],a[68:71],0
trr a[252:253],v200,16384
trr a[254:255],v200,18432
s_add_u32 m0,s49,65536
mf v[8:11],a[228:231],a[64:67],0
s_add_u32 s48,s45,s93
buffer_load_dwordx4 v212,s[20:23],s48 offen lds
mf v[12:15],a[228:231],a[68:71],0
s_waitcnt lgkmcnt(8)
trr a[224:225],v193,16640
mf v[16:19],a[232:235],a[64:67],0
trr a[226:227],v193,18688
buffer_load_dwordx4 v213,s[20:23],s48 offen offset:1024 lds
mf v[20:23],a[232:235],a[68:71],0
trr a[228:229],v194,16640
trr a[230:231],v194,18688
mf v[24:27],a[236:239],a[64:67],0
buffer_load_dwordx4 v214,s[20:23],s48 offen offset:2048 lds
mf v[28:31],a[236:239],a[68:71],0
s_waitcnt lgkmcnt(8)
trr a[232:233],v195,16640
mf v[32:35],a[240:243],a[64:67],0
trr a[234:235],v195,18688
buffer_load_dwordx4 v215,s[20:23],s48 offen offset:3072 lds
mf v[36:39],a[240:243],a[68:71],0
trr a[236:237],v196,16640
trr a[238:239],v196,18688
s_add_u32 m0,s49,81920
mf v[40:43],a[244:247],a[64:67],0
s_lshl_b32 s48,s93,12
s_add_u32 s48,s48,s52
buffer_load_dwordx4 v216,s[32:35],s48 offen lds
mf v[44:47],a[244:247],a[68:71],0
s_waitcnt lgkmcnt(8)
trr a[240:241],v197,16640
mf v[48:51],a[248:251],a[64:67],0
trr a[242:243],v197,18688
buffer_load_dwordx4 v217,s[32:35],s48 offen offset:1024 lds
mf v[52:55],a[248:251],a[68:71],0
trr a[244:245],v198,16640
trr a[246:247],v198,18688
mf v[56:59],a[252:255],a[64:67],0
buffer_load_dwordx4 v218,s[32:35],s48 offen offset:2048 lds
mf v[60:63],a[252:255],a[68:71],0
s_waitcnt lgkmcnt(8)
trr a[248:249],v199,16640
mf v[64:67],a[224:227],a[64:67],0
trr a[250:251],v199,18688
buffer_load_dwordx4 v219,s[32:35],s48 offen offset:3072 lds
mf v[68:71],a[224:227],a[68:71],0
trr a[252:253],v200,16640
mf v[72:75],a[228:231],a[64:67],0
trr a[254:255],v200,18688
mf v[76:79],a[228:231],a[68:71],0
s_waitcnt lgkmcnt(8)
s_waitcnt vmcnt(12)
s_barrier
mf v[80:83],a[232:235],a[64:67],0
trr a[224:225],v193,32768
trr a[226:227],v193,34816
mf v[84:87],a[232:235],a[68:71],0
trr a[228:229],v194,32768
trr a[230:231],v194,34816
s_add_u32 m0,s49,0
s_lshl_b32 s48,s93,12
mf v[88:91],a[236:239],a[64:67],0
s_add_u32 s48,s48,s52
s_add_u32 s48,s48,262144
buffer_load_dwordx4 v216,s[32:35],s48 offen lds
mf v[92:95],a[236:239],a[68:71],0
s_waitcnt lgkmcnt(8)
trr a[232:233],v195,32768
mf v[96:99],a[240:243],a[64:67],0
trr a[234:235],v195,34816
mf v[100:103],a[240:243],a[68:71],0
trr a[236:237],v196,32768
mf v[104:107],a[244:247],a[64:67],0
trr a[238:239],v196,34816
mf v[108:111],a[244:247],a[68:71],0
s_waitcnt lgkmcnt(8)
trr a[240:241],v197,32768
mf v[112:115],a[248:251],a[64:67],0
trr a[242:243],v197,34816
buffer_load_dwordx4 v217,s[32:35],s48 offen offset:1024 lds
mf v[116:119],a[248:251],a[68:71],0
trr a[244:245],v198,32768
mf v[120:123],a[252:255],a[64:67],0
trr a[246:247],v198,34816
mf v[124:127],a[252:255],a[68:71],0
s_waitcnt lgkmcnt(8)
trr a[248:249],v199,32768
mf v[0:3],a[224:227],a[72:75],v[0:3]
trr a[250:251],v199,34816
mf v[4:7],a[224:227],a[76:79],v[4:7]
trr a[252:253],v200,32768
trr a[254:255],v200,34816
mf v[8:11],a[228:231],a[72:75],v[8:11]
buffer_load_dwordx4 v218,s[32:35],s48 offen offset:2048 lds
mf v[12:15],a[228:231],a[76:79],v[12:15]
s_waitcnt lgkmcnt(8)
trr a[224:225],v193,33024
mf v[16:19],a[232:235],a[72:75],v[16:19]
trr a[226:227],v193,35072
mf v[20:23],a[232:235],a[76:79],v[20:23]
trr a[228:229],v194,33024
mf v[24:27],a[236:239],a[72:75],v[24:27]
trr a[230:231],v194,35072
mf v[28:31],a[236:239],a[76:79],v[28:31]
s_waitcnt lgkmcnt(8)
trr a[232:233],v195,33024
mf v[32:35],a[240:243],a[72:75],v[32:35]
trr a[234:235],v195,35072
buffer_load_dwordx4 v219,s[32:35],s48 offen offset:3072 lds
mf v[36:39],a[240:243],a[76:79],v[36:39]
trr a[236:237],v196,33024
mf v[40:43],a[244:247],a[72:75],v[40:43]
trr a[238:239],v196,35072
mf v[44:47],a[244:247],a[76:79],v[44:47]
s_waitcnt lgkmcnt(8)
trr a[240:241],v197,33024
mf v[48:51],a[248:251],a[72:75],v[48:51]
trr a[242:243],v197,35072
mf v[52:55],a[248:251],a[76:79],v[52:55]
trr a[244:245],v198,33024
mf v[56:59],a[252:255],a[72:75],v[56:59]
trr a[246:247],v198,35072
mf v[60:63],a[252:255],a[76:79],v[60:63]
s_waitcnt lgkmcnt(8)
trr a[248:249],v199,33024
mf v[64:67],a[224:227],a[72:75],v[64:67]
trr a[250:251],v199,35072
mf v[68:71],a[224:227],a[76:79],v[68:71]
v_add_u32 v193,0x10000,v193
trr a[252:253],v200,33024
mf v[72:75],a[228:231],a[72:75],v[72:75]
trr a[254:255],v200,35072
mf v[76:79],a[228:231],a[76:79],v[76:79]
s_waitcnt lgkmcnt(8)
s_waitcnt vmcnt(4)
s_barrier
mf v[80:83],a[232:235],a[72:75],v[80:83]
v_add_u32 v194,0x10000,v194
trr a[224:225],v193,16384
trr a[226:227],v193,18432
mf v[84:87],a[232:235],a[76:79],v[84:87]
v_add_u32 v205,0x10000,v205
v_add_u32 v206,0x10000,v206
v_add_u32 v195,0x10000,v195
trr a[228:229],v194,16384
mf v[88:91],a[236:239],a[72:75],v[88:91]
trr a[230:231],v194,18432
s_add_u32 m0,s49,16384
s_add_u32 s48,s45,s94
buffer_load_dwordx4 v212,s[20:23],s48 offen lds
mf v[92:95],a[236:239],a[76:79],v[92:95]
s_waitcnt lgkmcnt(8)
ds_read_b128 a[80:83],v205
v_add_u32 v196,0x10000,v196
mf v[96:99],a[240:243],a[72:75],v[96:99]
trr a[232:233],v195,16384
trr a[234:235],v195,18432
buffer_load_dwordx4 v213,s[20:23],s48 offen offset:1024 lds
mf v[100:103],a[240:243],a[76:79],v[100:103]
ds_read_b128 a[84:87],v205 offset:2048
v_add_u32 v197,0x10000,v197
trr a[236:237],v196,16384
mf v[104:107],a[244:247],a[72:75],v[104:107]
trr a[238:239],v196,18432
buffer_load_dwordx4 v214,s[20:23],s48 offen offset:2048 lds
mf v[108:111],a[244:247],a[76:79],v[108:111]
s_waitcnt lgkmcnt(10)
ds_read_b128 a[88:91],v206
v_add_u32 v198,0x10000,v198
mf v[112:115],a[248:251],a[72:75],v[112:115]
trr a[240:241],v197,16384
trr a[242:243],v197,18432
buffer_load_dwordx4 v215,s[20:23],s48 offen offset:3072 lds
mf v[116:119],a[248:251],a[76:79],v[116:119]
ds_read_b128 a[92:95],v206 offset:2048
v_add_u32 v199,0x10000,v199
trr a[244:245],v198,16384
s_waitcnt lgkmcnt(14)
trr a[246:247],v198,18432
mf v[120:123],a[252:255],a[72:75],v[120:123]
s_add_u32 m0,s49,98304
s_lshl_b32 s48,s94,12
s_add_u32 s48,s48,s52
buffer_load_dwordx4 v216,s[32:35],s48 offen lds
mf v[124:127],a[252:255],a[76:79],v[124:127]
s_waitcnt lgkmcnt(12)
v_add_u32 v200,0x10000,v200
trr a[248:249],v199,16384
s_waitcnt lgkmcnt(12)
mf v[0:3],a[224:227],a[80:83],v[0:3]
trr a[250:251],v199,18432
buffer_load_dwordx4 v217,s[32:35],s48 offen offset:1024 lds
s_waitcnt lgkmcnt(10)
mf v[4:7],a[224:227],a[84:87],v[4:7]
trr a[252:253],v200,16384
trr a[254:255],v200,18432
mf v[8:11],a[228:231],a[80:83],v[8:11]
buffer_load_dwordx4 v218,s[32:35],s48 offen offset:2048 lds
mf v[12:15],a[228:231],a[84:87],v[12:15]
s_waitcnt lgkmcnt(10)
trr a[224:225],v193,16640
mf v[16:19],a[232:235],a[80:83],v[16:19]
trr a[226:227],v193,18688
buffer_load_dwordx4 v219,s[32:35],s48 offen offset:3072 lds
mf v[20:23],a[232:235],a[84:87],v[20:23]
trr a[228:229],v194,16640
trr a[230:231],v194,18688
s_add_u32 m0,s49,114688
mf v[24:27],a[236:239],a[80:83],v[24:27]
s_add_u32 s48,s50,16384
buffer_load_dwordx4 v208,s[24:27],s48 offen nt lds
mf v[28:31],a[236:239],a[84:87],v[28:31]
s_waitcnt lgkmcnt(8)
trr a[232:233],v195,16640
mf v[32:35],a[240:243],a[80:83],v[32:35]
trr a[234:235],v195,18688
buffer_load_dwordx4 v209,s[24:27],s48 offen offset:1024 nt lds
mf v[36:39],a[240:243],a[84:87],v[36:39]
trr a[236:237],v196,16640
trr a[238:239],v196,18688
mf v[40:43],a[244:247],a[80:83],v[40:43]
buffer_load_dwordx4 v210,s[24:27],s48 offen offset:2048 nt lds
mf v[44:47],a[244:247],a[84:87],v[44:47]
s_waitcnt lgkmcnt(8)
trr a[240:241],v197,16640
mf v[48:51],a[248:251],a[80:83],v[48:51]
trr a[242:243],v197,18688
buffer_load_dwordx4 v211,s[24:27],s48 offen offset:3072 nt lds
mf v[52:55],a[248:251],a[84:87],v[52:55]
trr a[244:245],v198,16640
mf v[56:59],a[252:255],a[80:83],v[56:59]
trr a[246:247],v198,18688
mf v[60:63],a[252:255],a[84:87],v[60:63]
s_waitcnt lgkmcnt(8)
trr a[248:249],v199,16640
mf v[64:67],a[224:227],a[80:83],v[64:67]
trr a[250:251],v199,18688
mf v[68:71],a[224:227],a[84:87],v[68:71]
v_add_u32 v193,0xffff0000,v193
trr a[252:253],v200,16640
mf v[72:75],a[228:231],a[80:83],v[72:75]
trr a[254:255],v200,18688
mf v[76:79],a[228:231],a[84:87],v[76:79]
s_waitcnt lgkmcnt(8)
s_waitcnt vmcnt(12)
s_barrier
mf v[80:83],a[232:235],a[80:83],v[80:83]
v_add_u32 v194,0xffff0000,v194
trr a[224:225],v193,0
trr a[226:227],v193,2048
mf v[84:87],a[232:235],a[84:87],v[84:87]
v_add_u32 v195,0xffff0000,v195
trr a[228:229],v194,0
trr a[230:231],v194,2048
s_add_u32 m0,s49,32768
mf v[88:91],a[236:239],a[80:83],v[88:91]
s_lshl_b32 s48,s94,12
s_add_u32 s48,s48,s52
s_add_u32 s48,s48,262144
buffer_load_dwordx4 v216,s[32:35],s48 offen lds
mf v[92:95],a[236:239],a[84:87],v[92:95]
s_waitcnt lgkmcnt(8)
v_add_u32 v196,0xffff0000,v196
mf v[96:99],a[240:243],a[80:83],v[96:99]
trr a[232:233],v195,0
trr a[234:235],v195,2048
mf v[100:103],a[240:243],a[84:87],v[100:103]
v_add_u32 v197,0xffff0000,v197
trr a[236:237],v196,0
mf v[104:107],a[244:247],a[80:83],v[104:107]
trr a[238:239],v196,2048
mf v[108:111],a[244:247],a[84:87],v[108:111]
s_waitcnt lgkmcnt(8)
v_add_u32 v198,0xffff0000,v198
trr a[240:241],v197,0
mf v[112:115],a[248:251],a[80:83],v[112:115]
trr a[242:243],v197,2048
buffer_load_dwordx4 v217,s[32:35],s48 offen offset:1024 lds
mf v[116:119],a[248:251],a[84:87],v[116:119]
v_add_u32 v199,0xffff0000,v199
trr a[244:245],v198,0
mf v[120:123],a[252:255],a[80:83],v[120:123]
trr a[246:247],v198,2048
mf v[124:127],a[252:255],a[84:87],v[124:127]
s_waitcnt lgkmcnt(8)
v_add_u32 v200,0xffff0000,v200
mf v[0:3],a[224:227],a[88:91],v[0:3]
trr a[248:249],v199,0
trr a[250:251],v199,2048
mf v[4:7],a[224:227],a[92:95],v[4:7]
trr a[252:253],v200,0
trr a[254:255],v200,2048
mf v[8:11],a[228:231],a[88:91],v[8:11]
buffer_load_dwordx4 v218,s[32:35],s48 offen offset:2048 lds
mf v[12:15],a[228:231],a[92:95],v[12:15]
s_waitcnt lgkmcnt(8)
trr a[224:225],v193,256
mf v[16:19],a[232:235],a[88:91],v[16:19]
trr a[226:227],v193,2304
mf v[20:23],a[232:235],a[92:95],v[20:23]
trr a[228:229],v194,256
mf v[24:27],a[236:239],a[88:91],v[24:27]
trr a[230:231],v194,2304
mf v[28:31],a[236:239],a[92:95],v[28:31]
s_waitcnt lgkmcnt(8)
trr a[232:233],v195,256
mf v[32:35],a[240:243],a[88:91],v[32:35]
trr a[234:235],v195,2304
buffer_load_dwordx4 v219,s[32:35],s48 offen offset:3072 lds
mf v[36:39],a[240:243],a[92:95],v[36:39]
trr a[236:237],v196,256
mf v[40:43],a[244:247],a[88:91],v[40:43]
trr a[238:239],v196,2304
mf v[44:47],a[244:247],a[92:95],v[44:47]
s_waitcnt lgkmcnt(8)
trr a[240:241],v197,256
mf v[48:51],a[248:251],a[88:91],v[48:51]
trr a[242:243],v197,2304
mf v[52:55],a[248:251],a[92:95],v[52:55]
trr a[244:245],v198,256
mf v[56:59],a[252:255],a[88:91],v[56:59]
trr a[246:247],v198,2304
mf v[60:63],a[252:255],a[92:95],v[60:63]
s_waitcnt lgkmcnt(8)
trr a[248:249],v199,256
mf v[64:67],a[224:227],a[88:91],v[64:67]
trr a[250:251],v199,2304
mf v[68:71],a[224:227],a[92:95],v[68:71]
v_add_u32 v193,0x10000,v193
trr a[252:253],v200,256
mf v[72:75],a[228:231],a[88:91],v[72:75]
trr a[254:255],v200,2304
mf v[76:79],a[228:231],a[92:95],v[76:79]
s_waitcnt lgkmcnt(8)
s_waitcnt vmcnt(8)
s_barrier
mf v[80:83],a[232:235],a[88:91],v[80:83]
v_add_u32 v194,0x10000,v194
trr a[224:225],v193,32768
trr a[226:227],v193,34816
mf v[84:87],a[232:235],a[92:95],v[84:87]
v_add_u32 v205,0xffff0000,v205
v_add_u32 v206,0xffff0000,v206
v_add_u32 v195,0x10000,v195
trr a[228:229],v194,32768
mf v[88:91],a[236:239],a[88:91],v[88:91]
trr a[230:231],v194,34816
s_add_u32 m0,s49,65536
s_add_u32 s48,s45,s95
buffer_load_dwordx4 v212,s[20:23],s48 offen lds
mf v[92:95],a[236:239],a[92:95],v[92:95]
s_waitcnt lgkmcnt(8)
ds_read_b128 a[64:67],v205 offset:16384
v_add_u32 v196,0x10000,v196
mf v[96:99],a[240:243],a[88:91],v[96:99]
trr a[232:233],v195,32768
trr a[234:235],v195,34816
buffer_load_dwordx4 v213,s[20:23],s48 offen offset:1024 lds
mf v[100:103],a[240:243],a[92:95],v[100:103]
ds_read_b128 a[68:71],v205 offset:18432
v_add_u32 v197,0x10000,v197
trr a[236:237],v196,32768
mf v[104:107],a[244:247],a[88:91],v[104:107]
trr a[238:239],v196,34816
buffer_load_dwordx4 v214,s[20:23],s48 offen offset:2048 lds
mf v[108:111],a[244:247],a[92:95],v[108:111]
s_waitcnt lgkmcnt(10)
ds_read_b128 a[72:75],v206 offset:16384
v_add_u32 v198,0x10000,v198
mf v[112:115],a[248:251],a[88:91],v[112:115]
trr a[240:241],v197,32768
trr a[242:243],v197,34816
buffer_load_dwordx4 v215,s[20:23],s48 offen offset:3072 lds
mf v[116:119],a[248:251],a[92:95],v[116:119]
ds_read_b128 a[76:79],v206 offset:18432
v_add_u32 v199,0x10000,v199
trr a[244:245],v198,32768
s_waitcnt lgkmcnt(14)
trr a[246:247],v198,34816
mf v[120:123],a[252:255],a[88:91],v[120:123]
s_add_u32 m0,s49,81920
s_lshl_b32 s48,s95,12
s_add_u32 s48,s48,s52
buffer_load_dwordx4 v216,s[32:35],s48 offen lds
mf v[124:127],a[252:255],a[92:95],v[124:127]
s_waitcnt lgkmcnt(12)
v_add_u32 v200,0x10000,v200
trr a[248:249],v199,32768
s_waitcnt lgkmcnt(12)
mf v[0:3],a[224:227],a[64:67],v[0:3]
trr a[250:251],v199,34816
buffer_load_dwordx4 v217,s[32:35],s48 offen offset:1024 lds
s_waitcnt lgkmcnt(10)
mf v[4:7],a[224:227],a[68:71],v[4:7]
trr a[252:253],v200,32768
trr a[254:255],v200,34816
mf v[8:11],a[228:231],a[64:67],v[8:11]
buffer_load_dwordx4 v218,s[32:35],s48 offen offset:2048 lds
mf v[12:15],a[228:231],a[68:71],v[12:15]
s_waitcnt lgkmcnt(10)
trr a[224:225],v193,33024
mf v[16:19],a[232:235],a[64:67],v[16:19]
trr a[226:227],v193,35072
buffer_load_dwordx4 v219,s[32:35],s48 offen offset:3072 lds
mf v[20:23],a[232:235],a[68:71],v[20:23]
trr a[228:229],v194,33024
mf v[24:27],a[236:239],a[64:67],v[24:27]
trr a[230:231],v194,35072
mf v[28:31],a[236:239],a[68:71],v[28:31]
s_waitcnt lgkmcnt(8)
trr a[232:233],v195,33024
mf v[32:35],a[240:243],a[64:67],v[32:35]
trr a[234:235],v195,35072
mf v[36:39],a[240:243],a[68:71],v[36:39]
trr a[236:237],v196,33024
mf v[40:43],a[244:247],a[64:67],v[40:43]
trr a[238:239],v196,35072
mf v[44:47],a[244:247],a[68:71],v[44:47]
s_waitcnt lgkmcnt(8)
trr a[240:241],v197,33024
mf v[48:51],a[248:251],a[64:67],v[48:51]
trr a[242:243],v197,35072
mf v[52:55],a[248:251],a[68:71],v[52:55]
trr a[244:245],v198,33024
mf v[56:59],a[252:255],a[64:67],v[56:59]
trr a[246:247],v198,35072
mf v[60:63],a[252:255],a[68:71],v[60:63]
s_waitcnt lgkmcnt(8)
trr a[248:249],v199,33024
mf v[64:67],a[224:227],a[64:67],v[64:67]
trr a[250:251],v199,35072
mf v[68:71],a[224:227],a[68:71],v[68:71]
v_add_u32 v193,0xffff0000,v193
trr a[252:253],v200,33024
mf v[72:75],a[228:231],a[64:67],v[72:75]
trr a[254:255],v200,35072
mf v[76:79],a[228:231],a[68:71],v[76:79]
s_waitcnt lgkmcnt(8)
s_waitcnt vmcnt(8)
s_barrier
mf v[80:83],a[232:235],a[64:67],v[80:83]
v_add_u32 v194,0xffff0000,v194
trr a[224:225],v193,32768
trr a[226:227],v193,34816
mf v[84:87],a[232:235],a[68:71],v[84:87]
v_add_u32 v195,0xffff0000,v195
trr a[228:229],v194,32768
trr a[230:231],v194,34816
s_add_u32 m0,s49,0
mf v[88:91],a[236:239],a[64:67],v[88:91]
s_lshl_b32 s48,s95,12
s_add_u32 s48,s48,s52
s_add_u32 s48,s48,262144
buffer_load_dwordx4 v216,s[32:35],s48 offen lds
mf v[92:95],a[236:239],a[68:71],v[92:95]
s_waitcnt lgkmcnt(8)
v_add_u32 v196,0xffff0000,v196
trr a[232:233],v195,32768
mf v[96:99],a[240:243],a[64:67],v[96:99]
trr a[234:235],v195,34816
buffer_load_dwordx4 v217,s[32:35],s48 offen offset:1024 lds
mf v[100:103],a[240:243],a[68:71],v[100:103]
v_add_u32 v197,0xffff0000,v197
trr a[236:237],v196,32768
mf v[104:107],a[244:247],a[64:67],v[104:107]
trr a[238:239],v196,34816
buffer_load_dwordx4 v218,s[32:35],s48 offen offset:2048 lds
mf v[108:111],a[244:247],a[68:71],v[108:111]
s_waitcnt lgkmcnt(8)
v_add_u32 v198,0xffff0000,v198
trr a[240:241],v197,32768
mf v[112:115],a[248:251],a[64:67],v[112:115]
trr a[242:243],v197,34816
buffer_load_dwordx4 v219,s[32:35],s48 offen offset:3072 lds
mf v[116:119],a[248:251],a[68:71],v[116:119]
v_add_u32 v199,0xffff0000,v199
trr a[244:245],v198,32768
trr a[246:247],v198,34816
mf v[120:123],a[252:255],a[64:67],v[120:123]
s_add_u32 m0,s49,16384
s_add_u32 s48,s50,32768
buffer_load_dwordx4 v208,s[24:27],s48 offen nt lds
mf v[124:127],a[252:255],a[68:71],v[124:127]
s_waitcnt lgkmcnt(8)
v_add_u32 v200,0xffff0000,v200
trr a[248:249],v199,32768
mf v[0:3],a[224:227],a[72:75],v[0:3]
trr a[250:251],v199,34816
buffer_load_dwordx4 v209,s[24:27],s48 offen offset:1024 nt lds
mf v[4:7],a[224:227],a[76:79],v[4:7]
trr a[252:253],v200,32768
trr a[254:255],v200,34816
mf v[8:11],a[228:231],a[72:75],v[8:11]
buffer_load_dwordx4 v210,s[24:27],s48 offen offset:2048 nt lds
mf v[12:15],a[228:231],a[76:79],v[12:15]
s_waitcnt lgkmcnt(8)
trr a[224:225],v193,33024
mf v[16:19],a[232:235],a[72:75],v[16:19]
trr a[226:227],v193,35072
buffer_load_dwordx4 v211,s[24:27],s48 offen offset:3072 nt lds
mf v[20:23],a[232:235],a[76:79],v[20:23]
trr a[228:229],v194,33024
mf v[24:27],a[236:239],a[72:75],v[24:27]
trr a[230:231],v194,35072
mf v[28:31],a[236:239],a[76:79],v[28:31]
s_waitcnt lgkmcnt(8)
trr a[232:233],v195,33024
mf v[32:35],a[240:243],a[72:75],v[32:35]
trr a[234:235],v195,35072
mf v[36:39],a[240:243],a[76:79],v[36:39]
trr a[236:237],v196,33024
mf v[40:43],a[244:247],a[72:75],v[40:43]
trr a[238:239],v196,35072
mf v[44:47],a[244:247],a[76:79],v[44:47]
s_waitcnt lgkmcnt(8)
trr a[240:241],v197,33024
mf v[48:51],a[248:251],a[72:75],v[48:51]
trr a[242:243],v197,35072
mf v[52:55],a[248:251],a[76:79],v[52:55]
trr a[244:245],v198,33024
mf v[56:59],a[252:255],a[72:75],v[56:59]
trr a[246:247],v198,35072
mf v[60:63],a[252:255],a[76:79],v[60:63]
s_waitcnt lgkmcnt(8)
trr a[248:249],v199,33024
mf v[64:67],a[224:227],a[72:75],v[64:67]
trr a[250:251],v199,35072
mf v[68:71],a[224:227],a[76:79],v[68:71]
v_add_u32 v193,0x10000,v193
trr a[252:253],v200,33024
mf v[72:75],a[228:231],a[72:75],v[72:75]
trr a[254:255],v200,35072
mf v[76:79],a[228:231],a[76:79],v[76:79]
s_waitcnt lgkmcnt(8)
s_waitcnt vmcnt(8)
s_barrier
mf v[80:83],a[232:235],a[72:75],v[80:83]
v_add_u32 v194,0x10000,v194
trr a[224:225],v193,16384
trr a[226:227],v193,18432
mf v[84:87],a[232:235],a[76:79],v[84:87]
v_add_u32 v205,0x10000,v205
v_add_u32 v206,0x10000,v206
v_add_u32 v195,0x10000,v195
trr a[228:229],v194,16384
mf v[88:91],a[236:239],a[72:75],v[88:91]
trr a[230:231],v194,18432
s_add_u32 m0,s49,98304
s_add_u32 s48,s45,s96
buffer_load_dwordx4 v212,s[20:23],s48 offen lds
mf v[92:95],a[236:239],a[76:79],v[92:95]
s_waitcnt lgkmcnt(8)
ds_read_b128 a[80:83],v205
v_add_u32 v196,0x10000,v196
mf v[96:99],a[240:243],a[72:75],v[96:99]
trr a[232:233],v195,16384
trr a[234:235],v195,18432
buffer_load_dwordx4 v213,s[20:23],s48 offen offset:1024 lds
mf v[100:103],a[240:243],a[76:79],v[100:103]
ds_read_b128 a[84:87],v205 offset:2048
v_add_u32 v197,0x10000,v197
trr a[236:237],v196,16384
mf v[104:107],a[244:247],a[72:75],v[104:107]
trr a[238:239],v196,18432
buffer_load_dwordx4 v214,s[20:23],s48 offen offset:2048 lds
mf v[108:111],a[244:247],a[76:79],v[108:111]
s_waitcnt lgkmcnt(10)
ds_read_b128 a[88:91],v206
v_add_u32 v198,0x10000,v198
mf v[112:115],a[248:251],a[72:75],v[112:115]
trr a[240:241],v197,16384
trr a[242:243],v197,18432
buffer_load_dwordx4 v215,s[20:23],s48 offen offset:3072 lds
mf v[116:119],a[248:251],a[76:79],v[116:119]
ds_read_b128 a[92:95],v206 offset:2048
v_add_u32 v199,0x10000,v199
trr a[244:245],v198,16384
s_waitcnt lgkmcnt(14)
trr a[246:247],v198,18432
mf v[120:123],a[252:255],a[72:75],v[120:123]
s_add_u32 m0,s49,131072
s_lshl_b32 s48,s96,12
s_add_u32 s48,s48,s52
buffer_load_dwordx4 v216,s[32:35],s48 offen lds
mf v[124:127],a[252:255],a[76:79],v[124:127]
s_waitcnt lgkmcnt(12)
v_add_u32 v200,0x10000,v200
trr a[248:249],v199,16384
s_waitcnt lgkmcnt(12)
mf v[0:3],a[224:227],a[80:83],v[0:3]
trr a[250:251],v199,18432
buffer_load_dwordx4 v217,s[32:35],s48 offen offset:1024 lds
s_waitcnt lgkmcnt(10)
mf v[4:7],a[224:227],a[84:87],v[4:7]
trr a[252:253],v200,16384
trr a[254:255],v200,18432
mf v[8:11],a[228:231],a[80:83],v[8:11]
buffer_load_dwordx4 v218,s[32:35],s48 offen offset:2048 lds
mf v[12:15],a[228:231],a[84:87],v[12:15]
s_waitcnt lgkmcnt(10)
trr a[224:225],v193,16640
mf v[16:19],a[232:235],a[80:83],v[16:19]
trr a[226:227],v193,18688
buffer_load_dwordx4 v219,s[32:35],s48 offen offset:3072 lds
mf v[20:23],a[232:235],a[84:87],v[20:23]
trr a[228:229],v194,16640
mf v[24:27],a[236:239],a[80:83],v[24:27]
trr a[230:231],v194,18688
mf v[28:31],a[236:239],a[84:87],v[28:31]
s_waitcnt lgkmcnt(8)
trr a[232:233],v195,16640
mf v[32:35],a[240:243],a[80:83],v[32:35]
trr a[234:235],v195,18688
mf v[36:39],a[240:243],a[84:87],v[36:39]
trr a[236:237],v196,16640
mf v[40:43],a[244:247],a[80:83],v[40:43]
trr a[238:239],v196,18688
mf v[44:47],a[244:247],a[84:87],v[44:47]
s_waitcnt lgkmcnt(8)
trr a[240:241],v197,16640
mf v[48:51],a[248:251],a[80:83],v[48:51]
trr a[242:243],v197,18688
mf v[52:55],a[248:251],a[84:87],v[52:55]
trr a[244:245],v198,16640
mf v[56:59],a[252:255],a[80:83],v[56:59]
trr a[246:247],v198,18688
mf v[60:63],a[252:255],a[84:87],v[60:63]
s_waitcnt lgkmcnt(8)
trr a[248:249],v199,16640
mf v[64:67],a[224:227],a[80:83],v[64:67]
trr a[250:251],v199,18688
mf v[68:71],a[224:227],a[84:87],v[68:71]
v_add_u32 v193,0xffff0000,v193
trr a[252:253],v200,16640
mf v[72:75],a[228:231],a[80:83],v[72:75]
trr a[254:255],v200,18688
mf v[76:79],a[228:231],a[84:87],v[76:79]
s_waitcnt lgkmcnt(8)
s_waitcnt vmcnt(12)
s_barrier
mf v[80:83],a[232:235],a[80:83],v[80:83]
v_add_u32 v194,0xffff0000,v194
trr a[224:225],v193,0
trr a[226:227],v193,2048
mf v[84:87],a[232:235],a[84:87],v[84:87]
v_add_u32 v195,0xffff0000,v195
trr a[228:229],v194,0
trr a[230:231],v194,2048
s_add_u32 m0,s49,32768
mf v[88:91],a[236:239],a[80:83],v[88:91]
s_lshl_b32 s48,s96,12
s_add_u32 s48,s48,s52
s_add_u32 s48,s48,262144
buffer_load_dwordx4 v216,s[32:35],s48 offen lds
mf v[92:95],a[236:239],a[84:87],v[92:95]
s_waitcnt lgkmcnt(8)
v_add_u32 v196,0xffff0000,v196
mf v[96:99],a[240:243],a[80:83],v[96:99]
trr a[232:233],v195,0
trr a[234:235],v195,2048
mf v[100:103],a[240:243],a[84:87],v[100:103]
v_add_u32 v197,0xffff0000,v197
trr a[236:237],v196,0
mf v[104:107],a[244:247],a[80:83],v[104:107]
trr a[238:239],v196,2048
mf v[108:111],a[244:247],a[84:87],v[108:111]
s_waitcnt lgkmcnt(8)
v_add_u32 v198,0xffff0000,v198
trr a[240:241],v197,0
mf v[112:115],a[248:251],a[80:83],v[112:115]
trr a[242:243],v197,2048
buffer_load_dwordx4 v217,s[32:35],s48 offen offset:1024 lds
mf v[116:119],a[248:251],a[84:87],v[116:119]
v_add_u32 v199,0xffff0000,v199
trr a[244:245],v198,0
mf v[120:123],a[252:255],a[80:83],v[120:123]
trr a[246:247],v198,2048
mf v[124:127],a[252:255],a[84:87],v[124:127]
s_waitcnt lgkmcnt(8)
v_add_u32 v200,0xffff0000,v200
mf v[0:3],a[224:227],a[88:91],v[0:3]
trr a[248:249],v199,0
trr a[250:251],v199,2048
mf v[4:7],a[224:227],a[92:95],v[4:7]
trr a[252:253],v200,0
trr a[254:255],v200,2048
mf v[8:11],a[228:231],a[88:91],v[8:11]
buffer_load_dwordx4 v218,s[32:35],s48 offen offset:2048 lds
mf v[12:15],a[228:231],a[92:95],v[12:15]
s_waitcnt lgkmcnt(8)
trr a[224:225],v193,256
mf v[16:19],a[232:235],a[88:91],v[16:19]
trr a[226:227],v193,2304
mf v[20:23],a[232:235],a[92:95],v[20:23]
trr a[228:229],v194,256
mf v[24:27],a[236:239],a[88:91],v[24:27]
trr a[230:231],v194,2304
mf v[28:31],a[236:239],a[92:95],v[28:31]
s_waitcnt lgkmcnt(8)
trr a[232:233],v195,256
mf v[32:35],a[240:243],a[88:91],v[32:35]
trr a[234:235],v195,2304
buffer_load_dwordx4 v219,s[32:35],s48 offen offset:3072 lds
mf v[36:39],a[240:243],a[92:95],v[36:39]
trr a[236:237],v196,256
mf v[40:43],a[244:247],a[88:91],v[40:43]
trr a[238:239],v196,2304
mf v[44:47],a[244:247],a[92:95],v[44:47]
s_waitcnt lgkmcnt(8)
trr a[240:241],v197,256
mf v[48:51],a[248:251],a[88:91],v[48:51]
trr a[242:243],v197,2304
mf v[52:55],a[248:251],a[92:95],v[52:55]
trr a[244:245],v198,256
mf v[56:59],a[252:255],a[88:91],v[56:59]
trr a[246:247],v198,2304
mf v[60:63],a[252:255],a[92:95],v[60:63]
s_waitcnt lgkmcnt(8)
trr a[248:249],v199,256
mf v[64:67],a[224:227],a[88:91],v[64:67]
trr a[250:251],v199,2304
mf v[68:71],a[224:227],a[92:95],v[68:71]
v_add_u32 v193,0x20000,v193
trr a[252:253],v200,256
mf v[72:75],a[228:231],a[88:91],v[72:75]
trr a[254:255],v200,2304
mf v[76:79],a[228:231],a[92:95],v[76:79]
s_waitcnt lgkmcnt(8)
s_waitcnt vmcnt(4)
s_barrier
mf v[80:83],a[232:235],a[88:91],v[80:83]
v_add_u32 v194,0x20000,v194
trr a[224:225],v193,0
trr a[226:227],v193,2048
mf v[84:87],a[232:235],a[92:95],v[84:87]
v_add_u32 v195,0x20000,v195
trr a[228:229],v194,0
trr a[230:231],v194,2048
mf v[88:91],a[236:239],a[88:91],v[88:91]
s_add_u32 m0,s49,65536
s_add_u32 s48,s45,s97
buffer_load_dwordx4 v212,s[20:23],s48 offen lds
mf v[92:95],a[236:239],a[92:95],v[92:95]
s_waitcnt lgkmcnt(8)
ds_read_b128 a[64:67],v205 offset:32768
v_add_u32 v196,0x20000,v196
mf v[96:99],a[240:243],a[88:91],v[96:99]
trr a[232:233],v195,0
trr a[234:235],v195,2048
buffer_load_dwordx4 v213,s[20:23],s48 offen offset:1024 lds
mf v[100:103],a[240:243],a[92:95],v[100:103]
ds_read_b128 a[68:71],v205 offset:34816
v_add_u32 v197,0x20000,v197
trr a[236:237],v196,0
mf v[104:107],a[244:247],a[88:91],v[104:107]
trr a[238:239],v196,2048
buffer_load_dwordx4 v214,s[20:23],s48 offen offset:2048 lds
mf v[108:111],a[244:247],a[92:95],v[108:111]
s_waitcnt lgkmcnt(10)
ds_read_b128 a[72:75],v206 offset:32768
v_add_u32 v198,0x20000,v198
mf v[112:115],a[248:251],a[88:91],v[112:115]
trr a[240:241],v197,0
trr a[242:243],v197,2048
buffer_load_dwordx4 v215,s[20:23],s48 offen offset:3072 lds
mf v[116:119],a[248:251],a[92:95],v[116:119]
ds_read_b128 a[76:79],v206 offset:34816
v_add_u32 v199,0x20000,v199
trr a[244:245],v198,0
s_waitcnt lgkmcnt(14)
trr a[246:247],v198,2048
mf v[120:123],a[252:255],a[88:91],v[120:123]
s_add_u32 m0,s49,81920
s_lshl_b32 s48,s97,12
s_add_u32 s48,s48,s52
buffer_load_dwordx4 v216,s[32:35],s48 offen lds
mf v[124:127],a[252:255],a[92:95],v[124:127]
s_waitcnt lgkmcnt(12)
v_add_u32 v200,0x20000,v200
trr a[248:249],v199,0
s_waitcnt lgkmcnt(12)
mf v[0:3],a[224:227],a[64:67],v[0:3]
trr a[250:251],v199,2048
buffer_load_dwordx4 v217,s[32:35],s48 offen offset:1024 lds
s_waitcnt lgkmcnt(10)
mf v[4:7],a[224:227],a[68:71],v[4:7]
trr a[252:253],v200,0
trr a[254:255],v200,2048
mf v[8:11],a[228:231],a[64:67],v[8:11]
buffer_load_dwordx4 v218,s[32:35],s48 offen offset:2048 lds
mf v[12:15],a[228:231],a[68:71],v[12:15]
s_waitcnt lgkmcnt(10)
trr a[224:225],v193,256
mf v[16:19],a[232:235],a[64:67],v[16:19]
trr a[226:227],v193,2304
buffer_load_dwordx4 v219,s[32:35],s48 offen offset:3072 lds
mf v[20:23],a[232:235],a[68:71],v[20:23]
trr a[228:229],v194,256
trr a[230:231],v194,2304
s_add_u32 m0,s49,147456
mf v[24:27],a[236:239],a[64:67],v[24:27]
s_add_u32 s48,s50,49152
buffer_load_dwordx4 v208,s[24:27],s48 offen nt lds
mf v[28:31],a[236:239],a[68:71],v[28:31]
s_waitcnt lgkmcnt(8)
trr a[232:233],v195,256
mf v[32:35],a[240:243],a[64:67],v[32:35]
trr a[234:235],v195,2304
buffer_load_dwordx4 v209,s[24:27],s48 offen offset:1024 nt lds
mf v[36:39],a[240:243],a[68:71],v[36:39]
trr a[236:237],v196,256
trr a[238:239],v196,2304
mf v[40:43],a[244:247],a[64:67],v[40:43]
buffer_load_dwordx4 v210,s[24:27],s48 offen offset:2048 nt lds
mf v[44:47],a[244:247],a[68:71],v[44:47]
s_waitcnt lgkmcnt(8)
trr a[240:241],v197,256
mf v[48:51],a[248:251],a[64:67],v[48:51]
trr a[242:243],v197,2304
buffer_load_dwordx4 v211,s[24:27],s48 offen offset:3072 nt lds
mf v[52:55],a[248:251],a[68:71],v[52:55]
trr a[244:245],v198,256
mf v[56:59],a[252:255],a[64:67],v[56:59]
trr a[246:247],v198,2304
mf v[60:63],a[252:255],a[68:71],v[60:63]
s_waitcnt lgkmcnt(8)
trr a[248:249],v199,256
mf v[64:67],a[224:227],a[64:67],v[64:67]
trr a[250:251],v199,2304
mf v[68:71],a[224:227],a[68:71],v[68:71]
v_add_u32 v193,0xfffe0000,v193
trr a[252:253],v200,256
mf v[72:75],a[228:231],a[64:67],v[72:75]
trr a[254:255],v200,2304
mf v[76:79],a[228:231],a[68:71],v[76:79]
s_waitcnt lgkmcnt(8)
s_waitcnt vmcnt(12)
s_barrier
mf v[80:83],a[232:235],a[64:67],v[80:83]
v_add_u32 v194,0xfffe0000,v194
trr a[224:225],v193,32768
trr a[226:227],v193,34816
mf v[84:87],a[232:235],a[68:71],v[84:87]
v_add_u32 v195,0xfffe0000,v195
trr a[228:229],v194,32768
trr a[230:231],v194,34816
s_add_u32 m0,s49,0
mf v[88:91],a[236:239],a[64:67],v[88:91]
s_lshl_b32 s48,s97,12
s_add_u32 s48,s48,s52
s_add_u32 s48,s48,262144
buffer_load_dwordx4 v216,s[32:35],s48 offen lds
mf v[92:95],a[236:239],a[68:71],v[92:95]
s_waitcnt lgkmcnt(8)
v_add_u32 v196,0xfffe0000,v196
mf v[96:99],a[240:243],a[64:67],v[96:99]
trr a[232:233],v195,32768
trr a[234:235],v195,34816
mf v[100:103],a[240:243],a[68:71],v[100:103]
v_add_u32 v197,0xfffe0000,v197
trr a[236:237],v196,32768
mf v[104:107],a[244:247],a[64:67],v[104:107]
trr a[238:239],v196,34816
mf v[108:111],a[244:247],a[68:71],v[108:111]
s_waitcnt lgkmcnt(8)
v_add_u32 v198,0xfffe0000,v198
trr a[240:241],v197,32768
mf v[112:115],a[248:251],a[64:67],v[112:115]
trr a[242:243],v197,34816
buffer_load_dwordx4 v217,s[32:35],s48 offen offset:1024 lds
mf v[116:119],a[248:251],a[68:71],v[116:119]
v_add_u32 v199,0xfffe0000,v199
trr a[244:245],v198,32768
mf v[120:123],a[252:255],a[64:67],v[120:123]
trr a[246:247],v198,34816
mf v[124:127],a[252:255],a[68:71],v[124:127]
s_waitcnt lgkmcnt(8)
v_add_u32 v200,0xfffe0000,v200
mf v[0:3],a[224:227],a[72:75],v[0:3]
trr a[248:249],v199,32768
trr a[250:251],v199,34816
mf v[4:7],a[224:227],a[76:79],v[4:7]
trr a[252:253],v200,32768
trr a[254:255],v200,34816
mf v[8:11],a[228:231],a[72:75],v[8:11]
buffer_load_dwordx4 v218,s[32:35],s48 offen offset:2048 lds
mf v[12:15],a[228:231],a[76:79],v[12:15]
s_waitcnt lgkmcnt(8)
trr a[224:225],v193,33024
mf v[16:19],a[232:235],a[72:75],v[16:19]
trr a[226:227],v193,35072
mf v[20:23],a[232:235],a[76:79],v[20:23]
trr a[228:229],v194,33024
mf v[24:27],a[236:239],a[72:75],v[24:27]
trr a[230:231],v194,35072
mf v[28:31],a[236:239],a[76:79],v[28:31]
s_waitcnt lgkmcnt(8)
trr a[232:233],v195,33024
mf v[32:35],a[240:243],a[72:75],v[32:35]
trr a[234:235],v195,35072
buffer_load_dwordx4 v219,s[32:35],s48 offen offset:3072 lds
mf v[36:39],a[240:243],a[76:79],v[36:39]
trr a[236:237],v196,33024
mf v[40:43],a[244:247],a[72:75],v[40:43]
trr a[238:239],v196,35072
mf v[44:47],a[244:247],a[76:79],v[44:47]
s_waitcnt lgkmcnt(8)
trr a[240:241],v197,33024
mf v[48:51],a[248:251],a[72:75],v[48:51]
trr a[242:243],v197,35072
mf v[52:55],a[248:251],a[76:79],v[52:55]
trr a[244:245],v198,33024
mf v[56:59],a[252:255],a[72:75],v[56:59]
trr a[246:247],v198,35072
mf v[60:63],a[252:255],a[76:79],v[60:63]
s_waitcnt lgkmcnt(8)
trr a[248:249],v199,33024
mf v[64:67],a[224:227],a[72:75],v[64:67]
trr a[250:251],v199,35072
mf v[68:71],a[224:227],a[76:79],v[68:71]
v_add_u32 v193,0x10000,v193
trr a[252:253],v200,33024
mf v[72:75],a[228:231],a[72:75],v[72:75]
trr a[254:255],v200,35072
mf v[76:79],a[228:231],a[76:79],v[76:79]
s_waitcnt lgkmcnt(8)
s_waitcnt vmcnt(8)
s_barrier
mf v[80:83],a[232:235],a[72:75],v[80:83]
v_add_u32 v194,0x10000,v194
trr a[224:225],v193,16384
trr a[226:227],v193,18432
mf v[84:87],a[232:235],a[76:79],v[84:87]
v_add_u32 v195,0x10000,v195
trr a[228:229],v194,16384
trr a[230:231],v194,18432
mf v[88:91],a[236:239],a[72:75],v[88:91]
s_add_u32 m0,s49,98304
s_add_u32 s48,s45,s98
buffer_load_dwordx4 v212,s[20:23],s48 offen lds
mf v[92:95],a[236:239],a[76:79],v[92:95]
s_waitcnt lgkmcnt(8)
ds_read_b128 a[80:83],v205
v_add_u32 v196,0x10000,v196
mf v[96:99],a[240:243],a[72:75],v[96:99]
trr a[232:233],v195,16384
trr a[234:235],v195,18432
buffer_load_dwordx4 v213,s[20:23],s48 offen offset:1024 lds
mf v[100:103],a[240:243],a[76:79],v[100:103]
ds_read_b128 a[84:87],v205 offset:2048
v_add_u32 v197,0x10000,v197
trr a[236:237],v196,16384
mf v[104:107],a[244:247],a[72:75],v[104:107]
trr a[238:239],v196,18432
buffer_load_dwordx4 v214,s[20:23],s48 offen offset:2048 lds
mf v[108:111],a[244:247],a[76:79],v[108:111]
s_waitcnt lgkmcnt(10)
ds_read_b128 a[88:91],v206
v_add_u32 v198,0x10000,v198
mf v[112:115],a[248:251],a[72:75],v[112:115]
trr a[240:241],v197,16384
trr a[242:243],v197,18432
buffer_load_dwordx4 v215,s[20:23],s48 offen offset:3072 lds
mf v[116:119],a[248:251],a[76:79],v[116:119]
ds_read_b128 a[92:95],v206 offset:2048
v_add_u32 v199,0x10000,v199
trr a[244:245],v198,16384
s_waitcnt lgkmcnt(14)
trr a[246:247],v198,18432
mf v[120:123],a[252:255],a[72:75],v[120:123]
s_add_u32 m0,s49,131072
s_lshl_b32 s48,s98,12
s_add_u32 s48,s48,s52
buffer_load_dwordx4 v216,s[32:35],s48 offen lds
mf v[124:127],a[252:255],a[76:79],v[124:127]
s_waitcnt lgkmcnt(12)
v_add_u32 v200,0x10000,v200
trr a[248:249],v199,16384
s_waitcnt lgkmcnt(12)
mf v[0:3],a[224:227],a[80:83],v[0:3]
trr a[250:251],v199,18432
buffer_load_dwordx4 v217,s[32:35],s48 offen offset:1024 lds
s_waitcnt lgkmcnt(10)
mf v[4:7],a[224:227],a[84:87],v[4:7]
trr a[252:253],v200,16384
trr a[254:255],v200,18432
mf v[8:11],a[228:231],a[80:83],v[8:11]
buffer_load_dwordx4 v218,s[32:35],s48 offen offset:2048 lds
mf v[12:15],a[228:231],a[84:87],v[12:15]
s_waitcnt lgkmcnt(10)
trr a[224:225],v193,16640
mf v[16:19],a[232:235],a[80:83],v[16:19]
trr a[226:227],v193,18688
buffer_load_dwordx4 v219,s[32:35],s48 offen offset:3072 lds
mf v[20:23],a[232:235],a[84:87],v[20:23]
trr a[228:229],v194,16640
mf v[24:27],a[236:239],a[80:83],v[24:27]
trr a[230:231],v194,18688
mf v[28:31],a[236:239],a[84:87],v[28:31]
s_waitcnt lgkmcnt(8)
trr a[232:233],v195,16640
mf v[32:35],a[240:243],a[80:83],v[32:35]
trr a[234:235],v195,18688
mf v[36:39],a[240:243],a[84:87],v[36:39]
trr a[236:237],v196,16640
mf v[40:43],a[244:247],a[80:83],v[40:43]
trr a[238:239],v196,18688
mf v[44:47],a[244:247],a[84:87],v[44:47]
s_waitcnt lgkmcnt(8)
trr a[240:241],v197,16640
mf v[48:51],a[248:251],a[80:83],v[48:51]
trr a[242:243],v197,18688
mf v[52:55],a[248:251],a[84:87],v[52:55]
trr a[244:245],v198,16640
mf v[56:59],a[252:255],a[80:83],v[56:59]
trr a[246:247],v198,18688
mf v[60:63],a[252:255],a[84:87],v[60:63]
s_waitcnt lgkmcnt(8)
trr a[248:249],v199,16640
mf v[64:67],a[224:227],a[80:83],v[64:67]
trr a[250:251],v199,18688
mf v[68:71],a[224:227],a[84:87],v[68:71]
v_add_u32 v193,0xffff0000,v193
trr a[252:253],v200,16640
mf v[72:75],a[228:231],a[80:83],v[72:75]
trr a[254:255],v200,18688
mf v[76:79],a[228:231],a[84:87],v[76:79]
s_waitcnt lgkmcnt(8)
s_waitcnt vmcnt(8)
s_barrier
mf v[80:83],a[232:235],a[80:83],v[80:83]
v_add_u32 v194,0xffff0000,v194
trr a[224:225],v193,0
trr a[226:227],v193,2048
mf v[84:87],a[232:235],a[84:87],v[84:87]
v_add_u32 v195,0xffff0000,v195
trr a[228:229],v194,0
trr a[230:231],v194,2048
s_add_u32 m0,s49,32768
mf v[88:91],a[236:239],a[80:83],v[88:91]
s_lshl_b32 s48,s98,12
s_add_u32 s48,s48,s52
s_add_u32 s48,s48,262144
buffer_load_dwordx4 v216,s[32:35],s48 offen lds
mf v[92:95],a[236:239],a[84:87],v[92:95]
s_waitcnt lgkmcnt(8)
v_add_u32 v196,0xffff0000,v196
trr a[232:233],v195,0
mf v[96:99],a[240:243],a[80:83],v[96:99]
trr a[234:235],v195,2048
buffer_load_dwordx4 v217,s[32:35],s48 offen offset:1024 lds
mf v[100:103],a[240:243],a[84:87],v[100:103]
v_add_u32 v197,0xffff0000,v197
trr a[236:237],v196,0
mf v[104:107],a[244:247],a[80:83],v[104:107]
trr a[238:239],v196,2048
buffer_load_dwordx4 v218,s[32:35],s48 offen offset:2048 lds
mf v[108:111],a[244:247],a[84:87],v[108:111]
s_waitcnt lgkmcnt(8)
v_add_u32 v198,0xffff0000,v198
trr a[240:241],v197,0
mf v[112:115],a[248:251],a[80:83],v[112:115]
trr a[242:243],v197,2048
buffer_load_dwordx4 v219,s[32:35],s48 offen offset:3072 lds
mf v[116:119],a[248:251],a[84:87],v[116:119]
v_add_u32 v199,0xffff0000,v199
trr a[244:245],v198,0
trr a[246:247],v198,2048
mf v[120:123],a[252:255],a[80:83],v[120:123]
s_add_u32 m0,s49,65536
s_add_u32 s48,s50,65536
buffer_load_dwordx4 v208,s[24:27],s48 offen nt lds
mf v[124:127],a[252:255],a[84:87],v[124:127]
s_waitcnt lgkmcnt(8)
v_add_u32 v200,0xffff0000,v200
trr a[248:249],v199,0
mf v[0:3],a[224:227],a[88:91],v[0:3]
trr a[250:251],v199,2048
buffer_load_dwordx4 v209,s[24:27],s48 offen offset:1024 nt lds
mf v[4:7],a[224:227],a[92:95],v[4:7]
trr a[252:253],v200,0
trr a[254:255],v200,2048
mf v[8:11],a[228:231],a[88:91],v[8:11]
buffer_load_dwordx4 v210,s[24:27],s48 offen offset:2048 nt lds
mf v[12:15],a[228:231],a[92:95],v[12:15]
s_waitcnt lgkmcnt(8)
trr a[224:225],v193,256
mf v[16:19],a[232:235],a[88:91],v[16:19]
trr a[226:227],v193,2304
buffer_load_dwordx4 v211,s[24:27],s48 offen offset:3072 nt lds
mf v[20:23],a[232:235],a[92:95],v[20:23]
trr a[228:229],v194,256
mf v[24:27],a[236:239],a[88:91],v[24:27]
trr a[230:231],v194,2304
mf v[28:31],a[236:239],a[92:95],v[28:31]
s_waitcnt lgkmcnt(8)
trr a[232:233],v195,256
mf v[32:35],a[240:243],a[88:91],v[32:35]
trr a[234:235],v195,2304
mf v[36:39],a[240:243],a[92:95],v[36:39]
trr a[236:237],v196,256
mf v[40:43],a[244:247],a[88:91],v[40:43]
trr a[238:239],v196,2304
mf v[44:47],a[244:247],a[92:95],v[44:47]
s_waitcnt lgkmcnt(8)
trr a[240:241],v197,256
mf v[48:51],a[248:251],a[88:91],v[48:51]
trr a[242:243],v197,2304
mf v[52:55],a[248:251],a[92:95],v[52:55]
trr a[244:245],v198,256
mf v[56:59],a[252:255],a[88:91],v[56:59]
trr a[246:247],v198,2304
mf v[60:63],a[252:255],a[92:95],v[60:63]
s_waitcnt lgkmcnt(8)
trr a[248:249],v199,256
mf v[64:67],a[224:227],a[88:91],v[64:67]
trr a[250:251],v199,2304
mf v[68:71],a[224:227],a[92:95],v[68:71]
v_add_u32 v193,0x20000,v193
trr a[252:253],v200,256
mf v[72:75],a[228:231],a[88:91],v[72:75]
trr a[254:255],v200,2304
mf v[76:79],a[228:231],a[92:95],v[76:79]
s_waitcnt lgkmcnt(8)
s_waitcnt vmcnt(8)
s_barrier
mf v[80:83],a[232:235],a[88:91],v[80:83]
v_add_u32 v194,0x20000,v194
trr a[224:225],v193,0
trr a[226:227],v193,2048
mf v[84:87],a[232:235],a[92:95],v[84:87]
v_add_u32 v195,0x20000,v195
trr a[228:229],v194,0
mf v[88:91],a[236:239],a[88:91],v[88:91]
trr a[230:231],v194,2048
mf v[92:95],a[236:239],a[92:95],v[92:95]
s_waitcnt lgkmcnt(8)
ds_read_b128 a[64:67],v205 offset:32768
v_add_u32 v196,0x20000,v196
mf v[96:99],a[240:243],a[88:91],v[96:99]
trr a[232:233],v195,0
trr a[234:235],v195,2048
mf v[100:103],a[240:243],a[92:95],v[100:103]
ds_read_b128 a[68:71],v205 offset:34816
v_add_u32 v197,0x20000,v197
mf v[104:107],a[244:247],a[88:91],v[104:107]
trr a[236:237],v196,0
trr a[238:239],v196,2048
mf v[108:111],a[244:247],a[92:95],v[108:111]
s_waitcnt lgkmcnt(10)
ds_read_b128 a[72:75],v206 offset:32768
v_add_u32 v198,0x20000,v198
mf v[112:115],a[248:251],a[88:91],v[112:115]
trr a[240:241],v197,0
trr a[242:243],v197,2048
mf v[116:119],a[248:251],a[92:95],v[116:119]
ds_read_b128 a[76:79],v206 offset:34816
v_add_u32 v199,0x20000,v199
mf v[120:123],a[252:255],a[88:91],v[120:123]
trr a[244:245],v198,0
s_waitcnt lgkmcnt(14)
trr a[246:247],v198,2048
mf v[124:127],a[252:255],a[92:95],v[124:127]
s_waitcnt lgkmcnt(12)
v_add_u32 v200,0x20000,v200
trr a[248:249],v199,0
s_waitcnt lgkmcnt(12)
mf v[0:3],a[224:227],a[64:67],v[0:3]
trr a[250:251],v199,2048
v_lshrrev_b32 v186,4,v192
v_and_b32 v187,15,v192
s_waitcnt lgkmcnt(10)
mf v[4:7],a[224:227],a[68:71],v[4:7]
trr a[252:253],v200,0
trr a[254:255],v200,2048
mf v[8:11],a[228:231],a[64:67],v[8:11]
v_lshlrev_b32 v188,1,v186
mf v[12:15],a[228:231],a[68:71],v[12:15]
s_waitcnt lgkmcnt(10)
trr a[224:225],v193,256
mf v[16:19],a[232:235],a[64:67],v[16:19]
trr a[226:227],v193,2304
v_xor_b32 v187,v187,v188
mf v[20:23],a[232:235],a[68:71],v[20:23]
trr a[228:229],v194,256
trr a[230:231],v194,2304
mf v[24:27],a[236:239],a[64:67],v[24:27]
v_lshlrev_b32 v188,4,v187
mf v[28:31],a[236:239],a[68:71],v[28:31]
s_waitcnt lgkmcnt(8)
trr a[232:233],v195,256
mf v[32:35],a[240:243],a[64:67],v[32:35]
trr a[234:235],v195,2304
v_lshl_add_u32 v212,v186,9,v188
mf v[36:39],a[240:243],a[68:71],v[36:39]
trr a[236:237],v196,256
trr a[238:239],v196,2304
mf v[40:43],a[244:247],a[64:67],v[40:43]
v_xor_b32 v187,8,v187
mf v[44:47],a[244:247],a[68:71],v[44:47]
s_waitcnt lgkmcnt(8)
trr a[240:241],v197,256
mf v[48:51],a[248:251],a[64:67],v[48:51]
trr a[242:243],v197,2304
v_lshlrev_b32 v188,4,v187
mf v[52:55],a[248:251],a[68:71],v[52:55]
trr a[244:245],v198,256
trr a[246:247],v198,2304
mf v[56:59],a[252:255],a[64:67],v[56:59]
v_lshl_add_u32 v213,v186,9,v188
mf v[60:63],a[252:255],a[68:71],v[60:63]
s_waitcnt lgkmcnt(8)
trr a[248:249],v199,256
mf v[64:67],a[224:227],a[64:67],v[64:67]
trr a[250:251],v199,2304
v_add_u32 v213,1024,v213
mf v[68:71],a[224:227],a[68:71],v[68:71]
v_add_u32 v193,0xfffe0000,v193
trr a[252:253],v200,256
mf v[72:75],a[228:231],a[64:67],v[72:75]
trr a[254:255],v200,2304
v_add_u32 v214,2048,v212
mf v[76:79],a[228:231],a[68:71],v[76:79]
s_waitcnt lgkmcnt(8)
s_waitcnt vmcnt(4)
s_barrier
v_add_u32 v194,0xfffe0000,v194
mf v[80:83],a[232:235],a[64:67],v[80:83]
trr a[224:225],v193,32768
trr a[226:227],v193,34816
v_add_u32 v215,2048,v213
mf v[84:87],a[232:235],a[68:71],v[84:87]
v_add_u32 v195,0xfffe0000,v195
trr a[228:229],v194,32768
trr a[230:231],v194,34816
s_add_u32 m0,s49,0
mf v[88:91],a[236:239],a[64:67],v[88:91]
s_add_u32 s48,s50,81920
buffer_load_dwordx4 v208,s[24:27],s48 offen nt lds
v_lshrrev_b32 v186,3,v192
v_mul_u32_u24 v186,896,v186
mf v[92:95],a[236:239],a[68:71],v[92:95]
s_waitcnt lgkmcnt(8)
v_add_u32 v196,0xfffe0000,v196
trr a[232:233],v195,32768
trr a[234:235],v195,34816
mf v[96:99],a[240:243],a[64:67],v[96:99]
buffer_load_dwordx4 v209,s[24:27],s48 offen offset:1024 nt lds
v_lshrrev_b32 v187,4,v192
v_lshlrev_b32 v187,1,v187
mf v[100:103],a[240:243],a[68:71],v[100:103]
v_add_u32 v197,0xfffe0000,v197
trr a[236:237],v196,32768
trr a[238:239],v196,34816
mf v[104:107],a[244:247],a[64:67],v[104:107]
buffer_load_dwordx4 v210,s[24:27],s48 offen offset:2048 nt lds
v_and_b32 v188,7,v192
v_xor_b32 v187,v187,v188
mf v[108:111],a[244:247],a[68:71],v[108:111]
s_waitcnt lgkmcnt(8)
v_add_u32 v198,0xfffe0000,v198
trr a[240:241],v197,32768
trr a[242:243],v197,34816
mf v[112:115],a[248:251],a[64:67],v[112:115]
buffer_load_dwordx4 v211,s[24:27],s48 offen offset:3072 nt lds
v_lshl_add_u32 v216,v187,4,v186
v_add_u32 v217,6144,v216
mf v[116:119],a[248:251],a[68:71],v[116:119]
v_add_u32 v199,0xfffe0000,v199
trr a[244:245],v198,32768
trr a[246:247],v198,34816
s_add_u32 m0,s49,81920
mf v[120:123],a[252:255],a[64:67],v[120:123]
s_add_u32 s48,s50,98304
buffer_load_dwordx4 v208,s[24:27],s48 offen nt lds
v_add_u32 v218,12288,v216
v_add_u32 v219,18432,v216
mf v[124:127],a[252:255],a[68:71],v[124:127]
s_waitcnt lgkmcnt(8)
v_add_u32 v200,0xfffe0000,v200
trr a[248:249],v199,32768
mf v[0:3],a[224:227],a[72:75],v[0:3]
trr a[250:251],v199,34816
buffer_load_dwordx4 v209,s[24:27],s48 offen offset:1024 nt lds
mf v[4:7],a[224:227],a[76:79],v[4:7]
trr a[252:253],v200,32768
trr a[254:255],v200,34816
mf v[8:11],a[228:231],a[72:75],v[8:11]
buffer_load_dwordx4 v210,s[24:27],s48 offen offset:2048 nt lds
mf v[12:15],a[228:231],a[76:79],v[12:15]
s_waitcnt lgkmcnt(8)
trr a[224:225],v193,33024
mf v[16:19],a[232:235],a[72:75],v[16:19]
trr a[226:227],v193,35072
buffer_load_dwordx4 v211,s[24:27],s48 offen offset:3072 nt lds
mf v[20:23],a[232:235],a[76:79],v[20:23]
trr a[228:229],v194,33024
mf v[24:27],a[236:239],a[72:75],v[24:27]
trr a[230:231],v194,35072
mf v[28:31],a[236:239],a[76:79],v[28:31]
s_waitcnt lgkmcnt(8)
trr a[232:233],v195,33024
trr a[234:235],v195,35072
cvp v180,v0,v1
cvp v181,v2,v3
cvp v182,v8,v9
cvp v183,v10,v11
s_nop 0
v_permlane32_swap_b32 v180,v182
v_permlane32_swap_b32 v181,v183
s_nop 0
v_permlane16_swap_b32 v180,v182
v_permlane16_swap_b32 v181,v183
awr a0,v180
awr a1,v181
awr a2,v182
mf v[32:35],a[240:243],a[72:75],v[32:35]
awr a3,v183
cvp v184,v4,v5
cvp v185,v6,v7
cvp v186,v12,v13
cvp v187,v14,v15
s_nop 0
v_permlane32_swap_b32 v184,v186
v_permlane32_swap_b32 v185,v187
s_nop 0
v_permlane16_swap_b32 v184,v186
v_permlane16_swap_b32 v185,v187
awr a4,v184
awr a5,v185
awr a6,v186
awr a7,v187
mf v[36:39],a[240:243],a[76:79],v[36:39]
trr a[236:237],v196,33024
mf v[40:43],a[244:247],a[72:75],v[40:43]
trr a[238:239],v196,35072
mf v[44:47],a[244:247],a[76:79],v[44:47]
s_waitcnt lgkmcnt(8)
trr a[240:241],v197,33024
trr a[242:243],v197,35072
cvp v180,v16,v17
cvp v181,v18,v19
cvp v182,v24,v25
cvp v183,v26,v27
s_nop 0
v_permlane32_swap_b32 v180,v182
v_permlane32_swap_b32 v181,v183
s_nop 0
v_permlane16_swap_b32 v180,v182
v_permlane16_swap_b32 v181,v183
awr a8,v180
awr a9,v181
awr a10,v182
mf v[48:51],a[248:251],a[72:75],v[48:51]
awr a11,v183
cvp v184,v20,v21
cvp v185,v22,v23
cvp v186,v28,v29
cvp v187,v30,v31
s_nop 0
v_permlane32_swap_b32 v184,v186
v_permlane32_swap_b32 v185,v187
s_nop 0
v_permlane16_swap_b32 v184,v186
v_permlane16_swap_b32 v185,v187
awr a12,v184
awr a13,v185
awr a14,v186
awr a15,v187
mf v[52:55],a[248:251],a[76:79],v[52:55]
trr a[244:245],v198,33024
mf v[56:59],a[252:255],a[72:75],v[56:59]
trr a[246:247],v198,35072
mf v[60:63],a[252:255],a[76:79],v[60:63]
s_waitcnt lgkmcnt(8)
trr a[248:249],v199,33024
trr a[250:251],v199,35072
cvp v180,v32,v33
cvp v181,v34,v35
cvp v182,v40,v41
cvp v183,v42,v43
s_nop 0
v_permlane32_swap_b32 v180,v182
v_permlane32_swap_b32 v181,v183
s_nop 0
v_permlane16_swap_b32 v180,v182
v_permlane16_swap_b32 v181,v183
awr a16,v180
awr a17,v181
awr a18,v182
mf v[64:67],a[224:227],a[72:75],v[64:67]
awr a19,v183
cvp v184,v36,v37
cvp v185,v38,v39
cvp v186,v44,v45
cvp v187,v46,v47
s_nop 0
v_permlane32_swap_b32 v184,v186
v_permlane32_swap_b32 v185,v187
s_nop 0
v_permlane16_swap_b32 v184,v186
v_permlane16_swap_b32 v185,v187
awr a20,v184
awr a21,v185
awr a22,v186
awr a23,v187
mf v[68:71],a[224:227],a[76:79],v[68:71]
trr a[252:253],v200,33024
mf v[72:75],a[228:231],a[72:75],v[72:75]
trr a[254:255],v200,35072
mf v[76:79],a[228:231],a[76:79],v[76:79]
s_waitcnt lgkmcnt(8)
s_barrier
v_and_b32 v176,15,v192
v_lshrrev_b32 v177,4,v192
v_xor_b32 v177,v177,v176
v_lshlrev_b32 v177,4,v177
v_lshl_add_u32 v177,v176,9,v177
v_xor_b32 v193,0,v177
v_xor_b32 v194,64,v177
v_xor_b32 v195,128,v177
v_xor_b32 v196,192,v177
ds_read_b128 a[224:227],v193 offset:49152
cvp v180,v48,v49
cvp v181,v50,v51
cvp v182,v56,v57
cvp v183,v58,v59
s_nop 0
v_permlane32_swap_b32 v180,v182
v_permlane32_swap_b32 v181,v183
mf v[80:83],a[232:235],a[72:75],v[80:83]
v_permlane16_swap_b32 v180,v182
v_permlane16_swap_b32 v181,v183
awr a24,v180
awr a25,v181
awr a26,v182
awr a27,v183
cvp v184,v52,v53
cvp v185,v54,v55
cvp v186,v60,v61
cvp v187,v62,v63
s_nop 0
v_permlane32_swap_b32 v184,v186
v_permlane32_swap_b32 v185,v187
s_nop 0
v_permlane16_swap_b32 v184,v186
v_permlane16_swap_b32 v185,v187
awr a28,v184
awr a29,v185
awr a30,v186
awr a31,v187
mf v[84:87],a[232:235],a[76:79],v[84:87]
ds_read_b128 a[228:231],v194 offset:49152
s_add_u32 m0,s49,98304
mf v[88:91],a[236:239],a[72:75],v[88:91]
s_add_u32 s48,s50,114688
buffer_load_dwordx4 v208,s[24:27],s48 offen nt lds
mf v[92:95],a[236:239],a[76:79],v[92:95]
s_waitcnt lgkmcnt(6)
ds_read_b128 a[232:235],v195 offset:49152
cvp v180,v64,v65
cvp v181,v66,v67
cvp v182,v72,v73
cvp v183,v74,v75
s_nop 0
v_permlane32_swap_b32 v180,v182
v_permlane32_swap_b32 v181,v183
s_nop 0
v_permlane16_swap_b32 v180,v182
v_permlane16_swap_b32 v181,v183
awr a32,v180
awr a33,v181
awr a34,v182
mf v[96:99],a[240:243],a[72:75],v[96:99]
awr a35,v183
cvp v184,v68,v69
cvp v185,v70,v71
cvp v186,v76,v77
cvp v187,v78,v79
s_nop 0
v_permlane32_swap_b32 v184,v186
v_permlane32_swap_b32 v185,v187
s_nop 0
v_permlane16_swap_b32 v184,v186
v_permlane16_swap_b32 v185,v187
awr a36,v184
awr a37,v185
awr a38,v186
awr a39,v187
mf v[100:103],a[240:243],a[76:79],v[100:103]
ds_read_b128 a[236:239],v196 offset:49152
mf v[104:107],a[244:247],a[72:75],v[104:107]
mf v[108:111],a[244:247],a[76:79],v[108:111]
s_waitcnt lgkmcnt(4)
ds_read_b128 a[240:243],v193 offset:49408
buffer_load_dwordx4 v209,s[24:27],s48 offen offset:1024 nt lds
cvp v180,v80,v81
cvp v181,v82,v83
cvp v182,v88,v89
cvp v183,v90,v91
s_nop 0
v_permlane32_swap_b32 v180,v182
v_permlane32_swap_b32 v181,v183
s_nop 0
v_permlane16_swap_b32 v180,v182
v_permlane16_swap_b32 v181,v183
awr a40,v180
awr a41,v181
awr a42,v182
mf v[112:115],a[248:251],a[72:75],v[112:115]
awr a43,v183
cvp v184,v84,v85
cvp v185,v86,v87
cvp v186,v92,v93
cvp v187,v94,v95
s_nop 0
v_permlane32_swap_b32 v184,v186
v_permlane32_swap_b32 v185,v187
s_nop 0
v_permlane16_swap_b32 v184,v186
v_permlane16_swap_b32 v185,v187
awr a44,v184
awr a45,v185
awr a46,v186
awr a47,v187
mf v[116:119],a[248:251],a[76:79],v[116:119]
ds_read_b128 a[244:247],v194 offset:49408
mf v[120:123],a[252:255],a[72:75],v[120:123]
mf v[124:127],a[252:255],a[76:79],v[124:127]
s_waitcnt lgkmcnt(4)
ds_read_b128 a[248:251],v195 offset:49408
cvp v180,v96,v97
cvp v181,v98,v99
cvp v182,v104,v105
cvp v183,v106,v107
s_nop 0
v_permlane32_swap_b32 v180,v182
v_permlane32_swap_b32 v181,v183
s_nop 0
v_permlane16_swap_b32 v180,v182
v_permlane16_swap_b32 v181,v183
awr a48,v180
awr a49,v181
awr a50,v182
mf v[128:131],a[224:227],a[0:3],0
awr a51,v183
cvp v184,v100,v101
cvp v185,v102,v103
cvp v186,v108,v109
cvp v187,v110,v111
s_nop 0
v_permlane32_swap_b32 v184,v186
v_permlane32_swap_b32 v185,v187
s_nop 0
v_permlane16_swap_b32 v184,v186
v_permlane16_swap_b32 v185,v187
awr a52,v184
awr a53,v185
awr a54,v186
awr a55,v187
mf v[132:135],a[224:227],a[4:7],0
ds_read_b128 a[252:255],v196 offset:49408
mf v[128:131],a[228:231],a[8:11],v[128:131]
buffer_load_dwordx4 v210,s[24:27],s48 offen offset:2048 nt lds
mf v[132:135],a[228:231],a[12:15],v[132:135]
s_waitcnt lgkmcnt(4)
ds_read_b128 a[224:227],v193 offset:57344
cvp v180,v112,v113
cvp v181,v114,v115
cvp v182,v120,v121
cvp v183,v122,v123
s_nop 0
v_permlane32_swap_b32 v180,v182
v_permlane32_swap_b32 v181,v183
s_nop 0
v_permlane16_swap_b32 v180,v182
v_permlane16_swap_b32 v181,v183
awr a56,v180
awr a57,v181
awr a58,v182
mf v[128:131],a[232:235],a[16:19],v[128:131]
awr a59,v183
cvp v184,v116,v117
cvp v185,v118,v119
cvp v186,v124,v125
cvp v187,v126,v127
s_nop 0
v_permlane32_swap_b32 v184,v186
v_permlane32_swap_b32 v185,v187
s_nop 0
v_permlane16_swap_b32 v184,v186
v_permlane16_swap_b32 v185,v187
awr a60,v184
awr a61,v185
awr a62,v186
awr a63,v187
mf v[132:135],a[232:235],a[20:23],v[132:135]
ds_read_b128 a[228:231],v194 offset:57344
mf v[128:131],a[236:239],a[24:27],v[128:131]
mf v[132:135],a[236:239],a[28:31],v[132:135]
s_waitcnt lgkmcnt(4)
ds_read_b128 a[232:235],v195 offset:57344
mf v[128:131],a[240:243],a[32:35],v[128:131]
buffer_load_dwordx4 v211,s[24:27],s48 offen offset:3072 nt lds
mf v[132:135],a[240:243],a[36:39],v[132:135]
ds_read_b128 a[236:239],v196 offset:57344
mf v[128:131],a[244:247],a[40:43],v[128:131]
mf v[132:135],a[244:247],a[44:47],v[132:135]
s_waitcnt lgkmcnt(4)
mf v[128:131],a[248:251],a[48:51],v[128:131]
ds_read_b128 a[240:243],v193 offset:57600
mf v[132:135],a[248:251],a[52:55],v[132:135]
ds_read_b128 a[244:247],v194 offset:57600
mf v[128:131],a[252:255],a[56:59],v[128:131]
mf v[132:135],a[252:255],a[60:63],v[132:135]
s_waitcnt lgkmcnt(4)
mf v[136:139],a[224:227],a[0:3],0
ds_read_b128 a[248:251],v195 offset:57600
mf v[140:143],a[224:227],a[4:7],0
v_add_u32 v193,0x10000,v193
mf v[136:139],a[228:231],a[8:11],v[136:139]
ds_read_b128 a[252:255],v196 offset:57600
mf v[140:143],a[228:231],a[12:15],v[140:143]
s_waitcnt lgkmcnt(4)
s_barrier
mf v[136:139],a[232:235],a[16:19],v[136:139]
v_add_u32 v194,0x10000,v194
ds_read_b128 a[224:227],v193 offset:49152
mf v[140:143],a[232:235],a[20:23],v[140:143]
v_add_u32 v195,0x10000,v195
mf v[136:139],a[236:239],a[24:27],v[136:139]
ds_read_b128 a[228:231],v194 offset:49152
mf v[140:143],a[236:239],a[28:31],v[140:143]
s_waitcnt lgkmcnt(4)
v_add_u32 v196,0x10000,v196
mf v[136:139],a[240:243],a[32:35],v[136:139]
ds_read_b128 a[232:235],v195 offset:49152
mf v[140:143],a[240:243],a[36:39],v[140:143]
ds_read_b128 a[236:239],v196 offset:49152
mf v[136:139],a[244:247],a[40:43],v[136:139]
mf v[140:143],a[244:247],a[44:47],v[140:143]
s_waitcnt lgkmcnt(4)
mf v[136:139],a[248:251],a[48:51],v[136:139]
ds_read_b128 a[240:243],v193 offset:49408
mf v[140:143],a[248:251],a[52:55],v[140:143]
ds_read_b128 a[244:247],v194 offset:49408
mf v[136:139],a[252:255],a[56:59],v[136:139]
mf v[140:143],a[252:255],a[60:63],v[140:143]
s_waitcnt lgkmcnt(4)
mf v[144:147],a[224:227],a[0:3],0
ds_read_b128 a[248:251],v195 offset:49408
mf v[148:151],a[224:227],a[4:7],0
ds_read_b128 a[252:255],v196 offset:49408
mf v[144:147],a[228:231],a[8:11],v[144:147]
mf v[148:151],a[228:231],a[12:15],v[148:151]
s_waitcnt lgkmcnt(4)
mf v[144:147],a[232:235],a[16:19],v[144:147]
ds_read_b128 a[224:227],v193 offset:57344
mf v[148:151],a[232:235],a[20:23],v[148:151]
ds_read_b128 a[228:231],v194 offset:57344
v_max3_f32 v222,v222,v128,v129
v_max3_f32 v223,v223,v132,v133
mf v[144:147],a[236:239],a[24:27],v[144:147]
v_max3_f32 v222,v222,v130,v131
v_max3_f32 v223,v223,v134,v135
v_max3_f32 v222,v222,v136,v137
mf v[148:151],a[236:239],a[28:31],v[148:151]
s_waitcnt lgkmcnt(4)
ds_read_b128 a[232:235],v195 offset:57344
v_max3_f32 v223,v223,v140,v141
mf v[144:147],a[240:243],a[32:35],v[144:147]
v_max3_f32 v222,v222,v138,v139
v_max3_f32 v223,v223,v142,v143
v_mul_f32 v176,s46,v222
mf v[148:151],a[240:243],a[36:39],v[148:151]
ds_read_b128 a[236:239],v196 offset:57344
v_mul_f32 v180,s46,v223
v_ceil_f32 v226,v176
mf v[144:147],a[244:247],a[40:43],v[144:147]
v_ceil_f32 v227,v180
v_fma_f32 v128,v128,s46,-v226
mf v[148:151],a[244:247],a[44:47],v[148:151]
s_waitcnt lgkmcnt(4)
ds_read_b128 a[240:243],v193 offset:57600
v_fma_f32 v132,v132,s46,-v227
mf v[144:147],a[248:251],a[48:51],v[144:147]
v_fma_f32 v129,v129,s46,-v226
v_fma_f32 v133,v133,s46,-v227
v_exp_f32 v128,v128
mf v[148:151],a[248:251],a[52:55],v[148:151]
ds_read_b128 a[244:247],v194 offset:57600
v_exp_f32 v132,v132
v_fma_f32 v130,v130,s46,-v226
mf v[144:147],a[252:255],a[56:59],v[144:147]
v_fma_f32 v134,v134,s46,-v227
v_exp_f32 v129,v129
v_exp_f32 v133,v133
mf v[148:151],a[252:255],a[60:63],v[148:151]
s_waitcnt lgkmcnt(4)
ds_read_b128 a[248:251],v195 offset:57600
v_fma_f32 v131,v131,s46,-v226
mf v[152:155],a[224:227],a[0:3],0
v_fma_f32 v135,v135,s46,-v227
v_exp_f32 v130,v130
v_exp_f32 v134,v134
mf v[156:159],a[224:227],a[4:7],0
v_add_u32 v193,0xffff0000,v193
ds_read_b128 a[252:255],v196 offset:57600
v_fma_f32 v136,v136,s46,-v226
mf v[152:155],a[228:231],a[8:11],v[152:155]
v_fma_f32 v140,v140,s46,-v227
v_exp_f32 v131,v131
v_exp_f32 v135,v135
mf v[156:159],a[228:231],a[12:15],v[156:159]
s_waitcnt lgkmcnt(4)
s_barrier
v_add_u32 v194,0xffff0000,v194
ds_read_b128 a[224:227],v193 offset:16384
mf v[152:155],a[232:235],a[16:19],v[152:155]
v_add_f32 v178,v128,v129
v_add_f32 v182,v132,v133
cvp v0,v128,v129
cvp v4,v132,v133
mf v[156:159],a[232:235],a[20:23],v[156:159]
v_add_u32 v195,0xffff0000,v195
ds_read_b128 a[228:231],v194 offset:16384
s_add_u32 m0,s49,32768
s_add_u32 s48,s50,131072
buffer_load_dwordx4 v208,s[24:27],s48 offen nt lds
mf v[152:155],a[236:239],a[24:27],v[152:155]
v_fma_f32 v137,v137,s46,-v226
v_fma_f32 v141,v141,s46,-v227
v_exp_f32 v136,v136
v_exp_f32 v140,v140
v_fma_f32 v138,v138,s46,-v226
mf v[156:159],a[236:239],a[28:31],v[156:159]
s_waitcnt lgkmcnt(4)
v_add_u32 v196,0xffff0000,v196
ds_read_b128 a[232:235],v195 offset:16384
buffer_load_dwordx4 v209,s[24:27],s48 offen offset:1024 nt lds
mf v[152:155],a[240:243],a[32:35],v[152:155]
v_fma_f32 v142,v142,s46,-v227
v_exp_f32 v137,v137
v_exp_f32 v141,v141
v_add_f32 v179,v130,v131
mf v[156:159],a[240:243],a[36:39],v[156:159]
ds_read_b128 a[236:239],v196 offset:16384
buffer_load_dwordx4 v210,s[24:27],s48 offen offset:2048 nt lds
v_add_f32 v183,v134,v135
mf v[152:155],a[244:247],a[40:43],v[152:155]
cvp v1,v130,v131
cvp v5,v134,v135
v_fma_f32 v139,v139,s46,-v226
mf v[156:159],a[244:247],a[44:47],v[156:159]
s_waitcnt lgkmcnt(4)
ds_read_b128 a[240:243],v193 offset:16640
buffer_load_dwordx4 v211,s[24:27],s48 offen offset:3072 nt lds
v_fma_f32 v143,v143,s46,-v227
mf v[152:155],a[248:251],a[48:51],v[152:155]
v_exp_f32 v138,v138
v_exp_f32 v142,v142
v_add_f32 v178,v178,v136
mf v[156:159],a[248:251],a[52:55],v[156:159]
ds_read_b128 a[244:247],v194 offset:16640
s_add_u32 m0,s49,49152
s_add_u32 s48,s50,147456
buffer_load_dwordx4 v208,s[24:27],s48 offen nt lds
v_add_f32 v182,v182,v140
mf v[152:155],a[252:255],a[56:59],v[152:155]
v_exp_f32 v139,v139
v_exp_f32 v143,v143
v_add_f32 v179,v179,v137
v_add_f32 v183,v183,v141
mf v[156:159],a[252:255],a[60:63],v[156:159]
s_waitcnt lgkmcnt(4)
ds_read_b128 a[248:251],v195 offset:16640
buffer_load_dwordx4 v209,s[24:27],s48 offen offset:1024 nt lds
cvp v2,v136,v137
mf v[160:163],a[224:227],a[0:3],0
cvp v6,v140,v141
v_add_f32 v178,v178,v138
v_add_f32 v182,v182,v142
mf v[164:167],a[224:227],a[4:7],0
ds_read_b128 a[252:255],v196 offset:16640
buffer_load_dwordx4 v210,s[24:27],s48 offen offset:2048 nt lds
v_add_f32 v179,v179,v139
mf v[160:163],a[228:231],a[8:11],v[160:163]
v_add_f32 v183,v183,v143
cvp v3,v138,v139
cvp v7,v142,v143
mf v[164:167],a[228:231],a[12:15],v[164:167]
s_waitcnt lgkmcnt(4)
ds_read_b128 a[224:227],v193 offset:24576
buffer_load_dwordx4 v211,s[24:27],s48 offen offset:3072 nt lds
v_add_f32 v178,v178,v179
mf v[160:163],a[232:235],a[16:19],v[160:163]
v_add_f32 v182,v182,v183
v_mov_b32 v224,v178
v_mov_b32 v225,v182
mf v[164:167],a[232:235],a[20:23],v[164:167]
ds_read_b128 a[228:231],v194 offset:24576
v_max3_f32 v222,v222,v144,v145
v_max3_f32 v223,v223,v148,v149
mf v[160:163],a[236:239],a[24:27],v[160:163]
v_max3_f32 v222,v222,v146,v147
v_max3_f32 v223,v223,v150,v151
v_max3_f32 v222,v222,v152,v153
mf v[164:167],a[236:239],a[28:31],v[164:167]
s_waitcnt lgkmcnt(4)
ds_read_b128 a[232:235],v195 offset:24576
v_max3_f32 v223,v223,v156,v157
mf v[160:163],a[240:243],a[32:35],v[160:163]
v_max3_f32 v222,v222,v154,v155
v_max3_f32 v223,v223,v158,v159
v_mul_f32 v176,s46,v222
mf v[164:167],a[240:243],a[36:39],v[164:167]
ds_read_b128 a[236:239],v196 offset:24576
v_mul_f32 v180,s46,v223
v_ceil_f32 v228,v176
mf v[160:163],a[244:247],a[40:43],v[160:163]
v_ceil_f32 v229,v180
v_sub_f32 v177,v226,v228
v_sub_f32 v181,v227,v229
mf v[164:167],a[244:247],a[44:47],v[164:167]
s_waitcnt lgkmcnt(4)
ds_read_b128 a[240:243],v193 offset:24832
v_exp_f32 v177,v177
mf v[160:163],a[248:251],a[48:51],v[160:163]
v_exp_f32 v181,v181
v_fma_f32 v144,v144,s46,-v228
v_fma_f32 v148,v148,s46,-v229
mf v[164:167],a[248:251],a[52:55],v[164:167]
ds_read_b128 a[244:247],v194 offset:24832
v_fma_f32 v145,v145,s46,-v228
v_fma_f32 v149,v149,s46,-v229
mf v[160:163],a[252:255],a[56:59],v[160:163]
v_exp_f32 v144,v144
v_exp_f32 v148,v148
v_fma_f32 v146,v146,s46,-v228
mf v[164:167],a[252:255],a[60:63],v[164:167]
s_waitcnt lgkmcnt(4)
ds_read_b128 a[248:251],v195 offset:24832
v_fma_f32 v150,v150,s46,-v229
mf v[168:171],a[224:227],a[0:3],0
v_exp_f32 v145,v145
v_exp_f32 v149,v149
v_fma_f32 v147,v147,s46,-v228
mf v[172:175],a[224:227],a[4:7],0
v_add_u32 v193,0x20000,v193
ds_read_b128 a[252:255],v196 offset:24832
v_fma_f32 v151,v151,s46,-v229
v_exp_f32 v146,v146
mf v[168:171],a[228:231],a[8:11],v[168:171]
v_exp_f32 v150,v150
v_fma_f32 v152,v152,s46,-v228
v_fma_f32 v156,v156,s46,-v229
mf v[172:175],a[228:231],a[12:15],v[172:175]
s_waitcnt lgkmcnt(4)
s_barrier
v_add_u32 v194,0x20000,v194
ds_read_b128 a[224:227],v193 offset:16384
mf v[168:171],a[232:235],a[16:19],v[168:171]
v_exp_f32 v147,v147
v_exp_f32 v151,v151
v_add_f32 v178,v144,v145
v_add_f32 v182,v148,v149
mf v[172:175],a[232:235],a[20:23],v[172:175]
v_add_u32 v195,0x20000,v195
ds_read_b128 a[228:231],v194 offset:16384
cvp v8,v144,v145
cvp v12,v148,v149
mf v[168:171],a[236:239],a[24:27],v[168:171]
v_fma_f32 v153,v153,s46,-v228
v_fma_f32 v157,v157,s46,-v229
v_exp_f32 v152,v152
mf v[172:175],a[236:239],a[28:31],v[172:175]
s_waitcnt lgkmcnt(4)
v_add_u32 v196,0x20000,v196
ds_read_b128 a[232:235],v195 offset:16384
v_exp_f32 v156,v156
mf v[168:171],a[240:243],a[32:35],v[168:171]
v_fma_f32 v154,v154,s46,-v228
v_fma_f32 v158,v158,s46,-v229
v_exp_f32 v153,v153
mf v[172:175],a[240:243],a[36:39],v[172:175]
ds_read_b128 a[236:239],v196 offset:16384
v_exp_f32 v157,v157
v_add_f32 v179,v146,v147
mf v[168:171],a[244:247],a[40:43],v[168:171]
v_add_f32 v183,v150,v151
cvp v9,v146,v147
cvp v13,v150,v151
mf v[172:175],a[244:247],a[44:47],v[172:175]
s_waitcnt lgkmcnt(4)
ds_read_b128 a[240:243],v193 offset:16640
v_fma_f32 v155,v155,s46,-v228
mf v[168:171],a[248:251],a[48:51],v[168:171]
v_fma_f32 v159,v159,s46,-v229
v_exp_f32 v154,v154
v_exp_f32 v158,v158
mf v[172:175],a[248:251],a[52:55],v[172:175]
ds_read_b128 a[244:247],v194 offset:16640
v_add_f32 v178,v178,v152
v_add_f32 v182,v182,v156
mf v[168:171],a[252:255],a[56:59],v[168:171]
v_exp_f32 v155,v155
v_exp_f32 v159,v159
v_add_f32 v179,v179,v153
mf v[172:175],a[252:255],a[60:63],v[172:175]
s_waitcnt lgkmcnt(4)
ds_read_b128 a[248:251],v195 offset:16640
v_add_f32 v183,v183,v157
mf v[128:131],a[224:227],a[0:3],0
cvp v10,v152,v153
cvp v14,v156,v157
v_add_f32 v178,v178,v154
mf v[132:135],a[224:227],a[4:7],0
ds_read_b128 a[252:255],v196 offset:16640
v_add_f32 v182,v182,v158
v_add_f32 v179,v179,v155
mf v[128:131],a[228:231],a[8:11],v[128:131]
v_add_f32 v183,v183,v159
cvp v11,v154,v155
cvp v15,v158,v159
mf v[132:135],a[228:231],a[12:15],v[132:135]
s_waitcnt lgkmcnt(4)
ds_read_b128 a[224:227],v193 offset:24576
v_add_f32 v178,v178,v179
mf v[128:131],a[232:235],a[16:19],v[128:131]
v_add_f32 v182,v182,v183
v_fma_f32 v224,v224,v177,v178
v_fma_f32 v225,v225,v181,v182
mf v[132:135],a[232:235],a[20:23],v[132:135]
ds_read_b128 a[228:231],v194 offset:24576
v_max3_f32 v222,v222,v160,v161
v_max3_f32 v223,v223,v164,v165
mf v[128:131],a[236:239],a[24:27],v[128:131]
v_max3_f32 v222,v222,v162,v163
v_max3_f32 v223,v223,v166,v167
v_max3_f32 v222,v222,v168,v169
mf v[132:135],a[236:239],a[28:31],v[132:135]
s_waitcnt lgkmcnt(4)
ds_read_b128 a[232:235],v195 offset:24576
v_max3_f32 v223,v223,v172,v173
mf v[128:131],a[240:243],a[32:35],v[128:131]
v_max3_f32 v222,v222,v170,v171
v_max3_f32 v223,v223,v174,v175
v_mul_f32 v176,s46,v222
mf v[132:135],a[240:243],a[36:39],v[132:135]
ds_read_b128 a[236:239],v196 offset:24576
v_mul_f32 v180,s46,v223
v_ceil_f32 v230,v176
mf v[128:131],a[244:247],a[40:43],v[128:131]
v_ceil_f32 v231,v180
v_sub_f32 v177,v228,v230
v_sub_f32 v181,v229,v231
mf v[132:135],a[244:247],a[44:47],v[132:135]
s_waitcnt lgkmcnt(4)
ds_read_b128 a[240:243],v193 offset:24832
v_exp_f32 v177,v177
mf v[128:131],a[248:251],a[48:51],v[128:131]
v_exp_f32 v181,v181
v_fma_f32 v160,v160,s46,-v230
v_fma_f32 v164,v164,s46,-v231
mf v[132:135],a[248:251],a[52:55],v[132:135]
ds_read_b128 a[244:247],v194 offset:24832
v_fma_f32 v161,v161,s46,-v230
v_fma_f32 v165,v165,s46,-v231
mf v[128:131],a[252:255],a[56:59],v[128:131]
v_exp_f32 v160,v160
v_exp_f32 v164,v164
v_fma_f32 v162,v162,s46,-v230
mf v[132:135],a[252:255],a[60:63],v[132:135]
s_waitcnt lgkmcnt(4)
ds_read_b128 a[248:251],v195 offset:24832
v_fma_f32 v166,v166,s46,-v231
mf v[136:139],a[224:227],a[0:3],0
v_exp_f32 v161,v161
v_exp_f32 v165,v165
v_fma_f32 v163,v163,s46,-v230
mf v[140:143],a[224:227],a[4:7],0
v_add_u32 v193,0xffff0000,v193
ds_read_b128 a[252:255],v196 offset:24832
v_fma_f32 v167,v167,s46,-v231
v_exp_f32 v162,v162
mf v[136:139],a[228:231],a[8:11],v[136:139]
v_exp_f32 v166,v166
v_fma_f32 v168,v168,s46,-v230
v_fma_f32 v172,v172,s46,-v231
mf v[140:143],a[228:231],a[12:15],v[140:143]
s_waitcnt lgkmcnt(4)
s_waitcnt vmcnt(20)
s_barrier
v_add_u32 v194,0xffff0000,v194
ds_read_b128 a[224:227],v193
mf v[136:139],a[232:235],a[16:19],v[136:139]
v_exp_f32 v163,v163
v_exp_f32 v167,v167
v_add_f32 v178,v160,v161
v_add_f32 v182,v164,v165
mf v[140:143],a[232:235],a[20:23],v[140:143]
v_add_u32 v195,0xffff0000,v195
ds_read_b128 a[228:231],v194
cvp v16,v160,v161
cvp v20,v164,v165
mf v[136:139],a[236:239],a[24:27],v[136:139]
v_fma_f32 v169,v169,s46,-v230
v_fma_f32 v173,v173,s46,-v231
v_exp_f32 v168,v168
mf v[140:143],a[236:239],a[28:31],v[140:143]
s_waitcnt lgkmcnt(4)
v_add_u32 v196,0xffff0000,v196
ds_read_b128 a[232:235],v195
v_exp_f32 v172,v172
mf v[136:139],a[240:243],a[32:35],v[136:139]
v_fma_f32 v170,v170,s46,-v230
v_fma_f32 v174,v174,s46,-v231
v_exp_f32 v169,v169
mf v[140:143],a[240:243],a[36:39],v[140:143]
ds_read_b128 a[236:239],v196
v_exp_f32 v173,v173
v_add_f32 v179,v162,v163
mf v[136:139],a[244:247],a[40:43],v[136:139]
v_add_f32 v183,v166,v167
cvp v17,v162,v163
cvp v21,v166,v167
mf v[140:143],a[244:247],a[44:47],v[140:143]
s_waitcnt lgkmcnt(4)
ds_read_b128 a[240:243],v193 offset:256
v_fma_f32 v171,v171,s46,-v230
mf v[136:139],a[248:251],a[48:51],v[136:139]
v_fma_f32 v175,v175,s46,-v231
v_exp_f32 v170,v170
v_exp_f32 v174,v174
mf v[140:143],a[248:251],a[52:55],v[140:143]
ds_read_b128 a[244:247],v194 offset:256
v_add_f32 v178,v178,v168
v_add_f32 v182,v182,v172
mf v[136:139],a[252:255],a[56:59],v[136:139]
v_exp_f32 v171,v171
v_exp_f32 v175,v175
v_add_f32 v179,v179,v169
mf v[140:143],a[252:255],a[60:63],v[140:143]
s_waitcnt lgkmcnt(4)
ds_read_b128 a[248:251],v195 offset:256
v_add_f32 v183,v183,v173
mf v[144:147],a[224:227],a[0:3],0
cvp v18,v168,v169
cvp v22,v172,v173
v_add_f32 v178,v178,v170
mf v[148:151],a[224:227],a[4:7],0
ds_read_b128 a[252:255],v196 offset:256
v_add_f32 v182,v182,v174
v_add_f32 v179,v179,v171
mf v[144:147],a[228:231],a[8:11],v[144:147]
v_add_f32 v183,v183,v175
cvp v19,v170,v171
cvp v23,v174,v175
mf v[148:151],a[228:231],a[12:15],v[148:151]
s_waitcnt lgkmcnt(4)
ds_read_b128 a[224:227],v193 offset:8192
v_add_f32 v178,v178,v179
mf v[144:147],a[232:235],a[16:19],v[144:147]
v_add_f32 v182,v182,v183
v_fma_f32 v224,v224,v177,v178
v_fma_f32 v225,v225,v181,v182
mf v[148:151],a[232:235],a[20:23],v[148:151]
ds_read_b128 a[228:231],v194 offset:8192
v_max3_f32 v222,v222,v128,v129
v_max3_f32 v223,v223,v132,v133
mf v[144:147],a[236:239],a[24:27],v[144:147]
v_max3_f32 v222,v222,v130,v131
v_max3_f32 v223,v223,v134,v135
v_max3_f32 v222,v222,v136,v137
mf v[148:151],a[236:239],a[28:31],v[148:151]
s_waitcnt lgkmcnt(4)
ds_read_b128 a[232:235],v195 offset:8192
v_max3_f32 v223,v223,v140,v141
mf v[144:147],a[240:243],a[32:35],v[144:147]
v_max3_f32 v222,v222,v138,v139
v_max3_f32 v223,v223,v142,v143
v_mul_f32 v176,s46,v222
mf v[148:151],a[240:243],a[36:39],v[148:151]
ds_read_b128 a[236:239],v196 offset:8192
v_mul_f32 v180,s46,v223
v_ceil_f32 v232,v176
mf v[144:147],a[244:247],a[40:43],v[144:147]
v_ceil_f32 v233,v180
v_sub_f32 v177,v230,v232
v_sub_f32 v181,v231,v233
mf v[148:151],a[244:247],a[44:47],v[148:151]
s_waitcnt lgkmcnt(4)
ds_read_b128 a[240:243],v193 offset:8448
v_exp_f32 v177,v177
mf v[144:147],a[248:251],a[48:51],v[144:147]
v_exp_f32 v181,v181
v_fma_f32 v128,v128,s46,-v232
v_fma_f32 v132,v132,s46,-v233
mf v[148:151],a[248:251],a[52:55],v[148:151]
ds_read_b128 a[244:247],v194 offset:8448
v_fma_f32 v129,v129,s46,-v232
v_fma_f32 v133,v133,s46,-v233
mf v[144:147],a[252:255],a[56:59],v[144:147]
v_exp_f32 v128,v128
v_exp_f32 v132,v132
v_fma_f32 v130,v130,s46,-v232
mf v[148:151],a[252:255],a[60:63],v[148:151]
s_waitcnt lgkmcnt(4)
ds_read_b128 a[248:251],v195 offset:8448
v_fma_f32 v134,v134,s46,-v233
mf v[152:155],a[224:227],a[0:3],0
v_exp_f32 v129,v129
v_exp_f32 v133,v133
v_fma_f32 v131,v131,s46,-v232
mf v[156:159],a[224:227],a[4:7],0
v_add_u32 v193,0xffff0000,v193
ds_read_b128 a[252:255],v196 offset:8448
v_fma_f32 v135,v135,s46,-v233
v_exp_f32 v130,v130
mf v[152:155],a[228:231],a[8:11],v[152:155]
v_exp_f32 v134,v134
v_fma_f32 v136,v136,s46,-v232
v_fma_f32 v140,v140,s46,-v233
mf v[156:159],a[228:231],a[12:15],v[156:159]
s_waitcnt lgkmcnt(4)
s_waitcnt vmcnt(16)
s_barrier
v_add_u32 v194,0xffff0000,v194
ds_read_b128 a[224:227],v193
mf v[152:155],a[232:235],a[16:19],v[152:155]
v_exp_f32 v131,v131
v_exp_f32 v135,v135
v_add_f32 v178,v128,v129
v_add_f32 v182,v132,v133
mf v[156:159],a[232:235],a[20:23],v[156:159]
v_add_u32 v195,0xffff0000,v195
ds_read_b128 a[228:231],v194
s_add_u32 m0,s49,16384
s_add_u32 s48,s50,163840
buffer_load_dwordx4 v208,s[24:27],s48 offen nt lds
mf v[152:155],a[236:239],a[24:27],v[152:155]
cvp v24,v128,v129
cvp v28,v132,v133
v_fma_f32 v137,v137,s46,-v232
v_fma_f32 v141,v141,s46,-v233
v_exp_f32 v136,v136
mf v[156:159],a[236:239],a[28:31],v[156:159]
s_waitcnt lgkmcnt(4)
v_add_u32 v196,0xffff0000,v196
ds_read_b128 a[232:235],v195
v_exp_f32 v140,v140
mf v[152:155],a[240:243],a[32:35],v[152:155]
v_fma_f32 v138,v138,s46,-v232
v_fma_f32 v142,v142,s46,-v233
v_exp_f32 v137,v137
mf v[156:159],a[240:243],a[36:39],v[156:159]
ds_read_b128 a[236:239],v196
v_exp_f32 v141,v141
v_add_f32 v179,v130,v131
mf v[152:155],a[244:247],a[40:43],v[152:155]
v_add_f32 v183,v134,v135
cvp v25,v130,v131
cvp v29,v134,v135
mf v[156:159],a[244:247],a[44:47],v[156:159]
s_waitcnt lgkmcnt(4)
ds_read_b128 a[240:243],v193 offset:256
buffer_load_dwordx4 v209,s[24:27],s48 offen offset:1024 nt lds
v_fma_f32 v139,v139,s46,-v232
mf v[152:155],a[248:251],a[48:51],v[152:155]
v_fma_f32 v143,v143,s46,-v233
v_exp_f32 v138,v138
v_exp_f32 v142,v142
mf v[156:159],a[248:251],a[52:55],v[156:159]
ds_read_b128 a[244:247],v194 offset:256
v_add_f32 v178,v178,v136
v_add_f32 v182,v182,v140
mf v[152:155],a[252:255],a[56:59],v[152:155]
v_exp_f32 v139,v139
v_exp_f32 v143,v143
v_add_f32 v179,v179,v137
mf v[156:159],a[252:255],a[60:63],v[156:159]
s_waitcnt lgkmcnt(4)
ds_read_b128 a[248:251],v195 offset:256
v_add_f32 v183,v183,v141
mf v[160:163],a[224:227],a[0:3],0
cvp v26,v136,v137
cvp v30,v140,v141
v_add_f32 v178,v178,v138
mf v[164:167],a[224:227],a[4:7],0
ds_read_b128 a[252:255],v196 offset:256
buffer_load_dwordx4 v210,s[24:27],s48 offen offset:2048 nt lds
v_add_f32 v182,v182,v142
v_add_f32 v179,v179,v139
mf v[160:163],a[228:231],a[8:11],v[160:163]
v_add_f32 v183,v183,v143
cvp v27,v138,v139
cvp v31,v142,v143
mf v[164:167],a[228:231],a[12:15],v[164:167]
s_waitcnt lgkmcnt(4)
ds_read_b128 a[224:227],v193 offset:8192
v_add_f32 v178,v178,v179
mf v[160:163],a[232:235],a[16:19],v[160:163]
v_add_f32 v182,v182,v183
v_fma_f32 v224,v224,v177,v178
v_fma_f32 v225,v225,v181,v182
mf v[164:167],a[232:235],a[20:23],v[164:167]
ds_read_b128 a[228:231],v194 offset:8192
v_max3_f32 v222,v222,v144,v145
v_max3_f32 v223,v223,v148,v149
mf v[160:163],a[236:239],a[24:27],v[160:163]
v_max3_f32 v222,v222,v146,v147
v_max3_f32 v223,v223,v150,v151
v_max3_f32 v222,v222,v152,v153
mf v[164:167],a[236:239],a[28:31],v[164:167]
s_waitcnt lgkmcnt(4)
ds_read_b128 a[232:235],v195 offset:8192
buffer_load_dwordx4 v211,s[24:27],s48 offen offset:3072 nt lds
v_max3_f32 v223,v223,v156,v157
mf v[160:163],a[240:243],a[32:35],v[160:163]
v_max3_f32 v222,v222,v154,v155
v_max3_f32 v223,v223,v158,v159
v_mul_f32 v176,s46,v222
mf v[164:167],a[240:243],a[36:39],v[164:167]
ds_read_b128 a[236:239],v196 offset:8192
v_mul_f32 v180,s46,v223
v_ceil_f32 v234,v176
mf v[160:163],a[244:247],a[40:43],v[160:163]
v_ceil_f32 v235,v180
v_sub_f32 v177,v232,v234
v_sub_f32 v181,v233,v235
mf v[164:167],a[244:247],a[44:47],v[164:167]
s_waitcnt lgkmcnt(4)
ds_read_b128 a[240:243],v193 offset:8448
v_exp_f32 v177,v177
mf v[160:163],a[248:251],a[48:51],v[160:163]
v_exp_f32 v181,v181
v_fma_f32 v144,v144,s46,-v234
v_fma_f32 v148,v148,s46,-v235
mf v[164:167],a[248:251],a[52:55],v[164:167]
ds_read_b128 a[244:247],v194 offset:8448
v_fma_f32 v145,v145,s46,-v234
v_fma_f32 v149,v149,s46,-v235
mf v[160:163],a[252:255],a[56:59],v[160:163]
v_exp_f32 v144,v144
v_exp_f32 v148,v148
v_fma_f32 v146,v146,s46,-v234
mf v[164:167],a[252:255],a[60:63],v[164:167]
s_waitcnt lgkmcnt(4)
ds_read_b128 a[248:251],v195 offset:8448
v_fma_f32 v150,v150,s46,-v235
mf v[168:171],a[224:227],a[0:3],0
v_exp_f32 v145,v145
v_exp_f32 v149,v149
v_fma_f32 v147,v147,s46,-v234
mf v[172:175],a[224:227],a[4:7],0
v_add_u32 v193,0x10000,v193
ds_read_b128 a[252:255],v196 offset:8448
v_fma_f32 v151,v151,s46,-v235
v_exp_f32 v146,v146
mf v[168:171],a[228:231],a[8:11],v[168:171]
v_exp_f32 v150,v150
v_fma_f32 v152,v152,s46,-v234
v_fma_f32 v156,v156,s46,-v235
mf v[172:175],a[228:231],a[12:15],v[172:175]
s_waitcnt lgkmcnt(4)
s_waitcnt vmcnt(16)
s_barrier
v_add_u32 v194,0x10000,v194
ds_read_b128 a[224:227],v193 offset:16384
mf v[168:171],a[232:235],a[16:19],v[168:171]
v_exp_f32 v147,v147
v_exp_f32 v151,v151
v_add_f32 v178,v144,v145
v_add_f32 v182,v148,v149
mf v[172:175],a[232:235],a[20:23],v[172:175]
v_add_u32 v195,0x10000,v195
ds_read_b128 a[228:231],v194 offset:16384
s_add_u32 m0,s49,65536
s_add_u32 s48,s50,180224
buffer_load_dwordx4 v208,s[24:27],s48 offen nt lds
mf v[168:171],a[236:239],a[24:27],v[168:171]
cvp v32,v144,v145
cvp v36,v148,v149
v_fma_f32 v153,v153,s46,-v234
v_fma_f32 v157,v157,s46,-v235
v_exp_f32 v152,v152
mf v[172:175],a[236:239],a[28:31],v[172:175]
s_waitcnt lgkmcnt(4)
v_add_u32 v196,0x10000,v196
ds_read_b128 a[232:235],v195 offset:16384
v_exp_f32 v156,v156
mf v[168:171],a[240:243],a[32:35],v[168:171]
v_fma_f32 v154,v154,s46,-v234
v_fma_f32 v158,v158,s46,-v235
v_exp_f32 v153,v153
mf v[172:175],a[240:243],a[36:39],v[172:175]
ds_read_b128 a[236:239],v196 offset:16384
v_exp_f32 v157,v157
v_add_f32 v179,v146,v147
mf v[168:171],a[244:247],a[40:43],v[168:171]
v_add_f32 v183,v150,v151
cvp v33,v146,v147
cvp v37,v150,v151
mf v[172:175],a[244:247],a[44:47],v[172:175]
s_waitcnt lgkmcnt(4)
ds_read_b128 a[240:243],v193 offset:16640
buffer_load_dwordx4 v209,s[24:27],s48 offen offset:1024 nt lds
v_fma_f32 v155,v155,s46,-v234
mf v[168:171],a[248:251],a[48:51],v[168:171]
v_fma_f32 v159,v159,s46,-v235
v_exp_f32 v154,v154
v_exp_f32 v158,v158
mf v[172:175],a[248:251],a[52:55],v[172:175]
ds_read_b128 a[244:247],v194 offset:16640
v_add_f32 v178,v178,v152
v_add_f32 v182,v182,v156
mf v[168:171],a[252:255],a[56:59],v[168:171]
v_exp_f32 v155,v155
v_exp_f32 v159,v159
v_add_f32 v179,v179,v153
mf v[172:175],a[252:255],a[60:63],v[172:175]
s_waitcnt lgkmcnt(4)
ds_read_b128 a[248:251],v195 offset:16640
v_add_f32 v183,v183,v157
mf v[128:131],a[224:227],a[0:3],0
cvp v34,v152,v153
cvp v38,v156,v157
v_add_f32 v178,v178,v154
mf v[132:135],a[224:227],a[4:7],0
ds_read_b128 a[252:255],v196 offset:16640
buffer_load_dwordx4 v210,s[24:27],s48 offen offset:2048 nt lds
v_add_f32 v182,v182,v158
v_add_f32 v179,v179,v155
mf v[128:131],a[228:231],a[8:11],v[128:131]
v_add_f32 v183,v183,v159
cvp v35,v154,v155
cvp v39,v158,v159
mf v[132:135],a[228:231],a[12:15],v[132:135]
s_waitcnt lgkmcnt(4)
ds_read_b128 a[224:227],v193 offset:24576
v_add_f32 v178,v178,v179
mf v[128:131],a[232:235],a[16:19],v[128:131]
v_add_f32 v182,v182,v183
v_fma_f32 v224,v224,v177,v178
v_fma_f32 v225,v225,v181,v182
mf v[132:135],a[232:235],a[20:23],v[132:135]
ds_read_b128 a[228:231],v194 offset:24576
v_max3_f32 v222,v222,v160,v161
v_max3_f32 v223,v223,v164,v165
mf v[128:131],a[236:239],a[24:27],v[128:131]
v_max3_f32 v222,v222,v162,v163
v_max3_f32 v223,v223,v166,v167
v_max3_f32 v222,v222,v168,v169
mf v[132:135],a[236:239],a[28:31],v[132:135]
s_waitcnt lgkmcnt(4)
ds_read_b128 a[232:235],v195 offset:24576
buffer_load_dwordx4 v211,s[24:27],s48 offen offset:3072 nt lds
v_max3_f32 v223,v223,v172,v173
mf v[128:131],a[240:243],a[32:35],v[128:131]
v_max3_f32 v222,v222,v170,v171
v_max3_f32 v223,v223,v174,v175
v_mul_f32 v176,s46,v222
mf v[132:135],a[240:243],a[36:39],v[132:135]
ds_read_b128 a[236:239],v196 offset:24576
v_mul_f32 v180,s46,v223
v_ceil_f32 v236,v176
mf v[128:131],a[244:247],a[40:43],v[128:131]
v_ceil_f32 v237,v180
v_sub_f32 v177,v234,v236
v_sub_f32 v181,v235,v237
mf v[132:135],a[244:247],a[44:47],v[132:135]
s_waitcnt lgkmcnt(4)
ds_read_b128 a[240:243],v193 offset:24832
v_exp_f32 v177,v177
mf v[128:131],a[248:251],a[48:51],v[128:131]
v_exp_f32 v181,v181
v_fma_f32 v160,v160,s46,-v236
v_fma_f32 v164,v164,s46,-v237
mf v[132:135],a[248:251],a[52:55],v[132:135]
ds_read_b128 a[244:247],v194 offset:24832
v_fma_f32 v161,v161,s46,-v236
v_fma_f32 v165,v165,s46,-v237
mf v[128:131],a[252:255],a[56:59],v[128:131]
v_exp_f32 v160,v160
v_exp_f32 v164,v164
v_fma_f32 v162,v162,s46,-v236
mf v[132:135],a[252:255],a[60:63],v[132:135]
s_waitcnt lgkmcnt(4)
ds_read_b128 a[248:251],v195 offset:24832
v_fma_f32 v166,v166,s46,-v237
mf v[136:139],a[224:227],a[0:3],0
v_exp_f32 v161,v161
v_exp_f32 v165,v165
v_fma_f32 v163,v163,s46,-v236
mf v[140:143],a[224:227],a[4:7],0
ds_read_b128 a[252:255],v196 offset:24832
v_fma_f32 v167,v167,s46,-v237
v_exp_f32 v162,v162
mf v[136:139],a[228:231],a[8:11],v[136:139]
v_exp_f32 v166,v166
v_fma_f32 v168,v168,s46,-v236
v_fma_f32 v172,v172,s46,-v237
mf v[140:143],a[228:231],a[12:15],v[140:143]
s_waitcnt lgkmcnt(4)
s_waitcnt vmcnt(16)
s_barrier
ds_read_b128 a[224:227],v193 offset:32768
mf v[136:139],a[232:235],a[16:19],v[136:139]
v_exp_f32 v163,v163
v_exp_f32 v167,v167
v_add_f32 v178,v160,v161
v_add_f32 v182,v164,v165
mf v[140:143],a[232:235],a[20:23],v[140:143]
ds_read_b128 a[228:231],v194 offset:32768
s_add_u32 m0,s49,0
s_add_u32 s48,s50,196608
buffer_load_dwordx4 v208,s[24:27],s48 offen nt lds
cvp v40,v160,v161
mf v[136:139],a[236:239],a[24:27],v[136:139]
cvp v44,v164,v165
v_fma_f32 v169,v169,s46,-v236
v_fma_f32 v173,v173,s46,-v237
v_exp_f32 v168,v168
mf v[140:143],a[236:239],a[28:31],v[140:143]
s_waitcnt lgkmcnt(4)
ds_read_b128 a[232:235],v195 offset:32768
v_exp_f32 v172,v172
mf v[136:139],a[240:243],a[32:35],v[136:139]
v_fma_f32 v170,v170,s46,-v236
v_fma_f32 v174,v174,s46,-v237
v_exp_f32 v169,v169
mf v[140:143],a[240:243],a[36:39],v[140:143]
ds_read_b128 a[236:239],v196 offset:32768
v_exp_f32 v173,v173
v_add_f32 v179,v162,v163
mf v[136:139],a[244:247],a[40:43],v[136:139]
v_add_f32 v183,v166,v167
cvp v41,v162,v163
cvp v45,v166,v167
mf v[140:143],a[244:247],a[44:47],v[140:143]
s_waitcnt lgkmcnt(4)
ds_read_b128 a[240:243],v193 offset:33024
buffer_load_dwordx4 v209,s[24:27],s48 offen offset:1024 nt lds
v_fma_f32 v171,v171,s46,-v236
mf v[136:139],a[248:251],a[48:51],v[136:139]
v_fma_f32 v175,v175,s46,-v237
v_exp_f32 v170,v170
v_exp_f32 v174,v174
mf v[140:143],a[248:251],a[52:55],v[140:143]
ds_read_b128 a[244:247],v194 offset:33024
v_add_f32 v178,v178,v168
v_add_f32 v182,v182,v172
mf v[136:139],a[252:255],a[56:59],v[136:139]
v_exp_f32 v171,v171
v_exp_f32 v175,v175
v_add_f32 v179,v179,v169
mf v[140:143],a[252:255],a[60:63],v[140:143]
s_waitcnt lgkmcnt(4)
ds_read_b128 a[248:251],v195 offset:33024
v_add_f32 v183,v183,v173
mf v[144:147],a[224:227],a[0:3],0
cvp v42,v168,v169
cvp v46,v172,v173
v_add_f32 v178,v178,v170
mf v[148:151],a[224:227],a[4:7],0
ds_read_b128 a[252:255],v196 offset:33024
buffer_load_dwordx4 v210,s[24:27],s48 offen offset:2048 nt lds
v_add_f32 v182,v182,v174
v_add_f32 v179,v179,v171
mf v[144:147],a[228:231],a[8:11],v[144:147]
v_add_f32 v183,v183,v175
cvp v43,v170,v171
cvp v47,v174,v175
mf v[148:151],a[228:231],a[12:15],v[148:151]
s_waitcnt lgkmcnt(4)
ds_read_b128 a[224:227],v193 offset:40960
v_add_f32 v178,v178,v179
mf v[144:147],a[232:235],a[16:19],v[144:147]
v_add_f32 v182,v182,v183
v_fma_f32 v224,v224,v177,v178
v_fma_f32 v225,v225,v181,v182
mf v[148:151],a[232:235],a[20:23],v[148:151]
ds_read_b128 a[228:231],v194 offset:40960
v_max3_f32 v222,v222,v128,v129
v_max3_f32 v223,v223,v132,v133
mf v[144:147],a[236:239],a[24:27],v[144:147]
v_max3_f32 v222,v222,v130,v131
v_max3_f32 v223,v223,v134,v135
v_max3_f32 v222,v222,v136,v137
mf v[148:151],a[236:239],a[28:31],v[148:151]
s_waitcnt lgkmcnt(4)
ds_read_b128 a[232:235],v195 offset:40960
buffer_load_dwordx4 v211,s[24:27],s48 offen offset:3072 nt lds
v_max3_f32 v223,v223,v140,v141
mf v[144:147],a[240:243],a[32:35],v[144:147]
v_max3_f32 v222,v222,v138,v139
v_max3_f32 v223,v223,v142,v143
v_mul_f32 v176,s46,v222
mf v[148:151],a[240:243],a[36:39],v[148:151]
ds_read_b128 a[236:239],v196 offset:40960
v_mul_f32 v180,s46,v223
v_ceil_f32 v238,v176
mf v[144:147],a[244:247],a[40:43],v[144:147]
v_ceil_f32 v239,v180
v_sub_f32 v177,v236,v238
v_sub_f32 v181,v237,v239
mf v[148:151],a[244:247],a[44:47],v[148:151]
s_waitcnt lgkmcnt(4)
ds_read_b128 a[240:243],v193 offset:41216
v_exp_f32 v177,v177
mf v[144:147],a[248:251],a[48:51],v[144:147]
v_exp_f32 v181,v181
v_fma_f32 v128,v128,s46,-v238
v_fma_f32 v132,v132,s46,-v239
mf v[148:151],a[248:251],a[52:55],v[148:151]
ds_read_b128 a[244:247],v194 offset:41216
v_fma_f32 v129,v129,s46,-v238
v_fma_f32 v133,v133,s46,-v239
mf v[144:147],a[252:255],a[56:59],v[144:147]
v_exp_f32 v128,v128
v_exp_f32 v132,v132
v_fma_f32 v130,v130,s46,-v238
mf v[148:151],a[252:255],a[60:63],v[148:151]
s_waitcnt lgkmcnt(4)
ds_read_b128 a[248:251],v195 offset:41216
v_fma_f32 v134,v134,s46,-v239
mf v[152:155],a[224:227],a[0:3],0
v_exp_f32 v129,v129
v_exp_f32 v133,v133
v_fma_f32 v131,v131,s46,-v238
mf v[156:159],a[224:227],a[4:7],0
v_add_u32 v193,0xffff0000,v193
ds_read_b128 a[252:255],v196 offset:41216
v_fma_f32 v135,v135,s46,-v239
v_exp_f32 v130,v130
mf v[152:155],a[228:231],a[8:11],v[152:155]
v_exp_f32 v134,v134
v_fma_f32 v136,v136,s46,-v238
v_fma_f32 v140,v140,s46,-v239
mf v[156:159],a[228:231],a[12:15],v[156:159]
s_waitcnt lgkmcnt(4)
s_waitcnt vmcnt(16)
s_barrier
v_add_u32 v194,0xffff0000,v194
ds_read_b128 a[224:227],v193 offset:32768
mf v[152:155],a[232:235],a[16:19],v[152:155]
v_exp_f32 v131,v131
v_exp_f32 v135,v135
v_add_f32 v178,v128,v129
v_add_f32 v182,v132,v133
mf v[156:159],a[232:235],a[20:23],v[156:159]
v_add_u32 v195,0xffff0000,v195
ds_read_b128 a[228:231],v194 offset:32768
cvp v48,v128,v129
cvp v52,v132,v133
mf v[152:155],a[236:239],a[24:27],v[152:155]
v_fma_f32 v137,v137,s46,-v238
v_fma_f32 v141,v141,s46,-v239
v_exp_f32 v136,v136
mf v[156:159],a[236:239],a[28:31],v[156:159]
s_waitcnt lgkmcnt(4)
v_add_u32 v196,0xffff0000,v196
ds_read_b128 a[232:235],v195 offset:32768
v_exp_f32 v140,v140
mf v[152:155],a[240:243],a[32:35],v[152:155]
v_fma_f32 v138,v138,s46,-v238
v_fma_f32 v142,v142,s46,-v239
v_exp_f32 v137,v137
mf v[156:159],a[240:243],a[36:39],v[156:159]
ds_read_b128 a[236:239],v196 offset:32768
v_exp_f32 v141,v141
v_add_f32 v179,v130,v131
mf v[152:155],a[244:247],a[40:43],v[152:155]
v_add_f32 v183,v134,v135
cvp v49,v130,v131
cvp v53,v134,v135
mf v[156:159],a[244:247],a[44:47],v[156:159]
s_waitcnt lgkmcnt(4)
ds_read_b128 a[240:243],v193 offset:33024
v_fma_f32 v139,v139,s46,-v238
mf v[152:155],a[248:251],a[48:51],v[152:155]
v_fma_f32 v143,v143,s46,-v239
v_exp_f32 v138,v138
v_exp_f32 v142,v142
mf v[156:159],a[248:251],a[52:55],v[156:159]
ds_read_b128 a[244:247],v194 offset:33024
v_add_f32 v178,v178,v136
v_add_f32 v182,v182,v140
mf v[152:155],a[252:255],a[56:59],v[152:155]
v_exp_f32 v139,v139
v_exp_f32 v143,v143
v_add_f32 v179,v179,v137
mf v[156:159],a[252:255],a[60:63],v[156:159]
s_waitcnt lgkmcnt(4)
ds_read_b128 a[248:251],v195 offset:33024
v_add_f32 v183,v183,v141
mf v[160:163],a[224:227],a[0:3],0
cvp v50,v136,v137
cvp v54,v140,v141
v_add_f32 v178,v178,v138
mf v[164:167],a[224:227],a[4:7],0
ds_read_b128 a[252:255],v196 offset:33024
v_add_f32 v182,v182,v142
v_add_f32 v179,v179,v139
mf v[160:163],a[228:231],a[8:11],v[160:163]
v_add_f32 v183,v183,v143
cvp v51,v138,v139
cvp v55,v142,v143
mf v[164:167],a[228:231],a[12:15],v[164:167]
s_waitcnt lgkmcnt(4)
ds_read_b128 a[224:227],v193 offset:40960
v_add_f32 v178,v178,v179
mf v[160:163],a[232:235],a[16:19],v[160:163]
v_add_f32 v182,v182,v183
v_fma_f32 v224,v224,v177,v178
v_fma_f32 v225,v225,v181,v182
mf v[164:167],a[232:235],a[20:23],v[164:167]
ds_read_b128 a[228:231],v194 offset:40960
v_max3_f32 v222,v222,v144,v145
v_max3_f32 v223,v223,v148,v149
mf v[160:163],a[236:239],a[24:27],v[160:163]
v_max3_f32 v222,v222,v146,v147
v_max3_f32 v223,v223,v150,v151
v_max3_f32 v222,v222,v152,v153
mf v[164:167],a[236:239],a[28:31],v[164:167]
s_waitcnt lgkmcnt(4)
ds_read_b128 a[232:235],v195 offset:40960
v_max3_f32 v223,v223,v156,v157
mf v[160:163],a[240:243],a[32:35],v[160:163]
v_max3_f32 v222,v222,v154,v155
v_max3_f32 v223,v223,v158,v159
v_mul_f32 v176,s46,v222
mf v[164:167],a[240:243],a[36:39],v[164:167]
ds_read_b128 a[236:239],v196 offset:40960
v_mul_f32 v180,s46,v223
v_ceil_f32 v240,v176
mf v[160:163],a[244:247],a[40:43],v[160:163]
v_ceil_f32 v241,v180
v_sub_f32 v177,v238,v240
v_sub_f32 v181,v239,v241
mf v[164:167],a[244:247],a[44:47],v[164:167]
s_waitcnt lgkmcnt(4)
ds_read_b128 a[240:243],v193 offset:41216
v_exp_f32 v177,v177
mf v[160:163],a[248:251],a[48:51],v[160:163]
v_exp_f32 v181,v181
v_fma_f32 v144,v144,s46,-v240
v_fma_f32 v148,v148,s46,-v241
mf v[164:167],a[248:251],a[52:55],v[164:167]
ds_read_b128 a[244:247],v194 offset:41216
v_fma_f32 v145,v145,s46,-v240
v_fma_f32 v149,v149,s46,-v241
mf v[160:163],a[252:255],a[56:59],v[160:163]
v_exp_f32 v144,v144
v_exp_f32 v148,v148
v_fma_f32 v146,v146,s46,-v240
mf v[164:167],a[252:255],a[60:63],v[164:167]
s_waitcnt lgkmcnt(4)
ds_read_b128 a[248:251],v195 offset:41216
v_fma_f32 v150,v150,s46,-v241
mf v[168:171],a[224:227],a[0:3],0
v_exp_f32 v145,v145
v_exp_f32 v149,v149
v_fma_f32 v147,v147,s46,-v240
mf v[172:175],a[224:227],a[4:7],0
ds_read_b128 a[252:255],v196 offset:41216
v_fma_f32 v151,v151,s46,-v241
v_exp_f32 v146,v146
mf v[168:171],a[228:231],a[8:11],v[168:171]
v_exp_f32 v150,v150
v_fma_f32 v152,v152,s46,-v240
v_fma_f32 v156,v156,s46,-v241
mf v[172:175],a[228:231],a[12:15],v[172:175]
s_waitcnt lgkmcnt(4)
s_waitcnt vmcnt(12)
s_barrier
ds_read_b128 a[224:227],v193 offset:49152
mf v[168:171],a[232:235],a[16:19],v[168:171]
v_exp_f32 v147,v147
v_exp_f32 v151,v151
v_add_f32 v178,v144,v145
v_add_f32 v182,v148,v149
mf v[172:175],a[232:235],a[20:23],v[172:175]
ds_read_b128 a[228:231],v194 offset:49152
s_add_u32 m0,s49,81920
s_add_u32 s48,s50,212992
buffer_load_dwordx4 v208,s[24:27],s48 offen nt lds
cvp v56,v144,v145
mf v[168:171],a[236:239],a[24:27],v[168:171]
cvp v60,v148,v149
v_fma_f32 v153,v153,s46,-v240
v_fma_f32 v157,v157,s46,-v241
v_exp_f32 v152,v152
mf v[172:175],a[236:239],a[28:31],v[172:175]
s_waitcnt lgkmcnt(4)
ds_read_b128 a[232:235],v195 offset:49152
v_exp_f32 v156,v156
mf v[168:171],a[240:243],a[32:35],v[168:171]
v_fma_f32 v154,v154,s46,-v240
v_fma_f32 v158,v158,s46,-v241
v_exp_f32 v153,v153
mf v[172:175],a[240:243],a[36:39],v[172:175]
ds_read_b128 a[236:239],v196 offset:49152
v_exp_f32 v157,v157
v_add_f32 v179,v146,v147
mf v[168:171],a[244:247],a[40:43],v[168:171]
v_add_f32 v183,v150,v151
cvp v57,v146,v147
cvp v61,v150,v151
mf v[172:175],a[244:247],a[44:47],v[172:175]
s_waitcnt lgkmcnt(4)
ds_read_b128 a[240:243],v193 offset:49408
buffer_load_dwordx4 v209,s[24:27],s48 offen offset:1024 nt lds
v_fma_f32 v155,v155,s46,-v240
mf v[168:171],a[248:251],a[48:51],v[168:171]
v_fma_f32 v159,v159,s46,-v241
v_exp_f32 v154,v154
v_exp_f32 v158,v158
mf v[172:175],a[248:251],a[52:55],v[172:175]
ds_read_b128 a[244:247],v194 offset:49408
v_add_f32 v178,v178,v152
v_add_f32 v182,v182,v156
mf v[168:171],a[252:255],a[56:59],v[168:171]
v_exp_f32 v155,v155
v_exp_f32 v159,v159
v_add_f32 v179,v179,v153
mf v[172:175],a[252:255],a[60:63],v[172:175]
s_waitcnt lgkmcnt(4)
ds_read_b128 a[248:251],v195 offset:49408
v_add_f32 v183,v183,v157
mf v[128:131],a[224:227],a[0:3],0
cvp v58,v152,v153
cvp v62,v156,v157
v_add_f32 v178,v178,v154
mf v[132:135],a[224:227],a[4:7],0
ds_read_b128 a[252:255],v196 offset:49408
buffer_load_dwordx4 v210,s[24:27],s48 offen offset:2048 nt lds
v_add_f32 v182,v182,v158
v_add_f32 v179,v179,v155
mf v[128:131],a[228:231],a[8:11],v[128:131]
v_add_f32 v183,v183,v159
cvp v59,v154,v155
cvp v63,v158,v159
mf v[132:135],a[228:231],a[12:15],v[132:135]
s_waitcnt lgkmcnt(4)
ds_read_b128 a[224:227],v193 offset:57344
v_add_f32 v178,v178,v179
mf v[128:131],a[232:235],a[16:19],v[128:131]
v_add_f32 v182,v182,v183
v_fma_f32 v224,v224,v177,v178
v_fma_f32 v225,v225,v181,v182
mf v[132:135],a[232:235],a[20:23],v[132:135]
ds_read_b128 a[228:231],v194 offset:57344
v_max3_f32 v222,v222,v160,v161
v_max3_f32 v223,v223,v164,v165
mf v[128:131],a[236:239],a[24:27],v[128:131]
v_max3_f32 v222,v222,v162,v163
v_max3_f32 v223,v223,v166,v167
v_max3_f32 v222,v222,v168,v169
mf v[132:135],a[236:239],a[28:31],v[132:135]
s_waitcnt lgkmcnt(4)
ds_read_b128 a[232:235],v195 offset:57344
buffer_load_dwordx4 v211,s[24:27],s48 offen offset:3072 nt lds
v_max3_f32 v223,v223,v172,v173
mf v[128:131],a[240:243],a[32:35],v[128:131]
v_max3_f32 v222,v222,v170,v171
v_max3_f32 v223,v223,v174,v175
v_mul_f32 v176,s46,v222
mf v[132:135],a[240:243],a[36:39],v[132:135]
ds_read_b128 a[236:239],v196 offset:57344
v_mul_f32 v180,s46,v223
v_ceil_f32 v242,v176
mf v[128:131],a[244:247],a[40:43],v[128:131]
v_ceil_f32 v243,v180
v_sub_f32 v177,v240,v242
v_sub_f32 v181,v241,v243
mf v[132:135],a[244:247],a[44:47],v[132:135]
s_waitcnt lgkmcnt(4)
ds_read_b128 a[240:243],v193 offset:57600
v_exp_f32 v177,v177
mf v[128:131],a[248:251],a[48:51],v[128:131]
v_exp_f32 v181,v181
v_fma_f32 v160,v160,s46,-v242
v_fma_f32 v164,v164,s46,-v243
mf v[132:135],a[248:251],a[52:55],v[132:135]
ds_read_b128 a[244:247],v194 offset:57600
v_fma_f32 v161,v161,s46,-v242
v_fma_f32 v165,v165,s46,-v243
mf v[128:131],a[252:255],a[56:59],v[128:131]
v_exp_f32 v160,v160
v_exp_f32 v164,v164
v_fma_f32 v162,v162,s46,-v242
mf v[132:135],a[252:255],a[60:63],v[132:135]
s_waitcnt lgkmcnt(4)
ds_read_b128 a[248:251],v195 offset:57600
v_fma_f32 v166,v166,s46,-v243
mf v[136:139],a[224:227],a[0:3],0
v_exp_f32 v161,v161
v_exp_f32 v165,v165
v_fma_f32 v163,v163,s46,-v242
mf v[140:143],a[224:227],a[4:7],0
ds_read_b128 a[252:255],v196 offset:57600
v_fma_f32 v167,v167,s46,-v243
v_exp_f32 v162,v162
mf v[136:139],a[228:231],a[8:11],v[136:139]
v_exp_f32 v166,v166
v_fma_f32 v168,v168,s46,-v242
v_fma_f32 v172,v172,s46,-v243
mf v[140:143],a[228:231],a[12:15],v[140:143]
s_waitcnt lgkmcnt(4)
s_waitcnt vmcnt(12)
s_barrier
ds_read_b128 a[224:227],v193 offset:16384
mf v[136:139],a[232:235],a[16:19],v[136:139]
v_exp_f32 v163,v163
v_exp_f32 v167,v167
v_add_f32 v178,v160,v161
v_add_f32 v182,v164,v165
mf v[140:143],a[232:235],a[20:23],v[140:143]
ds_read_b128 a[228:231],v194 offset:16384
s_add_u32 m0,s49,32768
s_add_u32 s48,s50,229376
buffer_load_dwordx4 v208,s[24:27],s48 offen nt lds
cvp v64,v160,v161
mf v[136:139],a[236:239],a[24:27],v[136:139]
cvp v68,v164,v165
v_fma_f32 v169,v169,s46,-v242
v_fma_f32 v173,v173,s46,-v243
v_exp_f32 v168,v168
mf v[140:143],a[236:239],a[28:31],v[140:143]
s_waitcnt lgkmcnt(4)
ds_read_b128 a[232:235],v195 offset:16384
buffer_load_dwordx4 v209,s[24:27],s48 offen offset:1024 nt lds
v_exp_f32 v172,v172
mf v[136:139],a[240:243],a[32:35],v[136:139]
v_fma_f32 v170,v170,s46,-v242
v_fma_f32 v174,v174,s46,-v243
v_exp_f32 v169,v169
mf v[140:143],a[240:243],a[36:39],v[140:143]
ds_read_b128 a[236:239],v196 offset:16384
buffer_load_dwordx4 v210,s[24:27],s48 offen offset:2048 nt lds
v_exp_f32 v173,v173
v_add_f32 v179,v162,v163
mf v[136:139],a[244:247],a[40:43],v[136:139]
v_add_f32 v183,v166,v167
cvp v65,v162,v163
cvp v69,v166,v167
mf v[140:143],a[244:247],a[44:47],v[140:143]
s_waitcnt lgkmcnt(4)
ds_read_b128 a[240:243],v193 offset:16640
buffer_load_dwordx4 v211,s[24:27],s48 offen offset:3072 nt lds
v_fma_f32 v171,v171,s46,-v242
mf v[136:139],a[248:251],a[48:51],v[136:139]
v_fma_f32 v175,v175,s46,-v243
v_exp_f32 v170,v170
v_exp_f32 v174,v174
mf v[140:143],a[248:251],a[52:55],v[140:143]
ds_read_b128 a[244:247],v194 offset:16640
s_add_u32 m0,s49,98304
s_add_u32 s48,s50,245760
buffer_load_dwordx4 v208,s[24:27],s48 offen nt lds
v_add_f32 v178,v178,v168
mf v[136:139],a[252:255],a[56:59],v[136:139]
v_add_f32 v182,v182,v172
v_exp_f32 v171,v171
v_exp_f32 v175,v175
v_add_f32 v179,v179,v169
mf v[140:143],a[252:255],a[60:63],v[140:143]
s_waitcnt lgkmcnt(4)
ds_read_b128 a[248:251],v195 offset:16640
buffer_load_dwordx4 v209,s[24:27],s48 offen offset:1024 nt lds
v_add_f32 v183,v183,v173
mf v[144:147],a[224:227],a[0:3],0
cvp v66,v168,v169
cvp v70,v172,v173
v_add_f32 v178,v178,v170
mf v[148:151],a[224:227],a[4:7],0
ds_read_b128 a[252:255],v196 offset:16640
buffer_load_dwordx4 v210,s[24:27],s48 offen offset:2048 nt lds
v_add_f32 v182,v182,v174
v_add_f32 v179,v179,v171
mf v[144:147],a[228:231],a[8:11],v[144:147]
v_add_f32 v183,v183,v175
cvp v67,v170,v171
cvp v71,v174,v175
mf v[148:151],a[228:231],a[12:15],v[148:151]
s_waitcnt lgkmcnt(4)
ds_read_b128 a[224:227],v193 offset:24576
buffer_load_dwordx4 v211,s[24:27],s48 offen offset:3072 nt lds
v_add_f32 v178,v178,v179
mf v[144:147],a[232:235],a[16:19],v[144:147]
v_add_f32 v182,v182,v183
v_fma_f32 v224,v224,v177,v178
v_fma_f32 v225,v225,v181,v182
mf v[148:151],a[232:235],a[20:23],v[148:151]
ds_read_b128 a[228:231],v194 offset:24576
v_max3_f32 v222,v222,v128,v129
v_max3_f32 v223,v223,v132,v133
mf v[144:147],a[236:239],a[24:27],v[144:147]
v_max3_f32 v222,v222,v130,v131
v_max3_f32 v223,v223,v134,v135
v_max3_f32 v222,v222,v136,v137
mf v[148:151],a[236:239],a[28:31],v[148:151]
s_waitcnt lgkmcnt(4)
ds_read_b128 a[232:235],v195 offset:24576
v_max3_f32 v223,v223,v140,v141
mf v[144:147],a[240:243],a[32:35],v[144:147]
v_max3_f32 v222,v222,v138,v139
v_max3_f32 v223,v223,v142,v143
v_mul_f32 v176,s46,v222
mf v[148:151],a[240:243],a[36:39],v[148:151]
ds_read_b128 a[236:239],v196 offset:24576
v_mul_f32 v180,s46,v223
v_ceil_f32 v244,v176
mf v[144:147],a[244:247],a[40:43],v[144:147]
v_ceil_f32 v245,v180
v_sub_f32 v177,v242,v244
v_sub_f32 v181,v243,v245
mf v[148:151],a[244:247],a[44:47],v[148:151]
s_waitcnt lgkmcnt(4)
ds_read_b128 a[240:243],v193 offset:24832
v_exp_f32 v177,v177
mf v[144:147],a[248:251],a[48:51],v[144:147]
v_exp_f32 v181,v181
v_fma_f32 v128,v128,s46,-v244
v_fma_f32 v132,v132,s46,-v245
mf v[148:151],a[248:251],a[52:55],v[148:151]
ds_read_b128 a[244:247],v194 offset:24832
v_fma_f32 v129,v129,s46,-v244
v_fma_f32 v133,v133,s46,-v245
mf v[144:147],a[252:255],a[56:59],v[144:147]
v_exp_f32 v128,v128
v_exp_f32 v132,v132
v_fma_f32 v130,v130,s46,-v244
mf v[148:151],a[252:255],a[60:63],v[148:151]
s_waitcnt lgkmcnt(4)
ds_read_b128 a[248:251],v195 offset:24832
v_fma_f32 v134,v134,s46,-v245
mf v[152:155],a[224:227],a[0:3],0
v_exp_f32 v129,v129
v_exp_f32 v133,v133
v_fma_f32 v131,v131,s46,-v244
mf v[156:159],a[224:227],a[4:7],0
v_add_u32 v193,0x10000,v193
ds_read_b128 a[252:255],v196 offset:24832
v_fma_f32 v135,v135,s46,-v245
v_exp_f32 v130,v130
mf v[152:155],a[228:231],a[8:11],v[152:155]
v_exp_f32 v134,v134
v_fma_f32 v136,v136,s46,-v244
v_fma_f32 v140,v140,s46,-v245
mf v[156:159],a[228:231],a[12:15],v[156:159]
s_waitcnt lgkmcnt(4)
s_waitcnt vmcnt(16)
s_barrier
v_add_u32 v194,0x10000,v194
ds_read_b128 a[224:227],v193
mf v[152:155],a[232:235],a[16:19],v[152:155]
v_exp_f32 v131,v131
v_exp_f32 v135,v135
v_add_f32 v178,v128,v129
v_add_f32 v182,v132,v133
mf v[156:159],a[232:235],a[20:23],v[156:159]
v_add_u32 v195,0x10000,v195
ds_read_b128 a[228:231],v194
s_add_u32 m0,s49,49152
s_add_u32 s48,s53,s92
buffer_load_dwordx4 v216,s[36:39],s48 offen lds
mf v[152:155],a[236:239],a[24:27],v[152:155]
cvp v72,v128,v129
cvp v76,v132,v133
v_fma_f32 v137,v137,s46,-v244
v_fma_f32 v141,v141,s46,-v245
v_exp_f32 v136,v136
mf v[156:159],a[236:239],a[28:31],v[156:159]
s_waitcnt lgkmcnt(4)
v_add_u32 v196,0x10000,v196
ds_read_b128 a[232:235],v195
buffer_load_dwordx4 v217,s[36:39],s48 offen offset:1024 lds
mf v[152:155],a[240:243],a[32:35],v[152:155]
v_exp_f32 v140,v140
v_fma_f32 v138,v138,s46,-v244
v_fma_f32 v142,v142,s46,-v245
v_exp_f32 v137,v137
mf v[156:159],a[240:243],a[36:39],v[156:159]
ds_read_b128 a[236:239],v196
buffer_load_dwordx4 v218,s[36:39],s48 offen offset:2048 lds
v_exp_f32 v141,v141
v_add_f32 v179,v130,v131
mf v[152:155],a[244:247],a[40:43],v[152:155]
v_add_f32 v183,v134,v135
cvp v73,v130,v131
cvp v77,v134,v135
mf v[156:159],a[244:247],a[44:47],v[156:159]
s_waitcnt lgkmcnt(4)
ds_read_b128 a[240:243],v193 offset:256
buffer_load_dwordx4 v219,s[36:39],s48 offen offset:3072 lds
v_fma_f32 v139,v139,s46,-v244
mf v[152:155],a[248:251],a[48:51],v[152:155]
v_fma_f32 v143,v143,s46,-v245
v_exp_f32 v138,v138
v_exp_f32 v142,v142
mf v[156:159],a[248:251],a[52:55],v[156:159]
ds_read_b128 a[244:247],v194 offset:256
s_add_u32 m0,s49,114688
s_add_u32 s48,s51,0
buffer_load_dwordx4 v212,s[28:31],s48 offen nt lds
v_add_f32 v178,v178,v136
mf v[152:155],a[252:255],a[56:59],v[152:155]
v_add_f32 v182,v182,v140
v_exp_f32 v139,v139
v_exp_f32 v143,v143
v_add_f32 v179,v179,v137
mf v[156:159],a[252:255],a[60:63],v[156:159]
s_waitcnt lgkmcnt(4)
ds_read_b128 a[248:251],v195 offset:256
buffer_load_dwordx4 v213,s[28:31],s48 offen offset:1024 nt lds
v_add_f32 v183,v183,v141
mf v[160:163],a[224:227],a[0:3],0
cvp v74,v136,v137
cvp v78,v140,v141
v_add_f32 v178,v178,v138
mf v[164:167],a[224:227],a[4:7],0
ds_read_b128 a[252:255],v196 offset:256
buffer_load_dwordx4 v214,s[28:31],s48 offen offset:2048 nt lds
v_add_f32 v182,v182,v142
v_add_f32 v179,v179,v139
mf v[160:163],a[228:231],a[8:11],v[160:163]
v_add_f32 v183,v183,v143
cvp v75,v138,v139
cvp v79,v142,v143
mf v[164:167],a[228:231],a[12:15],v[164:167]
s_waitcnt lgkmcnt(4)
ds_read_b128 a[224:227],v193 offset:8192
buffer_load_dwordx4 v215,s[28:31],s48 offen offset:3072 nt lds
v_add_f32 v178,v178,v179
mf v[160:163],a[232:235],a[16:19],v[160:163]
v_add_f32 v182,v182,v183
v_fma_f32 v224,v224,v177,v178
v_fma_f32 v225,v225,v181,v182
mf v[164:167],a[232:235],a[20:23],v[164:167]
ds_read_b128 a[228:231],v194 offset:8192
v_max3_f32 v222,v222,v144,v145
v_max3_f32 v223,v223,v148,v149
mf v[160:163],a[236:239],a[24:27],v[160:163]
v_max3_f32 v222,v222,v146,v147
v_max3_f32 v223,v223,v150,v151
v_max3_f32 v222,v222,v152,v153
mf v[164:167],a[236:239],a[28:31],v[164:167]
s_waitcnt lgkmcnt(4)
ds_read_b128 a[232:235],v195 offset:8192
v_max3_f32 v223,v223,v156,v157
mf v[160:163],a[240:243],a[32:35],v[160:163]
v_max3_f32 v222,v222,v154,v155
v_max3_f32 v223,v223,v158,v159
v_mul_f32 v176,s46,v222
mf v[164:167],a[240:243],a[36:39],v[164:167]
ds_read_b128 a[236:239],v196 offset:8192
v_mul_f32 v180,s46,v223
v_ceil_f32 v246,v176
mf v[160:163],a[244:247],a[40:43],v[160:163]
v_ceil_f32 v247,v180
v_sub_f32 v177,v244,v246
v_sub_f32 v181,v245,v247
mf v[164:167],a[244:247],a[44:47],v[164:167]
s_waitcnt lgkmcnt(4)
ds_read_b128 a[240:243],v193 offset:8448
v_exp_f32 v177,v177
mf v[160:163],a[248:251],a[48:51],v[160:163]
v_exp_f32 v181,v181
v_fma_f32 v144,v144,s46,-v246
v_fma_f32 v148,v148,s46,-v247
mf v[164:167],a[248:251],a[52:55],v[164:167]
ds_read_b128 a[244:247],v194 offset:8448
v_fma_f32 v145,v145,s46,-v246
v_fma_f32 v149,v149,s46,-v247
mf v[160:163],a[252:255],a[56:59],v[160:163]
v_exp_f32 v144,v144
v_exp_f32 v148,v148
v_fma_f32 v146,v146,s46,-v246
mf v[164:167],a[252:255],a[60:63],v[164:167]
s_waitcnt lgkmcnt(4)
ds_read_b128 a[248:251],v195 offset:8448
v_fma_f32 v150,v150,s46,-v247
mf v[168:171],a[224:227],a[0:3],0
v_exp_f32 v145,v145
v_exp_f32 v149,v149
v_fma_f32 v147,v147,s46,-v246
mf v[172:175],a[224:227],a[4:7],0
v_add_u32 v193,0xffff0000,v193
ds_read_b128 a[252:255],v196 offset:8448
v_fma_f32 v151,v151,s46,-v247
v_exp_f32 v146,v146
mf v[168:171],a[228:231],a[8:11],v[168:171]
v_exp_f32 v150,v150
v_fma_f32 v152,v152,s46,-v246
v_fma_f32 v156,v156,s46,-v247
mf v[172:175],a[228:231],a[12:15],v[172:175]
s_waitcnt lgkmcnt(4)
s_waitcnt vmcnt(20)
s_barrier
v_add_u32 v194,0xffff0000,v194
ds_read_b128 a[224:227],v193
mf v[168:171],a[232:235],a[16:19],v[168:171]
v_exp_f32 v147,v147
v_exp_f32 v151,v151
v_add_f32 v178,v144,v145
v_add_f32 v182,v148,v149
mf v[172:175],a[232:235],a[20:23],v[172:175]
v_add_u32 v195,0xffff0000,v195
ds_read_b128 a[228:231],v194
cvp v80,v144,v145
cvp v84,v148,v149
mf v[168:171],a[236:239],a[24:27],v[168:171]
v_fma_f32 v153,v153,s46,-v246
v_fma_f32 v157,v157,s46,-v247
v_exp_f32 v152,v152
mf v[172:175],a[236:239],a[28:31],v[172:175]
s_waitcnt lgkmcnt(4)
v_add_u32 v196,0xffff0000,v196
ds_read_b128 a[232:235],v195
v_exp_f32 v156,v156
mf v[168:171],a[240:243],a[32:35],v[168:171]
v_fma_f32 v154,v154,s46,-v246
v_fma_f32 v158,v158,s46,-v247
v_exp_f32 v153,v153
mf v[172:175],a[240:243],a[36:39],v[172:175]
ds_read_b128 a[236:239],v196
v_exp_f32 v157,v157
v_add_f32 v179,v146,v147
mf v[168:171],a[244:247],a[40:43],v[168:171]
v_add_f32 v183,v150,v151
cvp v81,v146,v147
cvp v85,v150,v151
mf v[172:175],a[244:247],a[44:47],v[172:175]
s_waitcnt lgkmcnt(4)
ds_read_b128 a[240:243],v193 offset:256
v_fma_f32 v155,v155,s46,-v246
mf v[168:171],a[248:251],a[48:51],v[168:171]
v_fma_f32 v159,v159,s46,-v247
v_exp_f32 v154,v154
v_exp_f32 v158,v158
mf v[172:175],a[248:251],a[52:55],v[172:175]
ds_read_b128 a[244:247],v194 offset:256
v_add_f32 v178,v178,v152
v_add_f32 v182,v182,v156
mf v[168:171],a[252:255],a[56:59],v[168:171]
v_exp_f32 v155,v155
v_exp_f32 v159,v159
v_add_f32 v179,v179,v153
mf v[172:175],a[252:255],a[60:63],v[172:175]
s_waitcnt lgkmcnt(4)
ds_read_b128 a[248:251],v195 offset:256
v_add_f32 v183,v183,v157
mf v[128:131],a[224:227],a[0:3],0
cvp v82,v152,v153
cvp v86,v156,v157
v_add_f32 v178,v178,v154
mf v[132:135],a[224:227],a[4:7],0
ds_read_b128 a[252:255],v196 offset:256
v_add_f32 v182,v182,v158
v_add_f32 v179,v179,v155
mf v[128:131],a[228:231],a[8:11],v[128:131]
v_add_f32 v183,v183,v159
cvp v83,v154,v155
cvp v87,v158,v159
mf v[132:135],a[228:231],a[12:15],v[132:135]
s_waitcnt lgkmcnt(4)
ds_read_b128 a[224:227],v193 offset:8192
v_add_f32 v178,v178,v179
mf v[128:131],a[232:235],a[16:19],v[128:131]
v_add_f32 v182,v182,v183
v_fma_f32 v224,v224,v177,v178
v_fma_f32 v225,v225,v181,v182
mf v[132:135],a[232:235],a[20:23],v[132:135]
ds_read_b128 a[228:231],v194 offset:8192
v_max3_f32 v222,v222,v160,v161
v_max3_f32 v223,v223,v164,v165
mf v[128:131],a[236:239],a[24:27],v[128:131]
v_max3_f32 v222,v222,v162,v163
v_max3_f32 v223,v223,v166,v167
v_max3_f32 v222,v222,v168,v169
mf v[132:135],a[236:239],a[28:31],v[132:135]
s_waitcnt lgkmcnt(4)
ds_read_b128 a[232:235],v195 offset:8192
v_max3_f32 v223,v223,v172,v173
mf v[128:131],a[240:243],a[32:35],v[128:131]
v_max3_f32 v222,v222,v170,v171
v_max3_f32 v223,v223,v174,v175
v_mul_f32 v176,s46,v222
mf v[132:135],a[240:243],a[36:39],v[132:135]
ds_read_b128 a[236:239],v196 offset:8192
v_mul_f32 v180,s46,v223
v_ceil_f32 v248,v176
mf v[128:131],a[244:247],a[40:43],v[128:131]
v_ceil_f32 v249,v180
v_sub_f32 v177,v246,v248
v_sub_f32 v181,v247,v249
mf v[132:135],a[244:247],a[44:47],v[132:135]
s_waitcnt lgkmcnt(4)
ds_read_b128 a[240:243],v193 offset:8448
v_exp_f32 v177,v177
mf v[128:131],a[248:251],a[48:51],v[128:131]
v_exp_f32 v181,v181
v_fma_f32 v160,v160,s46,-v248
v_fma_f32 v164,v164,s46,-v249
mf v[132:135],a[248:251],a[52:55],v[132:135]
ds_read_b128 a[244:247],v194 offset:8448
v_fma_f32 v161,v161,s46,-v248
v_fma_f32 v165,v165,s46,-v249
mf v[128:131],a[252:255],a[56:59],v[128:131]
v_exp_f32 v160,v160
v_exp_f32 v164,v164
v_fma_f32 v162,v162,s46,-v248
mf v[132:135],a[252:255],a[60:63],v[132:135]
s_waitcnt lgkmcnt(4)
ds_read_b128 a[248:251],v195 offset:8448
v_fma_f32 v166,v166,s46,-v249
mf v[136:139],a[224:227],a[0:3],0
v_exp_f32 v161,v161
v_exp_f32 v165,v165
v_fma_f32 v163,v163,s46,-v248
mf v[140:143],a[224:227],a[4:7],0
v_add_u32 v193,0x10000,v193
ds_read_b128 a[252:255],v196 offset:8448
v_fma_f32 v167,v167,s46,-v249
v_exp_f32 v162,v162
mf v[136:139],a[228:231],a[8:11],v[136:139]
v_exp_f32 v166,v166
v_fma_f32 v168,v168,s46,-v248
v_fma_f32 v172,v172,s46,-v249
mf v[140:143],a[228:231],a[12:15],v[140:143]
s_waitcnt lgkmcnt(4)
s_waitcnt vmcnt(16)
s_barrier
v_add_u32 v194,0x10000,v194
ds_read_b128 a[224:227],v193 offset:16384
mf v[136:139],a[232:235],a[16:19],v[136:139]
v_exp_f32 v163,v163
v_exp_f32 v167,v167
v_add_f32 v178,v160,v161
v_add_f32 v182,v164,v165
mf v[140:143],a[232:235],a[20:23],v[140:143]
v_add_u32 v195,0x10000,v195
ds_read_b128 a[228:231],v194 offset:16384
s_add_u32 m0,s49,16384
s_add_u32 s48,s51,32768
buffer_load_dwordx4 v212,s[28:31],s48 offen nt lds
mf v[136:139],a[236:239],a[24:27],v[136:139]
cvp v88,v160,v161
cvp v92,v164,v165
v_fma_f32 v169,v169,s46,-v248
v_fma_f32 v173,v173,s46,-v249
v_exp_f32 v168,v168
mf v[140:143],a[236:239],a[28:31],v[140:143]
s_waitcnt lgkmcnt(4)
v_add_u32 v196,0x10000,v196
ds_read_b128 a[232:235],v195 offset:16384
v_exp_f32 v172,v172
mf v[136:139],a[240:243],a[32:35],v[136:139]
v_fma_f32 v170,v170,s46,-v248
v_fma_f32 v174,v174,s46,-v249
v_exp_f32 v169,v169
mf v[140:143],a[240:243],a[36:39],v[140:143]
ds_read_b128 a[236:239],v196 offset:16384
v_exp_f32 v173,v173
v_add_f32 v179,v162,v163
mf v[136:139],a[244:247],a[40:43],v[136:139]
v_add_f32 v183,v166,v167
cvp v89,v162,v163
cvp v93,v166,v167
mf v[140:143],a[244:247],a[44:47],v[140:143]
s_waitcnt lgkmcnt(4)
ds_read_b128 a[240:243],v193 offset:16640
buffer_load_dwordx4 v213,s[28:31],s48 offen offset:1024 nt lds
v_fma_f32 v171,v171,s46,-v248
mf v[136:139],a[248:251],a[48:51],v[136:139]
v_fma_f32 v175,v175,s46,-v249
v_exp_f32 v170,v170
v_exp_f32 v174,v174
mf v[140:143],a[248:251],a[52:55],v[140:143]
ds_read_b128 a[244:247],v194 offset:16640
v_add_f32 v178,v178,v168
v_add_f32 v182,v182,v172
mf v[136:139],a[252:255],a[56:59],v[136:139]
v_exp_f32 v171,v171
v_exp_f32 v175,v175
v_add_f32 v179,v179,v169
mf v[140:143],a[252:255],a[60:63],v[140:143]
s_waitcnt lgkmcnt(4)
ds_read_b128 a[248:251],v195 offset:16640
v_add_f32 v183,v183,v173
mf v[144:147],a[224:227],a[0:3],0
cvp v90,v168,v169
cvp v94,v172,v173
v_add_f32 v178,v178,v170
mf v[148:151],a[224:227],a[4:7],0
ds_read_b128 a[252:255],v196 offset:16640
buffer_load_dwordx4 v214,s[28:31],s48 offen offset:2048 nt lds
v_add_f32 v182,v182,v174
v_add_f32 v179,v179,v171
mf v[144:147],a[228:231],a[8:11],v[144:147]
v_add_f32 v183,v183,v175
cvp v91,v170,v171
cvp v95,v174,v175
mf v[148:151],a[228:231],a[12:15],v[148:151]
s_waitcnt lgkmcnt(4)
ds_read_b128 a[224:227],v193 offset:24576
v_add_f32 v178,v178,v179
mf v[144:147],a[232:235],a[16:19],v[144:147]
v_add_f32 v182,v182,v183
v_fma_f32 v224,v224,v177,v178
v_fma_f32 v225,v225,v181,v182
mf v[148:151],a[232:235],a[20:23],v[148:151]
ds_read_b128 a[228:231],v194 offset:24576
v_max3_f32 v222,v222,v128,v129
v_max3_f32 v223,v223,v132,v133
mf v[144:147],a[236:239],a[24:27],v[144:147]
v_max3_f32 v222,v222,v130,v131
v_max3_f32 v223,v223,v134,v135
v_max3_f32 v222,v222,v136,v137
mf v[148:151],a[236:239],a[28:31],v[148:151]
s_waitcnt lgkmcnt(4)
ds_read_b128 a[232:235],v195 offset:24576
buffer_load_dwordx4 v215,s[28:31],s48 offen offset:3072 nt lds
v_max3_f32 v223,v223,v140,v141
mf v[144:147],a[240:243],a[32:35],v[144:147]
v_max3_f32 v222,v222,v138,v139
v_max3_f32 v223,v223,v142,v143
v_mul_f32 v176,s46,v222
mf v[148:151],a[240:243],a[36:39],v[148:151]
ds_read_b128 a[236:239],v196 offset:24576
v_mul_f32 v180,s46,v223
v_ceil_f32 v250,v176
mf v[144:147],a[244:247],a[40:43],v[144:147]
v_ceil_f32 v251,v180
v_sub_f32 v177,v248,v250
v_sub_f32 v181,v249,v251
mf v[148:151],a[244:247],a[44:47],v[148:151]
s_waitcnt lgkmcnt(4)
ds_read_b128 a[240:243],v193 offset:24832
v_exp_f32 v177,v177
mf v[144:147],a[248:251],a[48:51],v[144:147]
v_exp_f32 v181,v181
v_fma_f32 v128,v128,s46,-v250
v_fma_f32 v132,v132,s46,-v251
mf v[148:151],a[248:251],a[52:55],v[148:151]
ds_read_b128 a[244:247],v194 offset:24832
v_fma_f32 v129,v129,s46,-v250
v_fma_f32 v133,v133,s46,-v251
mf v[144:147],a[252:255],a[56:59],v[144:147]
v_exp_f32 v128,v128
v_exp_f32 v132,v132
v_fma_f32 v130,v130,s46,-v250
mf v[148:151],a[252:255],a[60:63],v[148:151]
s_waitcnt lgkmcnt(4)
ds_read_b128 a[248:251],v195 offset:24832
v_fma_f32 v134,v134,s46,-v251
mf v[152:155],a[224:227],a[0:3],0
v_exp_f32 v129,v129
v_exp_f32 v133,v133
v_fma_f32 v131,v131,s46,-v250
mf v[156:159],a[224:227],a[4:7],0
v_add_u32 v193,0xffff0000,v193
ds_read_b128 a[252:255],v196 offset:24832
v_fma_f32 v135,v135,s46,-v251
v_exp_f32 v130,v130
mf v[152:155],a[228:231],a[8:11],v[152:155]
v_exp_f32 v134,v134
v_fma_f32 v136,v136,s46,-v250
v_fma_f32 v140,v140,s46,-v251
mf v[156:159],a[228:231],a[12:15],v[156:159]
s_waitcnt lgkmcnt(4)
s_waitcnt vmcnt(16)
s_barrier
v_add_u32 v194,0xffff0000,v194
ds_read_b128 a[224:227],v193 offset:32768
mf v[152:155],a[232:235],a[16:19],v[152:155]
v_exp_f32 v131,v131
v_exp_f32 v135,v135
v_add_f32 v178,v128,v129
v_add_f32 v182,v132,v133
mf v[156:159],a[232:235],a[20:23],v[156:159]
v_add_u32 v195,0xffff0000,v195
ds_read_b128 a[228:231],v194 offset:32768
cvp v96,v128,v129
cvp v100,v132,v133
mf v[152:155],a[236:239],a[24:27],v[152:155]
v_fma_f32 v137,v137,s46,-v250
v_fma_f32 v141,v141,s46,-v251
v_exp_f32 v136,v136
mf v[156:159],a[236:239],a[28:31],v[156:159]
s_waitcnt lgkmcnt(4)
v_add_u32 v196,0xffff0000,v196
ds_read_b128 a[232:235],v195 offset:32768
v_exp_f32 v140,v140
mf v[152:155],a[240:243],a[32:35],v[152:155]
v_fma_f32 v138,v138,s46,-v250
v_fma_f32 v142,v142,s46,-v251
v_exp_f32 v137,v137
mf v[156:159],a[240:243],a[36:39],v[156:159]
ds_read_b128 a[236:239],v196 offset:32768
v_exp_f32 v141,v141
v_add_f32 v179,v130,v131
mf v[152:155],a[244:247],a[40:43],v[152:155]
v_add_f32 v183,v134,v135
cvp v97,v130,v131
cvp v101,v134,v135
mf v[156:159],a[244:247],a[44:47],v[156:159]
s_waitcnt lgkmcnt(4)
ds_read_b128 a[240:243],v193 offset:33024
v_fma_f32 v139,v139,s46,-v250
mf v[152:155],a[248:251],a[48:51],v[152:155]
v_fma_f32 v143,v143,s46,-v251
v_exp_f32 v138,v138
v_exp_f32 v142,v142
mf v[156:159],a[248:251],a[52:55],v[156:159]
ds_read_b128 a[244:247],v194 offset:33024
v_add_f32 v178,v178,v136
v_add_f32 v182,v182,v140
mf v[152:155],a[252:255],a[56:59],v[152:155]
v_exp_f32 v139,v139
v_exp_f32 v143,v143
v_add_f32 v179,v179,v137
mf v[156:159],a[252:255],a[60:63],v[156:159]
s_waitcnt lgkmcnt(4)
ds_read_b128 a[248:251],v195 offset:33024
v_add_f32 v183,v183,v141
mf v[160:163],a[224:227],a[0:3],0
cvp v98,v136,v137
cvp v102,v140,v141
v_add_f32 v178,v178,v138
mf v[164:167],a[224:227],a[4:7],0
ds_read_b128 a[252:255],v196 offset:33024
v_add_f32 v182,v182,v142
v_add_f32 v179,v179,v139
mf v[160:163],a[228:231],a[8:11],v[160:163]
v_add_f32 v183,v183,v143
cvp v99,v138,v139
cvp v103,v142,v143
mf v[164:167],a[228:231],a[12:15],v[164:167]
s_waitcnt lgkmcnt(4)
ds_read_b128 a[224:227],v193 offset:40960
v_add_f32 v178,v178,v179
mf v[160:163],a[232:235],a[16:19],v[160:163]
v_add_f32 v182,v182,v183
v_fma_f32 v224,v224,v177,v178
v_fma_f32 v225,v225,v181,v182
mf v[164:167],a[232:235],a[20:23],v[164:167]
ds_read_b128 a[228:231],v194 offset:40960
v_max3_f32 v222,v222,v144,v145
v_max3_f32 v223,v223,v148,v149
mf v[160:163],a[236:239],a[24:27],v[160:163]
v_max3_f32 v222,v222,v146,v147
v_max3_f32 v223,v223,v150,v151
v_max3_f32 v222,v222,v152,v153
mf v[164:167],a[236:239],a[28:31],v[164:167]
s_waitcnt lgkmcnt(4)
ds_read_b128 a[232:235],v195 offset:40960
v_max3_f32 v223,v223,v156,v157
mf v[160:163],a[240:243],a[32:35],v[160:163]
v_max3_f32 v222,v222,v154,v155
v_max3_f32 v223,v223,v158,v159
v_mul_f32 v176,s46,v222
mf v[164:167],a[240:243],a[36:39],v[164:167]
ds_read_b128 a[236:239],v196 offset:40960
v_mul_f32 v180,s46,v223
v_ceil_f32 v252,v176
mf v[160:163],a[244:247],a[40:43],v[160:163]
v_ceil_f32 v253,v180
v_sub_f32 v177,v250,v252
v_sub_f32 v181,v251,v253
mf v[164:167],a[244:247],a[44:47],v[164:167]
s_waitcnt lgkmcnt(4)
ds_read_b128 a[240:243],v193 offset:41216
v_exp_f32 v177,v177
mf v[160:163],a[248:251],a[48:51],v[160:163]
v_exp_f32 v181,v181
v_fma_f32 v144,v144,s46,-v252
v_fma_f32 v148,v148,s46,-v253
mf v[164:167],a[248:251],a[52:55],v[164:167]
ds_read_b128 a[244:247],v194 offset:41216
v_fma_f32 v145,v145,s46,-v252
v_fma_f32 v149,v149,s46,-v253
mf v[160:163],a[252:255],a[56:59],v[160:163]
v_exp_f32 v144,v144
v_exp_f32 v148,v148
v_fma_f32 v146,v146,s46,-v252
mf v[164:167],a[252:255],a[60:63],v[164:167]
s_waitcnt lgkmcnt(4)
ds_read_b128 a[248:251],v195 offset:41216
v_fma_f32 v150,v150,s46,-v253
mf v[168:171],a[224:227],a[0:3],0
v_exp_f32 v145,v145
v_exp_f32 v149,v149
v_fma_f32 v147,v147,s46,-v252
mf v[172:175],a[224:227],a[4:7],0
v_add_u32 v193,0x10000,v193
ds_read_b128 a[252:255],v196 offset:41216
v_fma_f32 v151,v151,s46,-v253
v_exp_f32 v146,v146
mf v[168:171],a[228:231],a[8:11],v[168:171]
v_exp_f32 v150,v150
v_fma_f32 v152,v152,s46,-v252
v_fma_f32 v156,v156,s46,-v253
mf v[172:175],a[228:231],a[12:15],v[172:175]
s_waitcnt lgkmcnt(4)
s_waitcnt vmcnt(12)
s_barrier
v_add_u32 v194,0x10000,v194
ds_read_b128 a[224:227],v193 offset:32768
mf v[168:171],a[232:235],a[16:19],v[168:171]
v_exp_f32 v147,v147
v_exp_f32 v151,v151
v_add_f32 v178,v144,v145
v_add_f32 v182,v148,v149
mf v[172:175],a[232:235],a[20:23],v[172:175]
v_add_u32 v195,0x10000,v195
ds_read_b128 a[228:231],v194 offset:32768
s_add_u32 m0,s49,0
s_add_u32 s48,s53,s93
buffer_load_dwordx4 v216,s[36:39],s48 offen lds
mf v[168:171],a[236:239],a[24:27],v[168:171]
cvp v104,v144,v145
cvp v108,v148,v149
v_fma_f32 v153,v153,s46,-v252
v_fma_f32 v157,v157,s46,-v253
v_exp_f32 v152,v152
mf v[172:175],a[236:239],a[28:31],v[172:175]
s_waitcnt lgkmcnt(4)
v_add_u32 v196,0x10000,v196
ds_read_b128 a[232:235],v195 offset:32768
buffer_load_dwordx4 v217,s[36:39],s48 offen offset:1024 lds
mf v[168:171],a[240:243],a[32:35],v[168:171]
v_exp_f32 v156,v156
v_fma_f32 v154,v154,s46,-v252
v_fma_f32 v158,v158,s46,-v253
v_exp_f32 v153,v153
mf v[172:175],a[240:243],a[36:39],v[172:175]
ds_read_b128 a[236:239],v196 offset:32768
buffer_load_dwordx4 v218,s[36:39],s48 offen offset:2048 lds
v_exp_f32 v157,v157
v_add_f32 v179,v146,v147
mf v[168:171],a[244:247],a[40:43],v[168:171]
v_add_f32 v183,v150,v151
cvp v105,v146,v147
cvp v109,v150,v151
mf v[172:175],a[244:247],a[44:47],v[172:175]
s_waitcnt lgkmcnt(4)
ds_read_b128 a[240:243],v193 offset:33024
buffer_load_dwordx4 v219,s[36:39],s48 offen offset:3072 lds
v_fma_f32 v155,v155,s46,-v252
mf v[168:171],a[248:251],a[48:51],v[168:171]
v_fma_f32 v159,v159,s46,-v253
v_exp_f32 v154,v154
v_exp_f32 v158,v158
mf v[172:175],a[248:251],a[52:55],v[172:175]
ds_read_b128 a[244:247],v194 offset:33024
s_add_u32 m0,s49,65536
s_add_u32 s48,s51,65536
buffer_load_dwordx4 v212,s[28:31],s48 offen nt lds
v_add_f32 v178,v178,v152
mf v[168:171],a[252:255],a[56:59],v[168:171]
v_add_f32 v182,v182,v156
v_exp_f32 v155,v155
v_exp_f32 v159,v159
v_add_f32 v179,v179,v153
mf v[172:175],a[252:255],a[60:63],v[172:175]
s_waitcnt lgkmcnt(4)
ds_read_b128 a[248:251],v195 offset:33024
buffer_load_dwordx4 v213,s[28:31],s48 offen offset:1024 nt lds
v_add_f32 v183,v183,v157
mf v[128:131],a[224:227],a[0:3],0
cvp v106,v152,v153
cvp v110,v156,v157
v_add_f32 v178,v178,v154
mf v[132:135],a[224:227],a[4:7],0
ds_read_b128 a[252:255],v196 offset:33024
buffer_load_dwordx4 v214,s[28:31],s48 offen offset:2048 nt lds
v_add_f32 v182,v182,v158
v_add_f32 v179,v179,v155
mf v[128:131],a[228:231],a[8:11],v[128:131]
v_add_f32 v183,v183,v159
cvp v107,v154,v155
cvp v111,v158,v159
mf v[132:135],a[228:231],a[12:15],v[132:135]
s_waitcnt lgkmcnt(4)
ds_read_b128 a[224:227],v193 offset:40960
buffer_load_dwordx4 v215,s[28:31],s48 offen offset:3072 nt lds
v_add_f32 v178,v178,v179
mf v[128:131],a[232:235],a[16:19],v[128:131]
v_add_f32 v182,v182,v183
v_fma_f32 v224,v224,v177,v178
v_fma_f32 v225,v225,v181,v182
mf v[132:135],a[232:235],a[20:23],v[132:135]
ds_read_b128 a[228:231],v194 offset:40960
v_max3_f32 v222,v222,v160,v161
v_max3_f32 v223,v223,v164,v165
v_max3_f32 v222,v222,v162,v163
mf v[128:131],a[236:239],a[24:27],v[128:131]
v_max3_f32 v223,v223,v166,v167
v_max3_f32 v222,v222,v168,v169
v_max3_f32 v223,v223,v172,v173
mf v[132:135],a[236:239],a[28:31],v[132:135]
s_waitcnt lgkmcnt(4)
ds_read_b128 a[232:235],v195 offset:40960
v_max3_f32 v222,v222,v170,v171
v_max3_f32 v223,v223,v174,v175
mf v[128:131],a[240:243],a[32:35],v[128:131]
v_mul_f32 v176,s46,v222
v_mul_f32 v180,s46,v223
v_ceil_f32 v254,v176
v_ceil_f32 v255,v180
mf v[132:135],a[240:243],a[36:39],v[132:135]
ds_read_b128 a[236:239],v196 offset:40960
v_sub_f32 v177,v252,v254
v_sub_f32 v181,v253,v255
mf v[128:131],a[244:247],a[40:43],v[128:131]
v_exp_f32 v177,v177
v_exp_f32 v181,v181
v_fma_f32 v160,v160,s46,-v254
mf v[132:135],a[244:247],a[44:47],v[132:135]
s_waitcnt lgkmcnt(4)
ds_read_b128 a[240:243],v193 offset:41216
v_fma_f32 v164,v164,s46,-v255
v_fma_f32 v161,v161,s46,-v254
mf v[128:131],a[248:251],a[48:51],v[128:131]
v_fma_f32 v165,v165,s46,-v255
v_exp_f32 v160,v160
v_exp_f32 v164,v164
v_fma_f32 v162,v162,s46,-v254
mf v[132:135],a[248:251],a[52:55],v[132:135]
ds_read_b128 a[244:247],v194 offset:41216
v_fma_f32 v166,v166,s46,-v255
v_exp_f32 v161,v161
mf v[128:131],a[252:255],a[56:59],v[128:131]
v_exp_f32 v165,v165
v_fma_f32 v163,v163,s46,-v254
v_fma_f32 v167,v167,s46,-v255
mf v[132:135],a[252:255],a[60:63],v[132:135]
s_waitcnt lgkmcnt(4)
ds_read_b128 a[248:251],v195 offset:41216
v_exp_f32 v162,v162
v_exp_f32 v166,v166
mf v[136:139],a[224:227],a[0:3],0
v_fma_f32 v168,v168,s46,-v254
v_fma_f32 v172,v172,s46,-v255
v_exp_f32 v163,v163
v_exp_f32 v167,v167
mf v[140:143],a[224:227],a[4:7],0
ds_read_b128 a[252:255],v196 offset:41216
v_add_f32 v178,v160,v161
v_add_f32 v182,v164,v165
mf v[136:139],a[228:231],a[8:11],v[136:139]
cvp v112,v160,v161
cvp v116,v164,v165
v_fma_f32 v169,v169,s46,-v254
mf v[140:143],a[228:231],a[12:15],v[140:143]
s_waitcnt lgkmcnt(4)
s_waitcnt vmcnt(12)
s_barrier
v_lshrrev_b32 v205,2,v192
v_and_b32 v206,7,v205
v_lshlrev_b32 v205,8,v205
v_lshl_add_u32 v205,v206,5,v205
v_and_b32 v206,3,v192
v_lshl_add_u32 v205,v206,3,v205
v_xor_b32 v193,0,v205
v_xor_b32 v194,32,v205
v_xor_b32 v195,64,v205
v_xor_b32 v196,96,v205
mf v[136:139],a[232:235],a[16:19],v[136:139]
v_xor_b32 v197,128,v205
v_xor_b32 v198,160,v205
v_xor_b32 v199,192,v205
v_xor_b32 v200,224,v205
v_add_u32 v193,0x10000,v193
trr a[224:225],v193,49152
trr a[226:227],v193,53248
v_fma_f32 v173,v173,s46,-v255
v_exp_f32 v168,v168
v_exp_f32 v172,v172
v_fma_f32 v170,v170,s46,-v254
v_fma_f32 v174,v174,s46,-v255
v_exp_f32 v169,v169
mf v[140:143],a[232:235],a[20:23],v[140:143]
v_add_u32 v194,0x10000,v194
trr a[228:229],v194,49152
trr a[230:231],v194,53248
s_add_u32 m0,s49,32768
s_add_u32 s48,s53,s94
buffer_load_dwordx4 v216,s[36:39],s48 offen lds
mf v[136:139],a[236:239],a[24:27],v[136:139]
v_exp_f32 v173,v173
v_add_f32 v179,v162,v163
v_add_f32 v183,v166,v167
cvp v113,v162,v163
cvp v117,v166,v167
mf v[140:143],a[236:239],a[28:31],v[140:143]
s_waitcnt lgkmcnt(6)
v_add_u32 v195,0x10000,v195
trr a[232:233],v195,49152
trr a[234:235],v195,53248
buffer_load_dwordx4 v217,s[36:39],s48 offen offset:1024 lds
v_fma_f32 v171,v171,s46,-v254
mf v[136:139],a[240:243],a[32:35],v[136:139]
v_fma_f32 v175,v175,s46,-v255
v_exp_f32 v170,v170
v_exp_f32 v174,v174
v_add_f32 v178,v178,v168
v_add_f32 v182,v182,v172
mf v[140:143],a[240:243],a[36:39],v[140:143]
v_add_u32 v196,0x10000,v196
trr a[236:237],v196,49152
trr a[238:239],v196,53248
buffer_load_dwordx4 v218,s[36:39],s48 offen offset:2048 lds
v_exp_f32 v171,v171
mf v[136:139],a[244:247],a[40:43],v[136:139]
v_exp_f32 v175,v175
v_add_f32 v179,v179,v169
v_add_f32 v183,v183,v173
cvp v114,v168,v169
mf v[140:143],a[244:247],a[44:47],v[140:143]
s_waitcnt lgkmcnt(8)
v_add_u32 v197,0x10000,v197
trr a[240:241],v197,49152
trr a[242:243],v197,53248
buffer_load_dwordx4 v219,s[36:39],s48 offen offset:3072 lds
cvp v118,v172,v173
mf v[136:139],a[248:251],a[48:51],v[136:139]
v_add_f32 v178,v178,v170
v_add_f32 v182,v182,v174
v_add_f32 v179,v179,v171
v_add_f32 v183,v183,v175
cvp v115,v170,v171
mf v[140:143],a[248:251],a[52:55],v[140:143]
v_add_u32 v198,0x10000,v198
trr a[244:245],v198,49152
trr a[246:247],v198,53248
s_add_u32 m0,s49,81920
s_add_u32 s48,s51,98304
buffer_load_dwordx4 v212,s[28:31],s48 offen nt lds
mf v[136:139],a[252:255],a[56:59],v[136:139]
cvp v119,v174,v175
v_add_f32 v178,v178,v179
v_add_f32 v182,v182,v183
v_fma_f32 v224,v224,v177,v178
v_fma_f32 v225,v225,v181,v182
mf v[140:143],a[252:255],a[60:63],v[140:143]
s_waitcnt lgkmcnt(8)
v_add_u32 v199,0x10000,v199
trr a[248:249],v199,49152
trr a[250:251],v199,53248
buffer_load_dwordx4 v213,s[28:31],s48 offen offset:1024 nt lds
v_max3_f32 v222,v222,v128,v129
v_max3_f32 v223,v223,v132,v133
v_max3_f32 v222,v222,v130,v131
v_max3_f32 v223,v223,v134,v135
v_max3_f32 v222,v222,v136,v137
v_max3_f32 v223,v223,v140,v141
v_max3_f32 v222,v222,v138,v139
v_max3_f32 v223,v223,v142,v143
v_mul_f32 v176,s46,v222
v_mul_f32 v180,s46,v223
v_ceil_f32 v222,v176
v_ceil_f32 v223,v180
v_mov_b32 v176,v222
v_mov_b32 v180,v223
s_nop 0
v_permlane32_swap_b32 v176,v222
v_permlane32_swap_b32 v180,v223
v_max_f32 v222,v222,v176
v_max_f32 v223,v223,v180
v_mov_b32 v176,v222
v_mov_b32 v180,v223
s_nop 0
v_permlane16_swap_b32 v176,v222
v_permlane16_swap_b32 v180,v223
v_max_f32 v222,v222,v176
v_max_f32 v223,v223,v180
v_sub_f32 v205,v222,v226
v_sub_f32 v206,v223,v227
v_min_f32 v205,0x437f0000,v205
v_min_f32 v206,0x437f0000,v206
v_cvt_u32_f32 v205,v205
v_cvt_u32_f32 v206,v206
v_mul_u32_u24 v205,0x800080,v205
v_mul_u32_u24 v206,0x800080,v206
v_pk_sub_u16 v0,v0,v205 clamp
v_pk_sub_u16 v4,v4,v206 clamp
v_pk_sub_u16 v1,v1,v205 clamp
v_pk_sub_u16 v5,v5,v206 clamp
v_pk_sub_u16 v2,v2,v205 clamp
v_pk_sub_u16 v6,v6,v206 clamp
v_pk_sub_u16 v3,v3,v205 clamp
v_pk_sub_u16 v7,v7,v206 clamp
v_sub_f32 v205,v222,v228
v_sub_f32 v206,v223,v229
v_min_f32 v205,0x437f0000,v205
v_min_f32 v206,0x437f0000,v206
v_cvt_u32_f32 v205,v205
v_cvt_u32_f32 v206,v206
v_mul_u32_u24 v205,0x800080,v205
v_mul_u32_u24 v206,0x800080,v206
v_pk_sub_u16 v8,v8,v205 clamp
v_pk_sub_u16 v12,v12,v206 clamp
v_pk_sub_u16 v9,v9,v205 clamp
v_pk_sub_u16 v13,v13,v206 clamp
v_pk_sub_u16 v10,v10,v205 clamp
v_pk_sub_u16 v14,v14,v206 clamp
v_pk_sub_u16 v11,v11,v205 clamp
v_pk_sub_u16 v15,v15,v206 clamp
v_sub_f32 v177,v254,v222
v_sub_f32 v181,v255,v223
v_exp_f32 v177,v177
v_exp_f32 v181,v181
v_fma_f32 v128,v128,s46,-v222
v_fma_f32 v132,v132,s46,-v223
v_fma_f32 v129,v129,s46,-v222
v_fma_f32 v133,v133,s46,-v223
v_exp_f32 v128,v128
v_exp_f32 v132,v132
v_fma_f32 v130,v130,s46,-v222
v_fma_f32 v134,v134,s46,-v223
v_exp_f32 v129,v129
v_exp_f32 v133,v133
v_fma_f32 v131,v131,s46,-v222
v_fma_f32 v135,v135,s46,-v223
v_exp_f32 v130,v130
v_exp_f32 v134,v134
v_fma_f32 v136,v136,s46,-v222
v_fma_f32 v140,v140,s46,-v223
v_exp_f32 v131,v131
v_exp_f32 v135,v135
v_add_f32 v178,v128,v129
v_add_f32 v182,v132,v133
cvp v120,v128,v129
cvp v124,v132,v133
v_fma_f32 v137,v137,s46,-v222
v_fma_f32 v141,v141,s46,-v223
v_exp_f32 v136,v136
v_exp_f32 v140,v140
v_fma_f32 v138,v138,s46,-v222
v_fma_f32 v142,v142,s46,-v223
v_exp_f32 v137,v137
v_exp_f32 v141,v141
v_add_f32 v179,v130,v131
v_add_f32 v183,v134,v135
cvp v121,v130,v131
cvp v125,v134,v135
mf v[128:131],a[224:227],v[0:3],0
v_fma_f32 v139,v139,s46,-v222
v_fma_f32 v143,v143,s46,-v223
v_exp_f32 v138,v138
v_exp_f32 v142,v142
v_add_f32 v178,v178,v136
v_add_f32 v182,v182,v140
v_exp_f32 v139,v139
v_exp_f32 v143,v143
v_add_f32 v179,v179,v137
v_add_f32 v183,v183,v141
cvp v122,v136,v137
cvp v126,v140,v141
v_add_f32 v178,v178,v138
v_add_f32 v182,v182,v142
v_add_f32 v179,v179,v139
v_add_f32 v183,v183,v143
cvp v123,v138,v139
cvp v127,v142,v143
v_add_f32 v178,v178,v179
v_add_f32 v182,v182,v183
v_fma_f32 v224,v224,v177,v178
v_fma_f32 v225,v225,v181,v182
v_mov_b32 v176,v224
v_mov_b32 v180,v225
s_nop 0
v_permlane32_swap_b32 v176,v224
v_permlane32_swap_b32 v180,v225
v_add_f32 v224,v224,v176
v_add_f32 v225,v225,v180
v_mov_b32 v176,v224
v_mov_b32 v180,v225
s_nop 0
v_permlane16_swap_b32 v176,v224
v_permlane16_swap_b32 v180,v225
v_add_f32 v224,v224,v176
v_add_f32 v225,v225,v180
v_rcp_f32 v224,v224
v_rcp_f32 v225,v225
s_cmp_eq_u32 s44,3
s_cselect_b64 vcc,0,-1
v_cndmask_b32 v225,0,v225,vcc
mf v[132:135],a[224:227],v[4:7],0
v_add_u32 v200,0x10000,v200
trr a[252:253],v200,49152
trr a[254:255],v200,53248
buffer_load_dwordx4 v214,s[28:31],s48 offen offset:2048 nt lds
mf v[136:139],a[228:231],v[0:3],0
v_sub_f32 v205,v222,v230
v_sub_f32 v206,v223,v231
v_min_f32 v205,0x437f0000,v205
mf v[140:143],a[228:231],v[4:7],0
s_waitcnt lgkmcnt(8)
trr a[224:225],v193,57344
trr a[226:227],v193,61440
mf v[144:147],a[232:235],v[0:3],0
buffer_load_dwordx4 v215,s[28:31],s48 offen offset:3072 nt lds
v_min_f32 v206,0x437f0000,v206
v_cvt_u32_f32 v205,v205
mf v[148:151],a[232:235],v[4:7],0
trr a[228:229],v194,57344
trr a[230:231],v194,61440
mf v[152:155],a[236:239],v[0:3],0
v_cvt_u32_f32 v206,v206
v_mul_u32_u24 v205,0x800080,v205
mf v[156:159],a[236:239],v[4:7],0
s_waitcnt lgkmcnt(8)
trr a[232:233],v195,57344
trr a[234:235],v195,61440
mf v[160:163],a[240:243],v[0:3],0
v_mul_u32_u24 v206,0x800080,v206
v_pk_sub_u16 v16,v16,v205 clamp
v_pk_sub_u16 v20,v20,v206 clamp
mf v[164:167],a[240:243],v[4:7],0
trr a[236:237],v196,57344
trr a[238:239],v196,61440
mf v[168:171],a[244:247],v[0:3],0
v_pk_sub_u16 v17,v17,v205 clamp
v_pk_sub_u16 v21,v21,v206 clamp
mf v[172:175],a[244:247],v[4:7],0
s_waitcnt lgkmcnt(8)
trr a[240:241],v197,57344
trr a[242:243],v197,61440
mf v[176:179],a[248:251],v[0:3],0
v_pk_sub_u16 v18,v18,v205 clamp
v_pk_sub_u16 v22,v22,v206 clamp
mf v[180:183],a[248:251],v[4:7],0
trr a[244:245],v198,57344
trr a[246:247],v198,61440
mf v[184:187],a[252:255],v[0:3],0
v_pk_sub_u16 v19,v19,v205 clamp
v_pk_sub_u16 v23,v23,v206 clamp
mf v[188:191],a[252:255],v[4:7],0
s_waitcnt lgkmcnt(8)
trr a[248:249],v199,57344
trr a[250:251],v199,61440
mf v[128:131],a[224:227],v[8:11],v[128:131]
v_sub_f32 v205,v222,v232
v_sub_f32 v206,v223,v233
v_min_f32 v205,0x437f0000,v205
mf v[132:135],a[224:227],v[12:15],v[132:135]
v_add_u32 v193,0xffff0000,v193
trr a[252:253],v200,57344
trr a[254:255],v200,61440
mf v[136:139],a[228:231],v[8:11],v[136:139]
v_min_f32 v206,0x437f0000,v206
v_cvt_u32_f32 v205,v205
mf v[140:143],a[228:231],v[12:15],v[140:143]
s_waitcnt lgkmcnt(8)
s_waitcnt vmcnt(16)
s_barrier
v_add_u32 v194,0xffff0000,v194
mf v[144:147],a[232:235],v[8:11],v[144:147]
trr a[224:225],v193,16384
trr a[226:227],v193,20480
v_cvt_u32_f32 v206,v206
v_mul_u32_u24 v205,0x800080,v205
mf v[148:151],a[232:235],v[12:15],v[148:151]
v_add_u32 v195,0xffff0000,v195
trr a[228:229],v194,16384
trr a[230:231],v194,20480
s_add_u32 m0,s49,98304
s_add_u32 s48,s53,s95
mf v[152:155],a[236:239],v[8:11],v[152:155]
buffer_load_dwordx4 v216,s[36:39],s48 offen lds
v_mul_u32_u24 v206,0x800080,v206
v_pk_sub_u16 v24,v24,v205 clamp
v_pk_sub_u16 v28,v28,v206 clamp
mf v[156:159],a[236:239],v[12:15],v[156:159]
s_waitcnt lgkmcnt(8)
v_add_u32 v196,0xffff0000,v196
trr a[232:233],v195,16384
trr a[234:235],v195,20480
mf v[160:163],a[240:243],v[8:11],v[160:163]
buffer_load_dwordx4 v217,s[36:39],s48 offen offset:1024 lds
v_pk_sub_u16 v25,v25,v205 clamp
v_pk_sub_u16 v29,v29,v206 clamp
mf v[164:167],a[240:243],v[12:15],v[164:167]
v_add_u32 v197,0xffff0000,v197
trr a[236:237],v196,16384
trr a[238:239],v196,20480
mf v[168:171],a[244:247],v[8:11],v[168:171]
buffer_load_dwordx4 v218,s[36:39],s48 offen offset:2048 lds
v_pk_sub_u16 v26,v26,v205 clamp
v_pk_sub_u16 v30,v30,v206 clamp
mf v[172:175],a[244:247],v[12:15],v[172:175]
s_waitcnt lgkmcnt(8)
v_add_u32 v198,0xffff0000,v198
trr a[240:241],v197,16384
trr a[242:243],v197,20480
mf v[176:179],a[248:251],v[8:11],v[176:179]
buffer_load_dwordx4 v219,s[36:39],s48 offen offset:3072 lds
v_pk_sub_u16 v27,v27,v205 clamp
v_pk_sub_u16 v31,v31,v206 clamp
mf v[180:183],a[248:251],v[12:15],v[180:183]
v_add_u32 v199,0xffff0000,v199
trr a[244:245],v198,16384
trr a[246:247],v198,20480
mf v[184:187],a[252:255],v[8:11],v[184:187]
s_add_u32 m0,s49,131072
s_add_u32 s48,s51,131072
buffer_load_dwordx4 v212,s[28:31],s48 offen nt lds
mf v[188:191],a[252:255],v[12:15],v[188:191]
s_waitcnt lgkmcnt(8)
v_add_u32 v200,0xffff0000,v200
trr a[248:249],v199,16384
mf v[128:131],a[224:227],v[16:19],v[128:131]
trr a[250:251],v199,20480
buffer_load_dwordx4 v213,s[28:31],s48 offen offset:1024 nt lds
mf v[132:135],a[224:227],v[20:23],v[132:135]
trr a[252:253],v200,16384
trr a[254:255],v200,20480
buffer_load_dwordx4 v214,s[28:31],s48 offen offset:2048 nt lds
mf v[136:139],a[228:231],v[16:19],v[136:139]
v_sub_f32 v205,v222,v234
v_sub_f32 v206,v223,v235
v_min_f32 v205,0x437f0000,v205
mf v[140:143],a[228:231],v[20:23],v[140:143]
s_waitcnt lgkmcnt(8)
trr a[224:225],v193,24576
trr a[226:227],v193,28672
mf v[144:147],a[232:235],v[16:19],v[144:147]
buffer_load_dwordx4 v215,s[28:31],s48 offen offset:3072 nt lds
v_min_f32 v206,0x437f0000,v206
v_cvt_u32_f32 v205,v205
mf v[148:151],a[232:235],v[20:23],v[148:151]
trr a[228:229],v194,24576
trr a[230:231],v194,28672
mf v[152:155],a[236:239],v[16:19],v[152:155]
v_cvt_u32_f32 v206,v206
v_mul_u32_u24 v205,0x800080,v205
mf v[156:159],a[236:239],v[20:23],v[156:159]
s_waitcnt lgkmcnt(8)
trr a[232:233],v195,24576
trr a[234:235],v195,28672
mf v[160:163],a[240:243],v[16:19],v[160:163]
v_mul_u32_u24 v206,0x800080,v206
v_pk_sub_u16 v32,v32,v205 clamp
v_pk_sub_u16 v36,v36,v206 clamp
mf v[164:167],a[240:243],v[20:23],v[164:167]
trr a[236:237],v196,24576
trr a[238:239],v196,28672
mf v[168:171],a[244:247],v[16:19],v[168:171]
v_pk_sub_u16 v33,v33,v205 clamp
v_pk_sub_u16 v37,v37,v206 clamp
mf v[172:175],a[244:247],v[20:23],v[172:175]
s_waitcnt lgkmcnt(8)
trr a[240:241],v197,24576
trr a[242:243],v197,28672
mf v[176:179],a[248:251],v[16:19],v[176:179]
v_pk_sub_u16 v34,v34,v205 clamp
v_pk_sub_u16 v38,v38,v206 clamp
mf v[180:183],a[248:251],v[20:23],v[180:183]
trr a[244:245],v198,24576
trr a[246:247],v198,28672
mf v[184:187],a[252:255],v[16:19],v[184:187]
v_pk_sub_u16 v35,v35,v205 clamp
v_pk_sub_u16 v39,v39,v206 clamp
mf v[188:191],a[252:255],v[20:23],v[188:191]
s_waitcnt lgkmcnt(8)
trr a[248:249],v199,24576
trr a[250:251],v199,28672
mf v[128:131],a[224:227],v[24:27],v[128:131]
v_sub_f32 v205,v222,v236
v_sub_f32 v206,v223,v237
v_min_f32 v205,0x437f0000,v205
mf v[132:135],a[224:227],v[28:31],v[132:135]
v_add_u32 v193,0x10000,v193
trr a[252:253],v200,24576
trr a[254:255],v200,28672
mf v[136:139],a[228:231],v[24:27],v[136:139]
v_min_f32 v206,0x437f0000,v206
v_cvt_u32_f32 v205,v205
mf v[140:143],a[228:231],v[28:31],v[140:143]
s_waitcnt lgkmcnt(8)
s_waitcnt vmcnt(16)
s_barrier
v_add_u32 v194,0x10000,v194
mf v[144:147],a[232:235],v[24:27],v[144:147]
trr a[224:225],v193,0
trr a[226:227],v193,4096
v_cvt_u32_f32 v206,v206
v_mul_u32_u24 v205,0x800080,v205
mf v[148:151],a[232:235],v[28:31],v[148:151]
v_add_u32 v195,0x10000,v195
trr a[228:229],v194,0
trr a[230:231],v194,4096
s_add_u32 m0,s49,114688
s_add_u32 s48,s53,s96
mf v[152:155],a[236:239],v[24:27],v[152:155]
buffer_load_dwordx4 v216,s[36:39],s48 offen lds
v_mul_u32_u24 v206,0x800080,v206
v_pk_sub_u16 v40,v40,v205 clamp
v_pk_sub_u16 v44,v44,v206 clamp
mf v[156:159],a[236:239],v[28:31],v[156:159]
s_waitcnt lgkmcnt(8)
v_add_u32 v196,0x10000,v196
trr a[232:233],v195,0
trr a[234:235],v195,4096
mf v[160:163],a[240:243],v[24:27],v[160:163]
buffer_load_dwordx4 v217,s[36:39],s48 offen offset:1024 lds
v_pk_sub_u16 v41,v41,v205 clamp
v_pk_sub_u16 v45,v45,v206 clamp
mf v[164:167],a[240:243],v[28:31],v[164:167]
v_add_u32 v197,0x10000,v197
trr a[236:237],v196,0
trr a[238:239],v196,4096
mf v[168:171],a[244:247],v[24:27],v[168:171]
buffer_load_dwordx4 v218,s[36:39],s48 offen offset:2048 lds
v_pk_sub_u16 v42,v42,v205 clamp
v_pk_sub_u16 v46,v46,v206 clamp
mf v[172:175],a[244:247],v[28:31],v[172:175]
s_waitcnt lgkmcnt(8)
v_add_u32 v198,0x10000,v198
trr a[240:241],v197,0
trr a[242:243],v197,4096
mf v[176:179],a[248:251],v[24:27],v[176:179]
buffer_load_dwordx4 v219,s[36:39],s48 offen offset:3072 lds
v_pk_sub_u16 v43,v43,v205 clamp
v_pk_sub_u16 v47,v47,v206 clamp
mf v[180:183],a[248:251],v[28:31],v[180:183]
v_add_u32 v199,0x10000,v199
trr a[244:245],v198,0
trr a[246:247],v198,4096
mf v[184:187],a[252:255],v[24:27],v[184:187]
s_add_u32 m0,s49,147456
s_add_u32 s48,s51,163840
buffer_load_dwordx4 v212,s[28:31],s48 offen nt lds
mf v[188:191],a[252:255],v[28:31],v[188:191]
s_waitcnt lgkmcnt(8)
v_add_u32 v200,0x10000,v200
trr a[248:249],v199,0
mf v[128:131],a[224:227],v[32:35],v[128:131]
trr a[250:251],v199,4096
buffer_load_dwordx4 v213,s[28:31],s48 offen offset:1024 nt lds
mf v[132:135],a[224:227],v[36:39],v[132:135]
trr a[252:253],v200,0
trr a[254:255],v200,4096
buffer_load_dwordx4 v214,s[28:31],s48 offen offset:2048 nt lds
mf v[136:139],a[228:231],v[32:35],v[136:139]
v_sub_f32 v205,v222,v238
v_sub_f32 v206,v223,v239
v_min_f32 v205,0x437f0000,v205
mf v[140:143],a[228:231],v[36:39],v[140:143]
s_waitcnt lgkmcnt(8)
trr a[224:225],v193,8192
trr a[226:227],v193,12288
mf v[144:147],a[232:235],v[32:35],v[144:147]
buffer_load_dwordx4 v215,s[28:31],s48 offen offset:3072 nt lds
v_min_f32 v206,0x437f0000,v206
v_cvt_u32_f32 v205,v205
mf v[148:151],a[232:235],v[36:39],v[148:151]
trr a[228:229],v194,8192
trr a[230:231],v194,12288
mf v[152:155],a[236:239],v[32:35],v[152:155]
v_cvt_u32_f32 v206,v206
v_mul_u32_u24 v205,0x800080,v205
mf v[156:159],a[236:239],v[36:39],v[156:159]
s_waitcnt lgkmcnt(8)
trr a[232:233],v195,8192
trr a[234:235],v195,12288
mf v[160:163],a[240:243],v[32:35],v[160:163]
v_mul_u32_u24 v206,0x800080,v206
v_pk_sub_u16 v48,v48,v205 clamp
v_pk_sub_u16 v52,v52,v206 clamp
mf v[164:167],a[240:243],v[36:39],v[164:167]
trr a[236:237],v196,8192
trr a[238:239],v196,12288
mf v[168:171],a[244:247],v[32:35],v[168:171]
v_pk_sub_u16 v49,v49,v205 clamp
v_pk_sub_u16 v53,v53,v206 clamp
mf v[172:175],a[244:247],v[36:39],v[172:175]
s_waitcnt lgkmcnt(8)
trr a[240:241],v197,8192
trr a[242:243],v197,12288
mf v[176:179],a[248:251],v[32:35],v[176:179]
v_pk_sub_u16 v50,v50,v205 clamp
v_pk_sub_u16 v54,v54,v206 clamp
mf v[180:183],a[248:251],v[36:39],v[180:183]
trr a[244:245],v198,8192
trr a[246:247],v198,12288
mf v[184:187],a[252:255],v[32:35],v[184:187]
v_pk_sub_u16 v51,v51,v205 clamp
v_pk_sub_u16 v55,v55,v206 clamp
mf v[188:191],a[252:255],v[36:39],v[188:191]
s_waitcnt lgkmcnt(8)
trr a[248:249],v199,8192
trr a[250:251],v199,12288
mf v[128:131],a[224:227],v[40:43],v[128:131]
v_sub_f32 v205,v222,v240
v_sub_f32 v206,v223,v241
v_min_f32 v205,0x437f0000,v205
mf v[132:135],a[224:227],v[44:47],v[132:135]
trr a[252:253],v200,8192
trr a[254:255],v200,12288
mf v[136:139],a[228:231],v[40:43],v[136:139]
v_min_f32 v206,0x437f0000,v206
v_cvt_u32_f32 v205,v205
mf v[140:143],a[228:231],v[44:47],v[140:143]
s_waitcnt lgkmcnt(8)
s_waitcnt vmcnt(16)
s_barrier
trr a[224:225],v193,16384
mf v[144:147],a[232:235],v[40:43],v[144:147]
trr a[226:227],v193,20480
v_cvt_u32_f32 v206,v206
v_mul_u32_u24 v205,0x800080,v205
mf v[148:151],a[232:235],v[44:47],v[148:151]
trr a[228:229],v194,16384
trr a[230:231],v194,20480
s_add_u32 m0,s49,16384
s_add_u32 s48,s51,196608
mf v[152:155],a[236:239],v[40:43],v[152:155]
buffer_load_dwordx4 v212,s[28:31],s48 offen nt lds
v_mul_u32_u24 v206,0x800080,v206
v_pk_sub_u16 v56,v56,v205 clamp
v_pk_sub_u16 v60,v60,v206 clamp
mf v[156:159],a[236:239],v[44:47],v[156:159]
s_waitcnt lgkmcnt(8)
trr a[232:233],v195,16384
trr a[234:235],v195,20480
mf v[160:163],a[240:243],v[40:43],v[160:163]
v_pk_sub_u16 v57,v57,v205 clamp
v_pk_sub_u16 v61,v61,v206 clamp
mf v[164:167],a[240:243],v[44:47],v[164:167]
trr a[236:237],v196,16384
trr a[238:239],v196,20480
mf v[168:171],a[244:247],v[40:43],v[168:171]
v_pk_sub_u16 v58,v58,v205 clamp
v_pk_sub_u16 v62,v62,v206 clamp
mf v[172:175],a[244:247],v[44:47],v[172:175]
s_waitcnt lgkmcnt(8)
trr a[240:241],v197,16384
trr a[242:243],v197,20480
mf v[176:179],a[248:251],v[40:43],v[176:179]
buffer_load_dwordx4 v213,s[28:31],s48 offen offset:1024 nt lds
v_pk_sub_u16 v59,v59,v205 clamp
v_pk_sub_u16 v63,v63,v206 clamp
mf v[180:183],a[248:251],v[44:47],v[180:183]
trr a[244:245],v198,16384
mf v[184:187],a[252:255],v[40:43],v[184:187]
trr a[246:247],v198,20480
mf v[188:191],a[252:255],v[44:47],v[188:191]
s_waitcnt lgkmcnt(8)
trr a[248:249],v199,16384
mf v[128:131],a[224:227],v[48:51],v[128:131]
trr a[250:251],v199,20480
mf v[132:135],a[224:227],v[52:55],v[132:135]
trr a[252:253],v200,16384
trr a[254:255],v200,20480
buffer_load_dwordx4 v214,s[28:31],s48 offen offset:2048 nt lds
mf v[136:139],a[228:231],v[48:51],v[136:139]
v_sub_f32 v205,v222,v242
v_sub_f32 v206,v223,v243
v_min_f32 v205,0x437f0000,v205
mf v[140:143],a[228:231],v[52:55],v[140:143]
s_waitcnt lgkmcnt(8)
trr a[224:225],v193,24576
trr a[226:227],v193,28672
mf v[144:147],a[232:235],v[48:51],v[144:147]
v_min_f32 v206,0x437f0000,v206
v_cvt_u32_f32 v205,v205
mf v[148:151],a[232:235],v[52:55],v[148:151]
trr a[228:229],v194,24576
trr a[230:231],v194,28672
mf v[152:155],a[236:239],v[48:51],v[152:155]
v_cvt_u32_f32 v206,v206
v_mul_u32_u24 v205,0x800080,v205
mf v[156:159],a[236:239],v[52:55],v[156:159]
s_waitcnt lgkmcnt(8)
trr a[232:233],v195,24576
trr a[234:235],v195,28672
buffer_load_dwordx4 v215,s[28:31],s48 offen offset:3072 nt lds
mf v[160:163],a[240:243],v[48:51],v[160:163]
v_mul_u32_u24 v206,0x800080,v206
v_pk_sub_u16 v64,v64,v205 clamp
v_pk_sub_u16 v68,v68,v206 clamp
mf v[164:167],a[240:243],v[52:55],v[164:167]
trr a[236:237],v196,24576
trr a[238:239],v196,28672
mf v[168:171],a[244:247],v[48:51],v[168:171]
v_pk_sub_u16 v65,v65,v205 clamp
v_pk_sub_u16 v69,v69,v206 clamp
mf v[172:175],a[244:247],v[52:55],v[172:175]
s_waitcnt lgkmcnt(8)
trr a[240:241],v197,24576
trr a[242:243],v197,28672
mf v[176:179],a[248:251],v[48:51],v[176:179]
v_pk_sub_u16 v66,v66,v205 clamp
v_pk_sub_u16 v70,v70,v206 clamp
mf v[180:183],a[248:251],v[52:55],v[180:183]
trr a[244:245],v198,24576
trr a[246:247],v198,28672
mf v[184:187],a[252:255],v[48:51],v[184:187]
v_pk_sub_u16 v67,v67,v205 clamp
v_pk_sub_u16 v71,v71,v206 clamp
mf v[188:191],a[252:255],v[52:55],v[188:191]
s_waitcnt lgkmcnt(8)
trr a[248:249],v199,24576
trr a[250:251],v199,28672
mf v[128:131],a[224:227],v[56:59],v[128:131]
v_sub_f32 v205,v222,v244
v_sub_f32 v206,v223,v245
v_min_f32 v205,0x437f0000,v205
mf v[132:135],a[224:227],v[60:63],v[132:135]
v_add_u32 v193,0x10000,v193
trr a[252:253],v200,24576
trr a[254:255],v200,28672
mf v[136:139],a[228:231],v[56:59],v[136:139]
v_min_f32 v206,0x437f0000,v206
v_cvt_u32_f32 v205,v205
mf v[140:143],a[228:231],v[60:63],v[140:143]
s_waitcnt lgkmcnt(8)
s_waitcnt vmcnt(12)
s_barrier
v_add_u32 v194,0x10000,v194
mf v[144:147],a[232:235],v[56:59],v[144:147]
trr a[224:225],v193,0
trr a[226:227],v193,4096
v_cvt_u32_f32 v206,v206
v_mul_u32_u24 v205,0x800080,v205
mf v[148:151],a[232:235],v[60:63],v[148:151]
v_add_u32 v195,0x10000,v195
trr a[228:229],v194,0
trr a[230:231],v194,4096
s_add_u32 m0,s49,65536
s_add_u32 s48,s51,229376
mf v[152:155],a[236:239],v[56:59],v[152:155]
buffer_load_dwordx4 v212,s[28:31],s48 offen nt lds
v_mul_u32_u24 v206,0x800080,v206
v_pk_sub_u16 v72,v72,v205 clamp
v_pk_sub_u16 v76,v76,v206 clamp
mf v[156:159],a[236:239],v[60:63],v[156:159]
s_waitcnt lgkmcnt(8)
v_add_u32 v196,0x10000,v196
trr a[232:233],v195,0
mf v[160:163],a[240:243],v[56:59],v[160:163]
trr a[234:235],v195,4096
v_pk_sub_u16 v73,v73,v205 clamp
v_pk_sub_u16 v77,v77,v206 clamp
mf v[164:167],a[240:243],v[60:63],v[164:167]
v_add_u32 v197,0x10000,v197
trr a[236:237],v196,0
trr a[238:239],v196,4096
mf v[168:171],a[244:247],v[56:59],v[168:171]
v_pk_sub_u16 v74,v74,v205 clamp
v_pk_sub_u16 v78,v78,v206 clamp
mf v[172:175],a[244:247],v[60:63],v[172:175]
s_waitcnt lgkmcnt(8)
v_add_u32 v198,0x10000,v198
trr a[240:241],v197,0
trr a[242:243],v197,4096
mf v[176:179],a[248:251],v[56:59],v[176:179]
buffer_load_dwordx4 v213,s[28:31],s48 offen offset:1024 nt lds
v_pk_sub_u16 v75,v75,v205 clamp
v_pk_sub_u16 v79,v79,v206 clamp
mf v[180:183],a[248:251],v[60:63],v[180:183]
v_add_u32 v199,0x10000,v199
trr a[244:245],v198,0
mf v[184:187],a[252:255],v[56:59],v[184:187]
trr a[246:247],v198,4096
mf v[188:191],a[252:255],v[60:63],v[188:191]
s_waitcnt lgkmcnt(8)
v_add_u32 v200,0x10000,v200
mf v[128:131],a[224:227],v[64:67],v[128:131]
trr a[248:249],v199,0
trr a[250:251],v199,4096
mf v[132:135],a[224:227],v[68:71],v[132:135]
trr a[252:253],v200,0
trr a[254:255],v200,4096
buffer_load_dwordx4 v214,s[28:31],s48 offen offset:2048 nt lds
mf v[136:139],a[228:231],v[64:67],v[136:139]
v_sub_f32 v205,v222,v246
v_sub_f32 v206,v223,v247
v_min_f32 v205,0x437f0000,v205
mf v[140:143],a[228:231],v[68:71],v[140:143]
s_waitcnt lgkmcnt(8)
trr a[224:225],v193,8192
trr a[226:227],v193,12288
mf v[144:147],a[232:235],v[64:67],v[144:147]
v_min_f32 v206,0x437f0000,v206
v_cvt_u32_f32 v205,v205
mf v[148:151],a[232:235],v[68:71],v[148:151]
trr a[228:229],v194,8192
trr a[230:231],v194,12288
mf v[152:155],a[236:239],v[64:67],v[152:155]
v_cvt_u32_f32 v206,v206
v_mul_u32_u24 v205,0x800080,v205
mf v[156:159],a[236:239],v[68:71],v[156:159]
s_waitcnt lgkmcnt(8)
trr a[232:233],v195,8192
trr a[234:235],v195,12288
buffer_load_dwordx4 v215,s[28:31],s48 offen offset:3072 nt lds
mf v[160:163],a[240:243],v[64:67],v[160:163]
v_mul_u32_u24 v206,0x800080,v206
v_pk_sub_u16 v80,v80,v205 clamp
v_pk_sub_u16 v84,v84,v206 clamp
mf v[164:167],a[240:243],v[68:71],v[164:167]
trr a[236:237],v196,8192
trr a[238:239],v196,12288
mf v[168:171],a[244:247],v[64:67],v[168:171]
v_pk_sub_u16 v81,v81,v205 clamp
v_pk_sub_u16 v85,v85,v206 clamp
mf v[172:175],a[244:247],v[68:71],v[172:175]
s_waitcnt lgkmcnt(8)
trr a[240:241],v197,8192
trr a[242:243],v197,12288
mf v[176:179],a[248:251],v[64:67],v[176:179]
v_pk_sub_u16 v82,v82,v205 clamp
v_pk_sub_u16 v86,v86,v206 clamp
mf v[180:183],a[248:251],v[68:71],v[180:183]
trr a[244:245],v198,8192
trr a[246:247],v198,12288
mf v[184:187],a[252:255],v[64:67],v[184:187]
v_pk_sub_u16 v83,v83,v205 clamp
v_pk_sub_u16 v87,v87,v206 clamp
mf v[188:191],a[252:255],v[68:71],v[188:191]
s_waitcnt lgkmcnt(8)
trr a[248:249],v199,8192
trr a[250:251],v199,12288
mf v[128:131],a[224:227],v[72:75],v[128:131]
v_sub_f32 v205,v222,v248
v_sub_f32 v206,v223,v249
v_min_f32 v205,0x437f0000,v205
mf v[132:135],a[224:227],v[76:79],v[132:135]
trr a[252:253],v200,8192
trr a[254:255],v200,12288
mf v[136:139],a[228:231],v[72:75],v[136:139]
v_min_f32 v206,0x437f0000,v206
v_cvt_u32_f32 v205,v205
mf v[140:143],a[228:231],v[76:79],v[140:143]
s_waitcnt lgkmcnt(8)
s_waitcnt vmcnt(8)
s_barrier
trr a[224:225],v193,16384
mf v[144:147],a[232:235],v[72:75],v[144:147]
trr a[226:227],v193,20480
v_cvt_u32_f32 v206,v206
v_mul_u32_u24 v205,0x800080,v205
mf v[148:151],a[232:235],v[76:79],v[148:151]
trr a[228:229],v194,16384
trr a[230:231],v194,20480
v_mul_u32_u24 v206,0x800080,v206
mf v[152:155],a[236:239],v[72:75],v[152:155]
v_pk_sub_u16 v88,v88,v205 clamp
v_pk_sub_u16 v92,v92,v206 clamp
mf v[156:159],a[236:239],v[76:79],v[156:159]
s_waitcnt lgkmcnt(8)
trr a[232:233],v195,16384
trr a[234:235],v195,20480
mf v[160:163],a[240:243],v[72:75],v[160:163]
v_pk_sub_u16 v89,v89,v205 clamp
v_pk_sub_u16 v93,v93,v206 clamp
mf v[164:167],a[240:243],v[76:79],v[164:167]
trr a[236:237],v196,16384
trr a[238:239],v196,20480
mf v[168:171],a[244:247],v[72:75],v[168:171]
v_pk_sub_u16 v90,v90,v205 clamp
v_pk_sub_u16 v94,v94,v206 clamp
mf v[172:175],a[244:247],v[76:79],v[172:175]
s_waitcnt lgkmcnt(8)
trr a[240:241],v197,16384
trr a[242:243],v197,20480
mf v[176:179],a[248:251],v[72:75],v[176:179]
v_pk_sub_u16 v91,v91,v205 clamp
v_pk_sub_u16 v95,v95,v206 clamp
mf v[180:183],a[248:251],v[76:79],v[180:183]
trr a[244:245],v198,16384
mf v[184:187],a[252:255],v[72:75],v[184:187]
trr a[246:247],v198,20480
mf v[188:191],a[252:255],v[76:79],v[188:191]
s_waitcnt lgkmcnt(8)
trr a[248:249],v199,16384
mf v[128:131],a[224:227],v[80:83],v[128:131]
trr a[250:251],v199,20480
mf v[132:135],a[224:227],v[84:87],v[132:135]
trr a[252:253],v200,16384
trr a[254:255],v200,20480
v_sub_f32 v205,v222,v250
mf v[136:139],a[228:231],v[80:83],v[136:139]
v_sub_f32 v206,v223,v251
v_min_f32 v205,0x437f0000,v205
mf v[140:143],a[228:231],v[84:87],v[140:143]
s_waitcnt lgkmcnt(8)
trr a[224:225],v193,24576
trr a[226:227],v193,28672
mf v[144:147],a[232:235],v[80:83],v[144:147]
v_min_f32 v206,0x437f0000,v206
v_cvt_u32_f32 v205,v205
mf v[148:151],a[232:235],v[84:87],v[148:151]
trr a[228:229],v194,24576
trr a[230:231],v194,28672
mf v[152:155],a[236:239],v[80:83],v[152:155]
v_cvt_u32_f32 v206,v206
v_mul_u32_u24 v205,0x800080,v205
mf v[156:159],a[236:239],v[84:87],v[156:159]
s_waitcnt lgkmcnt(8)
trr a[232:233],v195,24576
trr a[234:235],v195,28672
mf v[160:163],a[240:243],v[80:83],v[160:163]
v_mul_u32_u24 v206,0x800080,v206
v_pk_sub_u16 v96,v96,v205 clamp
v_pk_sub_u16 v100,v100,v206 clamp
mf v[164:167],a[240:243],v[84:87],v[164:167]
trr a[236:237],v196,24576
trr a[238:239],v196,28672
mf v[168:171],a[244:247],v[80:83],v[168:171]
v_pk_sub_u16 v97,v97,v205 clamp
v_pk_sub_u16 v101,v101,v206 clamp
mf v[172:175],a[244:247],v[84:87],v[172:175]
s_waitcnt lgkmcnt(8)
trr a[240:241],v197,24576
trr a[242:243],v197,28672
mf v[176:179],a[248:251],v[80:83],v[176:179]
v_pk_sub_u16 v98,v98,v205 clamp
v_pk_sub_u16 v102,v102,v206 clamp
mf v[180:183],a[248:251],v[84:87],v[180:183]
trr a[244:245],v198,24576
trr a[246:247],v198,28672
mf v[184:187],a[252:255],v[80:83],v[184:187]
v_pk_sub_u16 v99,v99,v205 clamp
v_pk_sub_u16 v103,v103,v206 clamp
mf v[188:191],a[252:255],v[84:87],v[188:191]
s_waitcnt lgkmcnt(8)
trr a[248:249],v199,24576
trr a[250:251],v199,28672
mf v[128:131],a[224:227],v[88:91],v[128:131]
v_sub_f32 v205,v222,v252
v_sub_f32 v206,v223,v253
v_min_f32 v205,0x437f0000,v205
mf v[132:135],a[224:227],v[92:95],v[132:135]
v_add_u32 v193,0xfffe0000,v193
trr a[252:253],v200,24576
trr a[254:255],v200,28672
mf v[136:139],a[228:231],v[88:91],v[136:139]
v_min_f32 v206,0x437f0000,v206
v_cvt_u32_f32 v205,v205
mf v[140:143],a[228:231],v[92:95],v[140:143]
s_waitcnt lgkmcnt(8)
s_waitcnt vmcnt(4)
s_barrier
v_add_u32 v194,0xfffe0000,v194
mf v[144:147],a[232:235],v[88:91],v[144:147]
trr a[224:225],v193,16384
trr a[226:227],v193,20480
v_cvt_u32_f32 v206,v206
v_mul_u32_u24 v205,0x800080,v205
mf v[148:151],a[232:235],v[92:95],v[148:151]
v_add_u32 v195,0xfffe0000,v195
trr a[228:229],v194,16384
trr a[230:231],v194,20480
s_add_u32 m0,s49,81920
s_add_u32 s48,s53,s97
mf v[152:155],a[236:239],v[88:91],v[152:155]
buffer_load_dwordx4 v216,s[36:39],s48 offen lds
v_mul_u32_u24 v206,0x800080,v206
v_pk_sub_u16 v104,v104,v205 clamp
v_pk_sub_u16 v108,v108,v206 clamp
mf v[156:159],a[236:239],v[92:95],v[156:159]
s_waitcnt lgkmcnt(8)
v_add_u32 v196,0xfffe0000,v196
trr a[232:233],v195,16384
trr a[234:235],v195,20480
mf v[160:163],a[240:243],v[88:91],v[160:163]
buffer_load_dwordx4 v217,s[36:39],s48 offen offset:1024 lds
v_pk_sub_u16 v105,v105,v205 clamp
v_pk_sub_u16 v109,v109,v206 clamp
mf v[164:167],a[240:243],v[92:95],v[164:167]
v_add_u32 v197,0xfffe0000,v197
trr a[236:237],v196,16384
trr a[238:239],v196,20480
mf v[168:171],a[244:247],v[88:91],v[168:171]
buffer_load_dwordx4 v218,s[36:39],s48 offen offset:2048 lds
v_pk_sub_u16 v106,v106,v205 clamp
v_pk_sub_u16 v110,v110,v206 clamp
mf v[172:175],a[244:247],v[92:95],v[172:175]
s_waitcnt lgkmcnt(8)
v_add_u32 v198,0xfffe0000,v198
trr a[240:241],v197,16384
trr a[242:243],v197,20480
mf v[176:179],a[248:251],v[88:91],v[176:179]
buffer_load_dwordx4 v219,s[36:39],s48 offen offset:3072 lds
v_pk_sub_u16 v107,v107,v205 clamp
v_pk_sub_u16 v111,v111,v206 clamp
mf v[180:183],a[248:251],v[92:95],v[180:183]
v_add_u32 v199,0xfffe0000,v199
trr a[244:245],v198,16384
trr a[246:247],v198,20480
mf v[184:187],a[252:255],v[88:91],v[184:187]
s_add_u32 m0,s49,131072
s_add_u32 s48,s51,256
buffer_load_dwordx4 v212,s[28:31],s48 offen nt lds
mf v[188:191],a[252:255],v[92:95],v[188:191]
s_waitcnt lgkmcnt(8)
v_add_u32 v200,0xfffe0000,v200
trr a[248:249],v199,16384
mf v[128:131],a[224:227],v[96:99],v[128:131]
trr a[250:251],v199,20480
buffer_load_dwordx4 v213,s[28:31],s48 offen offset:1024 nt lds
mf v[132:135],a[224:227],v[100:103],v[132:135]
trr a[252:253],v200,16384
trr a[254:255],v200,20480
buffer_load_dwordx4 v214,s[28:31],s48 offen offset:2048 nt lds
mf v[136:139],a[228:231],v[96:99],v[136:139]
v_sub_f32 v205,v222,v254
v_sub_f32 v206,v223,v255
mf v[140:143],a[228:231],v[100:103],v[140:143]
s_waitcnt lgkmcnt(8)
trr a[224:225],v193,24576
trr a[226:227],v193,28672
mf v[144:147],a[232:235],v[96:99],v[144:147]
buffer_load_dwordx4 v215,s[28:31],s48 offen offset:3072 nt lds
v_min_f32 v205,0x437f0000,v205
mf v[148:151],a[232:235],v[100:103],v[148:151]
trr a[228:229],v194,24576
trr a[230:231],v194,28672
mf v[152:155],a[236:239],v[96:99],v[152:155]
v_min_f32 v206,0x437f0000,v206
mf v[156:159],a[236:239],v[100:103],v[156:159]
s_waitcnt lgkmcnt(8)
trr a[232:233],v195,24576
mf v[160:163],a[240:243],v[96:99],v[160:163]
trr a[234:235],v195,28672
v_cvt_u32_f32 v205,v205
mf v[164:167],a[240:243],v[100:103],v[164:167]
trr a[236:237],v196,24576
trr a[238:239],v196,28672
mf v[168:171],a[244:247],v[96:99],v[168:171]
v_cvt_u32_f32 v206,v206
mf v[172:175],a[244:247],v[100:103],v[172:175]
s_waitcnt lgkmcnt(8)
trr a[240:241],v197,24576
mf v[176:179],a[248:251],v[96:99],v[176:179]
trr a[242:243],v197,28672
v_mul_u32_u24 v205,0x800080,v205
mf v[180:183],a[248:251],v[100:103],v[180:183]
trr a[244:245],v198,24576
trr a[246:247],v198,28672
mf v[184:187],a[252:255],v[96:99],v[184:187]
v_mul_u32_u24 v206,0x800080,v206
mf v[188:191],a[252:255],v[100:103],v[188:191]
s_waitcnt lgkmcnt(8)
trr a[248:249],v199,24576
trr a[250:251],v199,28672
mf v[128:131],a[224:227],v[104:107],v[128:131]
v_pk_sub_u16 v112,v112,v205 clamp
v_pk_sub_u16 v116,v116,v206 clamp
mf v[132:135],a[224:227],v[108:111],v[132:135]
v_add_u32 v193,0x10000,v193
trr a[252:253],v200,24576
mf v[136:139],a[228:231],v[104:107],v[136:139]
trr a[254:255],v200,28672
v_pk_sub_u16 v113,v113,v205 clamp
mf v[140:143],a[228:231],v[108:111],v[140:143]
s_waitcnt lgkmcnt(8)
s_waitcnt vmcnt(8)
s_barrier
v_add_u32 v194,0x10000,v194
mf v[144:147],a[232:235],v[104:107],v[144:147]
trr a[224:225],v193,0
trr a[226:227],v193,4096
v_pk_sub_u16 v117,v117,v206 clamp
mf v[148:151],a[232:235],v[108:111],v[148:151]
v_add_u32 v195,0x10000,v195
trr a[228:229],v194,0
trr a[230:231],v194,4096
s_add_u32 m0,s49,147456
mf v[152:155],a[236:239],v[104:107],v[152:155]
s_add_u32 s48,s51,33024
buffer_load_dwordx4 v212,s[28:31],s48 offen nt lds
v_pk_sub_u16 v114,v114,v205 clamp
mf v[156:159],a[236:239],v[108:111],v[156:159]
s_waitcnt lgkmcnt(8)
v_add_u32 v196,0x10000,v196
trr a[232:233],v195,0
mf v[160:163],a[240:243],v[104:107],v[160:163]
trr a[234:235],v195,4096
v_pk_sub_u16 v118,v118,v206 clamp
mf v[164:167],a[240:243],v[108:111],v[164:167]
v_add_u32 v197,0x10000,v197
trr a[236:237],v196,0
mf v[168:171],a[244:247],v[104:107],v[168:171]
trr a[238:239],v196,4096
v_pk_sub_u16 v115,v115,v205 clamp
mf v[172:175],a[244:247],v[108:111],v[172:175]
s_waitcnt lgkmcnt(8)
v_add_u32 v198,0x10000,v198
trr a[240:241],v197,0
mf v[176:179],a[248:251],v[104:107],v[176:179]
trr a[242:243],v197,4096
buffer_load_dwordx4 v213,s[28:31],s48 offen offset:1024 nt lds
v_pk_sub_u16 v119,v119,v206 clamp
mf v[180:183],a[248:251],v[108:111],v[180:183]
v_add_u32 v199,0x10000,v199
trr a[244:245],v198,0
mf v[184:187],a[252:255],v[104:107],v[184:187]
trr a[246:247],v198,4096
mf v[188:191],a[252:255],v[108:111],v[188:191]
s_waitcnt lgkmcnt(8)
v_add_u32 v200,0x10000,v200
mf v[128:131],a[224:227],v[112:115],v[128:131]
trr a[248:249],v199,0
trr a[250:251],v199,4096
mf v[132:135],a[224:227],v[116:119],v[132:135]
trr a[252:253],v200,0
trr a[254:255],v200,4096
mf v[136:139],a[228:231],v[112:115],v[136:139]
buffer_load_dwordx4 v214,s[28:31],s48 offen offset:2048 nt lds
mf v[140:143],a[228:231],v[116:119],v[140:143]
s_waitcnt lgkmcnt(8)
trr a[224:225],v193,8192
mf v[144:147],a[232:235],v[112:115],v[144:147]
trr a[226:227],v193,12288
mf v[148:151],a[232:235],v[116:119],v[148:151]
trr a[228:229],v194,8192
mf v[152:155],a[236:239],v[112:115],v[152:155]
trr a[230:231],v194,12288
mf v[156:159],a[236:239],v[116:119],v[156:159]
s_waitcnt lgkmcnt(8)
trr a[232:233],v195,8192
mf v[160:163],a[240:243],v[112:115],v[160:163]
trr a[234:235],v195,12288
buffer_load_dwordx4 v215,s[28:31],s48 offen offset:3072 nt lds
mf v[164:167],a[240:243],v[116:119],v[164:167]
trr a[236:237],v196,8192
mf v[168:171],a[244:247],v[112:115],v[168:171]
trr a[238:239],v196,12288
mf v[172:175],a[244:247],v[116:119],v[172:175]
s_waitcnt lgkmcnt(8)
trr a[240:241],v197,8192
mf v[176:179],a[248:251],v[112:115],v[176:179]
trr a[242:243],v197,12288
mf v[180:183],a[248:251],v[116:119],v[180:183]
trr a[244:245],v198,8192
mf v[184:187],a[252:255],v[112:115],v[184:187]
trr a[246:247],v198,12288
mf v[188:191],a[252:255],v[116:119],v[188:191]
s_waitcnt lgkmcnt(8)
trr a[248:249],v199,8192
mf v[128:131],a[224:227],v[120:123],v[128:131]
trr a[250:251],v199,12288
mf v[132:135],a[224:227],v[124:127],v[132:135]
trr a[252:253],v200,8192
mf v[136:139],a[228:231],v[120:123],v[136:139]
trr a[254:255],v200,12288
mf v[140:143],a[228:231],v[124:127],v[140:143]
s_waitcnt lgkmcnt(8)
s_barrier
mf v[144:147],a[232:235],v[120:123],v[144:147]
trr a[224:225],v201,49152
trr a[226:227],v201,51200
mf v[148:151],a[232:235],v[124:127],v[148:151]
trr a[228:229],v202,49152
mf v[152:155],a[236:239],v[120:123],v[152:155]
trr a[230:231],v202,51200
mf v[156:159],a[236:239],v[124:127],v[156:159]
s_waitcnt lgkmcnt(8)
trr a[232:233],v203,49152
mf v[160:163],a[240:243],v[120:123],v[160:163]
trr a[234:235],v203,51200
mf v[164:167],a[240:243],v[124:127],v[164:167]
trr a[236:237],v204,49152
mf v[168:171],a[244:247],v[120:123],v[168:171]
trr a[238:239],v204,51200
mf v[172:175],a[244:247],v[124:127],v[172:175]
s_waitcnt lgkmcnt(8)
trr a[240:241],v201,53248
mf v[176:179],a[248:251],v[120:123],v[176:179]
trr a[242:243],v201,55296
mf v[180:183],a[248:251],v[124:127],v[180:183]
trr a[244:245],v202,53248
mf v[184:187],a[252:255],v[120:123],v[184:187]
trr a[246:247],v202,55296
mf v[188:191],a[252:255],v[124:127],v[188:191]
s_waitcnt lgkmcnt(8)
trr a[248:249],v203,53248
trr a[250:251],v203,55296
v_mul_f32 v128,v128,v224
v_mul_f32 v129,v129,v224
v_mul_f32 v130,v130,v224
v_mul_f32 v131,v131,v224
v_mul_f32 v136,v136,v224
v_mul_f32 v137,v137,v224
v_mul_f32 v138,v138,v224
v_mul_f32 v139,v139,v224
v_mul_f32 v132,v132,v225
v_mul_f32 v133,v133,v225
v_mul_f32 v134,v134,v225
v_mul_f32 v135,v135,v225
v_mul_f32 v140,v140,v225
v_mul_f32 v141,v141,v225
v_mul_f32 v142,v142,v225
v_mul_f32 v143,v143,v225
cvp v128,v128,v129
cvp v129,v130,v131
cvp v130,v136,v137
cvp v131,v138,v139
cvp v132,v132,v133
cvp v133,v134,v135
cvp v134,v140,v141
cvp v135,v142,v143
mf a[0:3],a[224:227],v[128:131],0
s_nop 0
mf a[4:7],a[224:227],v[132:135],0
trr a[252:253],v204,53248
trr a[254:255],v204,55296
v_mul_f32 v144,v144,v224
v_mul_f32 v145,v145,v224
v_mul_f32 v146,v146,v224
mf a[8:11],a[228:231],v[128:131],0
v_mul_f32 v147,v147,v224
v_mul_f32 v152,v152,v224
v_mul_f32 v153,v153,v224
v_mul_f32 v154,v154,v224
v_mul_f32 v155,v155,v224
mf a[12:15],a[228:231],v[132:135],0
s_waitcnt lgkmcnt(8)
trr a[224:225],v201,57344
trr a[226:227],v201,59392
v_mul_f32 v148,v148,v225
v_mul_f32 v149,v149,v225
v_mul_f32 v150,v150,v225
mf a[16:19],a[232:235],v[128:131],0
v_mul_f32 v151,v151,v225
v_mul_f32 v156,v156,v225
v_mul_f32 v157,v157,v225
v_mul_f32 v158,v158,v225
v_mul_f32 v159,v159,v225
mf a[20:23],a[232:235],v[132:135],0
trr a[228:229],v202,57344
trr a[230:231],v202,59392
cvp v136,v144,v145
cvp v137,v146,v147
cvp v138,v152,v153
mf a[24:27],a[236:239],v[128:131],0
cvp v139,v154,v155
cvp v140,v148,v149
cvp v141,v150,v151
cvp v142,v156,v157
cvp v143,v158,v159
mf a[28:31],a[236:239],v[132:135],0
s_waitcnt lgkmcnt(8)
trr a[232:233],v203,57344
mf a[0:3],a[240:243],v[136:139],a[0:3]
trr a[234:235],v203,59392
mf a[4:7],a[240:243],v[140:143],a[4:7]
trr a[236:237],v204,57344
trr a[238:239],v204,59392
v_mul_f32 v160,v160,v224
v_mul_f32 v161,v161,v224
v_mul_f32 v162,v162,v224
mf a[8:11],a[244:247],v[136:139],a[8:11]
v_mul_f32 v163,v163,v224
v_mul_f32 v168,v168,v224
v_mul_f32 v169,v169,v224
v_mul_f32 v170,v170,v224
v_mul_f32 v171,v171,v224
mf a[12:15],a[244:247],v[140:143],a[12:15]
s_waitcnt lgkmcnt(8)
trr a[240:241],v201,61440
trr a[242:243],v201,63488
v_mul_f32 v164,v164,v225
v_mul_f32 v165,v165,v225
v_mul_f32 v166,v166,v225
mf a[16:19],a[248:251],v[136:139],a[16:19]
v_mul_f32 v167,v167,v225
v_mul_f32 v172,v172,v225
v_mul_f32 v173,v173,v225
v_mul_f32 v174,v174,v225
v_mul_f32 v175,v175,v225
mf a[20:23],a[248:251],v[140:143],a[20:23]
trr a[244:245],v202,61440
trr a[246:247],v202,63488
cvp v144,v160,v161
cvp v145,v162,v163
cvp v146,v168,v169
mf a[24:27],a[252:255],v[136:139],a[24:27]
cvp v147,v170,v171
cvp v148,v164,v165
cvp v149,v166,v167
cvp v150,v172,v173
cvp v151,v174,v175
mf a[28:31],a[252:255],v[140:143],a[28:31]
s_waitcnt lgkmcnt(8)
trr a[248:249],v203,61440
mf a[0:3],a[224:227],v[144:147],a[0:3]
trr a[250:251],v203,63488
mf a[4:7],a[224:227],v[148:151],a[4:7]
trr a[252:253],v204,61440
trr a[254:255],v204,63488
v_mul_f32 v176,v176,v224
v_mul_f32 v177,v177,v224
v_mul_f32 v178,v178,v224
mf a[8:11],a[228:231],v[144:147],a[8:11]
v_mul_f32 v179,v179,v224
v_mul_f32 v184,v184,v224
v_mul_f32 v185,v185,v224
v_mul_f32 v186,v186,v224
v_mul_f32 v187,v187,v224
mf a[12:15],a[228:231],v[148:151],a[12:15]
s_waitcnt lgkmcnt(8)
s_barrier
trr a[224:225],v201,0
trr a[226:227],v201,2048
v_mul_f32 v180,v180,v225
v_mul_f32 v181,v181,v225
mf a[16:19],a[232:235],v[144:147],a[16:19]
v_mul_f32 v182,v182,v225
v_mul_f32 v183,v183,v225
v_mul_f32 v188,v188,v225
v_mul_f32 v189,v189,v225
v_mul_f32 v190,v190,v225
v_mul_f32 v191,v191,v225
mf a[20:23],a[232:235],v[148:151],a[20:23]
trr a[228:229],v202,0
trr a[230:231],v202,2048
s_add_u32 m0,s49,16384
s_add_u32 s48,s53,s98
buffer_load_dwordx4 v216,s[36:39],s48 offen lds
cvp v152,v176,v177
cvp v153,v178,v179
mf a[24:27],a[236:239],v[144:147],a[24:27]
cvp v154,v184,v185
cvp v155,v186,v187
cvp v156,v180,v181
cvp v157,v182,v183
cvp v158,v188,v189
cvp v159,v190,v191
mf a[28:31],a[236:239],v[148:151],a[28:31]
s_waitcnt lgkmcnt(8)
trr a[232:233],v203,0
mf a[0:3],a[240:243],v[152:155],a[0:3]
trr a[234:235],v203,2048
buffer_load_dwordx4 v217,s[36:39],s48 offen offset:1024 lds
mf a[4:7],a[240:243],v[156:159],a[4:7]
trr a[236:237],v204,0
trr a[238:239],v204,2048
mf a[8:11],a[244:247],v[152:155],a[8:11]
buffer_load_dwordx4 v218,s[36:39],s48 offen offset:2048 lds
mf a[12:15],a[244:247],v[156:159],a[12:15]
s_waitcnt lgkmcnt(8)
trr a[240:241],v201,4096
mf a[16:19],a[248:251],v[152:155],a[16:19]
trr a[242:243],v201,6144
buffer_load_dwordx4 v219,s[36:39],s48 offen offset:3072 lds
mf a[20:23],a[248:251],v[156:159],a[20:23]
trr a[244:245],v202,4096
trr a[246:247],v202,6144
s_add_u32 m0,s49,65536
mf a[24:27],a[252:255],v[152:155],a[24:27]
s_add_u32 s48,s51,65792
buffer_load_dwordx4 v212,s[28:31],s48 offen nt lds
mf a[28:31],a[252:255],v[156:159],a[28:31]
s_waitcnt lgkmcnt(8)
trr a[248:249],v203,4096
mf a[32:35],a[224:227],v[128:131],0
trr a[250:251],v203,6144
buffer_load_dwordx4 v213,s[28:31],s48 offen offset:1024 nt lds
mf a[36:39],a[224:227],v[132:135],0
trr a[252:253],v204,4096
trr a[254:255],v204,6144
mf a[40:43],a[228:231],v[128:131],0
buffer_load_dwordx4 v214,s[28:31],s48 offen offset:2048 nt lds
mf a[44:47],a[228:231],v[132:135],0
s_waitcnt lgkmcnt(8)
trr a[224:225],v201,8192
mf a[48:51],a[232:235],v[128:131],0
trr a[226:227],v201,10240
buffer_load_dwordx4 v215,s[28:31],s48 offen offset:3072 nt lds
mf a[52:55],a[232:235],v[132:135],0
trr a[228:229],v202,8192
mf a[56:59],a[236:239],v[128:131],0
trr a[230:231],v202,10240
mf a[60:63],a[236:239],v[132:135],0
s_waitcnt lgkmcnt(8)
trr a[232:233],v203,8192
mf a[32:35],a[240:243],v[136:139],a[32:35]
trr a[234:235],v203,10240
mf a[36:39],a[240:243],v[140:143],a[36:39]
trr a[236:237],v204,8192
mf a[40:43],a[244:247],v[136:139],a[40:43]
trr a[238:239],v204,10240
mf a[44:47],a[244:247],v[140:143],a[44:47]
s_waitcnt lgkmcnt(8)
trr a[240:241],v201,12288
mf a[48:51],a[248:251],v[136:139],a[48:51]
trr a[242:243],v201,14336
mf a[52:55],a[248:251],v[140:143],a[52:55]
trr a[244:245],v202,12288
mf a[56:59],a[252:255],v[136:139],a[56:59]
trr a[246:247],v202,14336
mf a[60:63],a[252:255],v[140:143],a[60:63]
s_waitcnt lgkmcnt(8)
trr a[248:249],v203,12288
mf a[32:35],a[224:227],v[144:147],a[32:35]
trr a[250:251],v203,14336
mf a[36:39],a[224:227],v[148:151],a[36:39]
trr a[252:253],v204,12288
mf a[40:43],a[228:231],v[144:147],a[40:43]
trr a[254:255],v204,14336
mf a[44:47],a[228:231],v[148:151],a[44:47]
s_waitcnt lgkmcnt(8)
s_barrier
mf a[48:51],a[232:235],v[144:147],a[48:51]
trr a[224:225],v201,32768
trr a[226:227],v201,34816
mf a[52:55],a[232:235],v[148:151],a[52:55]
trr a[228:229],v202,32768
mf a[56:59],a[236:239],v[144:147],a[56:59]
trr a[230:231],v202,34816
mf a[60:63],a[236:239],v[148:151],a[60:63]
s_waitcnt lgkmcnt(8)
trr a[232:233],v203,32768
mf a[32:35],a[240:243],v[152:155],a[32:35]
trr a[234:235],v203,34816
mf a[36:39],a[240:243],v[156:159],a[36:39]
trr a[236:237],v204,32768
mf a[40:43],a[244:247],v[152:155],a[40:43]
trr a[238:239],v204,34816
mf a[44:47],a[244:247],v[156:159],a[44:47]
s_waitcnt lgkmcnt(8)
trr a[240:241],v201,36864
mf a[48:51],a[248:251],v[152:155],a[48:51]
trr a[242:243],v201,38912
mf a[52:55],a[248:251],v[156:159],a[52:55]
trr a[244:245],v202,36864
mf a[56:59],a[252:255],v[152:155],a[56:59]
trr a[246:247],v202,38912
mf a[60:63],a[252:255],v[156:159],a[60:63]
s_waitcnt lgkmcnt(8)
trr a[248:249],v203,36864
mf a[64:67],a[224:227],v[128:131],0
trr a[250:251],v203,38912
mf a[68:71],a[224:227],v[132:135],0
trr a[252:253],v204,36864
mf a[72:75],a[228:231],v[128:131],0
trr a[254:255],v204,38912
mf a[76:79],a[228:231],v[132:135],0
s_waitcnt lgkmcnt(8)
trr a[224:225],v201,40960
mf a[80:83],a[232:235],v[128:131],0
trr a[226:227],v201,43008
mf a[84:87],a[232:235],v[132:135],0
trr a[228:229],v202,40960
mf a[88:91],a[236:239],v[128:131],0
trr a[230:231],v202,43008
mf a[92:95],a[236:239],v[132:135],0
s_waitcnt lgkmcnt(8)
trr a[232:233],v203,40960
mf a[64:67],a[240:243],v[136:139],a[64:67]
trr a[234:235],v203,43008
mf a[68:71],a[240:243],v[140:143],a[68:71]
trr a[236:237],v204,40960
mf a[72:75],a[244:247],v[136:139],a[72:75]
trr a[238:239],v204,43008
mf a[76:79],a[244:247],v[140:143],a[76:79]
s_waitcnt lgkmcnt(8)
trr a[240:241],v201,45056
mf a[80:83],a[248:251],v[136:139],a[80:83]
trr a[242:243],v201,47104
mf a[84:87],a[248:251],v[140:143],a[84:87]
trr a[244:245],v202,45056
mf a[88:91],a[252:255],v[136:139],a[88:91]
trr a[246:247],v202,47104
mf a[92:95],a[252:255],v[140:143],a[92:95]
s_waitcnt lgkmcnt(8)
trr a[248:249],v203,45056
mf a[64:67],a[224:227],v[144:147],a[64:67]
trr a[250:251],v203,47104
mf a[68:71],a[224:227],v[148:151],a[68:71]
v_add_u32 v201,0x10000,v201
trr a[252:253],v204,45056
mf a[72:75],a[228:231],v[144:147],a[72:75]
trr a[254:255],v204,47104
mf a[76:79],a[228:231],v[148:151],a[76:79]
s_waitcnt lgkmcnt(8)
s_barrier
mf a[80:83],a[232:235],v[144:147],a[80:83]
v_add_u32 v202,0x10000,v202
trr a[224:225],v201,32768
trr a[226:227],v201,34816
mf a[84:87],a[232:235],v[148:151],a[84:87]
v_add_u32 v203,0x10000,v203
trr a[228:229],v202,32768
trr a[230:231],v202,34816
mf a[88:91],a[236:239],v[144:147],a[88:91]
s_add_u32 m0,s49,0
s_add_u32 s48,s51,98560
buffer_load_dwordx4 v212,s[28:31],s48 offen nt lds
mf a[92:95],a[236:239],v[148:151],a[92:95]
s_waitcnt lgkmcnt(8)
v_add_u32 v204,0x10000,v204
mf a[64:67],a[240:243],v[152:155],a[64:67]
trr a[232:233],v203,32768
trr a[234:235],v203,34816
mf a[68:71],a[240:243],v[156:159],a[68:71]
trr a[236:237],v204,32768
mf a[72:75],a[244:247],v[152:155],a[72:75]
trr a[238:239],v204,34816
mf a[76:79],a[244:247],v[156:159],a[76:79]
s_waitcnt lgkmcnt(8)
trr a[240:241],v201,36864
mf a[80:83],a[248:251],v[152:155],a[80:83]
trr a[242:243],v201,38912
buffer_load_dwordx4 v213,s[28:31],s48 offen offset:1024 nt lds
mf a[84:87],a[248:251],v[156:159],a[84:87]
trr a[244:245],v202,36864
mf a[88:91],a[252:255],v[152:155],a[88:91]
trr a[246:247],v202,38912
mf a[92:95],a[252:255],v[156:159],a[92:95]
s_waitcnt lgkmcnt(8)
trr a[248:249],v203,36864
mf a[96:99],a[224:227],v[128:131],0
trr a[250:251],v203,38912
mf a[100:103],a[224:227],v[132:135],0
trr a[252:253],v204,36864
trr a[254:255],v204,38912
mf a[104:107],a[228:231],v[128:131],0
buffer_load_dwordx4 v214,s[28:31],s48 offen offset:2048 nt lds
mf a[108:111],a[228:231],v[132:135],0
s_waitcnt lgkmcnt(8)
trr a[224:225],v201,40960
mf a[112:115],a[232:235],v[128:131],0
trr a[226:227],v201,43008
mf a[116:119],a[232:235],v[132:135],0
trr a[228:229],v202,40960
mf a[120:123],a[236:239],v[128:131],0
trr a[230:231],v202,43008
mf a[124:127],a[236:239],v[132:135],0
s_waitcnt lgkmcnt(8)
trr a[232:233],v203,40960
mf a[96:99],a[240:243],v[136:139],a[96:99]
trr a[234:235],v203,43008
buffer_load_dwordx4 v215,s[28:31],s48 offen offset:3072 nt lds
mf a[100:103],a[240:243],v[140:143],a[100:103]
trr a[236:237],v204,40960
mf a[104:107],a[244:247],v[136:139],a[104:107]
trr a[238:239],v204,43008
mf a[108:111],a[244:247],v[140:143],a[108:111]
s_waitcnt lgkmcnt(8)
trr a[240:241],v201,45056
mf a[112:115],a[248:251],v[136:139],a[112:115]
trr a[242:243],v201,47104
mf a[116:119],a[248:251],v[140:143],a[116:119]
trr a[244:245],v202,45056
mf a[120:123],a[252:255],v[136:139],a[120:123]
trr a[246:247],v202,47104
mf a[124:127],a[252:255],v[140:143],a[124:127]
s_waitcnt lgkmcnt(8)
trr a[248:249],v203,45056
mf a[96:99],a[224:227],v[144:147],a[96:99]
trr a[250:251],v203,47104
mf a[100:103],a[224:227],v[148:151],a[100:103]
trr a[252:253],v204,45056
mf a[104:107],a[228:231],v[144:147],a[104:107]
trr a[254:255],v204,47104
mf a[108:111],a[228:231],v[148:151],a[108:111]
s_waitcnt lgkmcnt(8)
s_barrier
mf a[112:115],a[232:235],v[144:147],a[112:115]
trr a[224:225],v201,49152
trr a[226:227],v201,51200
mf a[116:119],a[232:235],v[148:151],a[116:119]
trr a[228:229],v202,49152
mf a[120:123],a[236:239],v[144:147],a[120:123]
trr a[230:231],v202,51200
mf a[124:127],a[236:239],v[148:151],a[124:127]
s_waitcnt lgkmcnt(8)
trr a[232:233],v203,49152
mf a[96:99],a[240:243],v[152:155],a[96:99]
trr a[234:235],v203,51200
mf a[100:103],a[240:243],v[156:159],a[100:103]
trr a[236:237],v204,49152
mf a[104:107],a[244:247],v[152:155],a[104:107]
trr a[238:239],v204,51200
mf a[108:111],a[244:247],v[156:159],a[108:111]
s_waitcnt lgkmcnt(8)
trr a[240:241],v201,53248
mf a[112:115],a[248:251],v[152:155],a[112:115]
trr a[242:243],v201,55296
mf a[116:119],a[248:251],v[156:159],a[116:119]
trr a[244:245],v202,53248
mf a[120:123],a[252:255],v[152:155],a[120:123]
trr a[246:247],v202,55296
mf a[124:127],a[252:255],v[156:159],a[124:127]
s_waitcnt lgkmcnt(8)
trr a[248:249],v203,53248
mf a[128:131],a[224:227],v[128:131],0
trr a[250:251],v203,55296
mf a[132:135],a[224:227],v[132:135],0
trr a[252:253],v204,53248
mf a[136:139],a[228:231],v[128:131],0
trr a[254:255],v204,55296
mf a[140:143],a[228:231],v[132:135],0
s_waitcnt lgkmcnt(8)
trr a[224:225],v201,57344
mf a[144:147],a[232:235],v[128:131],0
trr a[226:227],v201,59392
mf a[148:151],a[232:235],v[132:135],0
trr a[228:229],v202,57344
mf a[152:155],a[236:239],v[128:131],0
trr a[230:231],v202,59392
mf a[156:159],a[236:239],v[132:135],0
s_waitcnt lgkmcnt(8)
trr a[232:233],v203,57344
mf a[128:131],a[240:243],v[136:139],a[128:131]
trr a[234:235],v203,59392
mf a[132:135],a[240:243],v[140:143],a[132:135]
trr a[236:237],v204,57344
mf a[136:139],a[244:247],v[136:139],a[136:139]
trr a[238:239],v204,59392
mf a[140:143],a[244:247],v[140:143],a[140:143]
s_waitcnt lgkmcnt(8)
trr a[240:241],v201,61440
mf a[144:147],a[248:251],v[136:139],a[144:147]
trr a[242:243],v201,63488
mf a[148:151],a[248:251],v[140:143],a[148:151]
trr a[244:245],v202,61440
mf a[152:155],a[252:255],v[136:139],a[152:155]
trr a[246:247],v202,63488
mf a[156:159],a[252:255],v[140:143],a[156:159]
s_waitcnt lgkmcnt(8)
trr a[248:249],v203,61440
mf a[128:131],a[224:227],v[144:147],a[128:131]
trr a[250:251],v203,63488
mf a[132:135],a[224:227],v[148:151],a[132:135]
trr a[252:253],v204,61440
mf a[136:139],a[228:231],v[144:147],a[136:139]
trr a[254:255],v204,63488
mf a[140:143],a[228:231],v[148:151],a[140:143]
s_waitcnt lgkmcnt(8)
s_waitcnt vmcnt(20)
s_barrier
mf a[144:147],a[232:235],v[144:147],a[144:147]
trr a[224:225],v201,16384
trr a[226:227],v201,18432
mf a[148:151],a[232:235],v[148:151],a[148:151]
trr a[228:229],v202,16384
trr a[230:231],v202,18432
s_add_u32 m0,s49,32768
mf a[152:155],a[236:239],v[144:147],a[152:155]
s_add_u32 s48,s51,131328
buffer_load_dwordx4 v212,s[28:31],s48 offen nt lds
mf a[156:159],a[236:239],v[148:151],a[156:159]
s_waitcnt lgkmcnt(8)
trr a[232:233],v203,16384
mf a[128:131],a[240:243],v[152:155],a[128:131]
trr a[234:235],v203,18432
mf a[132:135],a[240:243],v[156:159],a[132:135]
trr a[236:237],v204,16384
mf a[136:139],a[244:247],v[152:155],a[136:139]
trr a[238:239],v204,18432
mf a[140:143],a[244:247],v[156:159],a[140:143]
s_waitcnt lgkmcnt(8)
trr a[240:241],v201,20480
mf a[144:147],a[248:251],v[152:155],a[144:147]
trr a[242:243],v201,22528
buffer_load_dwordx4 v213,s[28:31],s48 offen offset:1024 nt lds
mf a[148:151],a[248:251],v[156:159],a[148:151]
trr a[244:245],v202,20480
mf a[152:155],a[252:255],v[152:155],a[152:155]
trr a[246:247],v202,22528
mf a[156:159],a[252:255],v[156:159],a[156:159]
s_waitcnt lgkmcnt(8)
trr a[248:249],v203,20480
mf a[160:163],a[224:227],v[128:131],0
trr a[250:251],v203,22528
mf a[164:167],a[224:227],v[132:135],0
trr a[252:253],v204,20480
trr a[254:255],v204,22528
mf a[168:171],a[228:231],v[128:131],0
buffer_load_dwordx4 v214,s[28:31],s48 offen offset:2048 nt lds
mf a[172:175],a[228:231],v[132:135],0
s_waitcnt lgkmcnt(8)
trr a[224:225],v201,24576
mf a[176:179],a[232:235],v[128:131],0
trr a[226:227],v201,26624
mf a[180:183],a[232:235],v[132:135],0
trr a[228:229],v202,24576
mf a[184:187],a[236:239],v[128:131],0
trr a[230:231],v202,26624
mf a[188:191],a[236:239],v[132:135],0
s_waitcnt lgkmcnt(8)
trr a[232:233],v203,24576
mf a[160:163],a[240:243],v[136:139],a[160:163]
trr a[234:235],v203,26624
buffer_load_dwordx4 v215,s[28:31],s48 offen offset:3072 nt lds
mf a[164:167],a[240:243],v[140:143],a[164:167]
trr a[236:237],v204,24576
mf a[168:171],a[244:247],v[136:139],a[168:171]
trr a[238:239],v204,26624
mf a[172:175],a[244:247],v[140:143],a[172:175]
s_waitcnt lgkmcnt(8)
trr a[240:241],v201,28672
mf a[176:179],a[248:251],v[136:139],a[176:179]
trr a[242:243],v201,30720
mf a[180:183],a[248:251],v[140:143],a[180:183]
trr a[244:245],v202,28672
mf a[184:187],a[252:255],v[136:139],a[184:187]
trr a[246:247],v202,30720
mf a[188:191],a[252:255],v[140:143],a[188:191]
s_waitcnt lgkmcnt(8)
trr a[248:249],v203,28672
mf a[160:163],a[224:227],v[144:147],a[160:163]
trr a[250:251],v203,30720
mf a[164:167],a[224:227],v[148:151],a[164:167]
v_add_u32 v201,0xffff0000,v201
trr a[252:253],v204,28672
mf a[168:171],a[228:231],v[144:147],a[168:171]
trr a[254:255],v204,30720
mf a[172:175],a[228:231],v[148:151],a[172:175]
s_waitcnt lgkmcnt(8)
s_waitcnt vmcnt(12)
s_barrier
mf a[176:179],a[232:235],v[144:147],a[176:179]
v_add_u32 v202,0xffff0000,v202
trr a[224:225],v201,16384
trr a[226:227],v201,18432
mf a[180:183],a[232:235],v[148:151],a[180:183]
v_add_u32 v203,0xffff0000,v203
trr a[228:229],v202,16384
mf a[184:187],a[236:239],v[144:147],a[184:187]
trr a[230:231],v202,18432
mf a[188:191],a[236:239],v[148:151],a[188:191]
s_waitcnt lgkmcnt(8)
v_add_u32 v204,0xffff0000,v204
mf a[160:163],a[240:243],v[152:155],a[160:163]
trr a[232:233],v203,16384
trr a[234:235],v203,18432
mf a[164:167],a[240:243],v[156:159],a[164:167]
trr a[236:237],v204,16384
mf a[168:171],a[244:247],v[152:155],a[168:171]
trr a[238:239],v204,18432
mf a[172:175],a[244:247],v[156:159],a[172:175]
s_waitcnt lgkmcnt(8)
trr a[240:241],v201,20480
mf a[176:179],a[248:251],v[152:155],a[176:179]
trr a[242:243],v201,22528
mf a[180:183],a[248:251],v[156:159],a[180:183]
trr a[244:245],v202,20480
mf a[184:187],a[252:255],v[152:155],a[184:187]
trr a[246:247],v202,22528
mf a[188:191],a[252:255],v[156:159],a[188:191]
s_waitcnt lgkmcnt(8)
trr a[248:249],v203,20480
mf a[192:195],a[224:227],v[128:131],0
trr a[250:251],v203,22528
mf a[196:199],a[224:227],v[132:135],0
trr a[252:253],v204,20480
mf a[200:203],a[228:231],v[128:131],0
trr a[254:255],v204,22528
mf a[204:207],a[228:231],v[132:135],0
s_waitcnt lgkmcnt(8)
trr a[224:225],v201,24576
mf a[208:211],a[232:235],v[128:131],0
trr a[226:227],v201,26624
mf a[212:215],a[232:235],v[132:135],0
trr a[228:229],v202,24576
mf a[216:219],a[236:239],v[128:131],0
trr a[230:231],v202,26624
mf a[220:223],a[236:239],v[132:135],0
s_waitcnt lgkmcnt(8)
trr a[232:233],v203,24576
mf a[192:195],a[240:243],v[136:139],a[192:195]
trr a[234:235],v203,26624
mf a[196:199],a[240:243],v[140:143],a[196:199]
trr a[236:237],v204,24576
mf a[200:203],a[244:247],v[136:139],a[200:203]
trr a[238:239],v204,26624
mf a[204:207],a[244:247],v[140:143],a[204:207]
s_waitcnt lgkmcnt(8)
trr a[240:241],v201,28672
mf a[208:211],a[248:251],v[136:139],a[208:211]
trr a[242:243],v201,30720
mf a[212:215],a[248:251],v[140:143],a[212:215]
trr a[244:245],v202,28672
mf a[216:219],a[252:255],v[136:139],a[216:219]
trr a[246:247],v202,30720
mf a[220:223],a[252:255],v[140:143],a[220:223]
s_waitcnt lgkmcnt(8)
trr a[248:249],v203,28672
mf a[192:195],a[224:227],v[144:147],a[192:195]
trr a[250:251],v203,30720
mf a[196:199],a[224:227],v[148:151],a[196:199]
v_add_u32 v193,0x10000,v193
trr a[252:253],v204,28672
mf a[200:203],a[228:231],v[144:147],a[200:203]
trr a[254:255],v204,30720
mf a[204:207],a[228:231],v[148:151],a[204:207]
s_waitcnt lgkmcnt(8)
s_barrier
mf a[208:211],a[232:235],v[144:147],a[208:211]
v_add_u32 v194,0x10000,v194
trr a[224:225],v193,0
trr a[226:227],v193,4096
mf a[212:215],a[232:235],v[148:151],a[212:215]
v_add_u32 v195,0x10000,v195
trr a[228:229],v194,0
trr a[230:231],v194,4096
mf a[216:219],a[236:239],v[144:147],a[216:219]
s_add_u32 m0,s49,49152
s_add_u32 s48,s51,164096
buffer_load_dwordx4 v212,s[28:31],s48 offen nt lds
mf a[220:223],a[236:239],v[148:151],a[220:223]
s_waitcnt lgkmcnt(8)
v_add_u32 v196,0x10000,v196
mf a[192:195],a[240:243],v[152:155],a[192:195]
trr a[232:233],v195,0
trr a[234:235],v195,4096
mf a[196:199],a[240:243],v[156:159],a[196:199]
v_add_u32 v197,0x10000,v197
trr a[236:237],v196,0
mf a[200:203],a[244:247],v[152:155],a[200:203]
trr a[238:239],v196,4096
mf a[204:207],a[244:247],v[156:159],a[204:207]
s_waitcnt lgkmcnt(8)
v_add_u32 v198,0x10000,v198
trr a[240:241],v197,0
mf a[208:211],a[248:251],v[152:155],a[208:211]
trr a[242:243],v197,4096
buffer_load_dwordx4 v213,s[28:31],s48 offen offset:1024 nt lds
mf a[212:215],a[248:251],v[156:159],a[212:215]
v_add_u32 v199,0x10000,v199
trr a[244:245],v198,0
mf a[216:219],a[252:255],v[152:155],a[216:219]
trr a[246:247],v198,4096
mf a[220:223],a[252:255],v[156:159],a[220:223]
s_waitcnt lgkmcnt(8)
v_add_u32 v200,0x10000,v200
mf v[128:131],a[224:227],v[0:3],0
trr a[248:249],v199,0
trr a[250:251],v199,4096
mf v[132:135],a[224:227],v[4:7],0
trr a[252:253],v200,0
trr a[254:255],v200,4096
mf v[136:139],a[228:231],v[0:3],0
buffer_load_dwordx4 v214,s[28:31],s48 offen offset:2048 nt lds
mf v[140:143],a[228:231],v[4:7],0
s_waitcnt lgkmcnt(8)
trr a[224:225],v193,8192
mf v[144:147],a[232:235],v[0:3],0
trr a[226:227],v193,12288
mf v[148:151],a[232:235],v[4:7],0
trr a[228:229],v194,8192
mf v[152:155],a[236:239],v[0:3],0
trr a[230:231],v194,12288
mf v[156:159],a[236:239],v[4:7],0
s_waitcnt lgkmcnt(8)
trr a[232:233],v195,8192
mf v[160:163],a[240:243],v[0:3],0
trr a[234:235],v195,12288
buffer_load_dwordx4 v215,s[28:31],s48 offen offset:3072 nt lds
mf v[164:167],a[240:243],v[4:7],0
trr a[236:237],v196,8192
mf v[168:171],a[244:247],v[0:3],0
trr a[238:239],v196,12288
mf v[172:175],a[244:247],v[4:7],0
s_waitcnt lgkmcnt(8)
trr a[240:241],v197,8192
mf v[176:179],a[248:251],v[0:3],0
trr a[242:243],v197,12288
mf v[180:183],a[248:251],v[4:7],0
trr a[244:245],v198,8192
mf v[184:187],a[252:255],v[0:3],0
trr a[246:247],v198,12288
mf v[188:191],a[252:255],v[4:7],0
s_waitcnt lgkmcnt(8)
trr a[248:249],v199,8192
mf v[128:131],a[224:227],v[8:11],v[128:131]
trr a[250:251],v199,12288
mf v[132:135],a[224:227],v[12:15],v[132:135]
trr a[252:253],v200,8192
mf v[136:139],a[228:231],v[8:11],v[136:139]
trr a[254:255],v200,12288
mf v[140:143],a[228:231],v[12:15],v[140:143]
s_waitcnt lgkmcnt(8)
s_barrier
mf v[144:147],a[232:235],v[8:11],v[144:147]
trr a[224:225],v193,16384
trr a[226:227],v193,20480
mf v[148:151],a[232:235],v[12:15],v[148:151]
trr a[228:229],v194,16384
trr a[230:231],v194,20480
s_add_u32 m0,s49,16384
mf v[152:155],a[236:239],v[8:11],v[152:155]
s_add_u32 s48,s53,s92
s_add_u32 s48,s48,114688
buffer_load_dwordx4 v216,s[36:39],s48 offen lds
mf v[156:159],a[236:239],v[12:15],v[156:159]
s_waitcnt lgkmcnt(8)
trr a[232:233],v195,16384
mf v[160:163],a[240:243],v[8:11],v[160:163]
trr a[234:235],v195,20480
buffer_load_dwordx4 v217,s[36:39],s48 offen offset:1024 lds
mf v[164:167],a[240:243],v[12:15],v[164:167]
trr a[236:237],v196,16384
trr a[238:239],v196,20480
mf v[168:171],a[244:247],v[8:11],v[168:171]
buffer_load_dwordx4 v218,s[36:39],s48 offen offset:2048 lds
mf v[172:175],a[244:247],v[12:15],v[172:175]
s_waitcnt lgkmcnt(8)
trr a[240:241],v197,16384
mf v[176:179],a[248:251],v[8:11],v[176:179]
trr a[242:243],v197,20480
buffer_load_dwordx4 v219,s[36:39],s48 offen offset:3072 lds
mf v[180:183],a[248:251],v[12:15],v[180:183]
trr a[244:245],v198,16384
trr a[246:247],v198,20480
s_add_u32 m0,s49,81920
mf v[184:187],a[252:255],v[8:11],v[184:187]
s_add_u32 s48,s51,196864
buffer_load_dwordx4 v212,s[28:31],s48 offen nt lds
mf v[188:191],a[252:255],v[12:15],v[188:191]
s_waitcnt lgkmcnt(8)
trr a[248:249],v199,16384
mf v[128:131],a[224:227],v[16:19],v[128:131]
trr a[250:251],v199,20480
buffer_load_dwordx4 v213,s[28:31],s48 offen offset:1024 nt lds
mf v[132:135],a[224:227],v[20:23],v[132:135]
trr a[252:253],v200,16384
trr a[254:255],v200,20480
mf v[136:139],a[228:231],v[16:19],v[136:139]
buffer_load_dwordx4 v214,s[28:31],s48 offen offset:2048 nt lds
mf v[140:143],a[228:231],v[20:23],v[140:143]
s_waitcnt lgkmcnt(8)
trr a[224:225],v193,24576
mf v[144:147],a[232:235],v[16:19],v[144:147]
trr a[226:227],v193,28672
buffer_load_dwordx4 v215,s[28:31],s48 offen offset:3072 nt lds
mf v[148:151],a[232:235],v[20:23],v[148:151]
trr a[228:229],v194,24576
mf v[152:155],a[236:239],v[16:19],v[152:155]
trr a[230:231],v194,28672
mf v[156:159],a[236:239],v[20:23],v[156:159]
s_waitcnt lgkmcnt(8)
trr a[232:233],v195,24576
mf v[160:163],a[240:243],v[16:19],v[160:163]
trr a[234:235],v195,28672
mf v[164:167],a[240:243],v[20:23],v[164:167]
trr a[236:237],v196,24576
mf v[168:171],a[244:247],v[16:19],v[168:171]
trr a[238:239],v196,28672
mf v[172:175],a[244:247],v[20:23],v[172:175]
s_waitcnt lgkmcnt(8)
trr a[240:241],v197,24576
mf v[176:179],a[248:251],v[16:19],v[176:179]
trr a[242:243],v197,28672
mf v[180:183],a[248:251],v[20:23],v[180:183]
trr a[244:245],v198,24576
mf v[184:187],a[252:255],v[16:19],v[184:187]
trr a[246:247],v198,28672
mf v[188:191],a[252:255],v[20:23],v[188:191]
s_waitcnt lgkmcnt(8)
trr a[248:249],v199,24576
mf v[128:131],a[224:227],v[24:27],v[128:131]
trr a[250:251],v199,28672
mf v[132:135],a[224:227],v[28:31],v[132:135]
v_add_u32 v193,0xffff0000,v193
trr a[252:253],v200,24576
mf v[136:139],a[228:231],v[24:27],v[136:139]
trr a[254:255],v200,28672
mf v[140:143],a[228:231],v[28:31],v[140:143]
s_waitcnt lgkmcnt(8)
s_waitcnt vmcnt(20)
s_barrier
mf v[144:147],a[232:235],v[24:27],v[144:147]
v_add_u32 v194,0xffff0000,v194
trr a[224:225],v193,0
trr a[226:227],v193,4096
mf v[148:151],a[232:235],v[28:31],v[148:151]
v_add_u32 v195,0xffff0000,v195
trr a[228:229],v194,0
mf v[152:155],a[236:239],v[24:27],v[152:155]
trr a[230:231],v194,4096
mf v[156:159],a[236:239],v[28:31],v[156:159]
s_waitcnt lgkmcnt(8)
v_add_u32 v196,0xffff0000,v196
mf v[160:163],a[240:243],v[24:27],v[160:163]
trr a[232:233],v195,0
trr a[234:235],v195,4096
mf v[164:167],a[240:243],v[28:31],v[164:167]
v_add_u32 v197,0xffff0000,v197
trr a[236:237],v196,0
mf v[168:171],a[244:247],v[24:27],v[168:171]
trr a[238:239],v196,4096
mf v[172:175],a[244:247],v[28:31],v[172:175]
s_waitcnt lgkmcnt(8)
v_add_u32 v198,0xffff0000,v198
mf v[176:179],a[248:251],v[24:27],v[176:179]
trr a[240:241],v197,0
trr a[242:243],v197,4096
mf v[180:183],a[248:251],v[28:31],v[180:183]
v_add_u32 v199,0xffff0000,v199
trr a[244:245],v198,0
mf v[184:187],a[252:255],v[24:27],v[184:187]
trr a[246:247],v198,4096
mf v[188:191],a[252:255],v[28:31],v[188:191]
s_waitcnt lgkmcnt(8)
v_add_u32 v200,0xffff0000,v200
mf v[128:131],a[224:227],v[32:35],v[128:131]
trr a[248:249],v199,0
trr a[250:251],v199,4096
mf v[132:135],a[224:227],v[36:39],v[132:135]
trr a[252:253],v200,0
mf v[136:139],a[228:231],v[32:35],v[136:139]
trr a[254:255],v200,4096
mf v[140:143],a[228:231],v[36:39],v[140:143]
s_waitcnt lgkmcnt(8)
trr a[224:225],v193,8192
mf v[144:147],a[232:235],v[32:35],v[144:147]
trr a[226:227],v193,12288
mf v[148:151],a[232:235],v[36:39],v[148:151]
trr a[228:229],v194,8192
mf v[152:155],a[236:239],v[32:35],v[152:155]
trr a[230:231],v194,12288
mf v[156:159],a[236:239],v[36:39],v[156:159]
s_waitcnt lgkmcnt(8)
trr a[232:233],v195,8192
mf v[160:163],a[240:243],v[32:35],v[160:163]
trr a[234:235],v195,12288
mf v[164:167],a[240:243],v[36:39],v[164:167]
trr a[236:237],v196,8192
mf v[168:171],a[244:247],v[32:35],v[168:171]
trr a[238:239],v196,12288
mf v[172:175],a[244:247],v[36:39],v[172:175]
s_waitcnt lgkmcnt(8)
trr a[240:241],v197,8192
mf v[176:179],a[248:251],v[32:35],v[176:179]
trr a[242:243],v197,12288
mf v[180:183],a[248:251],v[36:39],v[180:183]
trr a[244:245],v198,8192
mf v[184:187],a[252:255],v[32:35],v[184:187]
trr a[246:247],v198,12288
mf v[188:191],a[252:255],v[36:39],v[188:191]
s_waitcnt lgkmcnt(8)
trr a[248:249],v199,8192
mf v[128:131],a[224:227],v[40:43],v[128:131]
trr a[250:251],v199,12288
mf v[132:135],a[224:227],v[44:47],v[132:135]
v_add_u32 v193,0xffff0000,v193
trr a[252:253],v200,8192
mf v[136:139],a[228:231],v[40:43],v[136:139]
trr a[254:255],v200,12288
mf v[140:143],a[228:231],v[44:47],v[140:143]
s_waitcnt lgkmcnt(8)
s_waitcnt vmcnt(16)
s_barrier
mf v[144:147],a[232:235],v[40:43],v[144:147]
v_add_u32 v194,0xffff0000,v194
trr a[224:225],v193,0
trr a[226:227],v193,4096
mf v[148:151],a[232:235],v[44:47],v[148:151]
v_add_u32 v195,0xffff0000,v195
trr a[228:229],v194,0
trr a[230:231],v194,4096
mf v[152:155],a[236:239],v[40:43],v[152:155]
s_add_u32 m0,s49,98304
s_add_u32 s48,s51,229632
buffer_load_dwordx4 v212,s[28:31],s48 offen nt lds
mf v[156:159],a[236:239],v[44:47],v[156:159]
s_waitcnt lgkmcnt(8)
v_add_u32 v196,0xffff0000,v196
mf v[160:163],a[240:243],v[40:43],v[160:163]
trr a[232:233],v195,0
trr a[234:235],v195,4096
mf v[164:167],a[240:243],v[44:47],v[164:167]
v_add_u32 v197,0xffff0000,v197
trr a[236:237],v196,0
mf v[168:171],a[244:247],v[40:43],v[168:171]
trr a[238:239],v196,4096
mf v[172:175],a[244:247],v[44:47],v[172:175]
s_waitcnt lgkmcnt(8)
v_add_u32 v198,0xffff0000,v198
trr a[240:241],v197,0
mf v[176:179],a[248:251],v[40:43],v[176:179]
trr a[242:243],v197,4096
buffer_load_dwordx4 v213,s[28:31],s48 offen offset:1024 nt lds
mf v[180:183],a[248:251],v[44:47],v[180:183]
v_add_u32 v199,0xffff0000,v199
trr a[244:245],v198,0
mf v[184:187],a[252:255],v[40:43],v[184:187]
trr a[246:247],v198,4096
mf v[188:191],a[252:255],v[44:47],v[188:191]
s_waitcnt lgkmcnt(8)
v_add_u32 v200,0xffff0000,v200
mf v[128:131],a[224:227],v[48:51],v[128:131]
trr a[248:249],v199,0
trr a[250:251],v199,4096
mf v[132:135],a[224:227],v[52:55],v[132:135]
trr a[252:253],v200,0
trr a[254:255],v200,4096
mf v[136:139],a[228:231],v[48:51],v[136:139]
buffer_load_dwordx4 v214,s[28:31],s48 offen offset:2048 nt lds
mf v[140:143],a[228:231],v[52:55],v[140:143]
s_waitcnt lgkmcnt(8)
trr a[224:225],v193,8192
mf v[144:147],a[232:235],v[48:51],v[144:147]
trr a[226:227],v193,12288
mf v[148:151],a[232:235],v[52:55],v[148:151]
trr a[228:229],v194,8192
mf v[152:155],a[236:239],v[48:51],v[152:155]
trr a[230:231],v194,12288
mf v[156:159],a[236:239],v[52:55],v[156:159]
s_waitcnt lgkmcnt(8)
trr a[232:233],v195,8192
mf v[160:163],a[240:243],v[48:51],v[160:163]
trr a[234:235],v195,12288
buffer_load_dwordx4 v215,s[28:31],s48 offen offset:3072 nt lds
mf v[164:167],a[240:243],v[52:55],v[164:167]
trr a[236:237],v196,8192
mf v[168:171],a[244:247],v[48:51],v[168:171]
trr a[238:239],v196,12288
mf v[172:175],a[244:247],v[52:55],v[172:175]
s_waitcnt lgkmcnt(8)
trr a[240:241],v197,8192
mf v[176:179],a[248:251],v[48:51],v[176:179]
trr a[242:243],v197,12288
mf v[180:183],a[248:251],v[52:55],v[180:183]
trr a[244:245],v198,8192
mf v[184:187],a[252:255],v[48:51],v[184:187]
trr a[246:247],v198,12288
mf v[188:191],a[252:255],v[52:55],v[188:191]
s_waitcnt lgkmcnt(8)
trr a[248:249],v199,8192
mf v[128:131],a[224:227],v[56:59],v[128:131]
trr a[250:251],v199,12288
mf v[132:135],a[224:227],v[60:63],v[132:135]
trr a[252:253],v200,8192
mf v[136:139],a[228:231],v[56:59],v[136:139]
trr a[254:255],v200,12288
mf v[140:143],a[228:231],v[60:63],v[140:143]
s_waitcnt lgkmcnt(8)
s_waitcnt vmcnt(16)
s_barrier
mf v[144:147],a[232:235],v[56:59],v[144:147]
trr a[224:225],v193,32768
trr a[226:227],v193,36864
mf v[148:151],a[232:235],v[60:63],v[148:151]
trr a[228:229],v194,32768
mf v[152:155],a[236:239],v[56:59],v[152:155]
trr a[230:231],v194,36864
mf v[156:159],a[236:239],v[60:63],v[156:159]
s_waitcnt lgkmcnt(8)
trr a[232:233],v195,32768
mf v[160:163],a[240:243],v[56:59],v[160:163]
trr a[234:235],v195,36864
mf v[164:167],a[240:243],v[60:63],v[164:167]
trr a[236:237],v196,32768
mf v[168:171],a[244:247],v[56:59],v[168:171]
trr a[238:239],v196,36864
mf v[172:175],a[244:247],v[60:63],v[172:175]
s_waitcnt lgkmcnt(8)
trr a[240:241],v197,32768
mf v[176:179],a[248:251],v[56:59],v[176:179]
trr a[242:243],v197,36864
mf v[180:183],a[248:251],v[60:63],v[180:183]
trr a[244:245],v198,32768
mf v[184:187],a[252:255],v[56:59],v[184:187]
trr a[246:247],v198,36864
mf v[188:191],a[252:255],v[60:63],v[188:191]
s_waitcnt lgkmcnt(8)
trr a[248:249],v199,32768
mf v[128:131],a[224:227],v[64:67],v[128:131]
trr a[250:251],v199,36864
mf v[132:135],a[224:227],v[68:71],v[132:135]
trr a[252:253],v200,32768
mf v[136:139],a[228:231],v[64:67],v[136:139]
trr a[254:255],v200,36864
mf v[140:143],a[228:231],v[68:71],v[140:143]
s_waitcnt lgkmcnt(8)
trr a[224:225],v193,40960
mf v[144:147],a[232:235],v[64:67],v[144:147]
trr a[226:227],v193,45056
mf v[148:151],a[232:235],v[68:71],v[148:151]
trr a[228:229],v194,40960
mf v[152:155],a[236:239],v[64:67],v[152:155]
trr a[230:231],v194,45056
mf v[156:159],a[236:239],v[68:71],v[156:159]
s_waitcnt lgkmcnt(8)
trr a[232:233],v195,40960
mf v[160:163],a[240:243],v[64:67],v[160:163]
trr a[234:235],v195,45056
mf v[164:167],a[240:243],v[68:71],v[164:167]
trr a[236:237],v196,40960
mf v[168:171],a[244:247],v[64:67],v[168:171]
trr a[238:239],v196,45056
mf v[172:175],a[244:247],v[68:71],v[172:175]
s_waitcnt lgkmcnt(8)
trr a[240:241],v197,40960
mf v[176:179],a[248:251],v[64:67],v[176:179]
trr a[242:243],v197,45056
mf v[180:183],a[248:251],v[68:71],v[180:183]
trr a[244:245],v198,40960
mf v[184:187],a[252:255],v[64:67],v[184:187]
trr a[246:247],v198,45056
mf v[188:191],a[252:255],v[68:71],v[188:191]
s_waitcnt lgkmcnt(8)
trr a[248:249],v199,40960
mf v[128:131],a[224:227],v[72:75],v[128:131]
trr a[250:251],v199,45056
mf v[132:135],a[224:227],v[76:79],v[132:135]
trr a[252:253],v200,40960
mf v[136:139],a[228:231],v[72:75],v[136:139]
trr a[254:255],v200,45056
mf v[140:143],a[228:231],v[76:79],v[140:143]
s_waitcnt lgkmcnt(8)
s_waitcnt vmcnt(12)
s_barrier
mf v[144:147],a[232:235],v[72:75],v[144:147]
trr a[224:225],v193,49152
trr a[226:227],v193,53248
mf v[148:151],a[232:235],v[76:79],v[148:151]
trr a[228:229],v194,49152
trr a[230:231],v194,53248
s_add_u32 m0,s49,0
mf v[152:155],a[236:239],v[72:75],v[152:155]
s_add_u32 s48,s53,s93
s_add_u32 s48,s48,114688
buffer_load_dwordx4 v216,s[36:39],s48 offen lds
mf v[156:159],a[236:239],v[76:79],v[156:159]
s_waitcnt lgkmcnt(8)
trr a[232:233],v195,49152
mf v[160:163],a[240:243],v[72:75],v[160:163]
trr a[234:235],v195,53248
mf v[164:167],a[240:243],v[76:79],v[164:167]
trr a[236:237],v196,49152
mf v[168:171],a[244:247],v[72:75],v[168:171]
trr a[238:239],v196,53248
mf v[172:175],a[244:247],v[76:79],v[172:175]
s_waitcnt lgkmcnt(8)
trr a[240:241],v197,49152
mf v[176:179],a[248:251],v[72:75],v[176:179]
trr a[242:243],v197,53248
buffer_load_dwordx4 v217,s[36:39],s48 offen offset:1024 lds
mf v[180:183],a[248:251],v[76:79],v[180:183]
trr a[244:245],v198,49152
mf v[184:187],a[252:255],v[72:75],v[184:187]
trr a[246:247],v198,53248
mf v[188:191],a[252:255],v[76:79],v[188:191]
s_waitcnt lgkmcnt(8)
trr a[248:249],v199,49152
mf v[128:131],a[224:227],v[80:83],v[128:131]
trr a[250:251],v199,53248
mf v[132:135],a[224:227],v[84:87],v[132:135]
trr a[252:253],v200,49152
trr a[254:255],v200,53248
mf v[136:139],a[228:231],v[80:83],v[136:139]
buffer_load_dwordx4 v218,s[36:39],s48 offen offset:2048 lds
mf v[140:143],a[228:231],v[84:87],v[140:143]
s_waitcnt lgkmcnt(8)
trr a[224:225],v193,57344
mf v[144:147],a[232:235],v[80:83],v[144:147]
trr a[226:227],v193,61440
mf v[148:151],a[232:235],v[84:87],v[148:151]
trr a[228:229],v194,57344
mf v[152:155],a[236:239],v[80:83],v[152:155]
trr a[230:231],v194,61440
mf v[156:159],a[236:239],v[84:87],v[156:159]
s_waitcnt lgkmcnt(8)
trr a[232:233],v195,57344
mf v[160:163],a[240:243],v[80:83],v[160:163]
trr a[234:235],v195,61440
buffer_load_dwordx4 v219,s[36:39],s48 offen offset:3072 lds
mf v[164:167],a[240:243],v[84:87],v[164:167]
trr a[236:237],v196,57344
mf v[168:171],a[244:247],v[80:83],v[168:171]
trr a[238:239],v196,61440
mf v[172:175],a[244:247],v[84:87],v[172:175]
s_waitcnt lgkmcnt(8)
trr a[240:241],v197,57344
mf v[176:179],a[248:251],v[80:83],v[176:179]
trr a[242:243],v197,61440
mf v[180:183],a[248:251],v[84:87],v[180:183]
trr a[244:245],v198,57344
mf v[184:187],a[252:255],v[80:83],v[184:187]
trr a[246:247],v198,61440
mf v[188:191],a[252:255],v[84:87],v[188:191]
s_waitcnt lgkmcnt(8)
trr a[248:249],v199,57344
mf v[128:131],a[224:227],v[88:91],v[128:131]
trr a[250:251],v199,61440
mf v[132:135],a[224:227],v[92:95],v[132:135]
v_add_u32 v193,0x10000,v193
trr a[252:253],v200,57344
mf v[136:139],a[228:231],v[88:91],v[136:139]
trr a[254:255],v200,61440
mf v[140:143],a[228:231],v[92:95],v[140:143]
s_waitcnt lgkmcnt(8)
s_waitcnt vmcnt(8)
s_barrier
mf v[144:147],a[232:235],v[88:91],v[144:147]
v_add_u32 v194,0x10000,v194
trr a[224:225],v193,16384
trr a[226:227],v193,20480
mf v[148:151],a[232:235],v[92:95],v[148:151]
v_add_u32 v195,0x10000,v195
trr a[228:229],v194,16384
mf v[152:155],a[236:239],v[88:91],v[152:155]
trr a[230:231],v194,20480
mf v[156:159],a[236:239],v[92:95],v[156:159]
s_waitcnt lgkmcnt(8)
v_add_u32 v196,0x10000,v196
mf v[160:163],a[240:243],v[88:91],v[160:163]
trr a[232:233],v195,16384
trr a[234:235],v195,20480
mf v[164:167],a[240:243],v[92:95],v[164:167]
v_add_u32 v197,0x10000,v197
trr a[236:237],v196,16384
mf v[168:171],a[244:247],v[88:91],v[168:171]
trr a[238:239],v196,20480
mf v[172:175],a[244:247],v[92:95],v[172:175]
s_waitcnt lgkmcnt(8)
v_add_u32 v198,0x10000,v198
mf v[176:179],a[248:251],v[88:91],v[176:179]
trr a[240:241],v197,16384
trr a[242:243],v197,20480
mf v[180:183],a[248:251],v[92:95],v[180:183]
v_add_u32 v199,0x10000,v199
trr a[244:245],v198,16384
mf v[184:187],a[252:255],v[88:91],v[184:187]
trr a[246:247],v198,20480
mf v[188:191],a[252:255],v[92:95],v[188:191]
s_waitcnt lgkmcnt(8)
v_add_u32 v200,0x10000,v200
mf v[128:131],a[224:227],v[96:99],v[128:131]
trr a[248:249],v199,16384
trr a[250:251],v199,20480
mf v[132:135],a[224:227],v[100:103],v[132:135]
trr a[252:253],v200,16384
mf v[136:139],a[228:231],v[96:99],v[136:139]
trr a[254:255],v200,20480
mf v[140:143],a[228:231],v[100:103],v[140:143]
s_waitcnt lgkmcnt(8)
trr a[224:225],v193,24576
mf v[144:147],a[232:235],v[96:99],v[144:147]
trr a[226:227],v193,28672
mf v[148:151],a[232:235],v[100:103],v[148:151]
trr a[228:229],v194,24576
mf v[152:155],a[236:239],v[96:99],v[152:155]
trr a[230:231],v194,28672
mf v[156:159],a[236:239],v[100:103],v[156:159]
s_waitcnt lgkmcnt(8)
trr a[232:233],v195,24576
mf v[160:163],a[240:243],v[96:99],v[160:163]
trr a[234:235],v195,28672
mf v[164:167],a[240:243],v[100:103],v[164:167]
trr a[236:237],v196,24576
mf v[168:171],a[244:247],v[96:99],v[168:171]
trr a[238:239],v196,28672
mf v[172:175],a[244:247],v[100:103],v[172:175]
s_waitcnt lgkmcnt(8)
trr a[240:241],v197,24576
mf v[176:179],a[248:251],v[96:99],v[176:179]
trr a[242:243],v197,28672
mf v[180:183],a[248:251],v[100:103],v[180:183]
trr a[244:245],v198,24576
mf v[184:187],a[252:255],v[96:99],v[184:187]
trr a[246:247],v198,28672
mf v[188:191],a[252:255],v[100:103],v[188:191]
s_waitcnt lgkmcnt(8)
trr a[248:249],v199,24576
mf v[128:131],a[224:227],v[104:107],v[128:131]
trr a[250:251],v199,28672
mf v[132:135],a[224:227],v[108:111],v[132:135]
trr a[252:253],v200,24576
mf v[136:139],a[228:231],v[104:107],v[136:139]
trr a[254:255],v200,28672
mf v[140:143],a[228:231],v[108:111],v[140:143]
s_waitcnt lgkmcnt(8)
s_waitcnt vmcnt(4)
s_barrier
mf v[144:147],a[232:235],v[104:107],v[144:147]
trr a[224:225],v193,32768
trr a[226:227],v193,36864
mf v[148:151],a[232:235],v[108:111],v[148:151]
trr a[228:229],v194,32768
trr a[230:231],v194,36864
s_add_u32 m0,s49,32768
mf v[152:155],a[236:239],v[104:107],v[152:155]
s_add_u32 s48,s53,s94
s_add_u32 s48,s48,114688
buffer_load_dwordx4 v216,s[36:39],s48 offen lds
mf v[156:159],a[236:239],v[108:111],v[156:159]
s_waitcnt lgkmcnt(8)
trr a[232:233],v195,32768
mf v[160:163],a[240:243],v[104:107],v[160:163]
trr a[234:235],v195,36864
buffer_load_dwordx4 v217,s[36:39],s48 offen offset:1024 lds
mf v[164:167],a[240:243],v[108:111],v[164:167]
trr a[236:237],v196,32768
trr a[238:239],v196,36864
mf v[168:171],a[244:247],v[104:107],v[168:171]
buffer_load_dwordx4 v218,s[36:39],s48 offen offset:2048 lds
mf v[172:175],a[244:247],v[108:111],v[172:175]
s_waitcnt lgkmcnt(8)
trr a[240:241],v197,32768
mf v[176:179],a[248:251],v[104:107],v[176:179]
trr a[242:243],v197,36864
buffer_load_dwordx4 v219,s[36:39],s48 offen offset:3072 lds
mf v[180:183],a[248:251],v[108:111],v[180:183]
trr a[244:245],v198,32768
trr a[246:247],v198,36864
s_add_u32 m0,s49,49152
mf v[184:187],a[252:255],v[104:107],v[184:187]
s_add_u32 s48,s53,s95
s_add_u32 s48,s48,114688
buffer_load_dwordx4 v216,s[36:39],s48 offen lds
mf v[188:191],a[252:255],v[108:111],v[188:191]
s_waitcnt lgkmcnt(8)
trr a[248:249],v199,32768
mf v[128:131],a[224:227],v[112:115],v[128:131]
trr a[250:251],v199,36864
buffer_load_dwordx4 v217,s[36:39],s48 offen offset:1024 lds
mf v[132:135],a[224:227],v[116:119],v[132:135]
trr a[252:253],v200,32768
trr a[254:255],v200,36864
mf v[136:139],a[228:231],v[112:115],v[136:139]
buffer_load_dwordx4 v218,s[36:39],s48 offen offset:2048 lds
mf v[140:143],a[228:231],v[116:119],v[140:143]
s_waitcnt lgkmcnt(8)
trr a[224:225],v193,40960
mf v[144:147],a[232:235],v[112:115],v[144:147]
trr a[226:227],v193,45056
buffer_load_dwordx4 v219,s[36:39],s48 offen offset:3072 lds
mf v[148:151],a[232:235],v[116:119],v[148:151]
trr a[228:229],v194,40960
mf v[152:155],a[236:239],v[112:115],v[152:155]
trr a[230:231],v194,45056
mf v[156:159],a[236:239],v[116:119],v[156:159]
s_waitcnt lgkmcnt(8)
trr a[232:233],v195,40960
mf v[160:163],a[240:243],v[112:115],v[160:163]
trr a[234:235],v195,45056
mf v[164:167],a[240:243],v[116:119],v[164:167]
trr a[236:237],v196,40960
mf v[168:171],a[244:247],v[112:115],v[168:171]
trr a[238:239],v196,45056
mf v[172:175],a[244:247],v[116:119],v[172:175]
s_waitcnt lgkmcnt(8)
trr a[240:241],v197,40960
mf v[176:179],a[248:251],v[112:115],v[176:179]
trr a[242:243],v197,45056
mf v[180:183],a[248:251],v[116:119],v[180:183]
trr a[244:245],v198,40960
mf v[184:187],a[252:255],v[112:115],v[184:187]
trr a[246:247],v198,45056
mf v[188:191],a[252:255],v[116:119],v[188:191]
s_waitcnt lgkmcnt(8)
trr a[248:249],v199,40960
mf v[128:131],a[224:227],v[120:123],v[128:131]
trr a[250:251],v199,45056
mf v[132:135],a[224:227],v[124:127],v[132:135]
trr a[252:253],v200,40960
mf v[136:139],a[228:231],v[120:123],v[136:139]
trr a[254:255],v200,45056
mf v[140:143],a[228:231],v[124:127],v[140:143]
s_waitcnt lgkmcnt(8)
s_barrier
mf v[144:147],a[232:235],v[120:123],v[144:147]
trr a[224:225],v201,16384
trr a[226:227],v201,18432
mf v[148:151],a[232:235],v[124:127],v[148:151]
trr a[228:229],v202,16384
trr a[230:231],v202,18432
s_add_u32 m0,s49,65536
mf v[152:155],a[236:239],v[120:123],v[152:155]
s_add_u32 s48,s53,s96
s_add_u32 s48,s48,114688
buffer_load_dwordx4 v216,s[36:39],s48 offen lds
mf v[156:159],a[236:239],v[124:127],v[156:159]
s_waitcnt lgkmcnt(8)
trr a[232:233],v203,16384
mf v[160:163],a[240:243],v[120:123],v[160:163]
trr a[234:235],v203,18432
buffer_load_dwordx4 v217,s[36:39],s48 offen offset:1024 lds
mf v[164:167],a[240:243],v[124:127],v[164:167]
trr a[236:237],v204,16384
trr a[238:239],v204,18432
mf v[168:171],a[244:247],v[120:123],v[168:171]
buffer_load_dwordx4 v218,s[36:39],s48 offen offset:2048 lds
mf v[172:175],a[244:247],v[124:127],v[172:175]
s_waitcnt lgkmcnt(8)
trr a[240:241],v201,20480
mf v[176:179],a[248:251],v[120:123],v[176:179]
trr a[242:243],v201,22528
buffer_load_dwordx4 v219,s[36:39],s48 offen offset:3072 lds
mf v[180:183],a[248:251],v[124:127],v[180:183]
trr a[244:245],v202,20480
trr a[246:247],v202,22528
s_add_u32 m0,s49,81920
mf v[184:187],a[252:255],v[120:123],v[184:187]
s_add_u32 s48,s53,s97
s_add_u32 s48,s48,114688
buffer_load_dwordx4 v216,s[36:39],s48 offen lds
mf v[188:191],a[252:255],v[124:127],v[188:191]
s_waitcnt lgkmcnt(8)
trr a[248:249],v203,20480
trr a[250:251],v203,22528
buffer_load_dwordx4 v217,s[36:39],s48 offen offset:1024 lds
v_mul_f32 v128,v128,v224
v_mul_f32 v129,v129,v224
v_mul_f32 v130,v130,v224
v_mul_f32 v131,v131,v224
v_mul_f32 v136,v136,v224
v_mul_f32 v137,v137,v224
v_mul_f32 v138,v138,v224
v_mul_f32 v139,v139,v224
v_mul_f32 v132,v132,v225
v_mul_f32 v133,v133,v225
v_mul_f32 v134,v134,v225
v_mul_f32 v135,v135,v225
v_mul_f32 v140,v140,v225
v_mul_f32 v141,v141,v225
v_mul_f32 v142,v142,v225
v_mul_f32 v143,v143,v225
cvp v128,v128,v129
cvp v129,v130,v131
cvp v130,v136,v137
cvp v131,v138,v139
cvp v132,v132,v133
cvp v133,v134,v135
cvp v134,v140,v141
cvp v135,v142,v143
mf a[0:3],a[224:227],v[128:131],a[0:3]
s_nop 0
mf a[4:7],a[224:227],v[132:135],a[4:7]
trr a[252:253],v204,20480
trr a[254:255],v204,22528
buffer_load_dwordx4 v218,s[36:39],s48 offen offset:2048 lds
v_mul_f32 v144,v144,v224
v_mul_f32 v145,v145,v224
v_mul_f32 v146,v146,v224
mf a[8:11],a[228:231],v[128:131],a[8:11]
v_mul_f32 v147,v147,v224
v_mul_f32 v152,v152,v224
v_mul_f32 v153,v153,v224
v_mul_f32 v154,v154,v224
v_mul_f32 v155,v155,v224
mf a[12:15],a[228:231],v[132:135],a[12:15]
s_waitcnt lgkmcnt(8)
trr a[224:225],v201,24576
trr a[226:227],v201,26624
buffer_load_dwordx4 v219,s[36:39],s48 offen offset:3072 lds
v_mul_f32 v148,v148,v225
v_mul_f32 v149,v149,v225
mf a[16:19],a[232:235],v[128:131],a[16:19]
v_mul_f32 v150,v150,v225
v_mul_f32 v151,v151,v225
v_mul_f32 v156,v156,v225
v_mul_f32 v157,v157,v225
v_mul_f32 v158,v158,v225
v_mul_f32 v159,v159,v225
mf a[20:23],a[232:235],v[132:135],a[20:23]
trr a[228:229],v202,24576
trr a[230:231],v202,26624
s_add_u32 m0,s49,114688
s_add_u32 s48,s53,s98
s_add_u32 s48,s48,114688
buffer_load_dwordx4 v216,s[36:39],s48 offen lds
cvp v136,v144,v145
mf a[24:27],a[236:239],v[128:131],a[24:27]
cvp v137,v146,v147
cvp v138,v152,v153
cvp v139,v154,v155
cvp v140,v148,v149
cvp v141,v150,v151
cvp v142,v156,v157
cvp v143,v158,v159
mf a[28:31],a[236:239],v[132:135],a[28:31]
s_waitcnt lgkmcnt(8)
trr a[232:233],v203,24576
mf a[0:3],a[240:243],v[136:139],a[0:3]
trr a[234:235],v203,26624
buffer_load_dwordx4 v217,s[36:39],s48 offen offset:1024 lds
mf a[4:7],a[240:243],v[140:143],a[4:7]
trr a[236:237],v204,24576
trr a[238:239],v204,26624
buffer_load_dwordx4 v218,s[36:39],s48 offen offset:2048 lds
v_mul_f32 v160,v160,v224
v_mul_f32 v161,v161,v224
v_mul_f32 v162,v162,v224
mf a[8:11],a[244:247],v[136:139],a[8:11]
v_mul_f32 v163,v163,v224
v_mul_f32 v168,v168,v224
v_mul_f32 v169,v169,v224
v_mul_f32 v170,v170,v224
v_mul_f32 v171,v171,v224
mf a[12:15],a[244:247],v[140:143],a[12:15]
s_waitcnt lgkmcnt(8)
trr a[240:241],v201,28672
trr a[242:243],v201,30720
buffer_load_dwordx4 v219,s[36:39],s48 offen offset:3072 lds
v_mul_f32 v164,v164,v225
v_mul_f32 v165,v165,v225
mf a[16:19],a[248:251],v[136:139],a[16:19]
v_mul_f32 v166,v166,v225
v_mul_f32 v167,v167,v225
v_mul_f32 v172,v172,v225
v_mul_f32 v173,v173,v225
v_mul_f32 v174,v174,v225
v_mul_f32 v175,v175,v225
mf a[20:23],a[248:251],v[140:143],a[20:23]
trr a[244:245],v202,28672
trr a[246:247],v202,30720
cvp v144,v160,v161
cvp v145,v162,v163
cvp v146,v168,v169
mf a[24:27],a[252:255],v[136:139],a[24:27]
cvp v147,v170,v171
cvp v148,v164,v165
cvp v149,v166,v167
cvp v150,v172,v173
cvp v151,v174,v175
mf a[28:31],a[252:255],v[140:143],a[28:31]
s_waitcnt lgkmcnt(8)
trr a[248:249],v203,28672
mf a[0:3],a[224:227],v[144:147],a[0:3]
trr a[250:251],v203,30720
mf a[4:7],a[224:227],v[148:151],a[4:7]
trr a[252:253],v204,28672
trr a[254:255],v204,30720
v_mul_f32 v176,v176,v224
v_mul_f32 v177,v177,v224
v_mul_f32 v178,v178,v224
mf a[8:11],a[228:231],v[144:147],a[8:11]
v_mul_f32 v179,v179,v224
v_mul_f32 v184,v184,v224
v_mul_f32 v185,v185,v224
v_mul_f32 v186,v186,v224
v_mul_f32 v187,v187,v224
mf a[12:15],a[228:231],v[148:151],a[12:15]
s_waitcnt lgkmcnt(8)
s_waitcnt vmcnt(20)
s_barrier
trr a[224:225],v201,0
trr a[226:227],v201,2048
v_mul_f32 v180,v180,v225
v_mul_f32 v181,v181,v225
mf a[16:19],a[232:235],v[144:147],a[16:19]
v_mul_f32 v182,v182,v225
v_mul_f32 v183,v183,v225
v_mul_f32 v188,v188,v225
v_mul_f32 v189,v189,v225
v_mul_f32 v190,v190,v225
v_mul_f32 v191,v191,v225
mf a[20:23],a[232:235],v[148:151],a[20:23]
trr a[228:229],v202,0
trr a[230:231],v202,2048
cvp v152,v176,v177
cvp v153,v178,v179
cvp v154,v184,v185
mf a[24:27],a[236:239],v[144:147],a[24:27]
cvp v155,v186,v187
cvp v156,v180,v181
cvp v157,v182,v183
cvp v158,v188,v189
cvp v159,v190,v191
mf a[28:31],a[236:239],v[148:151],a[28:31]
s_waitcnt lgkmcnt(8)
trr a[232:233],v203,0
mf a[0:3],a[240:243],v[152:155],a[0:3]
trr a[234:235],v203,2048
mf a[4:7],a[240:243],v[156:159],a[4:7]
trr a[236:237],v204,0
mf a[8:11],a[244:247],v[152:155],a[8:11]
trr a[238:239],v204,2048
mf a[12:15],a[244:247],v[156:159],a[12:15]
s_waitcnt lgkmcnt(8)
trr a[240:241],v201,4096
mf a[16:19],a[248:251],v[152:155],a[16:19]
trr a[242:243],v201,6144
mf a[20:23],a[248:251],v[156:159],a[20:23]
trr a[244:245],v202,4096
mf a[24:27],a[252:255],v[152:155],a[24:27]
trr a[246:247],v202,6144
mf a[28:31],a[252:255],v[156:159],a[28:31]
s_waitcnt lgkmcnt(8)
trr a[248:249],v203,4096
mf a[32:35],a[224:227],v[128:131],a[32:35]
trr a[250:251],v203,6144
mf a[36:39],a[224:227],v[132:135],a[36:39]
trr a[252:253],v204,4096
trr a[254:255],v204,6144
s_lshl_b32 s60,s92,5
mf a[40:43],a[228:231],v[128:131],a[40:43]
ard v0,a0
ard v1,a1
ard v2,a2
mf a[44:47],a[228:231],v[132:135],a[44:47]
s_waitcnt lgkmcnt(8)
trr a[224:225],v201,8192
trr a[226:227],v201,10240
ard v3,a3
mf a[48:51],a[232:235],v[128:131],a[48:51]
ard v4,a8
ard v5,a9
ard v6,a10
mf a[52:55],a[232:235],v[132:135],a[52:55]
trr a[228:229],v202,8192
trr a[230:231],v202,10240
ard v7,a11
mf a[56:59],a[236:239],v[128:131],a[56:59]
cvp v0,v0,v1
cvp v1,v2,v3
mf a[60:63],a[236:239],v[132:135],a[60:63]
s_waitcnt lgkmcnt(8)
trr a[232:233],v203,8192
trr a[234:235],v203,10240
cvp v2,v4,v5
mf a[32:35],a[240:243],v[136:139],a[32:35]
cvp v3,v6,v7
buffer_store_dwordx4 v[0:3],v220,s[40:43],s60 offen nt
ard v8,a4
mf a[36:39],a[240:243],v[140:143],a[36:39]
trr a[236:237],v204,8192
trr a[238:239],v204,10240
ard v9,a5
mf a[40:43],a[244:247],v[136:139],a[40:43]
ard v10,a6
ard v11,a7
mf a[44:47],a[244:247],v[140:143],a[44:47]
s_waitcnt lgkmcnt(8)
trr a[240:241],v201,12288
trr a[242:243],v201,14336
ard v12,a12
mf a[48:51],a[248:251],v[136:139],a[48:51]
ard v13,a13
ard v14,a14
ard v15,a15
mf a[52:55],a[248:251],v[140:143],a[52:55]
trr a[244:245],v202,12288
trr a[246:247],v202,14336
cvp v8,v8,v9
mf a[56:59],a[252:255],v[136:139],a[56:59]
cvp v9,v10,v11
cvp v10,v12,v13
mf a[60:63],a[252:255],v[140:143],a[60:63]
s_waitcnt lgkmcnt(8)
trr a[248:249],v203,12288
trr a[250:251],v203,14336
cvp v11,v14,v15
mf a[32:35],a[224:227],v[144:147],a[32:35]
buffer_store_dwordx4 v[8:11],v221,s[40:43],s60 offen nt
ard v16,a16
ard v17,a17
mf a[36:39],a[224:227],v[148:151],a[36:39]
trr a[252:253],v204,12288
trr a[254:255],v204,14336
ard v18,a18
mf a[40:43],a[228:231],v[144:147],a[40:43]
ard v19,a19
ard v20,a24
mf a[44:47],a[228:231],v[148:151],a[44:47]
s_waitcnt lgkmcnt(8)
s_waitcnt vmcnt(18)
s_barrier
trr a[224:225],v201,32768
trr a[226:227],v201,34816
mf a[48:51],a[232:235],v[144:147],a[48:51]
ard v21,a25
ard v22,a26
ard v23,a27
cvp v16,v16,v17
mf a[52:55],a[232:235],v[148:151],a[52:55]
trr a[228:229],v202,32768
trr a[230:231],v202,34816
cvp v17,v18,v19
mf a[56:59],a[236:239],v[144:147],a[56:59]
cvp v18,v20,v21
cvp v19,v22,v23
mf a[60:63],a[236:239],v[148:151],a[60:63]
s_waitcnt lgkmcnt(8)
trr a[232:233],v203,32768
trr a[234:235],v203,34816
buffer_store_dwordx4 v[16:19],v220,s[40:43],s60 offen offset:2048 nt
mf a[32:35],a[240:243],v[152:155],a[32:35]
ard v24,a20
ard v25,a21
ard v26,a22
mf a[36:39],a[240:243],v[156:159],a[36:39]
trr a[236:237],v204,32768
trr a[238:239],v204,34816
ard v27,a23
mf a[40:43],a[244:247],v[152:155],a[40:43]
ard v28,a28
ard v29,a29
mf a[44:47],a[244:247],v[156:159],a[44:47]
s_waitcnt lgkmcnt(8)
trr a[240:241],v201,36864
trr a[242:243],v201,38912
ard v30,a30
mf a[48:51],a[248:251],v[152:155],a[48:51]
ard v31,a31
cvp v24,v24,v25
cvp v25,v26,v27
mf a[52:55],a[248:251],v[156:159],a[52:55]
trr a[244:245],v202,36864
trr a[246:247],v202,38912
cvp v26,v28,v29
mf a[56:59],a[252:255],v[152:155],a[56:59]
cvp v27,v30,v31
buffer_store_dwordx4 v[24:27],v221,s[40:43],s60 offen offset:2048 nt
mf a[60:63],a[252:255],v[156:159],a[60:63]
s_waitcnt lgkmcnt(8)
trr a[248:249],v203,36864
mf a[64:67],a[224:227],v[128:131],a[64:67]
trr a[250:251],v203,38912
mf a[68:71],a[224:227],v[132:135],a[68:71]
trr a[252:253],v204,36864
trr a[254:255],v204,38912
s_lshl_b32 s60,s93,5
mf a[72:75],a[228:231],v[128:131],a[72:75]
ard v32,a32
ard v33,a33
ard v34,a34
mf a[76:79],a[228:231],v[132:135],a[76:79]
s_waitcnt lgkmcnt(8)
trr a[224:225],v201,40960
trr a[226:227],v201,43008
ard v35,a35
mf a[80:83],a[232:235],v[128:131],a[80:83]
ard v36,a40
ard v37,a41
ard v38,a42
mf a[84:87],a[232:235],v[132:135],a[84:87]
trr a[228:229],v202,40960
trr a[230:231],v202,43008
ard v39,a43
mf a[88:91],a[236:239],v[128:131],a[88:91]
cvp v32,v32,v33
cvp v33,v34,v35
mf a[92:95],a[236:239],v[132:135],a[92:95]
s_waitcnt lgkmcnt(8)
trr a[232:233],v203,40960
trr a[234:235],v203,43008
cvp v34,v36,v37
mf a[64:67],a[240:243],v[136:139],a[64:67]
cvp v35,v38,v39
buffer_store_dwordx4 v[32:35],v220,s[40:43],s60 offen nt
ard v40,a36
mf a[68:71],a[240:243],v[140:143],a[68:71]
trr a[236:237],v204,40960
trr a[238:239],v204,43008
ard v41,a37
mf a[72:75],a[244:247],v[136:139],a[72:75]
ard v42,a38
ard v43,a39
mf a[76:79],a[244:247],v[140:143],a[76:79]
s_waitcnt lgkmcnt(8)
trr a[240:241],v201,45056
trr a[242:243],v201,47104
ard v44,a44
mf a[80:83],a[248:251],v[136:139],a[80:83]
ard v45,a45
ard v46,a46
ard v47,a47
mf a[84:87],a[248:251],v[140:143],a[84:87]
trr a[244:245],v202,45056
trr a[246:247],v202,47104
cvp v40,v40,v41
mf a[88:91],a[252:255],v[136:139],a[88:91]
cvp v41,v42,v43
cvp v42,v44,v45
mf a[92:95],a[252:255],v[140:143],a[92:95]
s_waitcnt lgkmcnt(8)
trr a[248:249],v203,45056
trr a[250:251],v203,47104
cvp v43,v46,v47
mf a[64:67],a[224:227],v[144:147],a[64:67]
buffer_store_dwordx4 v[40:43],v221,s[40:43],s60 offen nt
ard v48,a48
ard v49,a49
mf a[68:71],a[224:227],v[148:151],a[68:71]
trr a[252:253],v204,45056
trr a[254:255],v204,47104
ard v50,a50
mf a[72:75],a[228:231],v[144:147],a[72:75]
ard v51,a51
ard v52,a56
mf a[76:79],a[228:231],v[148:151],a[76:79]
s_waitcnt lgkmcnt(8)
s_waitcnt vmcnt(18)
s_barrier
trr a[224:225],v201,49152
trr a[226:227],v201,51200
mf a[80:83],a[232:235],v[144:147],a[80:83]
ard v53,a57
ard v54,a58
ard v55,a59
cvp v48,v48,v49
mf a[84:87],a[232:235],v[148:151],a[84:87]
trr a[228:229],v202,49152
trr a[230:231],v202,51200
cvp v49,v50,v51
mf a[88:91],a[236:239],v[144:147],a[88:91]
cvp v50,v52,v53
cvp v51,v54,v55
mf a[92:95],a[236:239],v[148:151],a[92:95]
s_waitcnt lgkmcnt(8)
trr a[232:233],v203,49152
trr a[234:235],v203,51200
buffer_store_dwordx4 v[48:51],v220,s[40:43],s60 offen offset:2048 nt
mf a[64:67],a[240:243],v[152:155],a[64:67]
ard v56,a52
ard v57,a53
ard v58,a54
mf a[68:71],a[240:243],v[156:159],a[68:71]
trr a[236:237],v204,49152
trr a[238:239],v204,51200
ard v59,a55
mf a[72:75],a[244:247],v[152:155],a[72:75]
ard v60,a60
ard v61,a61
mf a[76:79],a[244:247],v[156:159],a[76:79]
s_waitcnt lgkmcnt(8)
trr a[240:241],v201,53248
trr a[242:243],v201,55296
ard v62,a62
mf a[80:83],a[248:251],v[152:155],a[80:83]
ard v63,a63
cvp v56,v56,v57
cvp v57,v58,v59
mf a[84:87],a[248:251],v[156:159],a[84:87]
trr a[244:245],v202,53248
trr a[246:247],v202,55296
cvp v58,v60,v61
mf a[88:91],a[252:255],v[152:155],a[88:91]
cvp v59,v62,v63
buffer_store_dwordx4 v[56:59],v221,s[40:43],s60 offen offset:2048 nt
mf a[92:95],a[252:255],v[156:159],a[92:95]
s_waitcnt lgkmcnt(8)
trr a[248:249],v203,53248
mf a[96:99],a[224:227],v[128:131],a[96:99]
trr a[250:251],v203,55296
mf a[100:103],a[224:227],v[132:135],a[100:103]
trr a[252:253],v204,53248
trr a[254:255],v204,55296
s_lshl_b32 s60,s94,5
mf a[104:107],a[228:231],v[128:131],a[104:107]
ard v0,a64
ard v1,a65
ard v2,a66
mf a[108:111],a[228:231],v[132:135],a[108:111]
s_waitcnt lgkmcnt(8)
trr a[224:225],v201,57344
trr a[226:227],v201,59392
ard v3,a67
mf a[112:115],a[232:235],v[128:131],a[112:115]
ard v4,a72
ard v5,a73
ard v6,a74
mf a[116:119],a[232:235],v[132:135],a[116:119]
trr a[228:229],v202,57344
trr a[230:231],v202,59392
ard v7,a75
mf a[120:123],a[236:239],v[128:131],a[120:123]
cvp v0,v0,v1
cvp v1,v2,v3
mf a[124:127],a[236:239],v[132:135],a[124:127]
s_waitcnt lgkmcnt(8)
trr a[232:233],v203,57344
trr a[234:235],v203,59392
cvp v2,v4,v5
mf a[96:99],a[240:243],v[136:139],a[96:99]
cvp v3,v6,v7
buffer_store_dwordx4 v[0:3],v220,s[40:43],s60 offen nt
ard v8,a68
mf a[100:103],a[240:243],v[140:143],a[100:103]
trr a[236:237],v204,57344
trr a[238:239],v204,59392
ard v9,a69
mf a[104:107],a[244:247],v[136:139],a[104:107]
ard v10,a70
ard v11,a71
mf a[108:111],a[244:247],v[140:143],a[108:111]
s_waitcnt lgkmcnt(8)
trr a[240:241],v201,61440
trr a[242:243],v201,63488
ard v12,a76
mf a[112:115],a[248:251],v[136:139],a[112:115]
ard v13,a77
ard v14,a78
ard v15,a79
mf a[116:119],a[248:251],v[140:143],a[116:119]
trr a[244:245],v202,61440
trr a[246:247],v202,63488
cvp v8,v8,v9
mf a[120:123],a[252:255],v[136:139],a[120:123]
cvp v9,v10,v11
cvp v10,v12,v13
mf a[124:127],a[252:255],v[140:143],a[124:127]
s_waitcnt lgkmcnt(8)
trr a[248:249],v203,61440
trr a[250:251],v203,63488
cvp v11,v14,v15
mf a[96:99],a[224:227],v[144:147],a[96:99]
buffer_store_dwordx4 v[8:11],v221,s[40:43],s60 offen nt
ard v16,a80
ard v17,a81
mf a[100:103],a[224:227],v[148:151],a[100:103]
v_add_u32 v201,0x10000,v201
trr a[252:253],v204,61440
trr a[254:255],v204,63488
mf a[104:107],a[228:231],v[144:147],a[104:107]
ard v18,a82
ard v19,a83
ard v20,a88
mf a[108:111],a[228:231],v[148:151],a[108:111]
s_waitcnt lgkmcnt(8)
s_waitcnt vmcnt(18)
s_barrier
v_add_u32 v202,0x10000,v202
trr a[224:225],v201,0
mf a[112:115],a[232:235],v[144:147],a[112:115]
trr a[226:227],v201,2048
ard v21,a89
ard v22,a90
ard v23,a91
cvp v16,v16,v17
mf a[116:119],a[232:235],v[148:151],a[116:119]
v_add_u32 v203,0x10000,v203
trr a[228:229],v202,0
trr a[230:231],v202,2048
mf a[120:123],a[236:239],v[144:147],a[120:123]
cvp v17,v18,v19
cvp v18,v20,v21
cvp v19,v22,v23
mf a[124:127],a[236:239],v[148:151],a[124:127]
s_waitcnt lgkmcnt(8)
v_add_u32 v204,0x10000,v204
trr a[232:233],v203,0
trr a[234:235],v203,2048
mf a[96:99],a[240:243],v[152:155],a[96:99]
buffer_store_dwordx4 v[16:19],v220,s[40:43],s60 offen offset:2048 nt
ard v24,a84
ard v25,a85
ard v26,a86
mf a[100:103],a[240:243],v[156:159],a[100:103]
trr a[236:237],v204,0
trr a[238:239],v204,2048
ard v27,a87
mf a[104:107],a[244:247],v[152:155],a[104:107]
ard v28,a92
ard v29,a93
mf a[108:111],a[244:247],v[156:159],a[108:111]
s_waitcnt lgkmcnt(8)
trr a[240:241],v201,4096
trr a[242:243],v201,6144
ard v30,a94
mf a[112:115],a[248:251],v[152:155],a[112:115]
ard v31,a95
cvp v24,v24,v25
cvp v25,v26,v27
mf a[116:119],a[248:251],v[156:159],a[116:119]
trr a[244:245],v202,4096
trr a[246:247],v202,6144
cvp v26,v28,v29
mf a[120:123],a[252:255],v[152:155],a[120:123]
cvp v27,v30,v31
buffer_store_dwordx4 v[24:27],v221,s[40:43],s60 offen offset:2048 nt
mf a[124:127],a[252:255],v[156:159],a[124:127]
s_waitcnt lgkmcnt(8)
trr a[248:249],v203,4096
mf a[128:131],a[224:227],v[128:131],a[128:131]
trr a[250:251],v203,6144
mf a[132:135],a[224:227],v[132:135],a[132:135]
trr a[252:253],v204,4096
trr a[254:255],v204,6144
s_lshl_b32 s60,s95,5
mf a[136:139],a[228:231],v[128:131],a[136:139]
ard v32,a96
ard v33,a97
ard v34,a98
mf a[140:143],a[228:231],v[132:135],a[140:143]
s_waitcnt lgkmcnt(8)
trr a[224:225],v201,8192
trr a[226:227],v201,10240
ard v35,a99
mf a[144:147],a[232:235],v[128:131],a[144:147]
ard v36,a104
ard v37,a105
ard v38,a106
mf a[148:151],a[232:235],v[132:135],a[148:151]
trr a[228:229],v202,8192
trr a[230:231],v202,10240
ard v39,a107
mf a[152:155],a[236:239],v[128:131],a[152:155]
cvp v32,v32,v33
cvp v33,v34,v35
mf a[156:159],a[236:239],v[132:135],a[156:159]
s_waitcnt lgkmcnt(8)
trr a[232:233],v203,8192
trr a[234:235],v203,10240
cvp v34,v36,v37
mf a[128:131],a[240:243],v[136:139],a[128:131]
cvp v35,v38,v39
buffer_store_dwordx4 v[32:35],v220,s[40:43],s60 offen nt
ard v40,a100
mf a[132:135],a[240:243],v[140:143],a[132:135]
trr a[236:237],v204,8192
trr a[238:239],v204,10240
ard v41,a101
mf a[136:139],a[244:247],v[136:139],a[136:139]
ard v42,a102
ard v43,a103
mf a[140:143],a[244:247],v[140:143],a[140:143]
s_waitcnt lgkmcnt(8)
trr a[240:241],v201,12288
trr a[242:243],v201,14336
ard v44,a108
mf a[144:147],a[248:251],v[136:139],a[144:147]
ard v45,a109
ard v46,a110
ard v47,a111
mf a[148:151],a[248:251],v[140:143],a[148:151]
trr a[244:245],v202,12288
trr a[246:247],v202,14336
cvp v40,v40,v41
mf a[152:155],a[252:255],v[136:139],a[152:155]
cvp v41,v42,v43
cvp v42,v44,v45
mf a[156:159],a[252:255],v[140:143],a[156:159]
s_waitcnt lgkmcnt(8)
trr a[248:249],v203,12288
trr a[250:251],v203,14336
cvp v43,v46,v47
mf a[128:131],a[224:227],v[144:147],a[128:131]
buffer_store_dwordx4 v[40:43],v221,s[40:43],s60 offen nt
ard v48,a112
ard v49,a113
mf a[132:135],a[224:227],v[148:151],a[132:135]
trr a[252:253],v204,12288
trr a[254:255],v204,14336
ard v50,a114
mf a[136:139],a[228:231],v[144:147],a[136:139]
ard v51,a115
ard v52,a120
mf a[140:143],a[228:231],v[148:151],a[140:143]
s_waitcnt lgkmcnt(8)
s_waitcnt vmcnt(18)
s_barrier
trr a[224:225],v201,16384
trr a[226:227],v201,18432
mf a[144:147],a[232:235],v[144:147],a[144:147]
ard v53,a121
ard v54,a122
ard v55,a123
cvp v48,v48,v49
mf a[148:151],a[232:235],v[148:151],a[148:151]
trr a[228:229],v202,16384
trr a[230:231],v202,18432
cvp v49,v50,v51
mf a[152:155],a[236:239],v[144:147],a[152:155]
cvp v50,v52,v53
cvp v51,v54,v55
mf a[156:159],a[236:239],v[148:151],a[156:159]
s_waitcnt lgkmcnt(8)
trr a[232:233],v203,16384
trr a[234:235],v203,18432
buffer_store_dwordx4 v[48:51],v220,s[40:43],s60 offen offset:2048 nt
mf a[128:131],a[240:243],v[152:155],a[128:131]
ard v56,a116
ard v57,a117
ard v58,a118
mf a[132:135],a[240:243],v[156:159],a[132:135]
trr a[236:237],v204,16384
trr a[238:239],v204,18432
ard v59,a119
mf a[136:139],a[244:247],v[152:155],a[136:139]
ard v60,a124
ard v61,a125
mf a[140:143],a[244:247],v[156:159],a[140:143]
s_waitcnt lgkmcnt(8)
trr a[240:241],v201,20480
trr a[242:243],v201,22528
ard v62,a126
mf a[144:147],a[248:251],v[152:155],a[144:147]
ard v63,a127
cvp v56,v56,v57
cvp v57,v58,v59
mf a[148:151],a[248:251],v[156:159],a[148:151]
trr a[244:245],v202,20480
trr a[246:247],v202,22528
cvp v58,v60,v61
mf a[152:155],a[252:255],v[152:155],a[152:155]
cvp v59,v62,v63
buffer_store_dwordx4 v[56:59],v221,s[40:43],s60 offen offset:2048 nt
mf a[156:159],a[252:255],v[156:159],a[156:159]
s_waitcnt lgkmcnt(8)
trr a[248:249],v203,20480
mf a[160:163],a[224:227],v[128:131],a[160:163]
trr a[250:251],v203,22528
mf a[164:167],a[224:227],v[132:135],a[164:167]
trr a[252:253],v204,20480
trr a[254:255],v204,22528
s_lshl_b32 s60,s96,5
mf a[168:171],a[228:231],v[128:131],a[168:171]
ard v0,a128
ard v1,a129
ard v2,a130
mf a[172:175],a[228:231],v[132:135],a[172:175]
s_waitcnt lgkmcnt(8)
trr a[224:225],v201,24576
trr a[226:227],v201,26624
ard v3,a131
mf a[176:179],a[232:235],v[128:131],a[176:179]
ard v4,a136
ard v5,a137
ard v6,a138
mf a[180:183],a[232:235],v[132:135],a[180:183]
trr a[228:229],v202,24576
trr a[230:231],v202,26624
ard v7,a139
mf a[184:187],a[236:239],v[128:131],a[184:187]
cvp v0,v0,v1
cvp v1,v2,v3
mf a[188:191],a[236:239],v[132:135],a[188:191]
s_waitcnt lgkmcnt(8)
trr a[232:233],v203,24576
trr a[234:235],v203,26624
cvp v2,v4,v5
mf a[160:163],a[240:243],v[136:139],a[160:163]
cvp v3,v6,v7
buffer_store_dwordx4 v[0:3],v220,s[40:43],s60 offen nt
ard v8,a132
mf a[164:167],a[240:243],v[140:143],a[164:167]
trr a[236:237],v204,24576
trr a[238:239],v204,26624
ard v9,a133
mf a[168:171],a[244:247],v[136:139],a[168:171]
ard v10,a134
ard v11,a135
mf a[172:175],a[244:247],v[140:143],a[172:175]
s_waitcnt lgkmcnt(8)
trr a[240:241],v201,28672
trr a[242:243],v201,30720
ard v12,a140
mf a[176:179],a[248:251],v[136:139],a[176:179]
ard v13,a141
ard v14,a142
ard v15,a143
mf a[180:183],a[248:251],v[140:143],a[180:183]
trr a[244:245],v202,28672
trr a[246:247],v202,30720
cvp v8,v8,v9
mf a[184:187],a[252:255],v[136:139],a[184:187]
cvp v9,v10,v11
cvp v10,v12,v13
mf a[188:191],a[252:255],v[140:143],a[188:191]
s_waitcnt lgkmcnt(8)
trr a[248:249],v203,28672
trr a[250:251],v203,30720
cvp v11,v14,v15
mf a[160:163],a[224:227],v[144:147],a[160:163]
buffer_store_dwordx4 v[8:11],v221,s[40:43],s60 offen nt
ard v16,a144
ard v17,a145
mf a[164:167],a[224:227],v[148:151],a[164:167]
trr a[252:253],v204,28672
trr a[254:255],v204,30720
ard v18,a146
mf a[168:171],a[228:231],v[144:147],a[168:171]
ard v19,a147
ard v20,a152
mf a[172:175],a[228:231],v[148:151],a[172:175]
s_waitcnt lgkmcnt(8)
s_waitcnt vmcnt(18)
s_barrier
trr a[224:225],v201,49152
trr a[226:227],v201,51200
mf a[176:179],a[232:235],v[144:147],a[176:179]
ard v21,a153
ard v22,a154
ard v23,a155
cvp v16,v16,v17
mf a[180:183],a[232:235],v[148:151],a[180:183]
trr a[228:229],v202,49152
trr a[230:231],v202,51200
cvp v17,v18,v19
mf a[184:187],a[236:239],v[144:147],a[184:187]
cvp v18,v20,v21
cvp v19,v22,v23
mf a[188:191],a[236:239],v[148:151],a[188:191]
s_waitcnt lgkmcnt(8)
trr a[232:233],v203,49152
trr a[234:235],v203,51200
buffer_store_dwordx4 v[16:19],v220,s[40:43],s60 offen offset:2048 nt
mf a[160:163],a[240:243],v[152:155],a[160:163]
ard v24,a148
ard v25,a149
ard v26,a150
mf a[164:167],a[240:243],v[156:159],a[164:167]
trr a[236:237],v204,49152
trr a[238:239],v204,51200
ard v27,a151
mf a[168:171],a[244:247],v[152:155],a[168:171]
ard v28,a156
ard v29,a157
mf a[172:175],a[244:247],v[156:159],a[172:175]
s_waitcnt lgkmcnt(8)
trr a[240:241],v201,53248
trr a[242:243],v201,55296
ard v30,a158
mf a[176:179],a[248:251],v[152:155],a[176:179]
ard v31,a159
cvp v24,v24,v25
cvp v25,v26,v27
mf a[180:183],a[248:251],v[156:159],a[180:183]
trr a[244:245],v202,53248
trr a[246:247],v202,55296
cvp v26,v28,v29
mf a[184:187],a[252:255],v[152:155],a[184:187]
cvp v27,v30,v31
buffer_store_dwordx4 v[24:27],v221,s[40:43],s60 offen offset:2048 nt
mf a[188:191],a[252:255],v[156:159],a[188:191]
s_waitcnt lgkmcnt(8)
trr a[248:249],v203,53248
mf a[192:195],a[224:227],v[128:131],a[192:195]
trr a[250:251],v203,55296
mf a[196:199],a[224:227],v[132:135],a[196:199]
trr a[252:253],v204,53248
trr a[254:255],v204,55296
s_lshl_b32 s60,s97,5
mf a[200:203],a[228:231],v[128:131],a[200:203]
ard v32,a160
ard v33,a161
ard v34,a162
mf a[204:207],a[228:231],v[132:135],a[204:207]
s_waitcnt lgkmcnt(8)
trr a[224:225],v201,57344
trr a[226:227],v201,59392
ard v35,a163
mf a[208:211],a[232:235],v[128:131],a[208:211]
ard v36,a168
ard v37,a169
ard v38,a170
mf a[212:215],a[232:235],v[132:135],a[212:215]
trr a[228:229],v202,57344
trr a[230:231],v202,59392
ard v39,a171
mf a[216:219],a[236:239],v[128:131],a[216:219]
cvp v32,v32,v33
cvp v33,v34,v35
mf a[220:223],a[236:239],v[132:135],a[220:223]
s_waitcnt lgkmcnt(8)
trr a[232:233],v203,57344
trr a[234:235],v203,59392
cvp v34,v36,v37
mf a[192:195],a[240:243],v[136:139],a[192:195]
cvp v35,v38,v39
buffer_store_dwordx4 v[32:35],v220,s[40:43],s60 offen nt
ard v40,a164
mf a[196:199],a[240:243],v[140:143],a[196:199]
trr a[236:237],v204,57344
trr a[238:239],v204,59392
ard v41,a165
mf a[200:203],a[244:247],v[136:139],a[200:203]
ard v42,a166
ard v43,a167
mf a[204:207],a[244:247],v[140:143],a[204:207]
s_waitcnt lgkmcnt(8)
trr a[240:241],v201,61440
trr a[242:243],v201,63488
ard v44,a172
mf a[208:211],a[248:251],v[136:139],a[208:211]
ard v45,a173
ard v46,a174
ard v47,a175
mf a[212:215],a[248:251],v[140:143],a[212:215]
trr a[244:245],v202,61440
trr a[246:247],v202,63488
cvp v40,v40,v41
mf a[216:219],a[252:255],v[136:139],a[216:219]
cvp v41,v42,v43
cvp v42,v44,v45
mf a[220:223],a[252:255],v[140:143],a[220:223]
s_waitcnt lgkmcnt(8)
trr a[248:249],v203,61440
trr a[250:251],v203,63488
cvp v43,v46,v47
mf a[192:195],a[224:227],v[144:147],a[192:195]
buffer_store_dwordx4 v[40:43],v221,s[40:43],s60 offen nt
ard v48,a176
ard v49,a177
mf a[196:199],a[224:227],v[148:151],a[196:199]
trr a[252:253],v204,61440
trr a[254:255],v204,63488
ard v50,a178
mf a[200:203],a[228:231],v[144:147],a[200:203]
ard v51,a179
ard v52,a184
mf a[204:207],a[228:231],v[148:151],a[204:207]
s_waitcnt lgkmcnt(8)
s_barrier
ard v53,a185
mf a[208:211],a[232:235],v[144:147],a[208:211]
ard v54,a186
ard v55,a187
cvp v48,v48,v49
mf a[212:215],a[232:235],v[148:151],a[212:215]
cvp v49,v50,v51
cvp v50,v52,v53
mf a[216:219],a[236:239],v[144:147],a[216:219]
cvp v51,v54,v55
mf a[220:223],a[236:239],v[148:151],a[220:223]
s_waitcnt lgkmcnt(4)
buffer_store_dwordx4 v[48:51],v220,s[40:43],s60 offen offset:2048 nt
ard v56,a180
mf a[192:195],a[240:243],v[152:155],a[192:195]
ard v57,a181
ard v58,a182
mf a[196:199],a[240:243],v[156:159],a[196:199]
ard v59,a183
ard v60,a188
mf a[200:203],a[244:247],v[152:155],a[200:203]
ard v61,a189
mf a[204:207],a[244:247],v[156:159],a[204:207]
s_waitcnt lgkmcnt(0)
ard v62,a190
ard v63,a191
mf a[208:211],a[248:251],v[152:155],a[208:211]
cvp v56,v56,v57
cvp v57,v58,v59
mf a[212:215],a[248:251],v[156:159],a[212:215]
cvp v58,v60,v61
cvp v59,v62,v63
mf a[216:219],a[252:255],v[152:155],a[216:219]
buffer_store_dwordx4 v[56:59],v221,s[40:43],s60 offen offset:2048 nt
mf a[220:223],a[252:255],v[156:159],a[220:223]
s_lshl_b32 s60,s98,5
ard v0,a192
ard v1,a193
ard v2,a194
ard v3,a195
ard v4,a200
ard v5,a201
ard v6,a202
ard v7,a203
cvp v0,v0,v1
cvp v1,v2,v3
cvp v2,v4,v5
cvp v3,v6,v7
buffer_store_dwordx4 v[0:3],v220,s[40:43],s60 offen nt
ard v8,a196
ard v9,a197
ard v10,a198
ard v11,a199
ard v12,a204
ard v13,a205
ard v14,a206
ard v15,a207
cvp v8,v8,v9
cvp v9,v10,v11
cvp v10,v12,v13
cvp v11,v14,v15
buffer_store_dwordx4 v[8:11],v221,s[40:43],s60 offen nt
ard v16,a208
ard v17,a209
ard v18,a210
ard v19,a211
ard v20,a216
ard v21,a217
ard v22,a218
ard v23,a219
cvp v16,v16,v17
cvp v17,v18,v19
cvp v18,v20,v21
cvp v19,v22,v23
buffer_store_dwordx4 v[16:19],v220,s[40:43],s60 offen offset:2048 nt
ard v24,a212
ard v25,a213
ard v26,a214
ard v27,a215
ard v28,a220
ard v29,a221
ard v30,a222
ard v31,a223
cvp v24,v24,v25
cvp v25,v26,v27
cvp v26,v28,v29
cvp v27,v30,v31
buffer_store_dwordx4 v[24:27],v221,s[40:43],s60 offen offset:2048 nt
s_getpc_b64 s[54:55]
L_k2pf_sf:
s_add_u32 s54,s54,mha_reduce_kernel-L_k2pf_sf
s_addc_u32 s55,s55,0
v_lshlrev_b32 v0,6,v192
v_min_u32 v0,K2_LAST,v0
global_load_dword v1,v0,s[54:55]
s_endpgm
L_code_end:
.set K2_LAST,L_k2_end-mha_reduce_kernel-4
.globl mha_reduce_kernel
.p2align 8
.type mha_reduce_kernel,@function
mha_reduce_kernel:
s_cmp_ge_u32 s2,224
s_cbranch_scc1 L_exit2
s_load_dwordx2 s[4:5],s[0:1],40
s_load_dwordx2 s[6:7],s[0:1],56
v_lshrrev_b32 v1,6,v0
s_nop 0
v_readfirstlane_b32 s3,v1
v_and_b32 v0,63,v0
s_mul_i32 s8,s2,7
s_nop 1
s_add_u32 s8,s8,s3
s_mul_i32 s9,s8,10700
s_lshr_b32 s9,s9,20
s_mul_i32 s10,s9,98
s_sub_u32 s10,s8,s10
s_mul_i32 s25,s10,4682
s_lshr_b32 s25,s25,16
s_mul_i32 s12,s25,14
s_sub_u32 s12,s10,s12
s_lshr_b32 s11,s25,1
s_mul_i32 s11,s11,28
s_lshl_b32 s13,s12,1
s_add_u32 s11,s11,s13
s_and_b32 s13,s25,1
s_add_u32 s11,s11,s13
s_mul_i32 s13,s9,1835008
s_lshl_b32 s14,s11,10
s_add_u32 s13,s13,s14
v_lshlrev_b32 v1,4,v0
s_mov_b32 s18,1721344
s_mov_b32 s19,0x20000
s_waitcnt lgkmcnt(0)
s_add_u32 s16,s6,s13
s_addc_u32 s17,s7,0
s_mov_b32 s15,0
buffer_load_dwordx4 v[16:19],v1,s[16:19],s15 offen nt
s_mov_b32 s15,114688
buffer_load_dwordx4 v[20:23],v1,s[16:19],s15 offen nt
s_mov_b32 s15,229376
buffer_load_dwordx4 v[24:27],v1,s[16:19],s15 offen nt
s_mov_b32 s15,344064
buffer_load_dwordx4 v[28:31],v1,s[16:19],s15 offen nt
s_mov_b32 s15,458752
buffer_load_dwordx4 v[32:35],v1,s[16:19],s15 offen nt
s_mov_b32 s15,573440
buffer_load_dwordx4 v[36:39],v1,s[16:19],s15 offen nt
s_mov_b32 s15,688128
buffer_load_dwordx4 v[40:43],v1,s[16:19],s15 offen nt
s_mov_b32 s15,802816
buffer_load_dwordx4 v[44:47],v1,s[16:19],s15 offen nt
s_mov_b32 s15,917504
buffer_load_dwordx4 v[48:51],v1,s[16:19],s15 offen nt
s_mov_b32 s15,1032192
buffer_load_dwordx4 v[52:55],v1,s[16:19],s15 offen nt
s_mov_b32 s15,1146880
buffer_load_dwordx4 v[56:59],v1,s[16:19],s15 offen nt
s_mov_b32 s15,1261568
buffer_load_dwordx4 v[60:63],v1,s[16:19],s15 offen nt
s_mov_b32 s15,1376256
buffer_load_dwordx4 v[64:67],v1,s[16:19],s15 offen nt
s_mov_b32 s15,1490944
buffer_load_dwordx4 v[68:71],v1,s[16:19],s15 offen nt
s_mov_b32 s15,1605632
buffer_load_dwordx4 v[72:75],v1,s[16:19],s15 offen nt
s_mov_b32 s15,1720320
buffer_load_dwordx4 v[76:79],v1,s[16:19],s15 offen nt
s_mov_b32 s20,s4
s_mov_b32 s21,s5
s_mov_b32 s22,1605632
s_mov_b32 s23,0x20000
v_and_b32 v2,15,v0
s_lshl_b32 s14,s25,4
s_mul_i32 s26,s9,112
s_add_u32 s14,s14,s26
v_add_u32 v2,s14,v2
v_mul_u32_u24 v2,896,v2
v_lshrrev_b32 v3,4,v0
v_lshl_add_u32 v2,v3,4,v2
s_lshl_b32 s14,s12,6
v_add_u32 v2,s14,v2
v_mov_b32 v4,0x3f80
v_mov_b32 v5,0x3f800000
v_mov_b32 v8,0
v_mov_b32 v9,0
v_mov_b32 v10,0
v_mov_b32 v11,0
v_mov_b32 v12,0
v_mov_b32 v13,0
v_mov_b32 v14,0
v_mov_b32 v15,0
s_waitcnt vmcnt(15)
v_dot2_f32_bf16 v8,v16,v4,v8
v_dot2_f32_bf16 v9,v16,v5,v9
v_dot2_f32_bf16 v10,v17,v4,v10
v_dot2_f32_bf16 v11,v17,v5,v11
v_dot2_f32_bf16 v12,v18,v4,v12
v_dot2_f32_bf16 v13,v18,v5,v13
v_dot2_f32_bf16 v14,v19,v4,v14
v_dot2_f32_bf16 v15,v19,v5,v15
s_waitcnt vmcnt(14)
v_dot2_f32_bf16 v8,v20,v4,v8
v_dot2_f32_bf16 v9,v20,v5,v9
v_dot2_f32_bf16 v10,v21,v4,v10
v_dot2_f32_bf16 v11,v21,v5,v11
v_dot2_f32_bf16 v12,v22,v4,v12
v_dot2_f32_bf16 v13,v22,v5,v13
v_dot2_f32_bf16 v14,v23,v4,v14
v_dot2_f32_bf16 v15,v23,v5,v15
s_waitcnt vmcnt(13)
v_dot2_f32_bf16 v8,v24,v4,v8
v_dot2_f32_bf16 v9,v24,v5,v9
v_dot2_f32_bf16 v10,v25,v4,v10
v_dot2_f32_bf16 v11,v25,v5,v11
v_dot2_f32_bf16 v12,v26,v4,v12
v_dot2_f32_bf16 v13,v26,v5,v13
v_dot2_f32_bf16 v14,v27,v4,v14
v_dot2_f32_bf16 v15,v27,v5,v15
s_waitcnt vmcnt(12)
v_dot2_f32_bf16 v8,v28,v4,v8
v_dot2_f32_bf16 v9,v28,v5,v9
v_dot2_f32_bf16 v10,v29,v4,v10
v_dot2_f32_bf16 v11,v29,v5,v11
v_dot2_f32_bf16 v12,v30,v4,v12
v_dot2_f32_bf16 v13,v30,v5,v13
v_dot2_f32_bf16 v14,v31,v4,v14
v_dot2_f32_bf16 v15,v31,v5,v15
s_waitcnt vmcnt(11)
v_dot2_f32_bf16 v8,v32,v4,v8
v_dot2_f32_bf16 v9,v32,v5,v9
v_dot2_f32_bf16 v10,v33,v4,v10
v_dot2_f32_bf16 v11,v33,v5,v11
v_dot2_f32_bf16 v12,v34,v4,v12
v_dot2_f32_bf16 v13,v34,v5,v13
v_dot2_f32_bf16 v14,v35,v4,v14
v_dot2_f32_bf16 v15,v35,v5,v15
s_waitcnt vmcnt(10)
v_dot2_f32_bf16 v8,v36,v4,v8
v_dot2_f32_bf16 v9,v36,v5,v9
v_dot2_f32_bf16 v10,v37,v4,v10
v_dot2_f32_bf16 v11,v37,v5,v11
v_dot2_f32_bf16 v12,v38,v4,v12
v_dot2_f32_bf16 v13,v38,v5,v13
v_dot2_f32_bf16 v14,v39,v4,v14
v_dot2_f32_bf16 v15,v39,v5,v15
s_waitcnt vmcnt(9)
v_dot2_f32_bf16 v8,v40,v4,v8
v_dot2_f32_bf16 v9,v40,v5,v9
v_dot2_f32_bf16 v10,v41,v4,v10
v_dot2_f32_bf16 v11,v41,v5,v11
v_dot2_f32_bf16 v12,v42,v4,v12
v_dot2_f32_bf16 v13,v42,v5,v13
v_dot2_f32_bf16 v14,v43,v4,v14
v_dot2_f32_bf16 v15,v43,v5,v15
s_waitcnt vmcnt(8)
v_dot2_f32_bf16 v8,v44,v4,v8
v_dot2_f32_bf16 v9,v44,v5,v9
v_dot2_f32_bf16 v10,v45,v4,v10
v_dot2_f32_bf16 v11,v45,v5,v11
v_dot2_f32_bf16 v12,v46,v4,v12
v_dot2_f32_bf16 v13,v46,v5,v13
v_dot2_f32_bf16 v14,v47,v4,v14
v_dot2_f32_bf16 v15,v47,v5,v15
s_waitcnt vmcnt(7)
v_dot2_f32_bf16 v8,v48,v4,v8
v_dot2_f32_bf16 v9,v48,v5,v9
v_dot2_f32_bf16 v10,v49,v4,v10
v_dot2_f32_bf16 v11,v49,v5,v11
v_dot2_f32_bf16 v12,v50,v4,v12
v_dot2_f32_bf16 v13,v50,v5,v13
v_dot2_f32_bf16 v14,v51,v4,v14
v_dot2_f32_bf16 v15,v51,v5,v15
s_waitcnt vmcnt(6)
v_dot2_f32_bf16 v8,v52,v4,v8
v_dot2_f32_bf16 v9,v52,v5,v9
v_dot2_f32_bf16 v10,v53,v4,v10
v_dot2_f32_bf16 v11,v53,v5,v11
v_dot2_f32_bf16 v12,v54,v4,v12
v_dot2_f32_bf16 v13,v54,v5,v13
v_dot2_f32_bf16 v14,v55,v4,v14
v_dot2_f32_bf16 v15,v55,v5,v15
s_waitcnt vmcnt(5)
v_dot2_f32_bf16 v8,v56,v4,v8
v_dot2_f32_bf16 v9,v56,v5,v9
v_dot2_f32_bf16 v10,v57,v4,v10
v_dot2_f32_bf16 v11,v57,v5,v11
v_dot2_f32_bf16 v12,v58,v4,v12
v_dot2_f32_bf16 v13,v58,v5,v13
v_dot2_f32_bf16 v14,v59,v4,v14
v_dot2_f32_bf16 v15,v59,v5,v15
s_waitcnt vmcnt(4)
v_dot2_f32_bf16 v8,v60,v4,v8
v_dot2_f32_bf16 v9,v60,v5,v9
v_dot2_f32_bf16 v10,v61,v4,v10
v_dot2_f32_bf16 v11,v61,v5,v11
v_dot2_f32_bf16 v12,v62,v4,v12
v_dot2_f32_bf16 v13,v62,v5,v13
v_dot2_f32_bf16 v14,v63,v4,v14
v_dot2_f32_bf16 v15,v63,v5,v15
s_waitcnt vmcnt(3)
v_dot2_f32_bf16 v8,v64,v4,v8
v_dot2_f32_bf16 v9,v64,v5,v9
v_dot2_f32_bf16 v10,v65,v4,v10
v_dot2_f32_bf16 v11,v65,v5,v11
v_dot2_f32_bf16 v12,v66,v4,v12
v_dot2_f32_bf16 v13,v66,v5,v13
v_dot2_f32_bf16 v14,v67,v4,v14
v_dot2_f32_bf16 v15,v67,v5,v15
s_waitcnt vmcnt(2)
v_dot2_f32_bf16 v8,v68,v4,v8
v_dot2_f32_bf16 v9,v68,v5,v9
v_dot2_f32_bf16 v10,v69,v4,v10
v_dot2_f32_bf16 v11,v69,v5,v11
v_dot2_f32_bf16 v12,v70,v4,v12
v_dot2_f32_bf16 v13,v70,v5,v13
v_dot2_f32_bf16 v14,v71,v4,v14
v_dot2_f32_bf16 v15,v71,v5,v15
s_waitcnt vmcnt(1)
v_dot2_f32_bf16 v8,v72,v4,v8
v_dot2_f32_bf16 v9,v72,v5,v9
v_dot2_f32_bf16 v10,v73,v4,v10
v_dot2_f32_bf16 v11,v73,v5,v11
v_dot2_f32_bf16 v12,v74,v4,v12
v_dot2_f32_bf16 v13,v74,v5,v13
v_dot2_f32_bf16 v14,v75,v4,v14
v_dot2_f32_bf16 v15,v75,v5,v15
s_waitcnt vmcnt(0)
v_dot2_f32_bf16 v8,v76,v4,v8
v_dot2_f32_bf16 v9,v76,v5,v9
v_dot2_f32_bf16 v10,v77,v4,v10
v_dot2_f32_bf16 v11,v77,v5,v11
v_dot2_f32_bf16 v12,v78,v4,v12
v_dot2_f32_bf16 v13,v78,v5,v13
v_dot2_f32_bf16 v14,v79,v4,v14
v_dot2_f32_bf16 v15,v79,v5,v15
s_nop 2
v_cvt_pk_bf16_f32 v16,v8,v9
v_cvt_pk_bf16_f32 v17,v10,v11
v_cvt_pk_bf16_f32 v18,v12,v13
v_cvt_pk_bf16_f32 v19,v14,v15
s_nop 0
v_permlane32_swap_b32 v16,v18
v_permlane32_swap_b32 v17,v19
s_nop 0
v_permlane16_swap_b32 v16,v18
v_permlane16_swap_b32 v17,v19
s_nop 1
buffer_store_dwordx4 v[16:19],v2,s[20:23],0 offen
L_exit2:
s_endpgm
L_k2_end:
.section .rodata,"a"
.p2align 6
.amdhsa_kernel standalone__mha_block_cached__near_ridge_kernel
  .amdhsa_next_free_vgpr 512
  .amdhsa_next_free_sgpr 102
  .amdhsa_accum_offset 256
  .amdhsa_group_segment_fixed_size 0
  .amdhsa_kernarg_size 64
  .amdhsa_user_sgpr_count 2
  .amdhsa_user_sgpr_kernarg_segment_ptr 1
  .amdhsa_system_sgpr_workgroup_id_x 1
  .amdhsa_float_denorm_mode_32 3
.end_amdhsa_kernel
.p2align 6
.amdhsa_kernel mha_reduce_kernel
  .amdhsa_next_free_vgpr 80
  .amdhsa_next_free_sgpr 102
  .amdhsa_accum_offset 80
  .amdhsa_group_segment_fixed_size 0
  .amdhsa_kernarg_size 64
  .amdhsa_user_sgpr_count 2
  .amdhsa_user_sgpr_kernarg_segment_ptr 1
  .amdhsa_system_sgpr_workgroup_id_x 1
  .amdhsa_float_denorm_mode_32 3
.end_amdhsa_kernel
```
